```python
import torch

def _softmax(x, axis=-1):
    return torch.softmax(x, dim=axis)

def _gelu(x):
    return torch.nn.functional.gelu(x, approximate='tanh')

def _silu(x):
    return torch.nn.functional.silu(x)

def _sigmoid(x):
    return torch.sigmoid(x)

def _layernorm(x, axis=-1, eps=1e-05):
    m = x.mean(dim=axis, keepdim=True)
    v = x.var(dim=axis, keepdim=True, unbiased=False)
    return (x - m) / torch.sqrt(v + eps)

def _scatter_add(tgt, idx, src, axis=0):
    return tgt.clone().index_add_(axis, idx, src)

def _segment_sum(src, seg, n):
    out = torch.zeros((n,) + src.shape[1:], dtype=src.dtype)
    return out.index_add_(0, seg, src)

def _pad(x, pw):
    flat = tuple((v for pair in reversed(pw) for v in pair))
    return torch.nn.functional.pad(x, flat)
kernel_name = 'adaLN_cond__grouped_kv_mqa__mixer_gmlp__prompt'

def setup_inputs():

    _w = lambda a: (lambda t: t.to(torch.bfloat16) if t.is_floating_point() else t)(torch.as_tensor(a))

    def _A_setup():
        B, S, D, H = (1, 2048, 576, 32)
        Dh = D // H
        return {'x': _w((lambda *s: torch.randn(*s, dtype=torch.bfloat16) * 0.05)(B, S, D)), 'wq': _w((lambda *s: torch.randn(*s, dtype=torch.bfloat16) * 0.05)(D, H * Dh)), 'wk': _w((lambda *s: torch.randn(*s, dtype=torch.bfloat16) * 0.05)(D, Dh)), 'wv': _w((lambda *s: torch.randn(*s, dtype=torch.bfloat16) * 0.05)(D, Dh)), 'wo': _w((lambda *s: torch.randn(*s, dtype=torch.bfloat16) * 0.05)(H * Dh, D))}
    _A_in = _A_setup()

    def _B_setup():
        B, S, D, F = (1, 2048, 576, 4608)
        Fh = F // 2
        return {'x': _w((lambda *s: torch.randn(*s, dtype=torch.bfloat16) * 0.05)(B, S, D)), 'w_in': _w((lambda *s: torch.randn(*s, dtype=torch.bfloat16) * 0.2)(D, 2 * Fh)), 'w_sp': _w(0.01 * (lambda *s: torch.randn(*s, dtype=torch.bfloat16) * 0.2)(S, S)), 'b_sp': _w(1.0 + 0.01 * (lambda *s: torch.randn(*s, dtype=torch.bfloat16) * 0.05)(S)), 'w_out': _w((lambda *s: torch.randn(*s, dtype=torch.bfloat16) * 0.05)(Fh, D))}
    _B_in = _B_setup()
    return {'A_x': _A_in['x'], 'A_wq': _A_in['wq'], 'A_wk': _A_in['wk'], 'A_wv': _A_in['wv'], 'A_wo': _A_in['wo'], 'B_x': _B_in['x'], 'B_w_in': _B_in['w_in'], 'B_w_sp': _B_in['w_sp'], 'B_b_sp': _B_in['b_sp'], 'B_w_out': _B_in['w_out'], 'c': _w((lambda *s: torch.randn(*s, dtype=torch.bfloat16) * 0.1)(1, 576) * 8.0), 'w_mod': _w((lambda *s: torch.randn(*s, dtype=torch.bfloat16) * 0.1)(576, 6 * 576) * 576 ** (-0.5) * 8.0)}

def reference(A_x, A_wq, A_wk, A_wv, A_wo, B_x, B_w_in, B_w_sp, B_b_sp, B_w_out, c, w_mod):

    def _A_ref(x, wq, wk, wv, wo):
        B, S, D = x.shape
        H = 32
        Dh = D // H
        q = (lambda x, *d: x.permute(*d))((x @ wq).reshape(B, S, H, Dh), 0, 2, 1, 3)
        k = x @ wk
        v = x @ wv
        scores = torch.einsum('bhqd,bkd->bhqk', q, k) * Dh ** (-0.5)
        p = _softmax(scores, axis=-1)
        o = torch.einsum('bhqk,bkd->bhqd', p, v)
        return (lambda x, *d: x.permute(*d))(o, 0, 2, 1, 3).reshape(B, S, H * Dh) @ wo

    def _B_ref(x, w_in, w_sp, b_sp, w_out):
        B, S, D = x.shape
        F = w_in.shape[-1]
        Fh = F // 2
        z = _gelu(torch.einsum('bsd,df->bsf', x, w_in))
        z1 = z[..., :Fh].clone()
        z2 = _layernorm(z[..., Fh:], axis=-1)
        g = torch.einsum('ts,bsf->btf', w_sp, z2) + b_sp[None, :, None]
        return torch.einsum('bsf,fd->bsd', z1 * g, w_out)
    x = A_x
    mod = (_silu(c) @ w_mod).reshape(c.shape[0], 6, 1, -1)
    sa, ca, ga, sb, cb, gb = (mod[:, 0].clone(), mod[:, 1].clone(), mod[:, 2].clone(), mod[:, 3].clone(), mod[:, 4].clone(), mod[:, 5].clone())
    h = _layernorm(x, axis=-1) * (1 + ca) + sa
    x = x + ga * _A_ref(h, A_wq, A_wk, A_wv, A_wo)
    h = _layernorm(x, axis=-1) * (1 + cb) + sb
    x = x + gb * _B_ref(h, B_w_in, B_w_sp, B_b_sp, B_w_out)
    return x
```

```asm
; @launch kernel=k1_prep_kernel grid=(392,1,1) block=(256,1,1) lds=24576
; @launch kernel=kf_front_kernel grid=(256,1,1) block=(768,1,1) lds=163840
; @launch kernel=kt_tail_kernel grid=(256,1,1) block=(256,1,1) lds=163840
.amdgcn_target "amdgcn-amd-amdhsa--gfx950"
.text
.globl k1_prep_kernel
.p2align 8
.type k1_prep_kernel,@function
k1_prep_kernel:
  s_cmp_ge_u32 s2, 392
  s_cbranch_scc1 k1_prep_kernel_end
  s_load_dwordx8 s[8:15], s[0:1], 0
  s_load_dwordx4 s[16:19], s[0:1], 80
  s_load_dwordx4 s[44:47], s[0:1], 104
  v_lshrrev_b32 v1, 6, v0
  s_nop 0
  v_readfirstlane_b32 s3, v1
  v_and_b32 v1, 63, v0
  s_cmp_ge_u32 s2, 352
  s_cbranch_scc1 k1_prep_kernel_wq
  s_cmp_ge_u32 s2, 224
  s_cbranch_scc1 k1_prep_kernel_xn
  s_cmp_ge_u32 s2, 216
  s_cbranch_scc1 k1_prep_kernel_zero
  s_and_b32 s4, s2, 7
  s_mul_i32 s4, s4, 27
  s_lshr_b32 s5, s2, 3
  s_add_u32 s4, s4, s5
  v_lshrrev_b32 v4, 1, v1
  v_mul_u32_u24 v4, 6912, v4
  v_and_b32 v5, 1, v1
  v_lshl_add_u32 v4, v5, 4, v4
  v_lshlrev_b32 v3, 2, v0
  s_mul_i32 s36, s3, 221184
  s_lshl_b32 s7, s4, 5
  s_add_u32 s36, s36, s7
  s_lshl_b32 s6, s3, 10
  s_waitcnt lgkmcnt(0)
  s_mov_b32 s28, s16
  s_and_b32 s29, s17, 0xffff
  s_mov_b32 s30, 1152
  s_mov_b32 s31, 0x20000
  s_mov_b32 s24, s18
  s_and_b32 s25, s19, 0xffff
  s_mov_b32 s26, 3981312
  s_mov_b32 s27, 0x20000
  buffer_load_dword v8, v3, s[28:31], 0 offen
  buffer_load_dword v9, v3, s[28:31], 0 offen offset:1024
  s_add_u32 m0, s6, 0
  s_add_u32 s37, s36, 0
  buffer_load_dwordx4 v4, s[24:27], s37 offen lds
  s_add_u32 m0, s6, 4096
  s_add_u32 s37, s36, 884736
  buffer_load_dwordx4 v4, s[24:27], s37 offen lds
  s_add_u32 m0, s6, 8192
  s_add_u32 s37, s36, 1769472
  buffer_load_dwordx4 v4, s[24:27], s37 offen lds
  s_add_u32 m0, s6, 12288
  s_add_u32 s37, s36, 2654208
  buffer_load_dwordx4 v4, s[24:27], s37 offen lds
  s_add_u32 m0, s6, 16384
  s_add_u32 s37, s36, 3538944
  buffer_load_dwordx4 v4, s[24:27], s37 offen lds
  s_add_u32 s32, s46, 0
  s_addc_u32 s33, s47, 0
  s_and_b32 s33, s33, 0xffff
  s_mov_b32 s34, 13824
  s_mov_b32 s35, 0x20000
  v_lshrrev_b32 v5, 4, v1
  v_lshlrev_b32 v6, 4, v5
  s_lshl_b32 s7, s3, 6
  s_add_u32 s7, s7, 20480
  v_add_u32 v6, s7, v6
  v_lshlrev_b32 v5, 8, v5
  v_bfe_u32 v7, v1, 2, 2
  v_lshl_add_u32 v5, v7, 5, v5
  v_and_b32 v7, 3, v1
  v_lshl_add_u32 v5, v7, 3, v5
  v_add_u32 v5, s6, v5
  s_mul_i32 s7, s4, 57
  s_lshr_b32 s7, s7, 11
  s_cmp_eq_u32 s7, 1
  s_cselect_b32 s22, 1.0, 0
  s_cmp_eq_u32 s7, 4
  s_cselect_b32 s22, 1.0, s22
  s_lshl_b32 s4, s4, 6
  s_waitcnt vmcnt(5)
  v_lshlrev_b32 v10, 16, v8
  v_and_b32 v11, 0xffff0000, v8
  v_lshlrev_b32 v12, 16, v9
  v_and_b32 v13, 0xffff0000, v9
  v_mul_f32 v14, 0xbfb8aa3b, v10
  v_mul_f32 v15, 0xbfb8aa3b, v11
  v_mul_f32 v16, 0xbfb8aa3b, v12
  v_mul_f32 v17, 0xbfb8aa3b, v13
  v_exp_f32 v14, v14
  v_exp_f32 v15, v15
  v_exp_f32 v16, v16
  v_exp_f32 v17, v17
  v_add_f32 v14, 1.0, v14
  v_add_f32 v15, 1.0, v15
  v_add_f32 v16, 1.0, v16
  v_add_f32 v17, 1.0, v17
  v_rcp_f32 v14, v14
  v_rcp_f32 v15, v15
  v_rcp_f32 v16, v16
  v_rcp_f32 v17, v17
  v_mul_f32 v10, v10, v14
  v_mul_f32 v11, v11, v15
  v_mul_f32 v12, v12, v16
  v_mul_f32 v13, v13, v17
  v_cvt_pk_bf16_f32 v8, v10, v11
  v_cvt_pk_bf16_f32 v9, v12, v13
  ds_write_b32 v3, v8 offset:20480
  ds_write_b32 v3, v9 offset:21504
  s_waitcnt lgkmcnt(0)
  s_barrier
  ds_read_b128 v[24:27], v6 offset:0
  ds_read_b128 v[32:35], v6 offset:256
  ds_read_b128 v[40:43], v6 offset:512
  ds_read_b128 v[48:51], v6 offset:768
  ds_read_b128 v[56:59], v6 offset:1024
  s_waitcnt vmcnt(0)
  ds_read_b64_tr_b16 v[28:29], v5 offset:0
  ds_read_b64_tr_b16 v[30:31], v5 offset:128
  ds_read_b64_tr_b16 v[36:37], v5 offset:4096
  ds_read_b64_tr_b16 v[38:39], v5 offset:4224
  ds_read_b64_tr_b16 v[44:45], v5 offset:8192
  ds_read_b64_tr_b16 v[46:47], v5 offset:8320
  ds_read_b64_tr_b16 v[52:53], v5 offset:12288
  ds_read_b64_tr_b16 v[54:55], v5 offset:12416
  ds_read_b64_tr_b16 v[60:61], v5 offset:16384
  ds_read_b64_tr_b16 v[62:63], v5 offset:16512
  s_waitcnt lgkmcnt(8)
  v_mfma_f32_16x16x32_bf16 v[20:23], v[24:27], v[28:31], 0
  s_waitcnt lgkmcnt(6)
  v_mfma_f32_16x16x32_bf16 v[20:23], v[32:35], v[36:39], v[20:23]
  s_waitcnt lgkmcnt(4)
  v_mfma_f32_16x16x32_bf16 v[20:23], v[40:43], v[44:47], v[20:23]
  s_waitcnt lgkmcnt(2)
  v_mfma_f32_16x16x32_bf16 v[20:23], v[48:51], v[52:55], v[20:23]
  s_waitcnt lgkmcnt(0)
  v_mfma_f32_16x16x32_bf16 v[20:23], v[56:59], v[60:63], v[20:23]
  v_lshlrev_b32 v7, 2, v1
  s_nop 6
  ds_write_b32 v3, v20 offset:22528
  s_waitcnt lgkmcnt(0)
  s_barrier
  s_cmp_lg_u32 s3, 0
  s_cbranch_scc1 k1_prep_kernel_end
  ds_read2st64_b32 v[8:9], v7 offset0:88 offset1:89
  ds_read2st64_b32 v[10:11], v7 offset0:90 offset1:91
  s_waitcnt lgkmcnt(0)
  v_pk_add_f32 v[8:9], v[8:9], v[10:11]
  v_add_f32 v8, v8, v9
  v_cvt_pk_bf16_f32 v8, v8, v8
  v_and_b32 v8, 0xffff0000, v8
  v_add_f32 v8, s22, v8
  v_cvt_pk_bf16_f32 v8, v8, v8
  v_and_b32 v8, 0xffff0000, v8
  s_mov_b64 exec, 0xffff
  buffer_store_dword v8, v7, s[32:35], s4 offen
  s_endpgm
k1_prep_kernel_zero:
  s_waitcnt lgkmcnt(0)
  s_add_u32 s24, s46, 3112960
  s_addc_u32 s25, s47, 0
  s_and_b32 s25, s25, 0xffff
  s_mov_b32 s26, 151552
  s_mov_b32 s27, 0x20000
  s_sub_u32 s4, s2, 216
  s_mul_i32 s4, s4, 20480
  v_lshlrev_b32 v2, 4, v0
  v_mov_b32 v4, -1
  v_mov_b32 v5, -1
  v_mov_b32 v6, -1
  v_mov_b32 v7, -1
  buffer_store_dwordx4 v[4:7], v2, s[24:27], s4 offen
  s_add_u32 s4, s4, 4096
  buffer_store_dwordx4 v[4:7], v2, s[24:27], s4 offen
  s_add_u32 s4, s4, 4096
  buffer_store_dwordx4 v[4:7], v2, s[24:27], s4 offen
  s_add_u32 s4, s4, 4096
  buffer_store_dwordx4 v[4:7], v2, s[24:27], s4 offen
  s_add_u32 s4, s4, 4096
  buffer_store_dwordx4 v[4:7], v2, s[24:27], s4 offen
  s_add_u32 s4, s4, 4096
  s_endpgm
k1_prep_kernel_xn:
  s_sub_u32 s4, s2, 224
  s_lshr_b32 s4, s4, 3
  s_and_b32 s5, s2, 7
  s_lshl_b32 s5, s5, 4
  s_add_u32 s4, s4, s5
  s_mul_i32 s36, s4, 18432
  v_lshrrev_b32 v2, 4, v1
  s_lshl_b32 s5, s3, 2
  v_add_u32 v2, s5, v2
  v_and_b32 v3, 15, v1
  v_mul_u32_u24 v4, 1152, v2
  v_lshl_add_u32 v4, v3, 3, v4
  s_waitcnt lgkmcnt(0)
  s_mov_b32 s24, s8
  s_and_b32 s25, s9, 0xffff
  s_mov_b32 s26, 2359296
  s_mov_b32 s27, 0x20000
  buffer_load_dwordx2 v[8:9], v4, s[24:27], s36 offen offset:0
  buffer_load_dwordx2 v[10:11], v4, s[24:27], s36 offen offset:128
  buffer_load_dwordx2 v[12:13], v4, s[24:27], s36 offen offset:256
  buffer_load_dwordx2 v[14:15], v4, s[24:27], s36 offen offset:384
  buffer_load_dwordx2 v[16:17], v4, s[24:27], s36 offen offset:512
  buffer_load_dwordx2 v[18:19], v4, s[24:27], s36 offen offset:640
  buffer_load_dwordx2 v[20:21], v4, s[24:27], s36 offen offset:768
  buffer_load_dwordx2 v[22:23], v4, s[24:27], s36 offen offset:896
  buffer_load_dwordx2 v[24:25], v4, s[24:27], s36 offen offset:1024
  s_add_u32 s28, s46, 16384
  s_addc_u32 s29, s47, 0
  s_and_b32 s29, s29, 0xffff
  s_mov_b32 s30, 2359296
  s_mov_b32 s31, 0x20000
  v_lshrrev_b32 v5, 3, v3
  v_lshlrev_b32 v5, 10, v5
  v_bfe_u32 v6, v3, 1, 2
  v_lshl_add_u32 v5, v6, 8, v5
  v_lshl_add_u32 v5, v2, 4, v5
  v_and_b32 v6, 1, v3
  v_lshl_add_u32 v5, v6, 3, v5
  s_waitcnt vmcnt(0)
  v_lshlrev_b32 v32, 16, v8
  v_and_b32 v33, 0xffff0000, v8
  v_lshlrev_b32 v34, 16, v9
  v_and_b32 v35, 0xffff0000, v9
  v_lshlrev_b32 v36, 16, v10
  v_and_b32 v37, 0xffff0000, v10
  v_lshlrev_b32 v38, 16, v11
  v_and_b32 v39, 0xffff0000, v11
  v_lshlrev_b32 v40, 16, v12
  v_and_b32 v41, 0xffff0000, v12
  v_lshlrev_b32 v42, 16, v13
  v_and_b32 v43, 0xffff0000, v13
  v_lshlrev_b32 v44, 16, v14
  v_and_b32 v45, 0xffff0000, v14
  v_lshlrev_b32 v46, 16, v15
  v_and_b32 v47, 0xffff0000, v15
  v_lshlrev_b32 v48, 16, v16
  v_and_b32 v49, 0xffff0000, v16
  v_lshlrev_b32 v50, 16, v17
  v_and_b32 v51, 0xffff0000, v17
  v_lshlrev_b32 v52, 16, v18
  v_and_b32 v53, 0xffff0000, v18
  v_lshlrev_b32 v54, 16, v19
  v_and_b32 v55, 0xffff0000, v19
  v_lshlrev_b32 v56, 16, v20
  v_and_b32 v57, 0xffff0000, v20
  v_lshlrev_b32 v58, 16, v21
  v_and_b32 v59, 0xffff0000, v21
  v_lshlrev_b32 v60, 16, v22
  v_and_b32 v61, 0xffff0000, v22
  v_lshlrev_b32 v62, 16, v23
  v_and_b32 v63, 0xffff0000, v23
  v_lshlrev_b32 v64, 16, v24
  v_and_b32 v65, 0xffff0000, v24
  v_lshlrev_b32 v66, 16, v25
  v_and_b32 v67, 0xffff0000, v25
  v_pk_add_f32 v[70:71], v[32:33], v[34:35]
  v_pk_mul_f32 v[72:73], v[32:33], v[32:33]
  v_pk_mul_f32 v[74:75], v[34:35], v[34:35]
  v_pk_add_f32 v[70:71], v[70:71], v[36:37]
  v_pk_fma_f32 v[72:73], v[36:37], v[36:37], v[72:73]
  v_pk_add_f32 v[70:71], v[70:71], v[38:39]
  v_pk_fma_f32 v[74:75], v[38:39], v[38:39], v[74:75]
  v_pk_add_f32 v[70:71], v[70:71], v[40:41]
  v_pk_fma_f32 v[72:73], v[40:41], v[40:41], v[72:73]
  v_pk_add_f32 v[70:71], v[70:71], v[42:43]
  v_pk_fma_f32 v[74:75], v[42:43], v[42:43], v[74:75]
  v_pk_add_f32 v[70:71], v[70:71], v[44:45]
  v_pk_fma_f32 v[72:73], v[44:45], v[44:45], v[72:73]
  v_pk_add_f32 v[70:71], v[70:71], v[46:47]
  v_pk_fma_f32 v[74:75], v[46:47], v[46:47], v[74:75]
  v_pk_add_f32 v[70:71], v[70:71], v[48:49]
  v_pk_fma_f32 v[72:73], v[48:49], v[48:49], v[72:73]
  v_pk_add_f32 v[70:71], v[70:71], v[50:51]
  v_pk_fma_f32 v[74:75], v[50:51], v[50:51], v[74:75]
  v_pk_add_f32 v[70:71], v[70:71], v[52:53]
  v_pk_fma_f32 v[72:73], v[52:53], v[52:53], v[72:73]
  v_pk_add_f32 v[70:71], v[70:71], v[54:55]
  v_pk_fma_f32 v[74:75], v[54:55], v[54:55], v[74:75]
  v_pk_add_f32 v[70:71], v[70:71], v[56:57]
  v_pk_fma_f32 v[72:73], v[56:57], v[56:57], v[72:73]
  v_pk_add_f32 v[70:71], v[70:71], v[58:59]
  v_pk_fma_f32 v[74:75], v[58:59], v[58:59], v[74:75]
  v_pk_add_f32 v[70:71], v[70:71], v[60:61]
  v_pk_fma_f32 v[72:73], v[60:61], v[60:61], v[72:73]
  v_pk_add_f32 v[70:71], v[70:71], v[62:63]
  v_pk_fma_f32 v[74:75], v[62:63], v[62:63], v[74:75]
  v_pk_add_f32 v[70:71], v[70:71], v[64:65]
  v_pk_fma_f32 v[72:73], v[64:65], v[64:65], v[72:73]
  v_pk_add_f32 v[70:71], v[70:71], v[66:67]
  v_pk_fma_f32 v[74:75], v[66:67], v[66:67], v[74:75]
  v_pk_add_f32 v[72:73], v[72:73], v[74:75]
  v_add_f32 v70, v70, v71
  v_add_f32 v72, v72, v73
  s_nop 0
  v_add_f32_dpp v70, v70, v70 row_ror:8 row_mask:0xf bank_mask:0xf
  v_add_f32_dpp v72, v72, v72 row_ror:8 row_mask:0xf bank_mask:0xf
  s_nop 0
  v_add_f32_dpp v70, v70, v70 row_ror:4 row_mask:0xf bank_mask:0xf
  v_add_f32_dpp v72, v72, v72 row_ror:4 row_mask:0xf bank_mask:0xf
  s_nop 0
  v_add_f32_dpp v70, v70, v70 row_ror:2 row_mask:0xf bank_mask:0xf
  v_add_f32_dpp v72, v72, v72 row_ror:2 row_mask:0xf bank_mask:0xf
  s_nop 0
  v_add_f32_dpp v70, v70, v70 row_ror:1 row_mask:0xf bank_mask:0xf
  v_add_f32_dpp v72, v72, v72 row_ror:1 row_mask:0xf bank_mask:0xf
  v_mul_f32 v70, 0x3ae38e39, v70
  v_mul_f32 v72, 0x3ae38e39, v72
  v_fma_f32 v72, -v70, v70, v72
  v_max_f32 v72, 0, v72
  v_add_f32 v72, 0x3727c5ac, v72
  v_rsq_f32 v72, v72
  s_nop 0
  v_mul_f32 v70, -v70, v72
  v_pk_fma_f32 v[32:33], v[32:33], v[72:73], v[70:71] op_sel_hi:[1,0,0]
  v_pk_fma_f32 v[34:35], v[34:35], v[72:73], v[70:71] op_sel_hi:[1,0,0]
  v_pk_fma_f32 v[36:37], v[36:37], v[72:73], v[70:71] op_sel_hi:[1,0,0]
  v_pk_fma_f32 v[38:39], v[38:39], v[72:73], v[70:71] op_sel_hi:[1,0,0]
  v_pk_fma_f32 v[40:41], v[40:41], v[72:73], v[70:71] op_sel_hi:[1,0,0]
  v_pk_fma_f32 v[42:43], v[42:43], v[72:73], v[70:71] op_sel_hi:[1,0,0]
  v_pk_fma_f32 v[44:45], v[44:45], v[72:73], v[70:71] op_sel_hi:[1,0,0]
  v_pk_fma_f32 v[46:47], v[46:47], v[72:73], v[70:71] op_sel_hi:[1,0,0]
  v_pk_fma_f32 v[48:49], v[48:49], v[72:73], v[70:71] op_sel_hi:[1,0,0]
  v_pk_fma_f32 v[50:51], v[50:51], v[72:73], v[70:71] op_sel_hi:[1,0,0]
  v_pk_fma_f32 v[52:53], v[52:53], v[72:73], v[70:71] op_sel_hi:[1,0,0]
  v_pk_fma_f32 v[54:55], v[54:55], v[72:73], v[70:71] op_sel_hi:[1,0,0]
  v_pk_fma_f32 v[56:57], v[56:57], v[72:73], v[70:71] op_sel_hi:[1,0,0]
  v_pk_fma_f32 v[58:59], v[58:59], v[72:73], v[70:71] op_sel_hi:[1,0,0]
  v_pk_fma_f32 v[60:61], v[60:61], v[72:73], v[70:71] op_sel_hi:[1,0,0]
  v_pk_fma_f32 v[62:63], v[62:63], v[72:73], v[70:71] op_sel_hi:[1,0,0]
  v_pk_fma_f32 v[64:65], v[64:65], v[72:73], v[70:71] op_sel_hi:[1,0,0]
  v_pk_fma_f32 v[66:67], v[66:67], v[72:73], v[70:71] op_sel_hi:[1,0,0]
  v_cvt_pk_bf16_f32 v8, v32, v33
  v_cvt_pk_bf16_f32 v9, v34, v35
  v_cvt_pk_bf16_f32 v10, v36, v37
  v_cvt_pk_bf16_f32 v11, v38, v39
  v_cvt_pk_bf16_f32 v12, v40, v41
  v_cvt_pk_bf16_f32 v13, v42, v43
  v_cvt_pk_bf16_f32 v14, v44, v45
  v_cvt_pk_bf16_f32 v15, v46, v47
  v_cvt_pk_bf16_f32 v16, v48, v49
  v_cvt_pk_bf16_f32 v17, v50, v51
  v_cvt_pk_bf16_f32 v18, v52, v53
  v_cvt_pk_bf16_f32 v19, v54, v55
  v_cvt_pk_bf16_f32 v20, v56, v57
  v_cvt_pk_bf16_f32 v21, v58, v59
  v_cvt_pk_bf16_f32 v22, v60, v61
  v_cvt_pk_bf16_f32 v23, v62, v63
  v_cvt_pk_bf16_f32 v24, v64, v65
  v_cvt_pk_bf16_f32 v25, v66, v67
  buffer_store_dwordx2 v[8:9], v5, s[28:31], s36 offen
  s_add_u32 s36, s36, 2048
  buffer_store_dwordx2 v[10:11], v5, s[28:31], s36 offen
  s_add_u32 s36, s36, 2048
  buffer_store_dwordx2 v[12:13], v5, s[28:31], s36 offen
  s_add_u32 s36, s36, 2048
  buffer_store_dwordx2 v[14:15], v5, s[28:31], s36 offen
  s_add_u32 s36, s36, 2048
  buffer_store_dwordx2 v[16:17], v5, s[28:31], s36 offen
  s_add_u32 s36, s36, 2048
  buffer_store_dwordx2 v[18:19], v5, s[28:31], s36 offen
  s_add_u32 s36, s36, 2048
  buffer_store_dwordx2 v[20:21], v5, s[28:31], s36 offen
  s_add_u32 s36, s36, 2048
  buffer_store_dwordx2 v[22:23], v5, s[28:31], s36 offen
  s_add_u32 s36, s36, 2048
  buffer_store_dwordx2 v[24:25], v5, s[28:31], s36 offen
  s_endpgm
k1_prep_kernel_wq:
  s_sub_u32 s4, s2, 352
  s_lshl_b32 s5, s4, 2
  s_add_u32 s5, s5, s3
  s_mul_i32 s7, s5, 57
  s_lshr_b32 s7, s7, 10
  s_mul_i32 s22, s7, 18
  s_sub_u32 s22, s5, s22
  v_lshrrev_b32 v2, 1, v1
  v_and_b32 v3, 1, v1
  v_mul_u32_u24 v4, 1152, v2
  v_lshl_add_u32 v4, v3, 4, v4
  v_mul_u32_u24 v6, 36, v2
  s_mul_i32 s36, s22, 36864
  s_mul_i32 s23, s7, 144
  s_add_u32 s36, s36, s23
  s_waitcnt lgkmcnt(0)
  s_cmp_lt_u32 s7, 3
  s_cselect_b32 s40, s12, s14
  s_cselect_b32 s41, s13, s15
  s_cselect_b32 s23, 0, 3
  s_sub_u32 s23, s7, s23
  s_min_u32 s23, s23, 2
  s_lshl_b32 s23, s23, 4
  s_mul_i32 s37, s22, 1152
  s_add_u32 s37, s37, s23
  s_mov_b32 s24, s10
  s_and_b32 s25, s11, 0xffff
  s_mov_b32 s26, 663552
  s_mov_b32 s27, 0x20000
  s_mov_b32 s28, s40
  s_and_b32 s29, s41, 0xffff
  s_mov_b32 s30, 20736
  s_mov_b32 s31, 0x20000
  buffer_load_dwordx4 v[24:27], v4, s[24:27], s36 offen offset:0
  buffer_load_dwordx4 v[28:31], v4, s[24:27], s36 offen offset:32
  buffer_load_dwordx4 v[32:35], v4, s[24:27], s36 offen offset:64
  buffer_load_dwordx4 v[36:39], v4, s[24:27], s36 offen offset:96
  buffer_load_dwordx4 v[40:43], v4, s[24:27], s36 offen offset:128
  s_mov_b32 exec_lo, 0xaaaaaaaa
  s_mov_b32 exec_hi, 0xaaaaaaaa
  buffer_load_dwordx4 v[40:43], v6, s[28:31], s37 offen
  s_mov_b64 exec, -1
  s_lshr_b32 s23, s2, 3
  s_and_b32 s23, s23, 1
  s_lshl_b32 s23, s23, 2
  s_add_u32 s23, s23, s3
  s_getpc_b64 s[48:49]
k1_prep_kernel_pc1:
  s_add_u32 s48, s48, kf_front_kernel-k1_prep_kernel_pc1
  s_addc_u32 s49, s49, 0
  s_lshl_b32 s50, s23, 13
  v_lshl_add_u32 v20, v1, 7, s50
  v_min_u32 v20, kt_tail_kernel-kf_front_kernel-4, v20
  global_load_dword v21, v20, s[48:49]
  s_add_u32 s32, s46, 2375680
  s_addc_u32 s33, s47, 0
  s_and_b32 s33, s33, 0xffff
  s_mov_b32 s34, 737280
  s_mov_b32 s35, 0x20000
  s_cmp_ge_u32 s5, 144
  s_cselect_b32 s34, 0, s34
  s_mul_i32 s37, s7, 92160
  s_lshl_b32 s36, s22, 12
  s_add_u32 s36, s36, s37
  s_add_u32 s36, s36, 18432
  s_lshl_b32 s23, s22, 10
  s_add_u32 s37, s37, s23
  s_mul_i32 s23, s3, 5120
  v_lshlrev_b32 v6, 4, v1
  v_add_u32 v7, s23, v6
  v_lshrrev_b32 v8, 4, v1
  v_lshlrev_b32 v8, 8, v8
  v_bfe_u32 v9, v1, 2, 2
  v_lshl_add_u32 v8, v9, 5, v8
  v_and_b32 v9, 3, v1
  v_lshl_add_u32 v8, v9, 3, v8
  v_add_u32 v8, s23, v8
  s_waitcnt vmcnt(6)
  ds_write_b128 v7, v[24:27] offset:0
  s_waitcnt vmcnt(5)
  ds_write_b128 v7, v[28:31] offset:1024
  s_waitcnt vmcnt(4)
  ds_write_b128 v7, v[32:35] offset:2048
  s_waitcnt vmcnt(3)
  ds_write_b128 v7, v[36:39] offset:3072
  s_waitcnt vmcnt(1)
  ds_write_b128 v7, v[40:43] offset:4096
  s_waitcnt lgkmcnt(0)
  ds_read_b64_tr_b16 v[44:45], v8 offset:0
  ds_read_b64_tr_b16 v[46:47], v8 offset:128
  ds_read_b64_tr_b16 v[48:49], v8 offset:1024
  ds_read_b64_tr_b16 v[50:51], v8 offset:1152
  ds_read_b64_tr_b16 v[52:53], v8 offset:2048
  ds_read_b64_tr_b16 v[54:55], v8 offset:2176
  ds_read_b64_tr_b16 v[56:57], v8 offset:3072
  ds_read_b64_tr_b16 v[58:59], v8 offset:3200
  ds_read_b64_tr_b16 v[60:61], v8 offset:4096
  ds_read_b64_tr_b16 v[62:63], v8 offset:4224
  s_waitcnt lgkmcnt(8)
  buffer_store_dwordx4 v[44:47], v6, s[32:35], s36 offen offset:0 sc1
  s_waitcnt lgkmcnt(6)
  buffer_store_dwordx4 v[48:51], v6, s[32:35], s36 offen offset:1024 sc1
  s_waitcnt lgkmcnt(4)
  buffer_store_dwordx4 v[52:55], v6, s[32:35], s36 offen offset:2048 sc1
  s_waitcnt lgkmcnt(2)
  buffer_store_dwordx4 v[56:59], v6, s[32:35], s36 offen offset:3072 sc1
  s_waitcnt lgkmcnt(0)
  buffer_store_dwordx4 v[60:63], v6, s[32:35], s37 offen offset:0 sc1
k1_prep_kernel_end:
  s_endpgm
.text
.globl kf_front_kernel
.p2align 8
.type kf_front_kernel,@function
kf_front_kernel:
  s_cmp_ge_u32 s2, 256
  s_cbranch_scc1 kf_front_kernel_end
  s_load_dwordx2 s[20:21], s[0:1], 112
  s_load_dwordx2 s[8:9], s[0:1], 32
  s_load_dwordx2 s[14:15], s[0:1], 72
  s_load_dwordx2 s[12:13], s[0:1], 48
  s_load_dwordx2 s[18:19], s[0:1], 56
  v_lshrrev_b32 v1, 6, v0
  s_nop 0
  v_readfirstlane_b32 s3, v1
  v_and_b32 v1, 63, v0
  s_cmp_lt_u32 s3, 8
  s_cbranch_scc1 kf_front_kernel_main
  s_waitcnt lgkmcnt(0)
  s_mov_b32 s10, s14
  s_setprio 3
  s_sub_u32 s3, s3, 8
  v_lshlrev_b32 v2, 4, v1
  s_lshl_b32 s4, s2, 2
  s_add_u32 s4, s4, s3
  s_lshl_b32 s16, s3, 10
  s_lshr_b32 s5, s2, 5
  s_mul_i32 s5, s5, 92160
  s_add_u32 s5, s5, s16
  s_waitcnt lgkmcnt(0)
  s_add_u32 s32, s20, 2375680
  s_addc_u32 s33, s21, 0
  s_and_b32 s33, s33, 0xffff
  s_mov_b32 s34, 737280
  s_mov_b32 s35, 0x20000
  s_add_u32 s36, s20, 0
  s_addc_u32 s37, s21, 0
  s_and_b32 s37, s37, 0xffff
  s_mov_b32 s38, 13824
  s_mov_b32 s39, 0x20000
  s_add_u32 m0, s16, 106496
  s_add_u32 s17, s16, 4096
  buffer_load_dwordx4 v2, s[36:39], s16 offen lds
  s_add_u32 m0, s16, 110592
  s_nop 0
  buffer_load_dwordx4 v2, s[36:39], s17 offen lds
  s_add_u32 m0, s16, 8192
  s_add_u32 s17, s5, 0
  buffer_load_dwordx4 v2, s[32:35], s17 offen lds
  s_add_u32 m0, s16, 12288
  s_add_u32 s17, s5, 4096
  buffer_load_dwordx4 v2, s[32:35], s17 offen lds
  s_add_u32 m0, s16, 16384
  s_add_u32 s17, s5, 8192
  buffer_load_dwordx4 v2, s[32:35], s17 offen lds
  s_add_u32 m0, s16, 20480
  s_add_u32 s17, s5, 12288
  buffer_load_dwordx4 v2, s[32:35], s17 offen lds
  s_add_u32 m0, s16, 24576
  s_add_u32 s17, s5, 16384
  buffer_load_dwordx4 v2, s[32:35], s17 offen lds
  s_add_u32 m0, s16, 40960
  s_add_u32 s17, s5, 18432
  buffer_load_dwordx4 v2, s[32:35], s17 offen lds
  s_add_u32 m0, s16, 120832
  s_add_u32 s17, s5, 55296
  buffer_load_dwordx4 v2, s[32:35], s17 offen lds
  s_waitcnt vmcnt(2)
  s_setprio 3
  s_barrier
  s_add_u32 m0, s16, 45056
  s_add_u32 s17, s5, 22528
  buffer_load_dwordx4 v2, s[32:35], s17 offen lds
  s_add_u32 m0, s16, 124928
  s_add_u32 s17, s5, 59392
  buffer_load_dwordx4 v2, s[32:35], s17 offen lds
  s_add_u32 m0, s16, 49152
  s_add_u32 s17, s5, 26624
  buffer_load_dwordx4 v2, s[32:35], s17 offen lds
  s_add_u32 m0, s16, 129024
  s_add_u32 s17, s5, 63488
  buffer_load_dwordx4 v2, s[32:35], s17 offen lds
  s_add_u32 m0, s16, 53248
  s_add_u32 s17, s5, 30720
  buffer_load_dwordx4 v2, s[32:35], s17 offen lds
  s_add_u32 m0, s16, 133120
  s_add_u32 s17, s5, 67584
  buffer_load_dwordx4 v2, s[32:35], s17 offen lds
  s_add_u32 m0, s16, 57344
  s_add_u32 s17, s5, 34816
  buffer_load_dwordx4 v2, s[32:35], s17 offen lds
  s_add_u32 m0, s16, 137216
  s_add_u32 s17, s5, 71680
  buffer_load_dwordx4 v2, s[32:35], s17 offen lds
  s_add_u32 m0, s16, 61440
  s_add_u32 s17, s5, 38912
  buffer_load_dwordx4 v2, s[32:35], s17 offen lds
  s_add_u32 m0, s16, 141312
  s_add_u32 s17, s5, 75776
  buffer_load_dwordx4 v2, s[32:35], s17 offen lds
  s_add_u32 m0, s16, 81920
  s_add_u32 s17, s5, 43008
  buffer_load_dwordx4 v2, s[32:35], s17 offen lds
  s_add_u32 m0, s16, 94208
  s_add_u32 s17, s5, 79872
  buffer_load_dwordx4 v2, s[32:35], s17 offen lds
  s_add_u32 m0, s16, 86016
  s_add_u32 s17, s5, 47104
  buffer_load_dwordx4 v2, s[32:35], s17 offen lds
  s_add_u32 m0, s16, 98304
  s_add_u32 s17, s5, 83968
  buffer_load_dwordx4 v2, s[32:35], s17 offen lds
  s_add_u32 m0, s16, 90112
  s_add_u32 s17, s5, 51200
  buffer_load_dwordx4 v2, s[32:35], s17 offen lds
  s_add_u32 m0, s16, 102400
  s_add_u32 s17, s5, 88064
  buffer_load_dwordx4 v2, s[32:35], s17 offen lds
  s_lshl_b32 s17, s3, 2
  s_add_u32 s17, s17, 31760
  v_mov_b32 v3, s17
  v_mov_b32 v4, 1
  s_waitcnt vmcnt(0)
  ds_write_b32 v3, v4
  s_add_u32 s32, s20, 3112960
  s_addc_u32 s33, s21, 0
  s_and_b32 s33, s33, 0xffff
  s_mov_b32 s34, 151552
  s_mov_b32 s35, 0x20000
  s_lshl_b32 s16, s3, 11
  s_mov_b32 s44, 200000
  v_add_u32 v3, s16, v2
  v_add_u32 v4, 65536, v3
  v_add_u32 v5, 131072, v3
  v_and_b32 v6, 7, v1
  v_lshlrev_b32 v6, 2, v6
kf_front_kernel_kw:
  s_sleep 1
  ds_read_b32 v7, v6 offset:31776
  s_waitcnt lgkmcnt(0)
  v_cmp_eq_u32 vcc, 0, v7
  s_nop 4
  s_cbranch_vccnz kf_front_kernel_kw
  s_add_u32 s17, s16, 65536
  s_mov_b32 m0, s17
  s_nop 0
  buffer_load_dwordx4 v2, s[32:35], s17 offen sc1 lds
  buffer_load_dwordx4 v2, s[32:35], s17 offen offset:1024 sc1 lds
  s_add_u32 s17, s16, 0
  s_mov_b32 m0, s17
  s_nop 0
  buffer_load_dwordx4 v2, s[32:35], s17 offen sc1 lds
  buffer_load_dwordx4 v2, s[32:35], s17 offen offset:1024 sc1 lds
  s_add_u32 s17, s16, 32768
  s_mov_b32 m0, s17
  s_nop 0
  buffer_load_dwordx4 v2, s[32:35], s17 offen sc1 lds
  buffer_load_dwordx4 v2, s[32:35], s17 offen offset:1024 sc1 lds
  s_add_u32 s17, s16, 73728
  s_mov_b32 m0, s17
  s_nop 0
  buffer_load_dwordx4 v2, s[32:35], s17 offen sc1 lds
  buffer_load_dwordx4 v2, s[32:35], s17 offen offset:1024 sc1 lds
  s_add_u32 s17, s16, 112640
  s_mov_b32 m0, s17
  s_nop 0
  buffer_load_dwordx4 v2, s[32:35], s17 offen sc1 lds
  buffer_load_dwordx4 v2, s[32:35], s17 offen offset:1024 sc1 lds
  s_barrier
  s_barrier
  s_branch kf_front_kernel_sk1
kf_front_kernel_sk0:
  s_add_u32 s17, s16, 65536
  s_mov_b32 m0, s17
  s_nop 0
  buffer_load_dwordx4 v2, s[32:35], s17 offen sc1 lds
  buffer_load_dwordx4 v2, s[32:35], s17 offen offset:1024 sc1 lds
  s_add_u32 s17, s16, 0
  s_mov_b32 m0, s17
  s_nop 0
  buffer_load_dwordx4 v2, s[32:35], s17 offen sc1 lds
  buffer_load_dwordx4 v2, s[32:35], s17 offen offset:1024 sc1 lds
  s_add_u32 s17, s16, 32768
  s_mov_b32 m0, s17
  s_nop 0
  buffer_load_dwordx4 v2, s[32:35], s17 offen sc1 lds
  buffer_load_dwordx4 v2, s[32:35], s17 offen offset:1024 sc1 lds
  s_add_u32 s17, s16, 73728
  s_mov_b32 m0, s17
  s_nop 0
  buffer_load_dwordx4 v2, s[32:35], s17 offen sc1 lds
  buffer_load_dwordx4 v2, s[32:35], s17 offen offset:1024 sc1 lds
  s_add_u32 s17, s16, 112640
  s_mov_b32 m0, s17
  s_nop 0
  buffer_load_dwordx4 v2, s[32:35], s17 offen sc1 lds
  buffer_load_dwordx4 v2, s[32:35], s17 offen offset:1024 sc1 lds
kf_front_kernel_sk1:
  s_waitcnt vmcnt(0)
  ds_read_b128 v[20:23], v4 offset:0
  ds_read_b128 v[24:27], v4 offset:1024
  ds_read_b128 v[28:31], v3 offset:0
  ds_read_b128 v[32:35], v3 offset:1024
  ds_read_b128 v[36:39], v3 offset:32768
  ds_read_b128 v[40:43], v3 offset:33792
  s_waitcnt lgkmcnt(0)
  v_max_u32 v16, v20, v21
  v_max_u32 v17, v22, v23
  v_max3_u32 v16, v16, v24, v25
  v_max3_u32 v17, v17, v26, v27
  v_max3_u32 v16, v16, v28, v29
  v_max3_u32 v17, v17, v30, v31
  v_max3_u32 v16, v16, v32, v33
  v_max3_u32 v17, v17, v34, v35
  v_max3_u32 v16, v16, v36, v37
  v_max3_u32 v17, v17, v38, v39
  v_max3_u32 v16, v16, v40, v41
  v_max3_u32 v17, v17, v42, v43
  ds_read_b128 v[20:23], v4 offset:8192
  ds_read_b128 v[24:27], v4 offset:9216
  ds_read_b128 v[28:31], v4 offset:47104
  ds_read_b128 v[32:35], v4 offset:48128
  s_waitcnt lgkmcnt(0)
  v_max3_u32 v16, v16, v20, v21
  v_max3_u32 v17, v17, v22, v23
  v_max3_u32 v16, v16, v24, v25
  v_max3_u32 v17, v17, v26, v27
  v_max3_u32 v16, v16, v28, v29
  v_max3_u32 v17, v17, v30, v31
  v_max3_u32 v16, v16, v32, v33
  v_max3_u32 v17, v17, v34, v35
  v_max_u32 v16, v16, v17
  v_cmp_eq_u32 vcc, -1, v16
  s_sub_u32 s44, s44, 1
  s_cselect_b64 vcc, 0, vcc
  s_nop 2
  s_cbranch_vccnz kf_front_kernel_sk0
  s_barrier
  s_add_u32 s17, s16, 81920
  s_mov_b32 m0, s17
  s_nop 0
  buffer_load_dwordx4 v2, s[32:35], s17 offen sc1 lds
  buffer_load_dwordx4 v2, s[32:35], s17 offen offset:1024 sc1 lds
  s_add_u32 s17, s16, 120832
  s_mov_b32 m0, s17
  s_nop 0
  buffer_load_dwordx4 v2, s[32:35], s17 offen sc1 lds
  buffer_load_dwordx4 v2, s[32:35], s17 offen offset:1024 sc1 lds
  s_add_u32 s17, s16, 8192
  s_mov_b32 m0, s17
  s_nop 0
  buffer_load_dwordx4 v2, s[32:35], s17 offen sc1 lds
  buffer_load_dwordx4 v2, s[32:35], s17 offen offset:1024 sc1 lds
  s_add_u32 s17, s16, 40960
  s_mov_b32 m0, s17
  s_nop 0
  buffer_load_dwordx4 v2, s[32:35], s17 offen sc1 lds
  buffer_load_dwordx4 v2, s[32:35], s17 offen offset:1024 sc1 lds
  s_add_u32 s17, s16, 90112
  s_mov_b32 m0, s17
  s_nop 0
  buffer_load_dwordx4 v2, s[32:35], s17 offen sc1 lds
  buffer_load_dwordx4 v2, s[32:35], s17 offen offset:1024 sc1 lds
  s_add_u32 s17, s16, 129024
  s_mov_b32 m0, s17
  s_nop 0
  buffer_load_dwordx4 v2, s[32:35], s17 offen sc1 lds
  buffer_load_dwordx4 v2, s[32:35], s17 offen offset:1024 sc1 lds
  s_add_u32 s17, s16, 16384
  s_mov_b32 m0, s17
  s_nop 0
  buffer_load_dwordx4 v2, s[32:35], s17 offen sc1 lds
  buffer_load_dwordx4 v2, s[32:35], s17 offen offset:1024 sc1 lds
  s_add_u32 s17, s16, 49152
  s_mov_b32 m0, s17
  s_nop 0
  buffer_load_dwordx4 v2, s[32:35], s17 offen sc1 lds
  buffer_load_dwordx4 v2, s[32:35], s17 offen offset:1024 sc1 lds
  s_add_u32 s17, s16, 98304
  s_mov_b32 m0, s17
  s_nop 0
  buffer_load_dwordx4 v2, s[32:35], s17 offen sc1 lds
  buffer_load_dwordx4 v2, s[32:35], s17 offen offset:1024 sc1 lds
  s_add_u32 s17, s16, 137216
  s_mov_b32 m0, s17
  s_nop 0
  buffer_load_dwordx4 v2, s[32:35], s17 offen sc1 lds
  buffer_load_dwordx4 v2, s[32:35], s17 offen offset:1024 sc1 lds
  s_add_u32 s17, s16, 24576
  s_mov_b32 m0, s17
  s_nop 0
  buffer_load_dwordx4 v2, s[32:35], s17 offen sc1 lds
  buffer_load_dwordx4 v2, s[32:35], s17 offen offset:1024 sc1 lds
  s_add_u32 s17, s16, 57344
  s_mov_b32 m0, s17
  s_nop 0
  buffer_load_dwordx4 v2, s[32:35], s17 offen sc1 lds
  buffer_load_dwordx4 v2, s[32:35], s17 offen offset:1024 sc1 lds
  s_add_u32 s17, s16, 106496
  s_mov_b32 m0, s17
  s_nop 0
  buffer_load_dwordx4 v2, s[32:35], s17 offen sc1 lds
  buffer_load_dwordx4 v2, s[32:35], s17 offen offset:1024 sc1 lds
  s_add_u32 s17, s16, 145408
  s_mov_b32 m0, s17
  s_nop 0
  buffer_load_dwordx4 v2, s[32:35], s17 offen sc1 lds
  buffer_load_dwordx4 v2, s[32:35], s17 offen offset:1024 sc1 lds
  s_waitcnt vmcnt(0)
  s_barrier
  s_add_u32 s36, s20, 26177536
  s_addc_u32 s37, s21, 0
  s_and_b32 s37, s37, 0xffff
  s_mov_b32 s38, 262144
  s_mov_b32 s39, 0x20000
  s_add_u32 s40, s20, 35876864
  s_addc_u32 s41, s21, 0
  s_and_b32 s41, s41, 0xffff
  s_mov_b32 s42, 163840
  s_mov_b32 s43, 0x20000
  s_lshl_b32 s17, s2, 10
  s_cmp_eq_u32 s3, 0
  s_cselect_b32 s38, s38, 0
  s_cselect_b32 s42, s42, 0
  v_mov_b32 v8, -1
  v_mov_b32 v9, -1
  v_mov_b32 v10, -1
  v_mov_b32 v11, -1
  v_mov_b32 v12, 0
  v_mov_b32 v13, 0
  v_mov_b32 v14, 0
  v_mov_b32 v15, 0
  buffer_store_dwordx4 v[8:11], v2, s[36:39], s17 offen sc1
  buffer_store_dwordx4 v[12:15], v2, s[40:43], s17 offen sc1
  s_lshl_b32 s5, s3, 11
  s_add_u32 s5, s5, 155648
  v_add_u32 v3, s5, v2
  v_bfe_u32 v5, v1, 2, 2
  v_and_b32 v6, 3, v1
  v_lshrrev_b32 v7, 4, v1
  s_cmp_lt_u32 s4, 576
  s_cbranch_scc0 kf_front_kernel_side2
  s_lshr_b32 s6, s4, 2
  s_and_b32 s7, s4, 3
  s_mul_i32 s10, s6, 57
  s_lshr_b32 s10, s10, 10
  s_mul_i32 s11, s10, 18
  s_sub_u32 s11, s6, s11
  s_mul_i32 s10, s10, 9
  s_add_u32 s10, s10, s11
  s_mov_b32 s14, 72
  s_cmp_ge_u32 s11, 5
  s_cselect_b32 s14, -5, s14
  s_cmp_ge_u32 s11, 9
  s_cselect_b32 s14, 68, s14
  s_cmp_ge_u32 s11, 13
  s_cselect_b32 s14, -9, s14
  s_add_u32 s10, s10, s14
  s_lshl_b32 s10, s10, 6
  s_mul_i32 s11, s7, 1327104
  s_add_u32 s10, s10, s11
  v_lshrrev_b32 v8, 5, v1
  v_bfe_u32 v9, v1, 2, 2
  v_bfe_u32 v10, v1, 4, 1
  v_lshl_add_u32 v10, v10, 4, v9
  v_bfe_u32 v11, v1, 2, 3
  v_cmp_gt_u32 vcc, 32, v1
  s_mov_b32 s24, s12
  s_and_b32 s25, s13, 0xffff
  s_mov_b32 s26, 5308416
  s_mov_b32 s27, 0x20000
  s_add_u32 s28, s20, 0
  s_addc_u32 s29, s21, 0
  s_and_b32 s29, s29, 0xffff
  s_mov_b32 s30, 13824
  s_mov_b32 s31, 0x20000
  s_movk_i32 s11, 9216
  v_add_u32 v12, 4, v10
  v_cndmask_b32 v12, v12, v10, vcc
  v_mul_lo_u32 v12, v12, s11
  v_lshl_add_u32 v110, v6, 4, v12
  v_add_u32 v12, 20, v10
  v_cndmask_b32 v12, v12, v10, vcc
  v_mul_lo_u32 v12, v12, s11
  v_lshl_add_u32 v111, v6, 4, v12
  v_add_u32 v12, 20, v11
  v_cndmask_b32 v12, v12, v10, vcc
  v_mul_lo_u32 v12, v12, s11
  v_lshl_add_u32 v112, v6, 4, v12
  v_add_u32 v12, 8, v10
  v_cndmask_b32 v12, v12, v11, vcc
  v_mul_lo_u32 v12, v12, s11
  v_lshl_add_u32 v113, v6, 4, v12
  s_add_u32 s11, s10, 0
  buffer_load_dwordx4 v[16:19], v110, s[24:27], s11 offen
  s_add_u32 s11, s10, 73728
  buffer_load_dwordx4 v[20:23], v110, s[24:27], s11 offen
  s_add_u32 s11, s10, 294912
  buffer_load_dwordx4 v[24:27], v110, s[24:27], s11 offen
  s_add_u32 s11, s10, 368640
  buffer_load_dwordx4 v[28:31], v110, s[24:27], s11 offen
  s_add_u32 s11, s10, 589824
  buffer_load_dwordx4 v[32:35], v113, s[24:27], s11 offen
  s_add_u32 s11, s10, 700416
  buffer_load_dwordx4 v[36:39], v110, s[24:27], s11 offen
  s_add_u32 s11, s10, 774144
  buffer_load_dwordx4 v[40:43], v111, s[24:27], s11 offen
  s_add_u32 s11, s10, 995328
  buffer_load_dwordx4 v[44:47], v110, s[24:27], s11 offen
  s_add_u32 s11, s10, 1069056
  buffer_load_dwordx4 v[48:51], v112, s[24:27], s11 offen
  s_mul_i32 s11, s7, 576
  s_add_u32 s11, s11, 6912
  buffer_load_dwordx4 v[64:67], v2, s[28:31], s11 offen offset:2304
  buffer_load_dwordx4 v[76:79], v2, s[28:31], s11 offen
  s_mov_b32 s36, s18
  s_and_b32 s37, s19, 0xffff
  s_mov_b32 s38, 8388608
  s_mov_b32 s39, 0x20000
  s_lshl_b32 s11, s4, 13
  buffer_load_dwordx4 v[120:123], v2, s[36:39], s11 offen offset:0
  buffer_load_dwordx4 v[120:123], v2, s[36:39], s11 offen offset:1024
  buffer_load_dwordx4 v[120:123], v2, s[36:39], s11 offen offset:2048
  buffer_load_dwordx4 v[120:123], v2, s[36:39], s11 offen offset:3072
  s_add_u32 s11, s11, 4096
  buffer_load_dwordx4 v[120:123], v2, s[36:39], s11 offen offset:0
  buffer_load_dwordx4 v[120:123], v2, s[36:39], s11 offen offset:1024
  buffer_load_dwordx4 v[120:123], v2, s[36:39], s11 offen offset:2048
  buffer_load_dwordx4 v[120:123], v2, s[36:39], s11 offen offset:3072
  s_lshr_b32 s11, s2, 1
  s_and_b32 s11, s11, 12
  s_add_u32 s11, s11, s3
  s_getpc_b64 s[40:41]
kf_front_kernel_a_pc1:
  s_add_u32 s40, s40, kt_tail_kernel-kf_front_kernel_a_pc1
  s_addc_u32 s41, s41, 0
  s_lshl_b32 s42, s11, 13
  v_lshl_add_u32 v124, v1, 7, s42
  v_min_u32 v124, code_end-kt_tail_kernel-4, v124
  global_load_dword v125, v124, s[40:41]
  s_add_u32 s28, s20, 8777728
  s_addc_u32 s29, s21, 0
  s_and_b32 s29, s29, 0xffff
  s_mov_b32 s30, 5308416
  s_mov_b32 s31, 0x20000
  s_add_u32 s36, s20, 36564992
  s_addc_u32 s37, s21, 0
  s_and_b32 s37, s37, 0xffff
  s_mov_b32 s38, 147456
  s_mov_b32 s39, 0x20000
  v_lshlrev_b32 v8, 9, v8
  v_lshl_add_u32 v8, v5, 6, v8
  v_and_b32 v9, 1, v7
  v_lshl_add_u32 v8, v9, 5, v8
  v_lshl_add_u32 v8, v6, 3, v8
  v_add_u32 v8, s5, v8
  s_mul_i32 s12, s6, 36
  s_mul_i32 s11, s7, 9
  s_add_u32 s12, s12, s11
  s_lshl_b32 s12, s12, 10
  v_mul_u32_u24 v9, 57, v1
  v_lshrrev_b32 v9, 10, v9
  v_mul_u32_u24 v10, 18, v9
  v_sub_u32 v10, v1, v10
  v_lshrrev_b32 v11, 3, v10
  v_lshlrev_b32 v11, 2, v11
  v_and_b32 v12, 3, v10
  v_add_u32 v11, v11, v12
  v_bfe_u32 v12, v10, 2, 1
  v_cmp_lt_u32 vcc, 15, v10
  v_and_b32 v13, 1, v10
  s_nop 0
  v_cndmask_b32 v11, v11, 8, vcc
  v_cndmask_b32 v12, v12, v13, vcc
  v_mad_u32_u24 v11, v9, 9, v11
  v_lshlrev_b32 v11, 5, v11
  v_lshl_add_u32 v11, v12, 3, v11
  v_add_u32 v11, s5, v11
  v_and_b32 v12, 1, v1
  v_lshlrev_b32 v12, 4, v12
  v_lshrrev_b32 v13, 5, v1
  v_lshl_add_u32 v12, v13, 5, v12
  v_add_u32 v12, s5, v12
  s_waitcnt vmcnt(9)
  v_cvt_pk_bf16_f32 v68, v64, v65
  v_cvt_pk_bf16_f32 v69, v66, v67
  v_cvt_pk_bf16_f32 v70, v76, v77
  v_cvt_pk_bf16_f32 v71, v78, v79
  s_mov_b32 exec_hi, 15
  ds_write_b64 v11, v[68:69]
  ds_write_b64 v11, v[70:71] offset:16
  s_mov_b32 exec_hi, -1
  s_waitcnt lgkmcnt(0)
  ds_read_b128 v[64:67], v12 offset:0
  ds_read_b128 v[68:71], v12 offset:64
  ds_read_b128 v[72:75], v12 offset:128
  ds_read_b128 v[76:79], v12 offset:192
  ds_read_b128 v[80:83], v12 offset:256
  ds_read_b128 v[84:87], v12 offset:320
  ds_read_b128 v[88:91], v12 offset:384
  ds_read_b128 v[92:95], v12 offset:448
  ds_read_b128 v[96:99], v12 offset:512
  s_waitcnt lgkmcnt(0)
  ds_write_b128 v3, v[16:19] offset:0
  s_waitcnt lgkmcnt(0)
  ds_read_b64_tr_b16 v[56:57], v8 offset:0
  ds_read_b64_tr_b16 v[58:59], v8 offset:256
  s_waitcnt lgkmcnt(0)
  buffer_store_dwordx4 v[56:59], v2, s[28:31], s12 offen offset:0 sc1
  v_mfma_f32_32x32x16_bf16 v[100:115], v[64:67], v[56:59], 0
  ds_write_b128 v3, v[20:23] offset:1024
  s_waitcnt lgkmcnt(0)
  ds_read_b64_tr_b16 v[60:61], v8 offset:1024
  ds_read_b64_tr_b16 v[62:63], v8 offset:1280
  s_waitcnt lgkmcnt(0)
  buffer_store_dwordx4 v[60:63], v2, s[28:31], s12 offen offset:1024 sc1
  v_mfma_f32_32x32x16_bf16 v[100:115], v[68:71], v[60:63], v[100:115]
  ds_write_b128 v3, v[24:27] offset:0
  s_waitcnt lgkmcnt(0)
  ds_read_b64_tr_b16 v[56:57], v8 offset:0
  ds_read_b64_tr_b16 v[58:59], v8 offset:256
  s_waitcnt lgkmcnt(0)
  buffer_store_dwordx4 v[56:59], v2, s[28:31], s12 offen offset:2048 sc1
  v_mfma_f32_32x32x16_bf16 v[100:115], v[72:75], v[56:59], v[100:115]
  ds_write_b128 v3, v[28:31] offset:1024
  s_waitcnt lgkmcnt(0)
  ds_read_b64_tr_b16 v[60:61], v8 offset:1024
  ds_read_b64_tr_b16 v[62:63], v8 offset:1280
  s_waitcnt lgkmcnt(0)
  buffer_store_dwordx4 v[60:63], v2, s[28:31], s12 offen offset:3072 sc1
  s_add_u32 s12, s12, 4096
  v_mfma_f32_32x32x16_bf16 v[100:115], v[76:79], v[60:63], v[100:115]
  ds_write_b128 v3, v[32:35] offset:0
  s_waitcnt lgkmcnt(0)
  ds_read_b64_tr_b16 v[56:57], v8 offset:0
  ds_read_b64_tr_b16 v[58:59], v8 offset:256
  s_waitcnt lgkmcnt(0)
  buffer_store_dwordx4 v[56:59], v2, s[28:31], s12 offen offset:0 sc1
  v_mfma_f32_32x32x16_bf16 v[100:115], v[80:83], v[56:59], v[100:115]
  ds_write_b128 v3, v[36:39] offset:1024
  s_waitcnt lgkmcnt(0)
  ds_read_b64_tr_b16 v[60:61], v8 offset:1024
  ds_read_b64_tr_b16 v[62:63], v8 offset:1280
  s_waitcnt lgkmcnt(0)
  buffer_store_dwordx4 v[60:63], v2, s[28:31], s12 offen offset:1024 sc1
  v_mfma_f32_32x32x16_bf16 v[100:115], v[84:87], v[60:63], v[100:115]
  ds_write_b128 v3, v[40:43] offset:0
  s_waitcnt lgkmcnt(0)
  ds_read_b64_tr_b16 v[56:57], v8 offset:0
  ds_read_b64_tr_b16 v[58:59], v8 offset:256
  s_waitcnt lgkmcnt(0)
  buffer_store_dwordx4 v[56:59], v2, s[28:31], s12 offen offset:2048 sc1
  v_mfma_f32_32x32x16_bf16 v[100:115], v[88:91], v[56:59], v[100:115]
  ds_write_b128 v3, v[44:47] offset:1024
  s_waitcnt lgkmcnt(0)
  ds_read_b64_tr_b16 v[60:61], v8 offset:1024
  ds_read_b64_tr_b16 v[62:63], v8 offset:1280
  s_waitcnt lgkmcnt(0)
  buffer_store_dwordx4 v[60:63], v2, s[28:31], s12 offen offset:3072 sc1
  s_add_u32 s12, s12, 4096
  v_mfma_f32_32x32x16_bf16 v[100:115], v[92:95], v[60:63], v[100:115]
  ds_write_b128 v3, v[48:51] offset:0
  s_waitcnt lgkmcnt(0)
  ds_read_b64_tr_b16 v[56:57], v8 offset:0
  ds_read_b64_tr_b16 v[58:59], v8 offset:256
  s_waitcnt lgkmcnt(0)
  buffer_store_dwordx4 v[56:59], v2, s[28:31], s12 offen offset:0 sc1
  v_mfma_f32_32x32x16_bf16 v[100:115], v[96:99], v[56:59], v[100:115]
  s_mul_i32 s11, s7, 144
  s_add_u32 s11, s11, s6
  s_lshl_b32 s11, s11, 8
  v_lshlrev_b32 v8, 3, v1
  s_mov_b32 exec_hi, 0
  s_nop 6
  buffer_store_dwordx2 v[100:101], v8, s[36:39], s11 offen sc1
  s_mov_b32 exec_hi, -1
  s_branch kf_front_kernel_warm
kf_front_kernel_side2:
  v_lshrrev_b32 v8, 4, v1
  v_bfe_u32 v9, v1, 1, 2
  v_bfe_u32 v10, v1, 3, 1
  v_bfe_u32 v11, v1, 4, 1
  v_lshlrev_b32 v11, 1, v11
  v_lshrrev_b32 v12, 5, v1
  v_or_b32 v11, v11, v12
  v_lshl_add_u32 v11, v11, 2, v9
  v_lshl_add_u32 v110, v10, 4, v11
  v_mul_u32_u24 v12, 144, v10
  v_add_u32 v111, v11, v12
  v_lshrrev_b32 v11, 1, v8
  v_mul_u32_u24 v11, 18, v11
  v_and_b32 v12, 1, v8
  v_lshl_add_u32 v11, v12, 2, v11
  v_add_u32 v11, v11, v9
  v_lshl_add_u32 v112, v10, 3, v11
  v_bfe_u32 v11, v1, 2, 2
  v_mul_u32_u24 v11, 18, v11
  v_bfe_u32 v12, v1, 1, 1
  v_add_u32 v11, v11, v12
  v_mul_u32_u24 v12, 72, v8
  v_add_u32 v113, v11, v12
  v_and_b32 v12, 1, v1
  v_lshlrev_b32 v12, 4, v12
  s_movk_i32 s11, 1152
  v_mad_u32_u24 v110, v110, s11, v12
  v_mad_u32_u24 v111, v111, s11, v12
  v_mad_u32_u24 v112, v112, s11, v12
  v_mad_u32_u24 v113, v113, s11, v12
  s_sub_u32 s6, s4, 576
  s_lshl_b32 s6, s6, 1
  s_mov_b32 s40, 663552
  s_mov_b32 s41, 5623808
  s_cmp_lt_u32 s6, 576
  s_cselect_b32 s24, s10, s8
  s_cselect_b32 s25, s15, s9
  s_cselect_b32 s26, 2654208, s40
  s_mov_b32 s27, 0x20000
  s_cselect_b32 s28, 14086144, s41
  s_mov_b32 s30, s26
  s_cselect_b32 s14, 0, 576
  s_mov_b32 s31, 0x20000
  s_and_b32 s25, s25, 0xffff
  s_add_u32 s28, s28, s20
  s_addc_u32 s29, s21, 0
  s_and_b32 s29, s29, 0xffff
  s_sub_u32 s14, s6, s14
  s_cmp_ge_u32 s6, 720
  s_cselect_b32 s26, 0, s26
  s_cselect_b32 s30, 0, s30
  s_mul_i32 s12, s14, 4608
  s_cmp_lt_u32 s6, 576
  s_cbranch_scc0 kf_front_kernel_u0s
  s_mul_i32 s16, s14, 911
  s_lshr_b32 s16, s16, 16
  s_mul_i32 s17, s16, 72
  s_sub_u32 s17, s14, s17
  s_and_b32 s22, s17, 15
  s_mul_i32 s22, s22, 9
  s_lshr_b32 s23, s17, 4
  s_lshl_b32 s23, s23, 1
  s_add_u32 s22, s22, s23
  s_mul_i32 s23, s17, 18
  s_sub_u32 s23, s23, 1144
  s_cmp_ge_u32 s17, 64
  s_cselect_b32 s17, s23, s22
  s_cselect_b64 vcc, -1, 0
  s_mul_i32 s17, s17, 18432
  v_cndmask_b32 v13, v110, v111, vcc
  s_branch kf_front_kernel_u0go
kf_front_kernel_u0s:
  s_mul_i32 s16, s14, 57
  s_lshr_b32 s16, s16, 10
  s_mul_i32 s17, s16, 18
  s_sub_u32 s17, s14, s17
  s_mul_i32 s22, s17, 41472
  s_mul_i32 s23, s17, 331776
  s_sub_u32 s23, s23, 5289984
  s_cmp_ge_u32 s17, 16
  s_cselect_b32 s17, s23, s22
  s_cselect_b64 vcc, -1, 0
  v_cndmask_b32 v13, v112, v113, vcc
kf_front_kernel_u0go:
  s_mul_i32 s16, s16, 144
  s_add_u32 s17, s17, s16
  buffer_load_dwordx4 v[16:19], v13, s[24:27], s17 offen offset:0
  buffer_load_dwordx4 v[20:23], v13, s[24:27], s17 offen offset:32
  buffer_load_dwordx4 v[24:27], v13, s[24:27], s17 offen offset:64
  buffer_load_dwordx4 v[28:31], v13, s[24:27], s17 offen offset:96
  buffer_load_dwordx4 v[32:35], v13, s[24:27], s17 offen offset:128
  s_add_u32 s14, s14, 1
  s_cmp_lt_u32 s6, 576
  s_cbranch_scc0 kf_front_kernel_u1s
  s_mul_i32 s16, s14, 911
  s_lshr_b32 s16, s16, 16
  s_mul_i32 s17, s16, 72
  s_sub_u32 s17, s14, s17
  s_and_b32 s22, s17, 15
  s_mul_i32 s22, s22, 9
  s_lshr_b32 s23, s17, 4
  s_lshl_b32 s23, s23, 1
  s_add_u32 s22, s22, s23
  s_mul_i32 s23, s17, 18
  s_sub_u32 s23, s23, 1144
  s_cmp_ge_u32 s17, 64
  s_cselect_b32 s17, s23, s22
  s_cselect_b64 vcc, -1, 0
  s_mul_i32 s17, s17, 18432
  v_cndmask_b32 v13, v110, v111, vcc
  s_branch kf_front_kernel_u1go
kf_front_kernel_u1s:
  s_mul_i32 s16, s14, 57
  s_lshr_b32 s16, s16, 10
  s_mul_i32 s17, s16, 18
  s_sub_u32 s17, s14, s17
  s_mul_i32 s22, s17, 41472
  s_mul_i32 s23, s17, 331776
  s_sub_u32 s23, s23, 5289984
  s_cmp_ge_u32 s17, 16
  s_cselect_b32 s17, s23, s22
  s_cselect_b64 vcc, -1, 0
  v_cndmask_b32 v13, v112, v113, vcc
kf_front_kernel_u1go:
  s_mul_i32 s16, s16, 144
  s_add_u32 s17, s17, s16
  buffer_load_dwordx4 v[36:39], v13, s[24:27], s17 offen offset:0
  buffer_load_dwordx4 v[40:43], v13, s[24:27], s17 offen offset:32
  buffer_load_dwordx4 v[44:47], v13, s[24:27], s17 offen offset:64
  buffer_load_dwordx4 v[48:51], v13, s[24:27], s17 offen offset:96
  buffer_load_dwordx4 v[52:55], v13, s[24:27], s17 offen offset:128
  s_mov_b32 s36, s18
  s_and_b32 s37, s19, 0xffff
  s_mov_b32 s38, 8388608
  s_mov_b32 s39, 0x20000
  s_lshl_b32 s11, s4, 13
  buffer_load_dwordx4 v[120:123], v2, s[36:39], s11 offen offset:0
  buffer_load_dwordx4 v[120:123], v2, s[36:39], s11 offen offset:1024
  buffer_load_dwordx4 v[120:123], v2, s[36:39], s11 offen offset:2048
  buffer_load_dwordx4 v[120:123], v2, s[36:39], s11 offen offset:3072
  s_add_u32 s11, s11, 4096
  buffer_load_dwordx4 v[120:123], v2, s[36:39], s11 offen offset:0
  buffer_load_dwordx4 v[120:123], v2, s[36:39], s11 offen offset:1024
  buffer_load_dwordx4 v[120:123], v2, s[36:39], s11 offen offset:2048
  buffer_load_dwordx4 v[120:123], v2, s[36:39], s11 offen offset:3072
  s_lshr_b32 s11, s2, 1
  s_and_b32 s11, s11, 12
  s_add_u32 s11, s11, s3
  s_getpc_b64 s[40:41]
kf_front_kernel_b_pc1:
  s_add_u32 s40, s40, kt_tail_kernel-kf_front_kernel_b_pc1
  s_addc_u32 s41, s41, 0
  s_lshl_b32 s42, s11, 13
  v_lshl_add_u32 v124, v1, 7, s42
  v_min_u32 v124, code_end-kt_tail_kernel-4, v124
  global_load_dword v125, v124, s[40:41]
  v_lshlrev_b32 v8, 8, v7
  v_lshl_add_u32 v8, v5, 5, v8
  v_lshl_add_u32 v8, v6, 3, v8
  v_add_u32 v8, s5, v8
  v_and_b32 v10, 15, v1
  v_lshlrev_b32 v9, 7, v7
  v_lshl_add_u32 v9, v10, 4, v9
  v_add_u32 v9, 4096, v9
  v_cmp_gt_u32 vcc, 8, v10
  v_mov_b32 v10, 0x40000000
  s_nop 0
  v_cndmask_b32 v9, v10, v9, vcc
  s_waitcnt vmcnt(18)
  ds_write_b128 v3, v[16:19] offset:0
  s_waitcnt lgkmcnt(0)
  ds_read_b64_tr_b16 v[56:57], v8 offset:0
  ds_read_b64_tr_b16 v[58:59], v8 offset:128
  s_waitcnt lgkmcnt(0)
  buffer_store_dwordx4 v[56:59], v2, s[28:31], s12 offen offset:0 sc1
  s_waitcnt vmcnt(18)
  ds_write_b128 v3, v[20:23] offset:1024
  s_waitcnt lgkmcnt(0)
  ds_read_b64_tr_b16 v[60:61], v8 offset:1024
  ds_read_b64_tr_b16 v[62:63], v8 offset:1152
  s_waitcnt lgkmcnt(0)
  buffer_store_dwordx4 v[60:63], v2, s[28:31], s12 offen offset:1024 sc1
  s_waitcnt vmcnt(18)
  ds_write_b128 v3, v[24:27] offset:0
  s_waitcnt lgkmcnt(0)
  ds_read_b64_tr_b16 v[56:57], v8 offset:0
  ds_read_b64_tr_b16 v[58:59], v8 offset:128
  s_waitcnt lgkmcnt(0)
  buffer_store_dwordx4 v[56:59], v2, s[28:31], s12 offen offset:2048 sc1
  s_waitcnt vmcnt(18)
  ds_write_b128 v3, v[28:31] offset:1024
  s_waitcnt lgkmcnt(0)
  ds_read_b64_tr_b16 v[60:61], v8 offset:1024
  ds_read_b64_tr_b16 v[62:63], v8 offset:1152
  s_waitcnt lgkmcnt(0)
  buffer_store_dwordx4 v[60:63], v2, s[28:31], s12 offen offset:3072 sc1
  s_waitcnt vmcnt(18)
  ds_write_b128 v3, v[32:35] offset:0
  s_waitcnt lgkmcnt(0)
  ds_read_b64_tr_b16 v[56:57], v8 offset:0
  ds_read_b64_tr_b16 v[58:59], v8 offset:128
  s_waitcnt lgkmcnt(0)
  buffer_store_dwordx4 v[56:59], v9, s[28:31], s12 offen sc1
  s_add_u32 s12, s12, 4608
  s_waitcnt vmcnt(18)
  ds_write_b128 v3, v[36:39] offset:1024
  s_waitcnt lgkmcnt(0)
  ds_read_b64_tr_b16 v[60:61], v8 offset:1024
  ds_read_b64_tr_b16 v[62:63], v8 offset:1152
  s_waitcnt lgkmcnt(0)
  buffer_store_dwordx4 v[60:63], v2, s[28:31], s12 offen offset:0 sc1
  s_waitcnt vmcnt(18)
  ds_write_b128 v3, v[40:43] offset:0
  s_waitcnt lgkmcnt(0)
  ds_read_b64_tr_b16 v[56:57], v8 offset:0
  ds_read_b64_tr_b16 v[58:59], v8 offset:128
  s_waitcnt lgkmcnt(0)
  buffer_store_dwordx4 v[56:59], v2, s[28:31], s12 offen offset:1024 sc1
  s_waitcnt vmcnt(18)
  ds_write_b128 v3, v[44:47] offset:1024
  s_waitcnt lgkmcnt(0)
  ds_read_b64_tr_b16 v[60:61], v8 offset:1024
  ds_read_b64_tr_b16 v[62:63], v8 offset:1152
  s_waitcnt lgkmcnt(0)
  buffer_store_dwordx4 v[60:63], v2, s[28:31], s12 offen offset:2048 sc1
  s_waitcnt vmcnt(18)
  ds_write_b128 v3, v[48:51] offset:0
  s_waitcnt lgkmcnt(0)
  ds_read_b64_tr_b16 v[56:57], v8 offset:0
  ds_read_b64_tr_b16 v[58:59], v8 offset:128
  s_waitcnt lgkmcnt(0)
  buffer_store_dwordx4 v[56:59], v2, s[28:31], s12 offen offset:3072 sc1
  s_waitcnt vmcnt(18)
  ds_write_b128 v3, v[52:55] offset:1024
  s_waitcnt lgkmcnt(0)
  ds_read_b64_tr_b16 v[60:61], v8 offset:1024
  ds_read_b64_tr_b16 v[62:63], v8 offset:1152
  s_waitcnt lgkmcnt(0)
  buffer_store_dwordx4 v[60:63], v9, s[28:31], s12 offen sc1
kf_front_kernel_warm:
  s_add_u32 s36, s20, 26439680
  s_addc_u32 s37, s21, 0
  s_and_b32 s37, s37, 0xffff
  s_mov_b32 s38, 9437184
  s_mov_b32 s39, 0x20000
  s_mul_i32 s17, s4, 9216
  v_mov_b32 v8, -1
  v_mov_b32 v9, -1
  v_mov_b32 v10, -1
  v_mov_b32 v11, -1
  buffer_store_dwordx4 v[8:11], v2, s[36:39], s17 offen offset:0 sc1
  buffer_store_dwordx4 v[8:11], v2, s[36:39], s17 offen offset:1024 sc1
  buffer_store_dwordx4 v[8:11], v2, s[36:39], s17 offen offset:2048 sc1
  buffer_store_dwordx4 v[8:11], v2, s[36:39], s17 offen offset:3072 sc1
  s_add_u32 s17, s17, 4096
  buffer_store_dwordx4 v[8:11], v2, s[36:39], s17 offen offset:0 sc1
  buffer_store_dwordx4 v[8:11], v2, s[36:39], s17 offen offset:1024 sc1
  buffer_store_dwordx4 v[8:11], v2, s[36:39], s17 offen offset:2048 sc1
  buffer_store_dwordx4 v[8:11], v2, s[36:39], s17 offen offset:3072 sc1
  s_add_u32 s17, s17, 4096
  buffer_store_dwordx4 v[8:11], v2, s[36:39], s17 offen offset:0 sc1
  s_mov_b32 s40, s20
  s_and_b32 s41, s21, 0xffff
  s_mov_b32 s42, 14086144
  s_mov_b32 s43, 0x20000
  s_lshr_b32 s5, s2, 3
  s_lshl_b32 s5, s5, 2
  s_add_u32 s5, s5, s3
  s_mul_i32 s6, s5, 5248
  s_add_u32 s6, s6, 5623808
  s_bfe_u32 s7, s2, 0x20001
  s_mul_i32 s7, s7, 1327104
  s_mul_i32 s5, s5, 10368
  s_add_u32 s7, s7, s5
  s_add_u32 s7, s7, 8777728
  v_lshlrev_b32 v10, 7, v1
  v_add_u32 v11, s7, v10
  v_add_u32 v12, s6, v10
  v_subrev_u32 v13, -2944, v11
  v_cmp_gt_u32 vcc, 41, v1
  s_nop 1
  v_cndmask_b32 v12, v13, v12, vcc
  s_barrier
  buffer_load_dword v9, v11, s[40:43], 0 offen
  buffer_load_dword v9, v12, s[40:43], 0 offen
  buffer_load_dword v9, v11, s[40:43], 0 offen offset:64
  buffer_load_dword v9, v12, s[40:43], 0 offen offset:64
  s_waitcnt vmcnt(0)
  s_endpgm
kf_front_kernel_main:
  s_and_b32 s4, s2, 7
  s_lshl_b32 s4, s4, 2
  s_bfe_u32 s5, s2, 0x20003
  s_add_u32 s4, s4, s5
  s_lshr_b32 s5, s2, 5
  s_lshr_b32 s6, s3, 2
  s_and_b32 s7, s3, 3
  s_lshl_b32 s22, s4, 2
  s_add_u32 s22, s22, s7
  v_lshlrev_b32 v2, 4, v1
  s_mul_i32 s10, s22, 18432
  s_mul_i32 s11, s6, 9216
  s_add_u32 s10, s10, s11
  s_waitcnt lgkmcnt(0)
  s_add_u32 s28, s20, 16384
  s_addc_u32 s29, s21, 0
  s_and_b32 s29, s29, 0xffff
  s_mov_b32 s30, 2359296
  s_mov_b32 s31, 0x20000
  buffer_load_dwordx4 v[112:115], v2, s[28:31], s10 offen offset:0
  buffer_load_dwordx4 v[116:119], v2, s[28:31], s10 offen offset:1024
  buffer_load_dwordx4 v[120:123], v2, s[28:31], s10 offen offset:2048
  buffer_load_dwordx4 v[124:127], v2, s[28:31], s10 offen offset:3072
  s_add_u32 s10, s10, 4096
  buffer_load_dwordx4 v[128:131], v2, s[28:31], s10 offen offset:0
  buffer_load_dwordx4 v[132:135], v2, s[28:31], s10 offen offset:1024
  buffer_load_dwordx4 v[136:139], v2, s[28:31], s10 offen offset:2048
  buffer_load_dwordx4 v[140:143], v2, s[28:31], s10 offen offset:3072
  s_add_u32 s10, s10, 4096
  buffer_load_dwordx4 v[144:147], v2, s[28:31], s10 offen offset:0
  s_add_u32 s32, s20, 3112960
  s_addc_u32 s33, s21, 0
  s_and_b32 s33, s33, 0xffff
  s_mov_b32 s34, 151552
  s_mov_b32 s35, 0x20000
  v_and_b32 v8, 15, v1
  v_lshrrev_b32 v9, 4, v1
  s_and_b32 s12, s3, 1
  s_lshl_b32 s12, s12, 4
  v_add_u32 v10, s12, v8
  s_mul_i32 s11, s6, 1152
  s_add_u32 s11, s11, 106496
  v_lshl_add_u32 v11, v9, 5, s11
  s_mul_i32 s11, s6, 9216
  s_add_u32 s11, s11, 8192
  v_add_u32 v13, s11, v2
  s_lshl_b32 s11, s7, 10
  s_add_u32 s11, s11, 26624
  v_add_u32 v14, s11, v2
  s_lshl_b32 s11, s7, 2
  s_add_u32 s11, s11, 31744
  v_mov_b32 v15, s11
  v_mov_b32 v16, 0
  ds_write_b32 v15, v16
  ds_write_b32 v15, v16 offset:16
  s_lshl_b32 s11, s3, 2
  s_add_u32 s11, s11, 31776
  v_mov_b32 v96, s11
  v_mov_b32 v97, 1
  ds_write_b32 v96, v16
  s_bfe_u32 s11, s3, 0x10001
  s_lshl_b32 s12, s11, 12
  s_add_u32 s12, s12, 145408
  v_lshl_add_u32 v3, v10, 4, s12
  s_lshl_b32 s11, s11, 9
  s_add_u32 s11, s11, 153600
  v_lshl_add_u32 v4, v10, 2, s11
  s_lshl_b32 s12, s6, 5
  v_lshl_add_u32 v5, v9, 2, s12
  v_lshlrev_b32 v6, 2, v9
  v_add_u32 v20, 0, v5
  v_mul_u32_u24 v17, 57, v20
  v_lshrrev_b32 v17, 10, v17
  v_mul_u32_u24 v18, 18, v17
  v_sub_u32 v20, v20, v18
  v_cmp_lt_u32 vcc, 15, v20
  v_lshl_add_u32 v18, v17, 10, v3
  v_lshl_add_u32 v17, v17, 7, v4
  v_lshrrev_b32 v19, 3, v20
  v_lshl_add_u32 v18, v19, 9, v18
  v_and_b32 v19, 7, v20
  v_lshl_add_u32 v18, v19, 1, v18
  v_cndmask_b32 v104, v18, v17, vcc
  v_add_u32 v20, 2, v5
  v_mul_u32_u24 v17, 57, v20
  v_lshrrev_b32 v17, 10, v17
  v_mul_u32_u24 v18, 18, v17
  v_sub_u32 v20, v20, v18
  v_cmp_lt_u32 vcc, 15, v20
  v_lshl_add_u32 v18, v17, 10, v3
  v_lshl_add_u32 v17, v17, 7, v4
  v_lshrrev_b32 v19, 3, v20
  v_lshl_add_u32 v18, v19, 9, v18
  v_and_b32 v19, 7, v20
  v_lshl_add_u32 v18, v19, 1, v18
  v_cndmask_b32 v105, v18, v17, vcc
  v_add_u32 v20, 64, v6
  v_mul_u32_u24 v17, 57, v20
  v_lshrrev_b32 v17, 10, v17
  v_mul_u32_u24 v18, 18, v17
  v_sub_u32 v20, v20, v18
  v_cmp_lt_u32 vcc, 15, v20
  v_lshl_add_u32 v18, v17, 10, v3
  v_lshl_add_u32 v17, v17, 7, v4
  v_lshrrev_b32 v19, 3, v20
  v_lshl_add_u32 v18, v19, 9, v18
  v_and_b32 v19, 7, v20
  v_lshl_add_u32 v18, v19, 1, v18
  v_cndmask_b32 v108, v18, v17, vcc
  v_add_u32 v20, 66, v6
  v_mul_u32_u24 v17, 57, v20
  v_lshrrev_b32 v17, 10, v17
  v_mul_u32_u24 v18, 18, v17
  v_sub_u32 v20, v20, v18
  v_cmp_lt_u32 vcc, 15, v20
  v_lshl_add_u32 v18, v17, 10, v3
  v_lshl_add_u32 v17, v17, 7, v4
  v_lshrrev_b32 v19, 3, v20
  v_lshl_add_u32 v18, v19, 9, v18
  v_and_b32 v19, 7, v20
  v_lshl_add_u32 v18, v19, 1, v18
  v_cndmask_b32 v109, v18, v17, vcc
  s_waitcnt lgkmcnt(0)
  s_barrier
  ds_read_b128 v[56:59], v11 offset:2304
  ds_read_b128 v[60:63], v11 offset:2320
  ds_read_b128 v[64:67], v11 offset:0
  ds_read_b128 v[68:71], v11 offset:16
  ds_read_b128 v[72:75], v11 offset:2432
  ds_read_b128 v[76:79], v11 offset:2448
  ds_read_b128 v[80:83], v11 offset:128
  ds_read_b128 v[84:87], v11 offset:144
  ds_read_b128 v[16:19], v13 offset:0
  s_waitcnt vmcnt(8) lgkmcnt(5)
  v_lshlrev_b32 v88, 16, v112
  v_and_b32 v89, 0xffff0000, v112
  v_lshlrev_b32 v90, 16, v113
  v_and_b32 v91, 0xffff0000, v113
  v_lshlrev_b32 v92, 16, v114
  v_and_b32 v93, 0xffff0000, v114
  v_lshlrev_b32 v94, 16, v115
  v_and_b32 v95, 0xffff0000, v115
  v_pk_fma_f32 v[88:89], v[88:89], v[56:57], v[64:65]
  v_pk_fma_f32 v[90:91], v[90:91], v[58:59], v[66:67]
  v_pk_fma_f32 v[92:93], v[92:93], v[60:61], v[68:69]
  v_pk_fma_f32 v[94:95], v[94:95], v[62:63], v[70:71]
  v_cvt_pk_bf16_f32 v112, v88, v89
  v_cvt_pk_bf16_f32 v113, v90, v91
  v_cvt_pk_bf16_f32 v114, v92, v93
  v_cvt_pk_bf16_f32 v115, v94, v95
  ds_read_b128 v[56:59], v11 offset:2560
  ds_read_b128 v[60:63], v11 offset:2576
  ds_read_b128 v[64:67], v11 offset:256
  ds_read_b128 v[68:71], v11 offset:272
  ds_read_b128 v[20:23], v13 offset:1024
  s_waitcnt vmcnt(7) lgkmcnt(6)
  v_lshlrev_b32 v88, 16, v116
  v_and_b32 v89, 0xffff0000, v116
  v_lshlrev_b32 v90, 16, v117
  v_and_b32 v91, 0xffff0000, v117
  v_lshlrev_b32 v92, 16, v118
  v_and_b32 v93, 0xffff0000, v118
  v_lshlrev_b32 v94, 16, v119
  v_and_b32 v95, 0xffff0000, v119
  v_pk_fma_f32 v[88:89], v[88:89], v[72:73], v[80:81]
  v_pk_fma_f32 v[90:91], v[90:91], v[74:75], v[82:83]
  v_pk_fma_f32 v[92:93], v[92:93], v[76:77], v[84:85]
  v_pk_fma_f32 v[94:95], v[94:95], v[78:79], v[86:87]
  v_cvt_pk_bf16_f32 v116, v88, v89
  v_cvt_pk_bf16_f32 v117, v90, v91
  v_cvt_pk_bf16_f32 v118, v92, v93
  v_cvt_pk_bf16_f32 v119, v94, v95
  ds_read_b128 v[72:75], v11 offset:2688
  ds_read_b128 v[76:79], v11 offset:2704
  ds_read_b128 v[80:83], v11 offset:384
  ds_read_b128 v[84:87], v11 offset:400
  ds_read_b128 v[24:27], v13 offset:2048
  s_waitcnt vmcnt(6) lgkmcnt(6)
  v_lshlrev_b32 v88, 16, v120
  v_and_b32 v89, 0xffff0000, v120
  v_lshlrev_b32 v90, 16, v121
  v_and_b32 v91, 0xffff0000, v121
  v_lshlrev_b32 v92, 16, v122
  v_and_b32 v93, 0xffff0000, v122
  v_lshlrev_b32 v94, 16, v123
  v_and_b32 v95, 0xffff0000, v123
  v_pk_fma_f32 v[88:89], v[88:89], v[56:57], v[64:65]
  v_pk_fma_f32 v[90:91], v[90:91], v[58:59], v[66:67]
  v_pk_fma_f32 v[92:93], v[92:93], v[60:61], v[68:69]
  v_pk_fma_f32 v[94:95], v[94:95], v[62:63], v[70:71]
  v_cvt_pk_bf16_f32 v120, v88, v89
  v_cvt_pk_bf16_f32 v121, v90, v91
  v_cvt_pk_bf16_f32 v122, v92, v93
  v_cvt_pk_bf16_f32 v123, v94, v95
  ds_read_b128 v[56:59], v11 offset:2816
  ds_read_b128 v[60:63], v11 offset:2832
  ds_read_b128 v[64:67], v11 offset:512
  ds_read_b128 v[68:71], v11 offset:528
  ds_read_b128 v[28:31], v13 offset:3072
  s_waitcnt vmcnt(5) lgkmcnt(6)
  v_lshlrev_b32 v88, 16, v124
  v_and_b32 v89, 0xffff0000, v124
  v_lshlrev_b32 v90, 16, v125
  v_and_b32 v91, 0xffff0000, v125
  v_lshlrev_b32 v92, 16, v126
  v_and_b32 v93, 0xffff0000, v126
  v_lshlrev_b32 v94, 16, v127
  v_and_b32 v95, 0xffff0000, v127
  v_pk_fma_f32 v[88:89], v[88:89], v[72:73], v[80:81]
  v_pk_fma_f32 v[90:91], v[90:91], v[74:75], v[82:83]
  v_pk_fma_f32 v[92:93], v[92:93], v[76:77], v[84:85]
  v_pk_fma_f32 v[94:95], v[94:95], v[78:79], v[86:87]
  v_cvt_pk_bf16_f32 v124, v88, v89
  v_cvt_pk_bf16_f32 v125, v90, v91
  v_cvt_pk_bf16_f32 v126, v92, v93
  v_cvt_pk_bf16_f32 v127, v94, v95
  ds_read_b128 v[72:75], v11 offset:2944
  ds_read_b128 v[76:79], v11 offset:2960
  ds_read_b128 v[80:83], v11 offset:640
  ds_read_b128 v[84:87], v11 offset:656
  ds_read_b128 v[32:35], v13 offset:4096
  s_waitcnt vmcnt(4) lgkmcnt(6)
  v_lshlrev_b32 v88, 16, v128
  v_and_b32 v89, 0xffff0000, v128
  v_lshlrev_b32 v90, 16, v129
  v_and_b32 v91, 0xffff0000, v129
  v_lshlrev_b32 v92, 16, v130
  v_and_b32 v93, 0xffff0000, v130
  v_lshlrev_b32 v94, 16, v131
  v_and_b32 v95, 0xffff0000, v131
  v_pk_fma_f32 v[88:89], v[88:89], v[56:57], v[64:65]
  v_pk_fma_f32 v[90:91], v[90:91], v[58:59], v[66:67]
  v_pk_fma_f32 v[92:93], v[92:93], v[60:61], v[68:69]
  v_pk_fma_f32 v[94:95], v[94:95], v[62:63], v[70:71]
  v_cvt_pk_bf16_f32 v128, v88, v89
  v_cvt_pk_bf16_f32 v129, v90, v91
  v_cvt_pk_bf16_f32 v130, v92, v93
  v_cvt_pk_bf16_f32 v131, v94, v95
  ds_read_b128 v[56:59], v11 offset:3072
  ds_read_b128 v[60:63], v11 offset:3088
  ds_read_b128 v[64:67], v11 offset:768
  ds_read_b128 v[68:71], v11 offset:784
  ds_read_b128 v[36:39], v13 offset:5120
  s_waitcnt vmcnt(3) lgkmcnt(6)
  v_lshlrev_b32 v88, 16, v132
  v_and_b32 v89, 0xffff0000, v132
  v_lshlrev_b32 v90, 16, v133
  v_and_b32 v91, 0xffff0000, v133
  v_lshlrev_b32 v92, 16, v134
  v_and_b32 v93, 0xffff0000, v134
  v_lshlrev_b32 v94, 16, v135
  v_and_b32 v95, 0xffff0000, v135
  v_pk_fma_f32 v[88:89], v[88:89], v[72:73], v[80:81]
  v_pk_fma_f32 v[90:91], v[90:91], v[74:75], v[82:83]
  v_pk_fma_f32 v[92:93], v[92:93], v[76:77], v[84:85]
  v_pk_fma_f32 v[94:95], v[94:95], v[78:79], v[86:87]
  v_cvt_pk_bf16_f32 v132, v88, v89
  v_cvt_pk_bf16_f32 v133, v90, v91
  v_cvt_pk_bf16_f32 v134, v92, v93
  v_cvt_pk_bf16_f32 v135, v94, v95
  ds_read_b128 v[72:75], v11 offset:3200
  ds_read_b128 v[76:79], v11 offset:3216
  ds_read_b128 v[80:83], v11 offset:896
  ds_read_b128 v[84:87], v11 offset:912
  ds_read_b128 v[40:43], v13 offset:6144
  s_waitcnt vmcnt(2) lgkmcnt(6)
  v_lshlrev_b32 v88, 16, v136
  v_and_b32 v89, 0xffff0000, v136
  v_lshlrev_b32 v90, 16, v137
  v_and_b32 v91, 0xffff0000, v137
  v_lshlrev_b32 v92, 16, v138
  v_and_b32 v93, 0xffff0000, v138
  v_lshlrev_b32 v94, 16, v139
  v_and_b32 v95, 0xffff0000, v139
  v_pk_fma_f32 v[88:89], v[88:89], v[56:57], v[64:65]
  v_pk_fma_f32 v[90:91], v[90:91], v[58:59], v[66:67]
  v_pk_fma_f32 v[92:93], v[92:93], v[60:61], v[68:69]
  v_pk_fma_f32 v[94:95], v[94:95], v[62:63], v[70:71]
  v_cvt_pk_bf16_f32 v136, v88, v89
  v_cvt_pk_bf16_f32 v137, v90, v91
  v_cvt_pk_bf16_f32 v138, v92, v93
  v_cvt_pk_bf16_f32 v139, v94, v95
  ds_read_b128 v[56:59], v11 offset:3328
  ds_read_b128 v[60:63], v11 offset:3344
  ds_read_b128 v[64:67], v11 offset:1024
  ds_read_b128 v[68:71], v11 offset:1040
  ds_read_b128 v[44:47], v13 offset:7168
  s_waitcnt vmcnt(1) lgkmcnt(6)
  v_lshlrev_b32 v88, 16, v140
  v_and_b32 v89, 0xffff0000, v140
  v_lshlrev_b32 v90, 16, v141
  v_and_b32 v91, 0xffff0000, v141
  v_lshlrev_b32 v92, 16, v142
  v_and_b32 v93, 0xffff0000, v142
  v_lshlrev_b32 v94, 16, v143
  v_and_b32 v95, 0xffff0000, v143
  v_pk_fma_f32 v[88:89], v[88:89], v[72:73], v[80:81]
  v_pk_fma_f32 v[90:91], v[90:91], v[74:75], v[82:83]
  v_pk_fma_f32 v[92:93], v[92:93], v[76:77], v[84:85]
  v_pk_fma_f32 v[94:95], v[94:95], v[78:79], v[86:87]
  v_cvt_pk_bf16_f32 v140, v88, v89
  v_cvt_pk_bf16_f32 v141, v90, v91
  v_cvt_pk_bf16_f32 v142, v92, v93
  v_cvt_pk_bf16_f32 v143, v94, v95
  ds_read_b128 v[48:51], v13 offset:8192
  s_waitcnt vmcnt(0) lgkmcnt(2)
  v_lshlrev_b32 v88, 16, v144
  v_and_b32 v89, 0xffff0000, v144
  v_lshlrev_b32 v90, 16, v145
  v_and_b32 v91, 0xffff0000, v145
  v_lshlrev_b32 v92, 16, v146
  v_and_b32 v93, 0xffff0000, v146
  v_lshlrev_b32 v94, 16, v147
  v_and_b32 v95, 0xffff0000, v147
  v_pk_fma_f32 v[88:89], v[88:89], v[56:57], v[64:65]
  v_pk_fma_f32 v[90:91], v[90:91], v[58:59], v[66:67]
  v_pk_fma_f32 v[92:93], v[92:93], v[60:61], v[68:69]
  v_pk_fma_f32 v[94:95], v[94:95], v[62:63], v[70:71]
  v_cvt_pk_bf16_f32 v144, v88, v89
  v_cvt_pk_bf16_f32 v145, v90, v91
  v_cvt_pk_bf16_f32 v146, v92, v93
  v_cvt_pk_bf16_f32 v147, v94, v95
  s_waitcnt lgkmcnt(0)
  v_mfma_f32_16x16x32_bf16 v[164:167], v[16:19], v[112:115], 0
  v_mfma_f32_16x16x32_bf16 v[164:167], v[20:23], v[116:119], v[164:167]
  v_mfma_f32_16x16x32_bf16 v[164:167], v[24:27], v[120:123], v[164:167]
  v_mfma_f32_16x16x32_bf16 v[164:167], v[28:31], v[124:127], v[164:167]
  v_mfma_f32_16x16x32_bf16 v[164:167], v[32:35], v[128:131], v[164:167]
  v_mfma_f32_16x16x32_bf16 v[164:167], v[36:39], v[132:135], v[164:167]
  v_mfma_f32_16x16x32_bf16 v[164:167], v[40:43], v[136:139], v[164:167]
  v_mfma_f32_16x16x32_bf16 v[164:167], v[44:47], v[140:143], v[164:167]
  v_mfma_f32_16x16x32_bf16 v[164:167], v[48:51], v[144:147], v[164:167]
  v_and_b32 v7, 1, v9
  v_mov_b32 v16, 0x3eae1a93
  v_cmp_gt_u32 vcc, 32, v1
  s_nop 1
  v_cndmask_b32 v17, 1.0, v16, vcc
  s_lshr_b32 s13, s22, 1
  s_cmp_eq_u32 s6, 0
  s_cbranch_scc1 kf_front_kernel_t4r
  ds_write_b128 v14, v[164:167]
  v_mov_b32 v18, 1
  s_waitcnt lgkmcnt(0)
  ds_write_b32 v15, v18
  s_branch kf_front_kernel_kvd
kf_front_kernel_t4r:
  ds_read_b32 v18, v15
  s_waitcnt lgkmcnt(0)
  v_cmp_eq_u32 vcc, 0, v18
  s_nop 4
  s_cbranch_vccnz kf_front_kernel_t4r
  ds_read_b128 v[20:23], v14
  s_waitcnt lgkmcnt(0)
  v_pk_add_f32 v[164:165], v[164:165], v[20:21]
  v_pk_add_f32 v[166:167], v[166:167], v[22:23]
  v_mul_f32 v164, v17, v164
  v_mul_f32 v165, v17, v165
  v_mul_f32 v166, v17, v166
  v_mul_f32 v167, v17, v167
  v_cvt_pk_bf16_f32 v32, v164, v165
  v_cvt_pk_bf16_f32 v33, v166, v167
  s_mov_b32 s17, 0xfffefffe
  v_pk_min_u16 v32, v32, s17
  v_pk_min_u16 v33, v33, s17
  s_mov_b32 exec_hi, 0
  ds_write_b32 v108, v32
  ds_write_b32 v109, v33
  s_mov_b32 exec_hi, -1
  s_mov_b32 exec_lo, 0
  s_cmp_ge_u32 s5, 6
  s_cbranch_scc1 kf_front_kernel_kvd
  s_cmp_ge_u32 s5, 3
  s_cbranch_scc1 kf_front_kernel_vpart
  s_cmp_eq_u32 s5, 2
  s_cbranch_scc1 kf_front_kernel_ktail
  v_lshlrev_b32 v19, 4, v10
  v_lshl_add_u32 v19, v7, 3, v19
  s_lshl_b32 s17, s13, 10
  s_lshl_b32 s18, s5, 9
  s_add_u32 s17, s17, s18
  buffer_store_dwordx2 v[32:33], v19, s[32:35], s17 offen sc1
  s_branch kf_front_kernel_kvd
kf_front_kernel_ktail:
  s_mov_b32 exec_hi, 0xffff
  v_lshlrev_b32 v19, 2, v8
  s_lshl_b32 s17, s22, 6
  s_add_u32 s17, s17, 65536
  buffer_store_dword v32, v19, s[32:35], s17 offen sc1
  s_branch kf_front_kernel_kvd
kf_front_kernel_vpart:
  v_bfe_u32 v19, v8, 2, 1
  v_lshlrev_b32 v19, 7, v19
  v_and_b32 v34, 3, v8
  v_lshl_add_u32 v19, v34, 1, v19
  v_lshrrev_b32 v34, 3, v8
  v_lshl_add_u32 v19, v34, 3, v19
  v_lshl_add_u32 v19, v7, 6, v19
  s_lshl_b32 s18, s3, 8
  s_add_u32 s18, s18, 30720
  v_add_u32 v19, s18, v19
  s_cmp_eq_u32 s5, 5
  s_cselect_b32 s17, 0x3f80, 0
  s_cselect_b32 s19, 0, -1
  v_and_b32 v33, s19, v33
  v_or_b32 v33, s17, v33
  ds_write_b16 v19, v32
  ds_write_b16_d16_hi v19, v32 offset:16
  ds_write_b16 v19, v33 offset:32
  ds_write_b16_d16_hi v19, v33 offset:48
  s_cselect_b32 exec_lo, 0x0707, -1
  s_and_b32 exec_lo, exec_lo, 0xffff
  s_mov_b32 exec_hi, 0
  v_add_u32 v19, s18, v2
  v_lshrrev_b32 v34, 3, v1
  v_mul_u32_u24 v34, 176, v34
  v_add_u32 v34, v34, v2
  s_mul_i32 s17, s22, 608
  s_sub_u32 s18, s5, 3
  s_lshl_b32 s18, s18, 7
  s_add_u32 s17, s17, s18
  s_add_u32 s17, s17, 73728
  s_waitcnt lgkmcnt(0)
  ds_read_b128 v[40:43], v19
  s_waitcnt lgkmcnt(0)
  buffer_store_dwordx4 v[40:43], v34, s[32:35], s17 offen sc1
kf_front_kernel_kvd:
  s_mov_b64 exec, -1
  s_mul_i32 s11, s6, 79872
  s_add_u32 s11, s11, 40960
  s_lshl_b32 s12, s6, 11
  s_add_u32 s13, s11, s12
  v_add_u32 v12, s13, v2
  s_xor_b32 s12, s12, 2048
  s_add_u32 s13, s11, s12
  v_add_u32 v13, s13, v2
  s_mul_i32 s11, s6, 67584
  s_sub_u32 s11, 40960, s11
  v_add_u32 v14, s11, v12
  v_add_u32 v15, s11, v13
  v_and_b32 v88, 3, v1
  v_lshlrev_b32 v88, 2, v88
kf_front_kernel_ww:
  ds_read_b32 v89, v88 offset:31760
  s_waitcnt lgkmcnt(0)
  v_cmp_eq_u32 vcc, 0, v89
  s_nop 4
  s_cbranch_vccnz kf_front_kernel_ww
  ds_read_b128 v[16:19], v12 offset:0
  ds_read_b128 v[20:23], v12 offset:1024
  ds_read_b128 v[24:27], v13 offset:0
  ds_read_b128 v[28:31], v13 offset:1024
  ds_read_b128 v[36:39], v12 offset:4096
  ds_read_b128 v[40:43], v12 offset:5120
  ds_read_b128 v[44:47], v13 offset:4096
  ds_read_b128 v[48:51], v13 offset:5120
  ds_read_b128 v[56:59], v12 offset:8192
  ds_read_b128 v[60:63], v12 offset:9216
  ds_read_b128 v[64:67], v13 offset:8192
  ds_read_b128 v[68:71], v13 offset:9216
  s_waitcnt lgkmcnt(8)
  v_mfma_f32_16x16x32_bf16 v[148:151], v[16:19], v[112:115], 0
  ds_read_b128 v[72:75], v12 offset:12288
  v_mfma_f32_16x16x32_bf16 v[152:155], v[20:23], v[112:115], 0
  ds_read_b128 v[76:79], v12 offset:13312
  v_mfma_f32_16x16x32_bf16 v[156:159], v[24:27], v[112:115], 0
  ds_read_b128 v[80:83], v13 offset:12288
  v_mfma_f32_16x16x32_bf16 v[160:163], v[28:31], v[112:115], 0
  ds_read_b128 v[84:87], v13 offset:13312
  v_add_u32 v91, 16, v5
  v_mul_u32_u24 v88, 57, v91
  v_lshrrev_b32 v88, 10, v88
  v_mul_u32_u24 v89, 18, v88
  v_sub_u32 v91, v91, v89
  v_cmp_lt_u32 vcc, 15, v91
  v_lshl_add_u32 v89, v88, 10, v3
  s_waitcnt lgkmcnt(8)
  v_mfma_f32_16x16x32_bf16 v[148:151], v[36:39], v[116:119], v[148:151]
  ds_read_b128 v[16:19], v12 offset:16384
  v_mfma_f32_16x16x32_bf16 v[152:155], v[40:43], v[116:119], v[152:155]
  ds_read_b128 v[20:23], v12 offset:17408
  v_mfma_f32_16x16x32_bf16 v[156:159], v[44:47], v[116:119], v[156:159]
  ds_read_b128 v[24:27], v13 offset:16384
  v_mfma_f32_16x16x32_bf16 v[160:163], v[48:51], v[116:119], v[160:163]
  ds_read_b128 v[28:31], v13 offset:17408
  v_lshl_add_u32 v88, v88, 7, v4
  v_lshrrev_b32 v90, 3, v91
  v_lshl_add_u32 v89, v90, 9, v89
  v_and_b32 v90, 7, v91
  v_lshl_add_u32 v89, v90, 1, v89
  v_cndmask_b32 v106, v89, v88, vcc
  v_add_u32 v91, 18, v5
  s_waitcnt lgkmcnt(8)
  v_mfma_f32_16x16x32_bf16 v[148:151], v[56:59], v[120:123], v[148:151]
  ds_read_b128 v[36:39], v12 offset:20480
  v_mfma_f32_16x16x32_bf16 v[152:155], v[60:63], v[120:123], v[152:155]
  ds_read_b128 v[40:43], v12 offset:21504
  v_mfma_f32_16x16x32_bf16 v[156:159], v[64:67], v[120:123], v[156:159]
  ds_read_b128 v[44:47], v13 offset:20480
  v_mfma_f32_16x16x32_bf16 v[160:163], v[68:71], v[120:123], v[160:163]
  ds_read_b128 v[48:51], v13 offset:21504
  v_mul_u32_u24 v88, 57, v91
  v_lshrrev_b32 v88, 10, v88
  v_mul_u32_u24 v89, 18, v88
  v_sub_u32 v91, v91, v89
  v_cmp_lt_u32 vcc, 15, v91
  v_lshl_add_u32 v89, v88, 10, v3
  v_lshl_add_u32 v88, v88, 7, v4
  s_waitcnt vmcnt(0)
  ds_write_b32 v96, v97
  s_waitcnt lgkmcnt(9)
  v_mfma_f32_16x16x32_bf16 v[148:151], v[72:75], v[124:127], v[148:151]
  ds_read_b128 v[56:59], v14 offset:0
  v_mfma_f32_16x16x32_bf16 v[152:155], v[76:79], v[124:127], v[152:155]
  ds_read_b128 v[60:63], v14 offset:1024
  v_mfma_f32_16x16x32_bf16 v[156:159], v[80:83], v[124:127], v[156:159]
  ds_read_b128 v[64:67], v15 offset:0
  v_mfma_f32_16x16x32_bf16 v[160:163], v[84:87], v[124:127], v[160:163]
  ds_read_b128 v[68:71], v15 offset:1024
  v_lshrrev_b32 v90, 3, v91
  v_lshl_add_u32 v89, v90, 9, v89
  v_and_b32 v90, 7, v91
  v_lshl_add_u32 v89, v90, 1, v89
  v_cndmask_b32 v107, v89, v88, vcc
  s_bfe_u32 s11, s3, 0x10001
  s_lshl_b32 s4, s4, 1
  s_waitcnt lgkmcnt(9)
  v_mfma_f32_16x16x32_bf16 v[148:151], v[16:19], v[128:131], v[148:151]
  ds_read_b128 v[72:75], v14 offset:4096
  v_mfma_f32_16x16x32_bf16 v[152:155], v[20:23], v[128:131], v[152:155]
  ds_read_b128 v[76:79], v14 offset:5120
  v_mfma_f32_16x16x32_bf16 v[156:159], v[24:27], v[128:131], v[156:159]
  ds_read_b128 v[80:83], v15 offset:4096
  v_mfma_f32_16x16x32_bf16 v[160:163], v[28:31], v[128:131], v[160:163]
  ds_read_b128 v[84:87], v15 offset:5120
  s_add_u32 s4, s4, s11
  s_and_b32 s7, s3, 1
  s_lshl_b32 s7, s7, 1
  s_add_u32 s7, s7, s6
  s_lshl_b32 s11, s11, 2
  s_add_u32 s11, s11, s7
  s_xor_b32 s12, s11, 1
  s_waitcnt lgkmcnt(9)
  v_mfma_f32_16x16x32_bf16 v[148:151], v[36:39], v[132:135], v[148:151]
  ds_read_b128 v[16:19], v14 offset:8192
  v_mfma_f32_16x16x32_bf16 v[152:155], v[40:43], v[132:135], v[152:155]
  ds_read_b128 v[20:23], v14 offset:9216
  v_mfma_f32_16x16x32_bf16 v[156:159], v[44:47], v[132:135], v[156:159]
  ds_read_b128 v[24:27], v15 offset:8192
  v_mfma_f32_16x16x32_bf16 v[160:163], v[48:51], v[132:135], v[160:163]
  ds_read_b128 v[28:31], v15 offset:9216
  s_lshl_b32 s13, s11, 10
  s_lshl_b32 s14, s12, 10
  s_lshl_b32 s11, s11, 7
  s_lshl_b32 s12, s12, 7
  v_add_u32 v92, 145408, v2
  v_add_u32 v93, s14, v92
  v_add_u32 v92, s13, v92
  s_waitcnt lgkmcnt(8)
  v_mfma_f32_16x16x32_bf16 v[148:151], v[56:59], v[136:139], v[148:151]
  v_mfma_f32_16x16x32_bf16 v[152:155], v[60:63], v[136:139], v[152:155]
  v_mfma_f32_16x16x32_bf16 v[156:159], v[64:67], v[136:139], v[156:159]
  v_mfma_f32_16x16x32_bf16 v[160:163], v[68:71], v[136:139], v[160:163]
  v_and_b32 v110, 31, v1
  v_lshlrev_b32 v111, 2, v110
  v_add_u32 v94, 153600, v111
  v_add_u32 v95, s12, v94
  v_add_u32 v94, s11, v94
  v_cmp_gt_u32 vcc, 32, v1
  s_lshl_b32 s5, s5, 2
  s_waitcnt lgkmcnt(4)
  v_mfma_f32_16x16x32_bf16 v[148:151], v[72:75], v[140:143], v[148:151]
  v_mfma_f32_16x16x32_bf16 v[152:155], v[76:79], v[140:143], v[152:155]
  v_mfma_f32_16x16x32_bf16 v[156:159], v[80:83], v[140:143], v[156:159]
  v_mfma_f32_16x16x32_bf16 v[160:163], v[84:87], v[140:143], v[160:163]
  s_add_u32 s7, s7, s5
  v_cndmask_b32 v94, v95, v94, vcc
  s_lshl_b32 s16, s6, 15
  v_add_u32 v0, s16, v2
  s_lshl_b32 s16, s6, 12
  s_add_u32 s16, s16, 65536
  v_add_u32 v7, s16, v111
  s_waitcnt lgkmcnt(0)
  v_mfma_f32_16x16x32_bf16 v[148:151], v[16:19], v[144:147], v[148:151]
  v_mfma_f32_16x16x32_bf16 v[152:155], v[20:23], v[144:147], v[152:155]
  v_mfma_f32_16x16x32_bf16 v[156:159], v[24:27], v[144:147], v[156:159]
  v_mfma_f32_16x16x32_bf16 v[160:163], v[28:31], v[144:147], v[160:163]
  v_min_u32 v110, 18, v110
  v_lshrrev_b32 v111, 5, v1
  v_mul_u32_u24 v111, 304, v111
  v_lshl_add_u32 v110, v110, 4, v111
  s_mul_i32 s16, s6, 38912
  s_add_u32 s16, s16, 73728
  v_add_u32 v11, s16, v110
  s_lshl_b32 s11, s3, 11
  s_add_u32 s11, s11, 8192
  v_add_u32 v13, s11, v2
  s_xor_b32 s12, s3, 4
  s_lshl_b32 s12, s12, 11
  s_add_u32 s12, s12, 8192
  v_add_u32 v14, s12, v2
  v_mov_b32 v16, 0x3eae1a93
  ds_write_b128 v13, v[156:159]
  ds_write_b128 v13, v[160:163] offset:1024
  s_waitcnt lgkmcnt(0)
  s_barrier
  ds_read_b128 v[24:27], v14
  ds_read_b128 v[28:31], v14 offset:1024
  s_waitcnt lgkmcnt(0)
  v_pk_add_f32 v[148:149], v[148:149], v[24:25]
  v_pk_add_f32 v[150:151], v[150:151], v[26:27]
  v_pk_mul_f32 v[148:149], v[148:149], v[16:17] op_sel_hi:[1,0]
  v_pk_mul_f32 v[150:151], v[150:151], v[16:17] op_sel_hi:[1,0]
  v_cvt_pk_bf16_f32 v36, v148, v149
  v_cvt_pk_bf16_f32 v37, v150, v151
  ds_write_b32 v104, v36
  ds_write_b32 v105, v37
  v_pk_add_f32 v[152:153], v[152:153], v[28:29]
  v_pk_add_f32 v[154:155], v[154:155], v[30:31]
  v_pk_mul_f32 v[152:153], v[152:153], v[16:17] op_sel_hi:[1,0]
  v_pk_mul_f32 v[154:155], v[154:155], v[16:17] op_sel_hi:[1,0]
  v_cvt_pk_bf16_f32 v38, v152, v153
  v_cvt_pk_bf16_f32 v39, v154, v155
  ds_write_b32 v106, v38
  ds_write_b32 v107, v39
  s_waitcnt lgkmcnt(0)
  s_barrier
  ds_read_b128 v[128:131], v92
  ds_read_b128 v[132:135], v93
  ds_read_b32 v136, v94
  s_mov_b32 s23, 0
kf_front_kernel_again:
  s_cmp_eq_u32 s23, 0
  s_cbranch_scc1 kf_front_kernel_m0
  s_lshl_b32 s17, s3, 10
  s_mov_b32 s9, 200000
kf_front_kernel_ldall:
  s_mov_b32 m0, s17
  v_add_u32 v14, s17, v2
  buffer_load_dwordx4 v2, s[32:35], s17 offen sc1 lds
  s_waitcnt vmcnt(0)
  ds_read_b128 v[20:23], v14 offset:0
  s_waitcnt lgkmcnt(0)
  v_max_u32 v16, v20, v21
  v_max_u32 v17, v22, v23
  v_max_u32 v16, v16, v17
  v_cmp_eq_u32 vcc, -1, v16
  s_sub_u32 s9, s9, 1
  s_cselect_b64 vcc, 0, vcc
  s_nop 2
  s_cbranch_vccnz kf_front_kernel_ldall
  s_add_u32 s17, s17, 8192
  s_cmp_lt_u32 s17, 151552
  s_cbranch_scc1 kf_front_kernel_ldall
kf_front_kernel_m0:
  v_mov_b32 v137, 0
  v_mov_b32 v149, 0x3f803f80
  v_mov_b32 v151, 0x3f803f80
  v_and_b32 v10, 31, v1
  v_lshlrev_b32 v10, 2, v10
  v_add_u32 v10, 65536, v10
  v_mov_b32 v9, v2
  v_mov_b32 v12, 0xff800000
  v_mov_b32 v13, 0xff800000
  s_cmp_eq_u32 s23, 0
  s_cselect_b32 s16, 1, 64
  v_cmp_gt_u32 vcc, 32, v1
  s_waitcnt vmcnt(0) lgkmcnt(0)
  s_barrier
kf_front_kernel_sh:
  ds_read_b128 v[140:143], v9
  ds_read_b32 v148, v10
  v_add_u32 v9, 1024, v9
  v_add_u32 v10, 128, v10
  s_waitcnt lgkmcnt(0)
  v_mfma_f32_32x32x4bf16_1k v[16:47], v[148:149], v[136:137], 0
  s_nop 15
  s_nop 1
  v_mfma_f32_32x32x16_bf16 v[16:31], v[140:143], v[128:131], v[16:31]
  v_mfma_f32_32x32x16_bf16 v[32:47], v[140:143], v[132:135], v[32:47]
  s_nop 10
  v_max3_f32 v12, v16, v17, v12
  v_max3_f32 v12, v18, v19, v12
  v_max3_f32 v12, v20, v21, v12
  v_max3_f32 v12, v22, v23, v12
  v_max3_f32 v12, v24, v25, v12
  v_max3_f32 v12, v26, v27, v12
  v_max3_f32 v12, v28, v29, v12
  v_max3_f32 v12, v30, v31, v12
  v_max3_f32 v13, v32, v33, v13
  v_max3_f32 v13, v34, v35, v13
  v_max3_f32 v13, v36, v37, v13
  v_max3_f32 v13, v38, v39, v13
  v_max3_f32 v13, v40, v41, v13
  v_max3_f32 v13, v42, v43, v13
  v_max3_f32 v13, v44, v45, v13
  v_max3_f32 v13, v46, v47, v13
  s_sub_u32 s16, s16, 1
  s_cmp_lg_u32 s16, 0
  s_cbranch_scc1 kf_front_kernel_sh
  ds_read_b128 v[140:143], v0 offset:0
  ds_read_b32 v148, v7 offset:0
  ds_read_b128 v[144:147], v0 offset:1024
  ds_read_b32 v150, v7 offset:128
  ds_read_b128 v[152:155], v11 offset:0
  ds_read_b128 v[156:159], v11 offset:608
  v_mov_b32 v14, v12
  v_mov_b32 v15, v13
  s_nop 0
  v_permlane32_swap_b32 v12, v14
  v_permlane32_swap_b32 v13, v15
  v_max_f32 v12, v12, v14
  v_max_f32 v13, v13, v15
  v_cndmask_b32 v12, v13, v12, vcc
  v_cvt_pk_bf16_f32 v15, v12, v12
  v_and_b32 v15, 0xffff0000, v15
  v_sub_f32 v12, v15, v12
  v_cvt_pk_bf16_f32 v137, -v15, v12
  s_waitcnt lgkmcnt(0)
  s_nop 0
  v_mfma_f32_32x32x4bf16_1k v[16:47], v[148:149], v[136:137], 0
  s_nop 15
  s_nop 1
  v_mfma_f32_32x32x16_bf16 v[16:31], v[140:143], v[128:131], v[16:31]
  v_mfma_f32_32x32x16_bf16 v[32:47], v[140:143], v[132:135], v[32:47]
  v_mfma_f32_32x32x4bf16_1k v[48:79], v[150:151], v[136:137], 0
  s_nop 9
  v_exp_f32 v16, v16
  v_exp_f32 v17, v17
  v_exp_f32 v18, v18
  v_exp_f32 v19, v19
  v_exp_f32 v20, v20
  v_exp_f32 v21, v21
  v_cvt_pk_bf16_f32 v112, v16, v17
  v_exp_f32 v22, v22
  v_exp_f32 v23, v23
  v_cvt_pk_bf16_f32 v113, v18, v19
  v_exp_f32 v24, v24
  v_exp_f32 v25, v25
  v_cvt_pk_bf16_f32 v114, v20, v21
  v_exp_f32 v26, v26
  v_exp_f32 v27, v27
  v_cvt_pk_bf16_f32 v115, v22, v23
  v_exp_f32 v28, v28
  v_exp_f32 v29, v29
  v_cvt_pk_bf16_f32 v116, v24, v25
  v_exp_f32 v30, v30
  v_exp_f32 v31, v31
  v_cvt_pk_bf16_f32 v117, v26, v27
  v_cvt_pk_bf16_f32 v118, v28, v29
  v_cvt_pk_bf16_f32 v119, v30, v31
  s_waitcnt lgkmcnt(0)
  v_mfma_f32_32x32x16_bf16 v[48:63], v[144:147], v[128:131], v[48:63]
  ds_read_b128 v[160:163], v11 offset:1216
  ds_read_b128 v[164:167], v11 offset:1824
  v_exp_f32 v32, v32
  v_exp_f32 v33, v33
  v_exp_f32 v34, v34
  v_exp_f32 v35, v35
  v_exp_f32 v36, v36
  v_exp_f32 v37, v37
  v_mfma_f32_32x32x16_bf16 v[64:79], v[144:147], v[132:135], v[64:79]
  ds_read_b32 v148, v7 offset:256
  v_cvt_pk_bf16_f32 v120, v32, v33
  v_exp_f32 v38, v38
  v_exp_f32 v39, v39
  v_cvt_pk_bf16_f32 v121, v34, v35
  v_exp_f32 v40, v40
  v_exp_f32 v41, v41
  v_mfma_f32_32x32x16_bf16 v[80:95], v[152:155], v[112:115], 0
  ds_read_b128 v[140:143], v0 offset:2048
  v_cvt_pk_bf16_f32 v122, v36, v37
  v_exp_f32 v42, v42
  v_exp_f32 v43, v43
  v_cvt_pk_bf16_f32 v123, v38, v39
  v_exp_f32 v44, v44
  v_exp_f32 v45, v45
  v_mfma_f32_32x32x16_bf16 v[80:95], v[156:159], v[116:119], v[80:95]
  v_cvt_pk_bf16_f32 v124, v40, v41
  v_exp_f32 v46, v46
  v_exp_f32 v47, v47
  v_cvt_pk_bf16_f32 v125, v42, v43
  v_cvt_pk_bf16_f32 v126, v44, v45
  v_cvt_pk_bf16_f32 v127, v46, v47
  s_waitcnt lgkmcnt(1)
  v_mfma_f32_32x32x4bf16_1k v[16:47], v[148:149], v[136:137], 0
  v_exp_f32 v48, v48
  v_exp_f32 v49, v49
  v_exp_f32 v50, v50
  v_exp_f32 v51, v51
  v_exp_f32 v52, v52
  v_exp_f32 v53, v53
  v_cvt_pk_bf16_f32 v112, v48, v49
  v_exp_f32 v54, v54
  v_exp_f32 v55, v55
  v_cvt_pk_bf16_f32 v113, v50, v51
  v_exp_f32 v56, v56
  v_exp_f32 v57, v57
  v_mfma_f32_32x32x16_bf16 v[96:111], v[152:155], v[120:123], 0
  v_cvt_pk_bf16_f32 v114, v52, v53
  v_exp_f32 v58, v58
  v_exp_f32 v59, v59
  v_cvt_pk_bf16_f32 v115, v54, v55
  v_exp_f32 v60, v60
  v_exp_f32 v61, v61
  v_mfma_f32_32x32x16_bf16 v[96:111], v[156:159], v[124:127], v[96:111]
  v_cvt_pk_bf16_f32 v116, v56, v57
  v_exp_f32 v62, v62
  v_exp_f32 v63, v63
  v_cvt_pk_bf16_f32 v117, v58, v59
  v_cvt_pk_bf16_f32 v118, v60, v61
  v_cvt_pk_bf16_f32 v119, v62, v63
  s_waitcnt lgkmcnt(0)
  v_mfma_f32_32x32x16_bf16 v[16:31], v[140:143], v[128:131], v[16:31]
  ds_read_b128 v[152:155], v11 offset:2432
  ds_read_b128 v[156:159], v11 offset:3040
  v_exp_f32 v64, v64
  v_exp_f32 v65, v65
  v_exp_f32 v66, v66
  v_exp_f32 v67, v67
  v_exp_f32 v68, v68
  v_exp_f32 v69, v69
  v_mfma_f32_32x32x16_bf16 v[32:47], v[140:143], v[132:135], v[32:47]
  ds_read_b32 v150, v7 offset:384
  v_cvt_pk_bf16_f32 v120, v64, v65
  v_exp_f32 v70, v70
  v_exp_f32 v71, v71
  v_cvt_pk_bf16_f32 v121, v66, v67
  v_exp_f32 v72, v72
  v_exp_f32 v73, v73
  v_mfma_f32_32x32x16_bf16 v[80:95], v[160:163], v[112:115], v[80:95]
  ds_read_b128 v[144:147], v0 offset:3072
  v_cvt_pk_bf16_f32 v122, v68, v69
  v_exp_f32 v74, v74
  v_exp_f32 v75, v75
  v_cvt_pk_bf16_f32 v123, v70, v71
  v_exp_f32 v76, v76
  v_exp_f32 v77, v77
  v_mfma_f32_32x32x16_bf16 v[80:95], v[164:167], v[116:119], v[80:95]
  v_cvt_pk_bf16_f32 v124, v72, v73
  v_exp_f32 v78, v78
  v_exp_f32 v79, v79
  v_cvt_pk_bf16_f32 v125, v74, v75
  v_cvt_pk_bf16_f32 v126, v76, v77
  v_cvt_pk_bf16_f32 v127, v78, v79
  s_waitcnt lgkmcnt(1)
  v_mfma_f32_32x32x4bf16_1k v[48:79], v[150:151], v[136:137], 0
  v_exp_f32 v16, v16
  v_exp_f32 v17, v17
  v_exp_f32 v18, v18
  v_exp_f32 v19, v19
  v_exp_f32 v20, v20
  v_exp_f32 v21, v21
  v_cvt_pk_bf16_f32 v112, v16, v17
  v_exp_f32 v22, v22
  v_exp_f32 v23, v23
  v_cvt_pk_bf16_f32 v113, v18, v19
  v_exp_f32 v24, v24
  v_exp_f32 v25, v25
  v_mfma_f32_32x32x16_bf16 v[96:111], v[160:163], v[120:123], v[96:111]
  v_cvt_pk_bf16_f32 v114, v20, v21
  v_exp_f32 v26, v26
  v_exp_f32 v27, v27
  v_cvt_pk_bf16_f32 v115, v22, v23
  v_exp_f32 v28, v28
  v_exp_f32 v29, v29
  v_mfma_f32_32x32x16_bf16 v[96:111], v[164:167], v[124:127], v[96:111]
  v_cvt_pk_bf16_f32 v116, v24, v25
  v_exp_f32 v30, v30
  v_exp_f32 v31, v31
  v_cvt_pk_bf16_f32 v117, v26, v27
  v_cvt_pk_bf16_f32 v118, v28, v29
  v_cvt_pk_bf16_f32 v119, v30, v31
  s_waitcnt lgkmcnt(0)
  v_mfma_f32_32x32x16_bf16 v[48:63], v[144:147], v[128:131], v[48:63]
  ds_read_b128 v[160:163], v11 offset:3648
  ds_read_b128 v[164:167], v11 offset:4256
  v_exp_f32 v32, v32
  v_exp_f32 v33, v33
  v_exp_f32 v34, v34
  v_exp_f32 v35, v35
  v_exp_f32 v36, v36
  v_exp_f32 v37, v37
  v_mfma_f32_32x32x16_bf16 v[64:79], v[144:147], v[132:135], v[64:79]
  ds_read_b32 v148, v7 offset:512
  v_cvt_pk_bf16_f32 v120, v32, v33
  v_exp_f32 v38, v38
  v_exp_f32 v39, v39
  v_cvt_pk_bf16_f32 v121, v34, v35
  v_exp_f32 v40, v40
  v_exp_f32 v41, v41
  v_mfma_f32_32x32x16_bf16 v[80:95], v[152:155], v[112:115], v[80:95]
  ds_read_b128 v[140:143], v0 offset:4096
  v_cvt_pk_bf16_f32 v122, v36, v37
  v_exp_f32 v42, v42
  v_exp_f32 v43, v43
  v_cvt_pk_bf16_f32 v123, v38, v39
  v_exp_f32 v44, v44
  v_exp_f32 v45, v45
  v_mfma_f32_32x32x16_bf16 v[80:95], v[156:159], v[116:119], v[80:95]
  v_cvt_pk_bf16_f32 v124, v40, v41
  v_exp_f32 v46, v46
  v_exp_f32 v47, v47
  v_cvt_pk_bf16_f32 v125, v42, v43
  v_cvt_pk_bf16_f32 v126, v44, v45
  v_cvt_pk_bf16_f32 v127, v46, v47
  s_waitcnt lgkmcnt(1)
  v_mfma_f32_32x32x4bf16_1k v[16:47], v[148:149], v[136:137], 0
  v_exp_f32 v48, v48
  v_exp_f32 v49, v49
  v_exp_f32 v50, v50
  v_exp_f32 v51, v51
  v_exp_f32 v52, v52
  v_exp_f32 v53, v53
  v_cvt_pk_bf16_f32 v112, v48, v49
  v_exp_f32 v54, v54
  v_exp_f32 v55, v55
  v_cvt_pk_bf16_f32 v113, v50, v51
  v_exp_f32 v56, v56
  v_exp_f32 v57, v57
  v_mfma_f32_32x32x16_bf16 v[96:111], v[152:155], v[120:123], v[96:111]
  v_cvt_pk_bf16_f32 v114, v52, v53
  v_exp_f32 v58, v58
  v_exp_f32 v59, v59
  v_cvt_pk_bf16_f32 v115, v54, v55
  v_exp_f32 v60, v60
  v_exp_f32 v61, v61
  v_mfma_f32_32x32x16_bf16 v[96:111], v[156:159], v[124:127], v[96:111]
  v_cvt_pk_bf16_f32 v116, v56, v57
  v_exp_f32 v62, v62
  v_exp_f32 v63, v63
  v_cvt_pk_bf16_f32 v117, v58, v59
  v_cvt_pk_bf16_f32 v118, v60, v61
  v_cvt_pk_bf16_f32 v119, v62, v63
  s_waitcnt lgkmcnt(0)
  v_mfma_f32_32x32x16_bf16 v[16:31], v[140:143], v[128:131], v[16:31]
  ds_read_b128 v[152:155], v11 offset:4864
  ds_read_b128 v[156:159], v11 offset:5472
  v_exp_f32 v64, v64
  v_exp_f32 v65, v65
  v_exp_f32 v66, v66
  v_exp_f32 v67, v67
  v_exp_f32 v68, v68
  v_exp_f32 v69, v69
  v_mfma_f32_32x32x16_bf16 v[32:47], v[140:143], v[132:135], v[32:47]
  ds_read_b32 v150, v7 offset:640
  v_cvt_pk_bf16_f32 v120, v64, v65
  v_exp_f32 v70, v70
  v_exp_f32 v71, v71
  v_cvt_pk_bf16_f32 v121, v66, v67
  v_exp_f32 v72, v72
  v_exp_f32 v73, v73
  v_mfma_f32_32x32x16_bf16 v[80:95], v[160:163], v[112:115], v[80:95]
  ds_read_b128 v[144:147], v0 offset:5120
  v_cvt_pk_bf16_f32 v122, v68, v69
  v_exp_f32 v74, v74
  v_exp_f32 v75, v75
  v_cvt_pk_bf16_f32 v123, v70, v71
  v_exp_f32 v76, v76
  v_exp_f32 v77, v77
  v_mfma_f32_32x32x16_bf16 v[80:95], v[164:167], v[116:119], v[80:95]
  v_cvt_pk_bf16_f32 v124, v72, v73
  v_exp_f32 v78, v78
  v_exp_f32 v79, v79
  v_cvt_pk_bf16_f32 v125, v74, v75
  v_cvt_pk_bf16_f32 v126, v76, v77
  v_cvt_pk_bf16_f32 v127, v78, v79
  s_waitcnt lgkmcnt(1)
  v_mfma_f32_32x32x4bf16_1k v[48:79], v[150:151], v[136:137], 0
  v_exp_f32 v16, v16
  v_exp_f32 v17, v17
  v_exp_f32 v18, v18
  v_exp_f32 v19, v19
  v_exp_f32 v20, v20
  v_exp_f32 v21, v21
  v_cvt_pk_bf16_f32 v112, v16, v17
  v_exp_f32 v22, v22
  v_exp_f32 v23, v23
  v_cvt_pk_bf16_f32 v113, v18, v19
  v_exp_f32 v24, v24
  v_exp_f32 v25, v25
  v_mfma_f32_32x32x16_bf16 v[96:111], v[160:163], v[120:123], v[96:111]
  v_cvt_pk_bf16_f32 v114, v20, v21
  v_exp_f32 v26, v26
  v_exp_f32 v27, v27
  v_cvt_pk_bf16_f32 v115, v22, v23
  v_exp_f32 v28, v28
  v_exp_f32 v29, v29
  v_mfma_f32_32x32x16_bf16 v[96:111], v[164:167], v[124:127], v[96:111]
  v_cvt_pk_bf16_f32 v116, v24, v25
  v_exp_f32 v30, v30
  v_exp_f32 v31, v31
  v_cvt_pk_bf16_f32 v117, v26, v27
  v_cvt_pk_bf16_f32 v118, v28, v29
  v_cvt_pk_bf16_f32 v119, v30, v31
  s_waitcnt lgkmcnt(0)
  v_mfma_f32_32x32x16_bf16 v[48:63], v[144:147], v[128:131], v[48:63]
  ds_read_b128 v[160:163], v11 offset:6080
  ds_read_b128 v[164:167], v11 offset:6688
  v_exp_f32 v32, v32
  v_exp_f32 v33, v33
  v_exp_f32 v34, v34
  v_exp_f32 v35, v35
  v_exp_f32 v36, v36
  v_exp_f32 v37, v37
  v_mfma_f32_32x32x16_bf16 v[64:79], v[144:147], v[132:135], v[64:79]
  ds_read_b32 v148, v7 offset:768
  v_cvt_pk_bf16_f32 v120, v32, v33
  v_exp_f32 v38, v38
  v_exp_f32 v39, v39
  v_cvt_pk_bf16_f32 v121, v34, v35
  v_exp_f32 v40, v40
  v_exp_f32 v41, v41
  v_mfma_f32_32x32x16_bf16 v[80:95], v[152:155], v[112:115], v[80:95]
  ds_read_b128 v[140:143], v0 offset:6144
  v_cvt_pk_bf16_f32 v122, v36, v37
  v_exp_f32 v42, v42
  v_exp_f32 v43, v43
  v_cvt_pk_bf16_f32 v123, v38, v39
  v_exp_f32 v44, v44
  v_exp_f32 v45, v45
  v_mfma_f32_32x32x16_bf16 v[80:95], v[156:159], v[116:119], v[80:95]
  v_cvt_pk_bf16_f32 v124, v40, v41
  v_exp_f32 v46, v46
  v_exp_f32 v47, v47
  v_cvt_pk_bf16_f32 v125, v42, v43
  v_cvt_pk_bf16_f32 v126, v44, v45
  v_cvt_pk_bf16_f32 v127, v46, v47
  s_barrier
  s_waitcnt lgkmcnt(1)
  v_mfma_f32_32x32x4bf16_1k v[16:47], v[148:149], v[136:137], 0
  v_exp_f32 v48, v48
  v_exp_f32 v49, v49
  v_exp_f32 v50, v50
  v_exp_f32 v51, v51
  v_exp_f32 v52, v52
  v_exp_f32 v53, v53
  v_cvt_pk_bf16_f32 v112, v48, v49
  v_exp_f32 v54, v54
  v_exp_f32 v55, v55
  v_cvt_pk_bf16_f32 v113, v50, v51
  v_exp_f32 v56, v56
  v_exp_f32 v57, v57
  v_mfma_f32_32x32x16_bf16 v[96:111], v[152:155], v[120:123], v[96:111]
  v_cvt_pk_bf16_f32 v114, v52, v53
  v_exp_f32 v58, v58
  v_exp_f32 v59, v59
  v_cvt_pk_bf16_f32 v115, v54, v55
  v_exp_f32 v60, v60
  v_exp_f32 v61, v61
  v_mfma_f32_32x32x16_bf16 v[96:111], v[156:159], v[124:127], v[96:111]
  v_cvt_pk_bf16_f32 v116, v56, v57
  v_exp_f32 v62, v62
  v_exp_f32 v63, v63
  v_cvt_pk_bf16_f32 v117, v58, v59
  v_cvt_pk_bf16_f32 v118, v60, v61
  v_cvt_pk_bf16_f32 v119, v62, v63
  s_waitcnt lgkmcnt(0)
  v_mfma_f32_32x32x16_bf16 v[16:31], v[140:143], v[128:131], v[16:31]
  ds_read_b128 v[152:155], v11 offset:7296
  ds_read_b128 v[156:159], v11 offset:7904
  v_exp_f32 v64, v64
  v_exp_f32 v65, v65
  v_exp_f32 v66, v66
  v_exp_f32 v67, v67
  v_exp_f32 v68, v68
  v_exp_f32 v69, v69
  v_mfma_f32_32x32x16_bf16 v[32:47], v[140:143], v[132:135], v[32:47]
  ds_read_b32 v150, v7 offset:896
  v_cvt_pk_bf16_f32 v120, v64, v65
  v_exp_f32 v70, v70
  v_exp_f32 v71, v71
  v_cvt_pk_bf16_f32 v121, v66, v67
  v_exp_f32 v72, v72
  v_exp_f32 v73, v73
  v_mfma_f32_32x32x16_bf16 v[80:95], v[160:163], v[112:115], v[80:95]
  ds_read_b128 v[144:147], v0 offset:7168
  v_cvt_pk_bf16_f32 v122, v68, v69
  v_exp_f32 v74, v74
  v_exp_f32 v75, v75
  v_cvt_pk_bf16_f32 v123, v70, v71
  v_exp_f32 v76, v76
  v_exp_f32 v77, v77
  v_mfma_f32_32x32x16_bf16 v[80:95], v[164:167], v[116:119], v[80:95]
  v_cvt_pk_bf16_f32 v124, v72, v73
  v_exp_f32 v78, v78
  v_exp_f32 v79, v79
  v_cvt_pk_bf16_f32 v125, v74, v75
  v_cvt_pk_bf16_f32 v126, v76, v77
  v_cvt_pk_bf16_f32 v127, v78, v79
  s_waitcnt lgkmcnt(1)
  v_mfma_f32_32x32x4bf16_1k v[48:79], v[150:151], v[136:137], 0
  v_exp_f32 v16, v16
  v_exp_f32 v17, v17
  v_exp_f32 v18, v18
  v_exp_f32 v19, v19
  v_exp_f32 v20, v20
  v_exp_f32 v21, v21
  v_cvt_pk_bf16_f32 v112, v16, v17
  v_exp_f32 v22, v22
  v_exp_f32 v23, v23
  v_cvt_pk_bf16_f32 v113, v18, v19
  v_exp_f32 v24, v24
  v_exp_f32 v25, v25
  v_mfma_f32_32x32x16_bf16 v[96:111], v[160:163], v[120:123], v[96:111]
  v_cvt_pk_bf16_f32 v114, v20, v21
  v_exp_f32 v26, v26
  v_exp_f32 v27, v27
  v_cvt_pk_bf16_f32 v115, v22, v23
  v_exp_f32 v28, v28
  v_exp_f32 v29, v29
  v_mfma_f32_32x32x16_bf16 v[96:111], v[164:167], v[124:127], v[96:111]
  v_cvt_pk_bf16_f32 v116, v24, v25
  v_exp_f32 v30, v30
  v_exp_f32 v31, v31
  v_cvt_pk_bf16_f32 v117, v26, v27
  v_cvt_pk_bf16_f32 v118, v28, v29
  v_cvt_pk_bf16_f32 v119, v30, v31
  s_waitcnt lgkmcnt(0)
  v_mfma_f32_32x32x16_bf16 v[48:63], v[144:147], v[128:131], v[48:63]
  ds_read_b128 v[160:163], v11 offset:8512
  ds_read_b128 v[164:167], v11 offset:9120
  v_exp_f32 v32, v32
  v_exp_f32 v33, v33
  v_exp_f32 v34, v34
  v_exp_f32 v35, v35
  v_exp_f32 v36, v36
  v_exp_f32 v37, v37
  v_mfma_f32_32x32x16_bf16 v[64:79], v[144:147], v[132:135], v[64:79]
  ds_read_b32 v148, v7 offset:1024
  v_cvt_pk_bf16_f32 v120, v32, v33
  v_exp_f32 v38, v38
  v_exp_f32 v39, v39
  v_cvt_pk_bf16_f32 v121, v34, v35
  v_exp_f32 v40, v40
  v_exp_f32 v41, v41
  v_mfma_f32_32x32x16_bf16 v[80:95], v[152:155], v[112:115], v[80:95]
  ds_read_b128 v[140:143], v0 offset:8192
  v_cvt_pk_bf16_f32 v122, v36, v37
  v_exp_f32 v42, v42
  v_exp_f32 v43, v43
  v_cvt_pk_bf16_f32 v123, v38, v39
  v_exp_f32 v44, v44
  v_exp_f32 v45, v45
  v_mfma_f32_32x32x16_bf16 v[80:95], v[156:159], v[116:119], v[80:95]
  v_cvt_pk_bf16_f32 v124, v40, v41
  v_exp_f32 v46, v46
  v_exp_f32 v47, v47
  v_cvt_pk_bf16_f32 v125, v42, v43
  v_cvt_pk_bf16_f32 v126, v44, v45
  v_cvt_pk_bf16_f32 v127, v46, v47
  s_waitcnt lgkmcnt(1)
  v_mfma_f32_32x32x4bf16_1k v[16:47], v[148:149], v[136:137], 0
  v_exp_f32 v48, v48
  v_exp_f32 v49, v49
  v_exp_f32 v50, v50
  v_exp_f32 v51, v51
  v_exp_f32 v52, v52
  v_exp_f32 v53, v53
  v_cvt_pk_bf16_f32 v112, v48, v49
  v_exp_f32 v54, v54
  v_exp_f32 v55, v55
  v_cvt_pk_bf16_f32 v113, v50, v51
  v_exp_f32 v56, v56
  v_exp_f32 v57, v57
  v_mfma_f32_32x32x16_bf16 v[96:111], v[152:155], v[120:123], v[96:111]
  v_cvt_pk_bf16_f32 v114, v52, v53
  v_exp_f32 v58, v58
  v_exp_f32 v59, v59
  v_cvt_pk_bf16_f32 v115, v54, v55
  v_exp_f32 v60, v60
  v_exp_f32 v61, v61
  v_mfma_f32_32x32x16_bf16 v[96:111], v[156:159], v[124:127], v[96:111]
  v_cvt_pk_bf16_f32 v116, v56, v57
  v_exp_f32 v62, v62
  v_exp_f32 v63, v63
  v_cvt_pk_bf16_f32 v117, v58, v59
  v_cvt_pk_bf16_f32 v118, v60, v61
  v_cvt_pk_bf16_f32 v119, v62, v63
  s_waitcnt lgkmcnt(0)
  v_mfma_f32_32x32x16_bf16 v[16:31], v[140:143], v[128:131], v[16:31]
  ds_read_b128 v[152:155], v11 offset:9728
  ds_read_b128 v[156:159], v11 offset:10336
  v_exp_f32 v64, v64
  v_exp_f32 v65, v65
  v_exp_f32 v66, v66
  v_exp_f32 v67, v67
  v_exp_f32 v68, v68
  v_exp_f32 v69, v69
  v_mfma_f32_32x32x16_bf16 v[32:47], v[140:143], v[132:135], v[32:47]
  ds_read_b32 v150, v7 offset:1152
  v_cvt_pk_bf16_f32 v120, v64, v65
  v_exp_f32 v70, v70
  v_exp_f32 v71, v71
  v_cvt_pk_bf16_f32 v121, v66, v67
  v_exp_f32 v72, v72
  v_exp_f32 v73, v73
  v_mfma_f32_32x32x16_bf16 v[80:95], v[160:163], v[112:115], v[80:95]
  ds_read_b128 v[144:147], v0 offset:9216
  v_cvt_pk_bf16_f32 v122, v68, v69
  v_exp_f32 v74, v74
  v_exp_f32 v75, v75
  v_cvt_pk_bf16_f32 v123, v70, v71
  v_exp_f32 v76, v76
  v_exp_f32 v77, v77
  v_mfma_f32_32x32x16_bf16 v[80:95], v[164:167], v[116:119], v[80:95]
  v_cvt_pk_bf16_f32 v124, v72, v73
  v_exp_f32 v78, v78
  v_exp_f32 v79, v79
  v_cvt_pk_bf16_f32 v125, v74, v75
  v_cvt_pk_bf16_f32 v126, v76, v77
  v_cvt_pk_bf16_f32 v127, v78, v79
  s_waitcnt lgkmcnt(1)
  v_mfma_f32_32x32x4bf16_1k v[48:79], v[150:151], v[136:137], 0
  v_exp_f32 v16, v16
  v_exp_f32 v17, v17
  v_exp_f32 v18, v18
  v_exp_f32 v19, v19
  v_exp_f32 v20, v20
  v_exp_f32 v21, v21
  v_cvt_pk_bf16_f32 v112, v16, v17
  v_exp_f32 v22, v22
  v_exp_f32 v23, v23
  v_cvt_pk_bf16_f32 v113, v18, v19
  v_exp_f32 v24, v24
  v_exp_f32 v25, v25
  v_mfma_f32_32x32x16_bf16 v[96:111], v[160:163], v[120:123], v[96:111]
  v_cvt_pk_bf16_f32 v114, v20, v21
  v_exp_f32 v26, v26
  v_exp_f32 v27, v27
  v_cvt_pk_bf16_f32 v115, v22, v23
  v_exp_f32 v28, v28
  v_exp_f32 v29, v29
  v_mfma_f32_32x32x16_bf16 v[96:111], v[164:167], v[124:127], v[96:111]
  v_cvt_pk_bf16_f32 v116, v24, v25
  v_exp_f32 v30, v30
  v_exp_f32 v31, v31
  v_cvt_pk_bf16_f32 v117, v26, v27
  v_cvt_pk_bf16_f32 v118, v28, v29
  v_cvt_pk_bf16_f32 v119, v30, v31
  s_waitcnt lgkmcnt(0)
  v_mfma_f32_32x32x16_bf16 v[48:63], v[144:147], v[128:131], v[48:63]
  ds_read_b128 v[160:163], v11 offset:10944
  ds_read_b128 v[164:167], v11 offset:11552
  v_exp_f32 v32, v32
  v_exp_f32 v33, v33
  v_exp_f32 v34, v34
  v_exp_f32 v35, v35
  v_exp_f32 v36, v36
  v_exp_f32 v37, v37
  v_mfma_f32_32x32x16_bf16 v[64:79], v[144:147], v[132:135], v[64:79]
  ds_read_b32 v148, v7 offset:1280
  v_cvt_pk_bf16_f32 v120, v32, v33
  v_exp_f32 v38, v38
  v_exp_f32 v39, v39
  v_cvt_pk_bf16_f32 v121, v34, v35
  v_exp_f32 v40, v40
  v_exp_f32 v41, v41
  v_mfma_f32_32x32x16_bf16 v[80:95], v[152:155], v[112:115], v[80:95]
  ds_read_b128 v[140:143], v0 offset:10240
  v_cvt_pk_bf16_f32 v122, v36, v37
  v_exp_f32 v42, v42
  v_exp_f32 v43, v43
  v_cvt_pk_bf16_f32 v123, v38, v39
  v_exp_f32 v44, v44
  v_exp_f32 v45, v45
  v_mfma_f32_32x32x16_bf16 v[80:95], v[156:159], v[116:119], v[80:95]
  v_cvt_pk_bf16_f32 v124, v40, v41
  v_exp_f32 v46, v46
  v_exp_f32 v47, v47
  v_cvt_pk_bf16_f32 v125, v42, v43
  v_cvt_pk_bf16_f32 v126, v44, v45
  v_cvt_pk_bf16_f32 v127, v46, v47
  s_waitcnt lgkmcnt(1)
  v_mfma_f32_32x32x4bf16_1k v[16:47], v[148:149], v[136:137], 0
  v_exp_f32 v48, v48
  v_exp_f32 v49, v49
  v_exp_f32 v50, v50
  v_exp_f32 v51, v51
  v_exp_f32 v52, v52
  v_exp_f32 v53, v53
  v_cvt_pk_bf16_f32 v112, v48, v49
  v_exp_f32 v54, v54
  v_exp_f32 v55, v55
  v_cvt_pk_bf16_f32 v113, v50, v51
  v_exp_f32 v56, v56
  v_exp_f32 v57, v57
  v_mfma_f32_32x32x16_bf16 v[96:111], v[152:155], v[120:123], v[96:111]
  v_cvt_pk_bf16_f32 v114, v52, v53
  v_exp_f32 v58, v58
  v_exp_f32 v59, v59
  v_cvt_pk_bf16_f32 v115, v54, v55
  v_exp_f32 v60, v60
  v_exp_f32 v61, v61
  v_mfma_f32_32x32x16_bf16 v[96:111], v[156:159], v[124:127], v[96:111]
  v_cvt_pk_bf16_f32 v116, v56, v57
  v_exp_f32 v62, v62
  v_exp_f32 v63, v63
  v_cvt_pk_bf16_f32 v117, v58, v59
  v_cvt_pk_bf16_f32 v118, v60, v61
  v_cvt_pk_bf16_f32 v119, v62, v63
  s_waitcnt lgkmcnt(0)
  v_mfma_f32_32x32x16_bf16 v[16:31], v[140:143], v[128:131], v[16:31]
  ds_read_b128 v[152:155], v11 offset:12160
  ds_read_b128 v[156:159], v11 offset:12768
  v_exp_f32 v64, v64
  v_exp_f32 v65, v65
  v_exp_f32 v66, v66
  v_exp_f32 v67, v67
  v_exp_f32 v68, v68
  v_exp_f32 v69, v69
  v_mfma_f32_32x32x16_bf16 v[32:47], v[140:143], v[132:135], v[32:47]
  ds_read_b32 v150, v7 offset:1408
  v_cvt_pk_bf16_f32 v120, v64, v65
  v_exp_f32 v70, v70
  v_exp_f32 v71, v71
  v_cvt_pk_bf16_f32 v121, v66, v67
  v_exp_f32 v72, v72
  v_exp_f32 v73, v73
  v_mfma_f32_32x32x16_bf16 v[80:95], v[160:163], v[112:115], v[80:95]
  ds_read_b128 v[144:147], v0 offset:11264
  v_cvt_pk_bf16_f32 v122, v68, v69
  v_exp_f32 v74, v74
  v_exp_f32 v75, v75
  v_cvt_pk_bf16_f32 v123, v70, v71
  v_exp_f32 v76, v76
  v_exp_f32 v77, v77
  v_mfma_f32_32x32x16_bf16 v[80:95], v[164:167], v[116:119], v[80:95]
  v_cvt_pk_bf16_f32 v124, v72, v73
  v_exp_f32 v78, v78
  v_exp_f32 v79, v79
  v_cvt_pk_bf16_f32 v125, v74, v75
  v_cvt_pk_bf16_f32 v126, v76, v77
  v_cvt_pk_bf16_f32 v127, v78, v79
  s_waitcnt lgkmcnt(1)
  v_mfma_f32_32x32x4bf16_1k v[48:79], v[150:151], v[136:137], 0
  v_exp_f32 v16, v16
  v_exp_f32 v17, v17
  v_exp_f32 v18, v18
  v_exp_f32 v19, v19
  v_exp_f32 v20, v20
  v_exp_f32 v21, v21
  v_cvt_pk_bf16_f32 v112, v16, v17
  v_exp_f32 v22, v22
  v_exp_f32 v23, v23
  v_cvt_pk_bf16_f32 v113, v18, v19
  v_exp_f32 v24, v24
  v_exp_f32 v25, v25
  v_mfma_f32_32x32x16_bf16 v[96:111], v[160:163], v[120:123], v[96:111]
  v_cvt_pk_bf16_f32 v114, v20, v21
  v_exp_f32 v26, v26
  v_exp_f32 v27, v27
  v_cvt_pk_bf16_f32 v115, v22, v23
  v_exp_f32 v28, v28
  v_exp_f32 v29, v29
  v_mfma_f32_32x32x16_bf16 v[96:111], v[164:167], v[124:127], v[96:111]
  v_cvt_pk_bf16_f32 v116, v24, v25
  v_exp_f32 v30, v30
  v_exp_f32 v31, v31
  v_cvt_pk_bf16_f32 v117, v26, v27
  v_cvt_pk_bf16_f32 v118, v28, v29
  v_cvt_pk_bf16_f32 v119, v30, v31
  s_waitcnt lgkmcnt(0)
  v_mfma_f32_32x32x16_bf16 v[48:63], v[144:147], v[128:131], v[48:63]
  ds_read_b128 v[160:163], v11 offset:13376
  ds_read_b128 v[164:167], v11 offset:13984
  v_exp_f32 v32, v32
  v_exp_f32 v33, v33
  v_exp_f32 v34, v34
  v_exp_f32 v35, v35
  v_exp_f32 v36, v36
  v_exp_f32 v37, v37
  v_mfma_f32_32x32x16_bf16 v[64:79], v[144:147], v[132:135], v[64:79]
  ds_read_b32 v148, v7 offset:1536
  v_cvt_pk_bf16_f32 v120, v32, v33
  v_exp_f32 v38, v38
  v_exp_f32 v39, v39
  v_cvt_pk_bf16_f32 v121, v34, v35
  v_exp_f32 v40, v40
  v_exp_f32 v41, v41
  v_mfma_f32_32x32x16_bf16 v[80:95], v[152:155], v[112:115], v[80:95]
  ds_read_b128 v[140:143], v0 offset:12288
  v_cvt_pk_bf16_f32 v122, v36, v37
  v_exp_f32 v42, v42
  v_exp_f32 v43, v43
  v_cvt_pk_bf16_f32 v123, v38, v39
  v_exp_f32 v44, v44
  v_exp_f32 v45, v45
  v_mfma_f32_32x32x16_bf16 v[80:95], v[156:159], v[116:119], v[80:95]
  v_cvt_pk_bf16_f32 v124, v40, v41
  v_exp_f32 v46, v46
  v_exp_f32 v47, v47
  v_cvt_pk_bf16_f32 v125, v42, v43
  v_cvt_pk_bf16_f32 v126, v44, v45
  v_cvt_pk_bf16_f32 v127, v46, v47
  s_waitcnt lgkmcnt(1)
  v_mfma_f32_32x32x4bf16_1k v[16:47], v[148:149], v[136:137], 0
  v_exp_f32 v48, v48
  v_exp_f32 v49, v49
  v_exp_f32 v50, v50
  v_exp_f32 v51, v51
  v_exp_f32 v52, v52
  v_exp_f32 v53, v53
  v_cvt_pk_bf16_f32 v112, v48, v49
  v_exp_f32 v54, v54
  v_exp_f32 v55, v55
  v_cvt_pk_bf16_f32 v113, v50, v51
  v_exp_f32 v56, v56
  v_exp_f32 v57, v57
  v_mfma_f32_32x32x16_bf16 v[96:111], v[152:155], v[120:123], v[96:111]
  v_cvt_pk_bf16_f32 v114, v52, v53
  v_exp_f32 v58, v58
  v_exp_f32 v59, v59
  v_cvt_pk_bf16_f32 v115, v54, v55
  v_exp_f32 v60, v60
  v_exp_f32 v61, v61
  v_mfma_f32_32x32x16_bf16 v[96:111], v[156:159], v[124:127], v[96:111]
  v_cvt_pk_bf16_f32 v116, v56, v57
  v_exp_f32 v62, v62
  v_exp_f32 v63, v63
  v_cvt_pk_bf16_f32 v117, v58, v59
  v_cvt_pk_bf16_f32 v118, v60, v61
  v_cvt_pk_bf16_f32 v119, v62, v63
  s_waitcnt lgkmcnt(0)
  v_mfma_f32_32x32x16_bf16 v[16:31], v[140:143], v[128:131], v[16:31]
  ds_read_b128 v[152:155], v11 offset:14592
  ds_read_b128 v[156:159], v11 offset:15200
  v_exp_f32 v64, v64
  v_exp_f32 v65, v65
  v_exp_f32 v66, v66
  v_exp_f32 v67, v67
  v_exp_f32 v68, v68
  v_exp_f32 v69, v69
  v_mfma_f32_32x32x16_bf16 v[32:47], v[140:143], v[132:135], v[32:47]
  ds_read_b32 v150, v7 offset:1664
  v_cvt_pk_bf16_f32 v120, v64, v65
  v_exp_f32 v70, v70
  v_exp_f32 v71, v71
  v_cvt_pk_bf16_f32 v121, v66, v67
  v_exp_f32 v72, v72
  v_exp_f32 v73, v73
  v_mfma_f32_32x32x16_bf16 v[80:95], v[160:163], v[112:115], v[80:95]
  ds_read_b128 v[144:147], v0 offset:13312
  v_cvt_pk_bf16_f32 v122, v68, v69
  v_exp_f32 v74, v74
  v_exp_f32 v75, v75
  v_cvt_pk_bf16_f32 v123, v70, v71
  v_exp_f32 v76, v76
  v_exp_f32 v77, v77
  v_mfma_f32_32x32x16_bf16 v[80:95], v[164:167], v[116:119], v[80:95]
  v_cvt_pk_bf16_f32 v124, v72, v73
  v_exp_f32 v78, v78
  v_exp_f32 v79, v79
  v_cvt_pk_bf16_f32 v125, v74, v75
  v_cvt_pk_bf16_f32 v126, v76, v77
  v_cvt_pk_bf16_f32 v127, v78, v79
  s_waitcnt lgkmcnt(1)
  v_mfma_f32_32x32x4bf16_1k v[48:79], v[150:151], v[136:137], 0
  v_exp_f32 v16, v16
  v_exp_f32 v17, v17
  v_exp_f32 v18, v18
  v_exp_f32 v19, v19
  v_exp_f32 v20, v20
  v_exp_f32 v21, v21
  v_cvt_pk_bf16_f32 v112, v16, v17
  v_exp_f32 v22, v22
  v_exp_f32 v23, v23
  v_cvt_pk_bf16_f32 v113, v18, v19
  v_exp_f32 v24, v24
  v_exp_f32 v25, v25
  v_mfma_f32_32x32x16_bf16 v[96:111], v[160:163], v[120:123], v[96:111]
  v_cvt_pk_bf16_f32 v114, v20, v21
  v_exp_f32 v26, v26
  v_exp_f32 v27, v27
  v_cvt_pk_bf16_f32 v115, v22, v23
  v_exp_f32 v28, v28
  v_exp_f32 v29, v29
  v_mfma_f32_32x32x16_bf16 v[96:111], v[164:167], v[124:127], v[96:111]
  v_cvt_pk_bf16_f32 v116, v24, v25
  v_exp_f32 v30, v30
  v_exp_f32 v31, v31
  v_cvt_pk_bf16_f32 v117, v26, v27
  v_cvt_pk_bf16_f32 v118, v28, v29
  v_cvt_pk_bf16_f32 v119, v30, v31
  s_waitcnt lgkmcnt(0)
  v_mfma_f32_32x32x16_bf16 v[48:63], v[144:147], v[128:131], v[48:63]
  ds_read_b128 v[160:163], v11 offset:15808
  ds_read_b128 v[164:167], v11 offset:16416
  v_exp_f32 v32, v32
  v_exp_f32 v33, v33
  v_exp_f32 v34, v34
  v_exp_f32 v35, v35
  v_exp_f32 v36, v36
  v_exp_f32 v37, v37
  v_mfma_f32_32x32x16_bf16 v[64:79], v[144:147], v[132:135], v[64:79]
  ds_read_b32 v148, v7 offset:1792
  v_cvt_pk_bf16_f32 v120, v32, v33
  v_exp_f32 v38, v38
  v_exp_f32 v39, v39
  v_cvt_pk_bf16_f32 v121, v34, v35
  v_exp_f32 v40, v40
  v_exp_f32 v41, v41
  v_mfma_f32_32x32x16_bf16 v[80:95], v[152:155], v[112:115], v[80:95]
  ds_read_b128 v[140:143], v0 offset:14336
  v_cvt_pk_bf16_f32 v122, v36, v37
  v_exp_f32 v42, v42
  v_exp_f32 v43, v43
  v_cvt_pk_bf16_f32 v123, v38, v39
  v_exp_f32 v44, v44
  v_exp_f32 v45, v45
  v_mfma_f32_32x32x16_bf16 v[80:95], v[156:159], v[116:119], v[80:95]
  v_cvt_pk_bf16_f32 v124, v40, v41
  v_exp_f32 v46, v46
  v_exp_f32 v47, v47
  v_cvt_pk_bf16_f32 v125, v42, v43
  v_cvt_pk_bf16_f32 v126, v44, v45
  v_cvt_pk_bf16_f32 v127, v46, v47
  s_waitcnt lgkmcnt(1)
  v_mfma_f32_32x32x4bf16_1k v[16:47], v[148:149], v[136:137], 0
  v_exp_f32 v48, v48
  v_exp_f32 v49, v49
  v_exp_f32 v50, v50
  v_exp_f32 v51, v51
  v_exp_f32 v52, v52
  v_exp_f32 v53, v53
  v_cvt_pk_bf16_f32 v112, v48, v49
  v_exp_f32 v54, v54
  v_exp_f32 v55, v55
  v_cvt_pk_bf16_f32 v113, v50, v51
  v_exp_f32 v56, v56
  v_exp_f32 v57, v57
  v_mfma_f32_32x32x16_bf16 v[96:111], v[152:155], v[120:123], v[96:111]
  v_cvt_pk_bf16_f32 v114, v52, v53
  v_exp_f32 v58, v58
  v_exp_f32 v59, v59
  v_cvt_pk_bf16_f32 v115, v54, v55
  v_exp_f32 v60, v60
  v_exp_f32 v61, v61
  v_mfma_f32_32x32x16_bf16 v[96:111], v[156:159], v[124:127], v[96:111]
  v_cvt_pk_bf16_f32 v116, v56, v57
  v_exp_f32 v62, v62
  v_exp_f32 v63, v63
  v_cvt_pk_bf16_f32 v117, v58, v59
  v_cvt_pk_bf16_f32 v118, v60, v61
  v_cvt_pk_bf16_f32 v119, v62, v63
  s_waitcnt lgkmcnt(0)
  v_mfma_f32_32x32x16_bf16 v[16:31], v[140:143], v[128:131], v[16:31]
  ds_read_b128 v[152:155], v11 offset:17024
  ds_read_b128 v[156:159], v11 offset:17632
  v_exp_f32 v64, v64
  v_exp_f32 v65, v65
  v_exp_f32 v66, v66
  v_exp_f32 v67, v67
  v_exp_f32 v68, v68
  v_exp_f32 v69, v69
  v_mfma_f32_32x32x16_bf16 v[32:47], v[140:143], v[132:135], v[32:47]
  ds_read_b32 v150, v7 offset:1920
  v_cvt_pk_bf16_f32 v120, v64, v65
  v_exp_f32 v70, v70
  v_exp_f32 v71, v71
  v_cvt_pk_bf16_f32 v121, v66, v67
  v_exp_f32 v72, v72
  v_exp_f32 v73, v73
  v_mfma_f32_32x32x16_bf16 v[80:95], v[160:163], v[112:115], v[80:95]
  ds_read_b128 v[144:147], v0 offset:15360
  v_cvt_pk_bf16_f32 v122, v68, v69
  v_exp_f32 v74, v74
  v_exp_f32 v75, v75
  v_cvt_pk_bf16_f32 v123, v70, v71
  v_exp_f32 v76, v76
  v_exp_f32 v77, v77
  v_mfma_f32_32x32x16_bf16 v[80:95], v[164:167], v[116:119], v[80:95]
  v_cvt_pk_bf16_f32 v124, v72, v73
  v_exp_f32 v78, v78
  v_exp_f32 v79, v79
  v_cvt_pk_bf16_f32 v125, v74, v75
  v_cvt_pk_bf16_f32 v126, v76, v77
  v_cvt_pk_bf16_f32 v127, v78, v79
  s_waitcnt lgkmcnt(1)
  v_mfma_f32_32x32x4bf16_1k v[48:79], v[150:151], v[136:137], 0
  v_exp_f32 v16, v16
  v_exp_f32 v17, v17
  v_exp_f32 v18, v18
  v_exp_f32 v19, v19
  v_exp_f32 v20, v20
  v_exp_f32 v21, v21
  v_cvt_pk_bf16_f32 v112, v16, v17
  v_exp_f32 v22, v22
  v_exp_f32 v23, v23
  v_cvt_pk_bf16_f32 v113, v18, v19
  v_exp_f32 v24, v24
  v_exp_f32 v25, v25
  v_mfma_f32_32x32x16_bf16 v[96:111], v[160:163], v[120:123], v[96:111]
  v_cvt_pk_bf16_f32 v114, v20, v21
  v_exp_f32 v26, v26
  v_exp_f32 v27, v27
  v_cvt_pk_bf16_f32 v115, v22, v23
  v_exp_f32 v28, v28
  v_exp_f32 v29, v29
  v_mfma_f32_32x32x16_bf16 v[96:111], v[164:167], v[124:127], v[96:111]
  v_cvt_pk_bf16_f32 v116, v24, v25
  v_exp_f32 v30, v30
  v_exp_f32 v31, v31
  v_cvt_pk_bf16_f32 v117, v26, v27
  v_cvt_pk_bf16_f32 v118, v28, v29
  v_cvt_pk_bf16_f32 v119, v30, v31
  s_waitcnt lgkmcnt(0)
  v_mfma_f32_32x32x16_bf16 v[48:63], v[144:147], v[128:131], v[48:63]
  ds_read_b128 v[160:163], v11 offset:18240
  ds_read_b128 v[164:167], v11 offset:18848
  v_exp_f32 v32, v32
  v_exp_f32 v33, v33
  v_exp_f32 v34, v34
  v_exp_f32 v35, v35
  v_exp_f32 v36, v36
  v_exp_f32 v37, v37
  v_mfma_f32_32x32x16_bf16 v[64:79], v[144:147], v[132:135], v[64:79]
  ds_read_b32 v148, v7 offset:2048
  v_cvt_pk_bf16_f32 v120, v32, v33
  v_exp_f32 v38, v38
  v_exp_f32 v39, v39
  v_cvt_pk_bf16_f32 v121, v34, v35
  v_exp_f32 v40, v40
  v_exp_f32 v41, v41
  v_mfma_f32_32x32x16_bf16 v[80:95], v[152:155], v[112:115], v[80:95]
  ds_read_b128 v[140:143], v0 offset:16384
  v_cvt_pk_bf16_f32 v122, v36, v37
  v_exp_f32 v42, v42
  v_exp_f32 v43, v43
  v_cvt_pk_bf16_f32 v123, v38, v39
  v_exp_f32 v44, v44
  v_exp_f32 v45, v45
  v_mfma_f32_32x32x16_bf16 v[80:95], v[156:159], v[116:119], v[80:95]
  v_cvt_pk_bf16_f32 v124, v40, v41
  v_exp_f32 v46, v46
  v_exp_f32 v47, v47
  v_cvt_pk_bf16_f32 v125, v42, v43
  v_cvt_pk_bf16_f32 v126, v44, v45
  v_cvt_pk_bf16_f32 v127, v46, v47
  s_waitcnt lgkmcnt(1)
  v_mfma_f32_32x32x4bf16_1k v[16:47], v[148:149], v[136:137], 0
  v_exp_f32 v48, v48
  v_exp_f32 v49, v49
  v_exp_f32 v50, v50
  v_exp_f32 v51, v51
  v_exp_f32 v52, v52
  v_exp_f32 v53, v53
  v_cvt_pk_bf16_f32 v112, v48, v49
  v_exp_f32 v54, v54
  v_exp_f32 v55, v55
  v_cvt_pk_bf16_f32 v113, v50, v51
  v_exp_f32 v56, v56
  v_exp_f32 v57, v57
  v_mfma_f32_32x32x16_bf16 v[96:111], v[152:155], v[120:123], v[96:111]
  v_cvt_pk_bf16_f32 v114, v52, v53
  v_exp_f32 v58, v58
  v_exp_f32 v59, v59
  v_cvt_pk_bf16_f32 v115, v54, v55
  v_exp_f32 v60, v60
  v_exp_f32 v61, v61
  v_mfma_f32_32x32x16_bf16 v[96:111], v[156:159], v[124:127], v[96:111]
  v_cvt_pk_bf16_f32 v116, v56, v57
  v_exp_f32 v62, v62
  v_exp_f32 v63, v63
  v_cvt_pk_bf16_f32 v117, v58, v59
  v_cvt_pk_bf16_f32 v118, v60, v61
  v_cvt_pk_bf16_f32 v119, v62, v63
  s_waitcnt lgkmcnt(0)
  v_mfma_f32_32x32x16_bf16 v[16:31], v[140:143], v[128:131], v[16:31]
  ds_read_b128 v[152:155], v11 offset:19456
  ds_read_b128 v[156:159], v11 offset:20064
  v_exp_f32 v64, v64
  v_exp_f32 v65, v65
  v_exp_f32 v66, v66
  v_exp_f32 v67, v67
  v_exp_f32 v68, v68
  v_exp_f32 v69, v69
  v_mfma_f32_32x32x16_bf16 v[32:47], v[140:143], v[132:135], v[32:47]
  ds_read_b32 v150, v7 offset:2176
  v_cvt_pk_bf16_f32 v120, v64, v65
  v_exp_f32 v70, v70
  v_exp_f32 v71, v71
  v_cvt_pk_bf16_f32 v121, v66, v67
  v_exp_f32 v72, v72
  v_exp_f32 v73, v73
  v_mfma_f32_32x32x16_bf16 v[80:95], v[160:163], v[112:115], v[80:95]
  ds_read_b128 v[144:147], v0 offset:17408
  v_cvt_pk_bf16_f32 v122, v68, v69
  v_exp_f32 v74, v74
  v_exp_f32 v75, v75
  v_cvt_pk_bf16_f32 v123, v70, v71
  v_exp_f32 v76, v76
  v_exp_f32 v77, v77
  v_mfma_f32_32x32x16_bf16 v[80:95], v[164:167], v[116:119], v[80:95]
  v_cvt_pk_bf16_f32 v124, v72, v73
  v_exp_f32 v78, v78
  v_exp_f32 v79, v79
  v_cvt_pk_bf16_f32 v125, v74, v75
  v_cvt_pk_bf16_f32 v126, v76, v77
  v_cvt_pk_bf16_f32 v127, v78, v79
  s_waitcnt lgkmcnt(1)
  v_mfma_f32_32x32x4bf16_1k v[48:79], v[150:151], v[136:137], 0
  v_exp_f32 v16, v16
  v_exp_f32 v17, v17
  v_exp_f32 v18, v18
  v_exp_f32 v19, v19
  v_exp_f32 v20, v20
  v_exp_f32 v21, v21
  v_cvt_pk_bf16_f32 v112, v16, v17
  v_exp_f32 v22, v22
  v_exp_f32 v23, v23
  v_cvt_pk_bf16_f32 v113, v18, v19
  v_exp_f32 v24, v24
  v_exp_f32 v25, v25
  v_mfma_f32_32x32x16_bf16 v[96:111], v[160:163], v[120:123], v[96:111]
  v_cvt_pk_bf16_f32 v114, v20, v21
  v_exp_f32 v26, v26
  v_exp_f32 v27, v27
  v_cvt_pk_bf16_f32 v115, v22, v23
  v_exp_f32 v28, v28
  v_exp_f32 v29, v29
  v_mfma_f32_32x32x16_bf16 v[96:111], v[164:167], v[124:127], v[96:111]
  v_cvt_pk_bf16_f32 v116, v24, v25
  v_exp_f32 v30, v30
  v_exp_f32 v31, v31
  v_cvt_pk_bf16_f32 v117, v26, v27
  v_cvt_pk_bf16_f32 v118, v28, v29
  v_cvt_pk_bf16_f32 v119, v30, v31
  s_waitcnt lgkmcnt(0)
  v_mfma_f32_32x32x16_bf16 v[48:63], v[144:147], v[128:131], v[48:63]
  ds_read_b128 v[160:163], v11 offset:20672
  ds_read_b128 v[164:167], v11 offset:21280
  v_exp_f32 v32, v32
  v_exp_f32 v33, v33
  v_exp_f32 v34, v34
  v_exp_f32 v35, v35
  v_exp_f32 v36, v36
  v_exp_f32 v37, v37
  v_mfma_f32_32x32x16_bf16 v[64:79], v[144:147], v[132:135], v[64:79]
  ds_read_b32 v148, v7 offset:2304
  v_cvt_pk_bf16_f32 v120, v32, v33
  v_exp_f32 v38, v38
  v_exp_f32 v39, v39
  v_cvt_pk_bf16_f32 v121, v34, v35
  v_exp_f32 v40, v40
  v_exp_f32 v41, v41
  v_mfma_f32_32x32x16_bf16 v[80:95], v[152:155], v[112:115], v[80:95]
  ds_read_b128 v[140:143], v0 offset:18432
  v_cvt_pk_bf16_f32 v122, v36, v37
  v_exp_f32 v42, v42
  v_exp_f32 v43, v43
  v_cvt_pk_bf16_f32 v123, v38, v39
  v_exp_f32 v44, v44
  v_exp_f32 v45, v45
  v_mfma_f32_32x32x16_bf16 v[80:95], v[156:159], v[116:119], v[80:95]
  v_cvt_pk_bf16_f32 v124, v40, v41
  v_exp_f32 v46, v46
  v_exp_f32 v47, v47
  v_cvt_pk_bf16_f32 v125, v42, v43
  v_cvt_pk_bf16_f32 v126, v44, v45
  v_cvt_pk_bf16_f32 v127, v46, v47
  s_waitcnt lgkmcnt(1)
  v_mfma_f32_32x32x4bf16_1k v[16:47], v[148:149], v[136:137], 0
  v_exp_f32 v48, v48
  v_exp_f32 v49, v49
  v_exp_f32 v50, v50
  v_exp_f32 v51, v51
  v_exp_f32 v52, v52
  v_exp_f32 v53, v53
  v_cvt_pk_bf16_f32 v112, v48, v49
  v_exp_f32 v54, v54
  v_exp_f32 v55, v55
  v_cvt_pk_bf16_f32 v113, v50, v51
  v_exp_f32 v56, v56
  v_exp_f32 v57, v57
  v_mfma_f32_32x32x16_bf16 v[96:111], v[152:155], v[120:123], v[96:111]
  v_cvt_pk_bf16_f32 v114, v52, v53
  v_exp_f32 v58, v58
  v_exp_f32 v59, v59
  v_cvt_pk_bf16_f32 v115, v54, v55
  v_exp_f32 v60, v60
  v_exp_f32 v61, v61
  v_mfma_f32_32x32x16_bf16 v[96:111], v[156:159], v[124:127], v[96:111]
  v_cvt_pk_bf16_f32 v116, v56, v57
  v_exp_f32 v62, v62
  v_exp_f32 v63, v63
  v_cvt_pk_bf16_f32 v117, v58, v59
  v_cvt_pk_bf16_f32 v118, v60, v61
  v_cvt_pk_bf16_f32 v119, v62, v63
  s_waitcnt lgkmcnt(0)
  v_mfma_f32_32x32x16_bf16 v[16:31], v[140:143], v[128:131], v[16:31]
  ds_read_b128 v[152:155], v11 offset:21888
  ds_read_b128 v[156:159], v11 offset:22496
  v_exp_f32 v64, v64
  v_exp_f32 v65, v65
  v_exp_f32 v66, v66
  v_exp_f32 v67, v67
  v_exp_f32 v68, v68
  v_exp_f32 v69, v69
  v_mfma_f32_32x32x16_bf16 v[32:47], v[140:143], v[132:135], v[32:47]
  ds_read_b32 v150, v7 offset:2432
  v_cvt_pk_bf16_f32 v120, v64, v65
  v_exp_f32 v70, v70
  v_exp_f32 v71, v71
  v_cvt_pk_bf16_f32 v121, v66, v67
  v_exp_f32 v72, v72
  v_exp_f32 v73, v73
  v_mfma_f32_32x32x16_bf16 v[80:95], v[160:163], v[112:115], v[80:95]
  ds_read_b128 v[144:147], v0 offset:19456
  v_cvt_pk_bf16_f32 v122, v68, v69
  v_exp_f32 v74, v74
  v_exp_f32 v75, v75
  v_cvt_pk_bf16_f32 v123, v70, v71
  v_exp_f32 v76, v76
  v_exp_f32 v77, v77
  v_mfma_f32_32x32x16_bf16 v[80:95], v[164:167], v[116:119], v[80:95]
  v_cvt_pk_bf16_f32 v124, v72, v73
  v_exp_f32 v78, v78
  v_exp_f32 v79, v79
  v_cvt_pk_bf16_f32 v125, v74, v75
  v_cvt_pk_bf16_f32 v126, v76, v77
  v_cvt_pk_bf16_f32 v127, v78, v79
  s_waitcnt lgkmcnt(1)
  v_mfma_f32_32x32x4bf16_1k v[48:79], v[150:151], v[136:137], 0
  v_exp_f32 v16, v16
  v_exp_f32 v17, v17
  v_exp_f32 v18, v18
  v_exp_f32 v19, v19
  v_exp_f32 v20, v20
  v_exp_f32 v21, v21
  v_cvt_pk_bf16_f32 v112, v16, v17
  v_exp_f32 v22, v22
  v_exp_f32 v23, v23
  v_cvt_pk_bf16_f32 v113, v18, v19
  v_exp_f32 v24, v24
  v_exp_f32 v25, v25
  v_mfma_f32_32x32x16_bf16 v[96:111], v[160:163], v[120:123], v[96:111]
  v_cvt_pk_bf16_f32 v114, v20, v21
  v_exp_f32 v26, v26
  v_exp_f32 v27, v27
  v_cvt_pk_bf16_f32 v115, v22, v23
  v_exp_f32 v28, v28
  v_exp_f32 v29, v29
  v_mfma_f32_32x32x16_bf16 v[96:111], v[164:167], v[124:127], v[96:111]
  v_cvt_pk_bf16_f32 v116, v24, v25
  v_exp_f32 v30, v30
  v_exp_f32 v31, v31
  v_cvt_pk_bf16_f32 v117, v26, v27
  v_cvt_pk_bf16_f32 v118, v28, v29
  v_cvt_pk_bf16_f32 v119, v30, v31
  s_waitcnt lgkmcnt(0)
  v_mfma_f32_32x32x16_bf16 v[48:63], v[144:147], v[128:131], v[48:63]
  ds_read_b128 v[160:163], v11 offset:23104
  ds_read_b128 v[164:167], v11 offset:23712
  v_exp_f32 v32, v32
  v_exp_f32 v33, v33
  v_exp_f32 v34, v34
  v_exp_f32 v35, v35
  v_exp_f32 v36, v36
  v_exp_f32 v37, v37
  v_mfma_f32_32x32x16_bf16 v[64:79], v[144:147], v[132:135], v[64:79]
  ds_read_b32 v148, v7 offset:2560
  v_cvt_pk_bf16_f32 v120, v32, v33
  v_exp_f32 v38, v38
  v_exp_f32 v39, v39
  v_cvt_pk_bf16_f32 v121, v34, v35
  v_exp_f32 v40, v40
  v_exp_f32 v41, v41
  v_mfma_f32_32x32x16_bf16 v[80:95], v[152:155], v[112:115], v[80:95]
  ds_read_b128 v[140:143], v0 offset:20480
  v_cvt_pk_bf16_f32 v122, v36, v37
  v_exp_f32 v42, v42
  v_exp_f32 v43, v43
  v_cvt_pk_bf16_f32 v123, v38, v39
  v_exp_f32 v44, v44
  v_exp_f32 v45, v45
  v_mfma_f32_32x32x16_bf16 v[80:95], v[156:159], v[116:119], v[80:95]
  v_cvt_pk_bf16_f32 v124, v40, v41
  v_exp_f32 v46, v46
  v_exp_f32 v47, v47
  v_cvt_pk_bf16_f32 v125, v42, v43
  v_cvt_pk_bf16_f32 v126, v44, v45
  v_cvt_pk_bf16_f32 v127, v46, v47
  s_waitcnt lgkmcnt(1)
  v_mfma_f32_32x32x4bf16_1k v[16:47], v[148:149], v[136:137], 0
  v_exp_f32 v48, v48
  v_exp_f32 v49, v49
  v_exp_f32 v50, v50
  v_exp_f32 v51, v51
  v_exp_f32 v52, v52
  v_exp_f32 v53, v53
  v_cvt_pk_bf16_f32 v112, v48, v49
  v_exp_f32 v54, v54
  v_exp_f32 v55, v55
  v_cvt_pk_bf16_f32 v113, v50, v51
  v_exp_f32 v56, v56
  v_exp_f32 v57, v57
  v_mfma_f32_32x32x16_bf16 v[96:111], v[152:155], v[120:123], v[96:111]
  v_cvt_pk_bf16_f32 v114, v52, v53
  v_exp_f32 v58, v58
  v_exp_f32 v59, v59
  v_cvt_pk_bf16_f32 v115, v54, v55
  v_exp_f32 v60, v60
  v_exp_f32 v61, v61
  v_mfma_f32_32x32x16_bf16 v[96:111], v[156:159], v[124:127], v[96:111]
  v_cvt_pk_bf16_f32 v116, v56, v57
  v_exp_f32 v62, v62
  v_exp_f32 v63, v63
  v_cvt_pk_bf16_f32 v117, v58, v59
  v_cvt_pk_bf16_f32 v118, v60, v61
  v_cvt_pk_bf16_f32 v119, v62, v63
  s_waitcnt lgkmcnt(0)
  v_mfma_f32_32x32x16_bf16 v[16:31], v[140:143], v[128:131], v[16:31]
  ds_read_b128 v[152:155], v11 offset:24320
  ds_read_b128 v[156:159], v11 offset:24928
  v_exp_f32 v64, v64
  v_exp_f32 v65, v65
  v_exp_f32 v66, v66
  v_exp_f32 v67, v67
  v_exp_f32 v68, v68
  v_exp_f32 v69, v69
  v_mfma_f32_32x32x16_bf16 v[32:47], v[140:143], v[132:135], v[32:47]
  ds_read_b32 v150, v7 offset:2688
  v_cvt_pk_bf16_f32 v120, v64, v65
  v_exp_f32 v70, v70
  v_exp_f32 v71, v71
  v_cvt_pk_bf16_f32 v121, v66, v67
  v_exp_f32 v72, v72
  v_exp_f32 v73, v73
  v_mfma_f32_32x32x16_bf16 v[80:95], v[160:163], v[112:115], v[80:95]
  ds_read_b128 v[144:147], v0 offset:21504
  v_cvt_pk_bf16_f32 v122, v68, v69
  v_exp_f32 v74, v74
  v_exp_f32 v75, v75
  v_cvt_pk_bf16_f32 v123, v70, v71
  v_exp_f32 v76, v76
  v_exp_f32 v77, v77
  v_mfma_f32_32x32x16_bf16 v[80:95], v[164:167], v[116:119], v[80:95]
  v_cvt_pk_bf16_f32 v124, v72, v73
  v_exp_f32 v78, v78
  v_exp_f32 v79, v79
  v_cvt_pk_bf16_f32 v125, v74, v75
  v_cvt_pk_bf16_f32 v126, v76, v77
  v_cvt_pk_bf16_f32 v127, v78, v79
  s_waitcnt lgkmcnt(1)
  v_mfma_f32_32x32x4bf16_1k v[48:79], v[150:151], v[136:137], 0
  v_exp_f32 v16, v16
  v_exp_f32 v17, v17
  v_exp_f32 v18, v18
  v_exp_f32 v19, v19
  v_exp_f32 v20, v20
  v_exp_f32 v21, v21
  v_cvt_pk_bf16_f32 v112, v16, v17
  v_exp_f32 v22, v22
  v_exp_f32 v23, v23
  v_cvt_pk_bf16_f32 v113, v18, v19
  v_exp_f32 v24, v24
  v_exp_f32 v25, v25
  v_mfma_f32_32x32x16_bf16 v[96:111], v[160:163], v[120:123], v[96:111]
  v_cvt_pk_bf16_f32 v114, v20, v21
  v_exp_f32 v26, v26
  v_exp_f32 v27, v27
  v_cvt_pk_bf16_f32 v115, v22, v23
  v_exp_f32 v28, v28
  v_exp_f32 v29, v29
  v_mfma_f32_32x32x16_bf16 v[96:111], v[164:167], v[124:127], v[96:111]
  v_cvt_pk_bf16_f32 v116, v24, v25
  v_exp_f32 v30, v30
  v_exp_f32 v31, v31
  v_cvt_pk_bf16_f32 v117, v26, v27
  v_cvt_pk_bf16_f32 v118, v28, v29
  v_cvt_pk_bf16_f32 v119, v30, v31
  s_waitcnt lgkmcnt(0)
  v_mfma_f32_32x32x16_bf16 v[48:63], v[144:147], v[128:131], v[48:63]
  ds_read_b128 v[160:163], v11 offset:25536
  ds_read_b128 v[164:167], v11 offset:26144
  v_exp_f32 v32, v32
  v_exp_f32 v33, v33
  v_exp_f32 v34, v34
  v_exp_f32 v35, v35
  v_exp_f32 v36, v36
  v_exp_f32 v37, v37
  v_mfma_f32_32x32x16_bf16 v[64:79], v[144:147], v[132:135], v[64:79]
  ds_read_b32 v148, v7 offset:2816
  v_cvt_pk_bf16_f32 v120, v32, v33
  v_exp_f32 v38, v38
  v_exp_f32 v39, v39
  v_cvt_pk_bf16_f32 v121, v34, v35
  v_exp_f32 v40, v40
  v_exp_f32 v41, v41
  v_mfma_f32_32x32x16_bf16 v[80:95], v[152:155], v[112:115], v[80:95]
  ds_read_b128 v[140:143], v0 offset:22528
  v_cvt_pk_bf16_f32 v122, v36, v37
  v_exp_f32 v42, v42
  v_exp_f32 v43, v43
  v_cvt_pk_bf16_f32 v123, v38, v39
  v_exp_f32 v44, v44
  v_exp_f32 v45, v45
  v_mfma_f32_32x32x16_bf16 v[80:95], v[156:159], v[116:119], v[80:95]
  v_cvt_pk_bf16_f32 v124, v40, v41
  v_exp_f32 v46, v46
  v_exp_f32 v47, v47
  v_cvt_pk_bf16_f32 v125, v42, v43
  v_cvt_pk_bf16_f32 v126, v44, v45
  v_cvt_pk_bf16_f32 v127, v46, v47
  s_waitcnt lgkmcnt(1)
  v_mfma_f32_32x32x4bf16_1k v[16:47], v[148:149], v[136:137], 0
  v_exp_f32 v48, v48
  v_exp_f32 v49, v49
  v_exp_f32 v50, v50
  v_exp_f32 v51, v51
  v_exp_f32 v52, v52
  v_exp_f32 v53, v53
  v_cvt_pk_bf16_f32 v112, v48, v49
  v_exp_f32 v54, v54
  v_exp_f32 v55, v55
  v_cvt_pk_bf16_f32 v113, v50, v51
  v_exp_f32 v56, v56
  v_exp_f32 v57, v57
  v_mfma_f32_32x32x16_bf16 v[96:111], v[152:155], v[120:123], v[96:111]
  v_cvt_pk_bf16_f32 v114, v52, v53
  v_exp_f32 v58, v58
  v_exp_f32 v59, v59
  v_cvt_pk_bf16_f32 v115, v54, v55
  v_exp_f32 v60, v60
  v_exp_f32 v61, v61
  v_mfma_f32_32x32x16_bf16 v[96:111], v[156:159], v[124:127], v[96:111]
  v_cvt_pk_bf16_f32 v116, v56, v57
  v_exp_f32 v62, v62
  v_exp_f32 v63, v63
  v_cvt_pk_bf16_f32 v117, v58, v59
  v_cvt_pk_bf16_f32 v118, v60, v61
  v_cvt_pk_bf16_f32 v119, v62, v63
  s_waitcnt lgkmcnt(0)
  v_mfma_f32_32x32x16_bf16 v[16:31], v[140:143], v[128:131], v[16:31]
  ds_read_b128 v[152:155], v11 offset:26752
  ds_read_b128 v[156:159], v11 offset:27360
  v_exp_f32 v64, v64
  v_exp_f32 v65, v65
  v_exp_f32 v66, v66
  v_exp_f32 v67, v67
  v_exp_f32 v68, v68
  v_exp_f32 v69, v69
  v_mfma_f32_32x32x16_bf16 v[32:47], v[140:143], v[132:135], v[32:47]
  ds_read_b32 v150, v7 offset:2944
  v_cvt_pk_bf16_f32 v120, v64, v65
  v_exp_f32 v70, v70
  v_exp_f32 v71, v71
  v_cvt_pk_bf16_f32 v121, v66, v67
  v_exp_f32 v72, v72
  v_exp_f32 v73, v73
  v_mfma_f32_32x32x16_bf16 v[80:95], v[160:163], v[112:115], v[80:95]
  ds_read_b128 v[144:147], v0 offset:23552
  v_cvt_pk_bf16_f32 v122, v68, v69
  v_exp_f32 v74, v74
  v_exp_f32 v75, v75
  v_cvt_pk_bf16_f32 v123, v70, v71
  v_exp_f32 v76, v76
  v_exp_f32 v77, v77
  v_mfma_f32_32x32x16_bf16 v[80:95], v[164:167], v[116:119], v[80:95]
  v_cvt_pk_bf16_f32 v124, v72, v73
  v_exp_f32 v78, v78
  v_exp_f32 v79, v79
  v_cvt_pk_bf16_f32 v125, v74, v75
  v_cvt_pk_bf16_f32 v126, v76, v77
  v_cvt_pk_bf16_f32 v127, v78, v79
  s_waitcnt lgkmcnt(1)
  v_mfma_f32_32x32x4bf16_1k v[48:79], v[150:151], v[136:137], 0
  v_exp_f32 v16, v16
  v_exp_f32 v17, v17
  v_exp_f32 v18, v18
  v_exp_f32 v19, v19
  v_exp_f32 v20, v20
  v_exp_f32 v21, v21
  v_cvt_pk_bf16_f32 v112, v16, v17
  v_exp_f32 v22, v22
  v_exp_f32 v23, v23
  v_cvt_pk_bf16_f32 v113, v18, v19
  v_exp_f32 v24, v24
  v_exp_f32 v25, v25
  v_mfma_f32_32x32x16_bf16 v[96:111], v[160:163], v[120:123], v[96:111]
  v_cvt_pk_bf16_f32 v114, v20, v21
  v_exp_f32 v26, v26
  v_exp_f32 v27, v27
  v_cvt_pk_bf16_f32 v115, v22, v23
  v_exp_f32 v28, v28
  v_exp_f32 v29, v29
  v_mfma_f32_32x32x16_bf16 v[96:111], v[164:167], v[124:127], v[96:111]
  v_cvt_pk_bf16_f32 v116, v24, v25
  v_exp_f32 v30, v30
  v_exp_f32 v31, v31
  v_cvt_pk_bf16_f32 v117, v26, v27
  v_cvt_pk_bf16_f32 v118, v28, v29
  v_cvt_pk_bf16_f32 v119, v30, v31
  s_waitcnt lgkmcnt(0)
  v_mfma_f32_32x32x16_bf16 v[48:63], v[144:147], v[128:131], v[48:63]
  ds_read_b128 v[160:163], v11 offset:27968
  ds_read_b128 v[164:167], v11 offset:28576
  v_exp_f32 v32, v32
  v_exp_f32 v33, v33
  v_exp_f32 v34, v34
  v_exp_f32 v35, v35
  v_exp_f32 v36, v36
  v_exp_f32 v37, v37
  v_mfma_f32_32x32x16_bf16 v[64:79], v[144:147], v[132:135], v[64:79]
  ds_read_b32 v148, v7 offset:3072
  v_cvt_pk_bf16_f32 v120, v32, v33
  v_exp_f32 v38, v38
  v_exp_f32 v39, v39
  v_cvt_pk_bf16_f32 v121, v34, v35
  v_exp_f32 v40, v40
  v_exp_f32 v41, v41
  v_mfma_f32_32x32x16_bf16 v[80:95], v[152:155], v[112:115], v[80:95]
  ds_read_b128 v[140:143], v0 offset:24576
  v_cvt_pk_bf16_f32 v122, v36, v37
  v_exp_f32 v42, v42
  v_exp_f32 v43, v43
  v_cvt_pk_bf16_f32 v123, v38, v39
  v_exp_f32 v44, v44
  v_exp_f32 v45, v45
  v_mfma_f32_32x32x16_bf16 v[80:95], v[156:159], v[116:119], v[80:95]
  v_cvt_pk_bf16_f32 v124, v40, v41
  v_exp_f32 v46, v46
  v_exp_f32 v47, v47
  v_cvt_pk_bf16_f32 v125, v42, v43
  v_cvt_pk_bf16_f32 v126, v44, v45
  v_cvt_pk_bf16_f32 v127, v46, v47
  s_waitcnt lgkmcnt(1)
  v_mfma_f32_32x32x4bf16_1k v[16:47], v[148:149], v[136:137], 0
  v_exp_f32 v48, v48
  v_exp_f32 v49, v49
  v_exp_f32 v50, v50
  v_exp_f32 v51, v51
  v_exp_f32 v52, v52
  v_exp_f32 v53, v53
  v_cvt_pk_bf16_f32 v112, v48, v49
  v_exp_f32 v54, v54
  v_exp_f32 v55, v55
  v_cvt_pk_bf16_f32 v113, v50, v51
  v_exp_f32 v56, v56
  v_exp_f32 v57, v57
  v_mfma_f32_32x32x16_bf16 v[96:111], v[152:155], v[120:123], v[96:111]
  v_cvt_pk_bf16_f32 v114, v52, v53
  v_exp_f32 v58, v58
  v_exp_f32 v59, v59
  v_cvt_pk_bf16_f32 v115, v54, v55
  v_exp_f32 v60, v60
  v_exp_f32 v61, v61
  v_mfma_f32_32x32x16_bf16 v[96:111], v[156:159], v[124:127], v[96:111]
  v_cvt_pk_bf16_f32 v116, v56, v57
  v_exp_f32 v62, v62
  v_exp_f32 v63, v63
  v_cvt_pk_bf16_f32 v117, v58, v59
  v_cvt_pk_bf16_f32 v118, v60, v61
  v_cvt_pk_bf16_f32 v119, v62, v63
  s_waitcnt lgkmcnt(0)
  v_mfma_f32_32x32x16_bf16 v[16:31], v[140:143], v[128:131], v[16:31]
  ds_read_b128 v[152:155], v11 offset:29184
  ds_read_b128 v[156:159], v11 offset:29792
  v_exp_f32 v64, v64
  v_exp_f32 v65, v65
  v_exp_f32 v66, v66
  v_exp_f32 v67, v67
  v_exp_f32 v68, v68
  v_exp_f32 v69, v69
  v_mfma_f32_32x32x16_bf16 v[32:47], v[140:143], v[132:135], v[32:47]
  ds_read_b32 v150, v7 offset:3200
  v_cvt_pk_bf16_f32 v120, v64, v65
  v_exp_f32 v70, v70
  v_exp_f32 v71, v71
  v_cvt_pk_bf16_f32 v121, v66, v67
  v_exp_f32 v72, v72
  v_exp_f32 v73, v73
  v_mfma_f32_32x32x16_bf16 v[80:95], v[160:163], v[112:115], v[80:95]
  ds_read_b128 v[144:147], v0 offset:25600
  v_cvt_pk_bf16_f32 v122, v68, v69
  v_exp_f32 v74, v74
  v_exp_f32 v75, v75
  v_cvt_pk_bf16_f32 v123, v70, v71
  v_exp_f32 v76, v76
  v_exp_f32 v77, v77
  v_mfma_f32_32x32x16_bf16 v[80:95], v[164:167], v[116:119], v[80:95]
  v_cvt_pk_bf16_f32 v124, v72, v73
  v_exp_f32 v78, v78
  v_exp_f32 v79, v79
  v_cvt_pk_bf16_f32 v125, v74, v75
  v_cvt_pk_bf16_f32 v126, v76, v77
  v_cvt_pk_bf16_f32 v127, v78, v79
  s_waitcnt lgkmcnt(1)
  v_mfma_f32_32x32x4bf16_1k v[48:79], v[150:151], v[136:137], 0
  v_exp_f32 v16, v16
  v_exp_f32 v17, v17
  v_exp_f32 v18, v18
  v_exp_f32 v19, v19
  v_exp_f32 v20, v20
  v_exp_f32 v21, v21
  v_cvt_pk_bf16_f32 v112, v16, v17
  v_exp_f32 v22, v22
  v_exp_f32 v23, v23
  v_cvt_pk_bf16_f32 v113, v18, v19
  v_exp_f32 v24, v24
  v_exp_f32 v25, v25
  v_mfma_f32_32x32x16_bf16 v[96:111], v[160:163], v[120:123], v[96:111]
  v_cvt_pk_bf16_f32 v114, v20, v21
  v_exp_f32 v26, v26
  v_exp_f32 v27, v27
  v_cvt_pk_bf16_f32 v115, v22, v23
  v_exp_f32 v28, v28
  v_exp_f32 v29, v29
  v_mfma_f32_32x32x16_bf16 v[96:111], v[164:167], v[124:127], v[96:111]
  v_cvt_pk_bf16_f32 v116, v24, v25
  v_exp_f32 v30, v30
  v_exp_f32 v31, v31
  v_cvt_pk_bf16_f32 v117, v26, v27
  v_cvt_pk_bf16_f32 v118, v28, v29
  v_cvt_pk_bf16_f32 v119, v30, v31
  s_waitcnt lgkmcnt(0)
  v_mfma_f32_32x32x16_bf16 v[48:63], v[144:147], v[128:131], v[48:63]
  ds_read_b128 v[160:163], v11 offset:30400
  ds_read_b128 v[164:167], v11 offset:31008
  v_exp_f32 v32, v32
  v_exp_f32 v33, v33
  v_exp_f32 v34, v34
  v_exp_f32 v35, v35
  v_exp_f32 v36, v36
  v_exp_f32 v37, v37
  v_mfma_f32_32x32x16_bf16 v[64:79], v[144:147], v[132:135], v[64:79]
  ds_read_b32 v148, v7 offset:3328
  v_cvt_pk_bf16_f32 v120, v32, v33
  v_exp_f32 v38, v38
  v_exp_f32 v39, v39
  v_cvt_pk_bf16_f32 v121, v34, v35
  v_exp_f32 v40, v40
  v_exp_f32 v41, v41
  v_mfma_f32_32x32x16_bf16 v[80:95], v[152:155], v[112:115], v[80:95]
  ds_read_b128 v[140:143], v0 offset:26624
  v_cvt_pk_bf16_f32 v122, v36, v37
  v_exp_f32 v42, v42
  v_exp_f32 v43, v43
  v_cvt_pk_bf16_f32 v123, v38, v39
  v_exp_f32 v44, v44
  v_exp_f32 v45, v45
  v_mfma_f32_32x32x16_bf16 v[80:95], v[156:159], v[116:119], v[80:95]
  v_cvt_pk_bf16_f32 v124, v40, v41
  v_exp_f32 v46, v46
  v_exp_f32 v47, v47
  v_cvt_pk_bf16_f32 v125, v42, v43
  v_cvt_pk_bf16_f32 v126, v44, v45
  v_cvt_pk_bf16_f32 v127, v46, v47
  s_waitcnt lgkmcnt(1)
  v_mfma_f32_32x32x4bf16_1k v[16:47], v[148:149], v[136:137], 0
  v_exp_f32 v48, v48
  v_exp_f32 v49, v49
  v_exp_f32 v50, v50
  v_exp_f32 v51, v51
  v_exp_f32 v52, v52
  v_exp_f32 v53, v53
  v_cvt_pk_bf16_f32 v112, v48, v49
  v_exp_f32 v54, v54
  v_exp_f32 v55, v55
  v_cvt_pk_bf16_f32 v113, v50, v51
  v_exp_f32 v56, v56
  v_exp_f32 v57, v57
  v_mfma_f32_32x32x16_bf16 v[96:111], v[152:155], v[120:123], v[96:111]
  v_cvt_pk_bf16_f32 v114, v52, v53
  v_exp_f32 v58, v58
  v_exp_f32 v59, v59
  v_cvt_pk_bf16_f32 v115, v54, v55
  v_exp_f32 v60, v60
  v_exp_f32 v61, v61
  v_mfma_f32_32x32x16_bf16 v[96:111], v[156:159], v[124:127], v[96:111]
  v_cvt_pk_bf16_f32 v116, v56, v57
  v_exp_f32 v62, v62
  v_exp_f32 v63, v63
  v_cvt_pk_bf16_f32 v117, v58, v59
  v_cvt_pk_bf16_f32 v118, v60, v61
  v_cvt_pk_bf16_f32 v119, v62, v63
  s_waitcnt lgkmcnt(0)
  v_mfma_f32_32x32x16_bf16 v[16:31], v[140:143], v[128:131], v[16:31]
  ds_read_b128 v[152:155], v11 offset:31616
  ds_read_b128 v[156:159], v11 offset:32224
  v_exp_f32 v64, v64
  v_exp_f32 v65, v65
  v_exp_f32 v66, v66
  v_exp_f32 v67, v67
  v_exp_f32 v68, v68
  v_exp_f32 v69, v69
  v_mfma_f32_32x32x16_bf16 v[32:47], v[140:143], v[132:135], v[32:47]
  ds_read_b32 v150, v7 offset:3456
  v_cvt_pk_bf16_f32 v120, v64, v65
  v_exp_f32 v70, v70
  v_exp_f32 v71, v71
  v_cvt_pk_bf16_f32 v121, v66, v67
  v_exp_f32 v72, v72
  v_exp_f32 v73, v73
  v_mfma_f32_32x32x16_bf16 v[80:95], v[160:163], v[112:115], v[80:95]
  ds_read_b128 v[144:147], v0 offset:27648
  v_cvt_pk_bf16_f32 v122, v68, v69
  v_exp_f32 v74, v74
  v_exp_f32 v75, v75
  v_cvt_pk_bf16_f32 v123, v70, v71
  v_exp_f32 v76, v76
  v_exp_f32 v77, v77
  v_mfma_f32_32x32x16_bf16 v[80:95], v[164:167], v[116:119], v[80:95]
  v_cvt_pk_bf16_f32 v124, v72, v73
  v_exp_f32 v78, v78
  v_exp_f32 v79, v79
  v_cvt_pk_bf16_f32 v125, v74, v75
  v_cvt_pk_bf16_f32 v126, v76, v77
  v_cvt_pk_bf16_f32 v127, v78, v79
  s_waitcnt lgkmcnt(1)
  v_mfma_f32_32x32x4bf16_1k v[48:79], v[150:151], v[136:137], 0
  v_exp_f32 v16, v16
  v_exp_f32 v17, v17
  v_exp_f32 v18, v18
  v_exp_f32 v19, v19
  v_exp_f32 v20, v20
  v_exp_f32 v21, v21
  v_cvt_pk_bf16_f32 v112, v16, v17
  v_exp_f32 v22, v22
  v_exp_f32 v23, v23
  v_cvt_pk_bf16_f32 v113, v18, v19
  v_exp_f32 v24, v24
  v_exp_f32 v25, v25
  v_mfma_f32_32x32x16_bf16 v[96:111], v[160:163], v[120:123], v[96:111]
  v_cvt_pk_bf16_f32 v114, v20, v21
  v_exp_f32 v26, v26
  v_exp_f32 v27, v27
  v_cvt_pk_bf16_f32 v115, v22, v23
  v_exp_f32 v28, v28
  v_exp_f32 v29, v29
  v_mfma_f32_32x32x16_bf16 v[96:111], v[164:167], v[124:127], v[96:111]
  v_cvt_pk_bf16_f32 v116, v24, v25
  v_exp_f32 v30, v30
  v_exp_f32 v31, v31
  v_cvt_pk_bf16_f32 v117, v26, v27
  v_cvt_pk_bf16_f32 v118, v28, v29
  v_cvt_pk_bf16_f32 v119, v30, v31
  s_waitcnt lgkmcnt(0)
  v_mfma_f32_32x32x16_bf16 v[48:63], v[144:147], v[128:131], v[48:63]
  ds_read_b128 v[160:163], v11 offset:32832
  ds_read_b128 v[164:167], v11 offset:33440
  v_exp_f32 v32, v32
  v_exp_f32 v33, v33
  v_exp_f32 v34, v34
  v_exp_f32 v35, v35
  v_exp_f32 v36, v36
  v_exp_f32 v37, v37
  v_mfma_f32_32x32x16_bf16 v[64:79], v[144:147], v[132:135], v[64:79]
  ds_read_b32 v148, v7 offset:3584
  v_cvt_pk_bf16_f32 v120, v32, v33
  v_exp_f32 v38, v38
  v_exp_f32 v39, v39
  v_cvt_pk_bf16_f32 v121, v34, v35
  v_exp_f32 v40, v40
  v_exp_f32 v41, v41
  v_mfma_f32_32x32x16_bf16 v[80:95], v[152:155], v[112:115], v[80:95]
  ds_read_b128 v[140:143], v0 offset:28672
  v_cvt_pk_bf16_f32 v122, v36, v37
  v_exp_f32 v42, v42
  v_exp_f32 v43, v43
  v_cvt_pk_bf16_f32 v123, v38, v39
  v_exp_f32 v44, v44
  v_exp_f32 v45, v45
  v_mfma_f32_32x32x16_bf16 v[80:95], v[156:159], v[116:119], v[80:95]
  v_cvt_pk_bf16_f32 v124, v40, v41
  v_exp_f32 v46, v46
  v_exp_f32 v47, v47
  v_cvt_pk_bf16_f32 v125, v42, v43
  v_cvt_pk_bf16_f32 v126, v44, v45
  v_cvt_pk_bf16_f32 v127, v46, v47
  s_barrier
  s_waitcnt lgkmcnt(1)
  v_mfma_f32_32x32x4bf16_1k v[16:47], v[148:149], v[136:137], 0
  v_exp_f32 v48, v48
  v_exp_f32 v49, v49
  v_exp_f32 v50, v50
  v_exp_f32 v51, v51
  v_exp_f32 v52, v52
  v_exp_f32 v53, v53
  v_cvt_pk_bf16_f32 v112, v48, v49
  v_exp_f32 v54, v54
  v_exp_f32 v55, v55
  v_cvt_pk_bf16_f32 v113, v50, v51
  v_exp_f32 v56, v56
  v_exp_f32 v57, v57
  v_mfma_f32_32x32x16_bf16 v[96:111], v[152:155], v[120:123], v[96:111]
  v_cvt_pk_bf16_f32 v114, v52, v53
  v_exp_f32 v58, v58
  v_exp_f32 v59, v59
  v_cvt_pk_bf16_f32 v115, v54, v55
  v_exp_f32 v60, v60
  v_exp_f32 v61, v61
  v_mfma_f32_32x32x16_bf16 v[96:111], v[156:159], v[124:127], v[96:111]
  v_cvt_pk_bf16_f32 v116, v56, v57
  v_exp_f32 v62, v62
  v_exp_f32 v63, v63
  v_cvt_pk_bf16_f32 v117, v58, v59
  v_cvt_pk_bf16_f32 v118, v60, v61
  v_cvt_pk_bf16_f32 v119, v62, v63
  s_waitcnt lgkmcnt(0)
  v_mfma_f32_32x32x16_bf16 v[16:31], v[140:143], v[128:131], v[16:31]
  ds_read_b128 v[152:155], v11 offset:34048
  ds_read_b128 v[156:159], v11 offset:34656
  v_exp_f32 v64, v64
  v_exp_f32 v65, v65
  v_exp_f32 v66, v66
  v_exp_f32 v67, v67
  v_exp_f32 v68, v68
  v_exp_f32 v69, v69
  v_mfma_f32_32x32x16_bf16 v[32:47], v[140:143], v[132:135], v[32:47]
  ds_read_b32 v150, v7 offset:3712
  v_cvt_pk_bf16_f32 v120, v64, v65
  v_exp_f32 v70, v70
  v_exp_f32 v71, v71
  v_cvt_pk_bf16_f32 v121, v66, v67
  v_exp_f32 v72, v72
  v_exp_f32 v73, v73
  v_mfma_f32_32x32x16_bf16 v[80:95], v[160:163], v[112:115], v[80:95]
  ds_read_b128 v[144:147], v0 offset:29696
  v_cvt_pk_bf16_f32 v122, v68, v69
  v_exp_f32 v74, v74
  v_exp_f32 v75, v75
  v_cvt_pk_bf16_f32 v123, v70, v71
  v_exp_f32 v76, v76
  v_exp_f32 v77, v77
  v_mfma_f32_32x32x16_bf16 v[80:95], v[164:167], v[116:119], v[80:95]
  v_cvt_pk_bf16_f32 v124, v72, v73
  v_exp_f32 v78, v78
  v_exp_f32 v79, v79
  v_cvt_pk_bf16_f32 v125, v74, v75
  v_cvt_pk_bf16_f32 v126, v76, v77
  v_cvt_pk_bf16_f32 v127, v78, v79
  s_waitcnt lgkmcnt(1)
  v_mfma_f32_32x32x4bf16_1k v[48:79], v[150:151], v[136:137], 0
  v_exp_f32 v16, v16
  v_exp_f32 v17, v17
  v_exp_f32 v18, v18
  v_exp_f32 v19, v19
  v_exp_f32 v20, v20
  v_exp_f32 v21, v21
  v_cvt_pk_bf16_f32 v112, v16, v17
  v_exp_f32 v22, v22
  v_exp_f32 v23, v23
  v_cvt_pk_bf16_f32 v113, v18, v19
  v_exp_f32 v24, v24
  v_exp_f32 v25, v25
  v_mfma_f32_32x32x16_bf16 v[96:111], v[160:163], v[120:123], v[96:111]
  v_cvt_pk_bf16_f32 v114, v20, v21
  v_exp_f32 v26, v26
  v_exp_f32 v27, v27
  v_cvt_pk_bf16_f32 v115, v22, v23
  v_exp_f32 v28, v28
  v_exp_f32 v29, v29
  v_mfma_f32_32x32x16_bf16 v[96:111], v[164:167], v[124:127], v[96:111]
  v_cvt_pk_bf16_f32 v116, v24, v25
  v_exp_f32 v30, v30
  v_exp_f32 v31, v31
  v_cvt_pk_bf16_f32 v117, v26, v27
  v_cvt_pk_bf16_f32 v118, v28, v29
  v_cvt_pk_bf16_f32 v119, v30, v31
  s_waitcnt lgkmcnt(0)
  v_mfma_f32_32x32x16_bf16 v[48:63], v[144:147], v[128:131], v[48:63]
  ds_read_b128 v[160:163], v11 offset:35264
  ds_read_b128 v[164:167], v11 offset:35872
  v_exp_f32 v32, v32
  v_exp_f32 v33, v33
  v_exp_f32 v34, v34
  v_exp_f32 v35, v35
  v_exp_f32 v36, v36
  v_exp_f32 v37, v37
  v_mfma_f32_32x32x16_bf16 v[64:79], v[144:147], v[132:135], v[64:79]
  ds_read_b32 v148, v7 offset:3840
  v_cvt_pk_bf16_f32 v120, v32, v33
  v_exp_f32 v38, v38
  v_exp_f32 v39, v39
  v_cvt_pk_bf16_f32 v121, v34, v35
  v_exp_f32 v40, v40
  v_exp_f32 v41, v41
  v_mfma_f32_32x32x16_bf16 v[80:95], v[152:155], v[112:115], v[80:95]
  ds_read_b128 v[140:143], v0 offset:30720
  v_cvt_pk_bf16_f32 v122, v36, v37
  v_exp_f32 v42, v42
  v_exp_f32 v43, v43
  v_cvt_pk_bf16_f32 v123, v38, v39
  v_exp_f32 v44, v44
  v_exp_f32 v45, v45
  v_mfma_f32_32x32x16_bf16 v[80:95], v[156:159], v[116:119], v[80:95]
  v_cvt_pk_bf16_f32 v124, v40, v41
  v_exp_f32 v46, v46
  v_exp_f32 v47, v47
  v_cvt_pk_bf16_f32 v125, v42, v43
  v_cvt_pk_bf16_f32 v126, v44, v45
  v_cvt_pk_bf16_f32 v127, v46, v47
  s_waitcnt lgkmcnt(1)
  v_mfma_f32_32x32x4bf16_1k v[16:47], v[148:149], v[136:137], 0
  v_exp_f32 v48, v48
  v_exp_f32 v49, v49
  v_exp_f32 v50, v50
  v_exp_f32 v51, v51
  v_exp_f32 v52, v52
  v_exp_f32 v53, v53
  v_cvt_pk_bf16_f32 v112, v48, v49
  v_exp_f32 v54, v54
  v_exp_f32 v55, v55
  v_cvt_pk_bf16_f32 v113, v50, v51
  v_exp_f32 v56, v56
  v_exp_f32 v57, v57
  v_mfma_f32_32x32x16_bf16 v[96:111], v[152:155], v[120:123], v[96:111]
  v_cvt_pk_bf16_f32 v114, v52, v53
  v_exp_f32 v58, v58
  v_exp_f32 v59, v59
  v_cvt_pk_bf16_f32 v115, v54, v55
  v_exp_f32 v60, v60
  v_exp_f32 v61, v61
  v_mfma_f32_32x32x16_bf16 v[96:111], v[156:159], v[124:127], v[96:111]
  v_cvt_pk_bf16_f32 v116, v56, v57
  v_exp_f32 v62, v62
  v_exp_f32 v63, v63
  v_cvt_pk_bf16_f32 v117, v58, v59
  v_cvt_pk_bf16_f32 v118, v60, v61
  v_cvt_pk_bf16_f32 v119, v62, v63
  s_waitcnt lgkmcnt(0)
  v_mfma_f32_32x32x16_bf16 v[16:31], v[140:143], v[128:131], v[16:31]
  ds_read_b128 v[152:155], v11 offset:36480
  ds_read_b128 v[156:159], v11 offset:37088
  v_exp_f32 v64, v64
  v_exp_f32 v65, v65
  v_exp_f32 v66, v66
  v_exp_f32 v67, v67
  v_exp_f32 v68, v68
  v_exp_f32 v69, v69
  v_mfma_f32_32x32x16_bf16 v[32:47], v[140:143], v[132:135], v[32:47]
  ds_read_b32 v150, v7 offset:3968
  v_cvt_pk_bf16_f32 v120, v64, v65
  v_exp_f32 v70, v70
  v_exp_f32 v71, v71
  v_cvt_pk_bf16_f32 v121, v66, v67
  v_exp_f32 v72, v72
  v_exp_f32 v73, v73
  v_mfma_f32_32x32x16_bf16 v[80:95], v[160:163], v[112:115], v[80:95]
  ds_read_b128 v[144:147], v0 offset:31744
  v_cvt_pk_bf16_f32 v122, v68, v69
  v_exp_f32 v74, v74
  v_exp_f32 v75, v75
  v_cvt_pk_bf16_f32 v123, v70, v71
  v_exp_f32 v76, v76
  v_exp_f32 v77, v77
  v_mfma_f32_32x32x16_bf16 v[80:95], v[164:167], v[116:119], v[80:95]
  v_cvt_pk_bf16_f32 v124, v72, v73
  v_exp_f32 v78, v78
  v_exp_f32 v79, v79
  v_cvt_pk_bf16_f32 v125, v74, v75
  v_cvt_pk_bf16_f32 v126, v76, v77
  v_cvt_pk_bf16_f32 v127, v78, v79
  s_waitcnt lgkmcnt(1)
  v_mfma_f32_32x32x4bf16_1k v[48:79], v[150:151], v[136:137], 0
  v_exp_f32 v16, v16
  v_exp_f32 v17, v17
  v_exp_f32 v18, v18
  v_exp_f32 v19, v19
  v_exp_f32 v20, v20
  v_exp_f32 v21, v21
  v_cvt_pk_bf16_f32 v112, v16, v17
  v_exp_f32 v22, v22
  v_exp_f32 v23, v23
  v_cvt_pk_bf16_f32 v113, v18, v19
  v_exp_f32 v24, v24
  v_exp_f32 v25, v25
  v_mfma_f32_32x32x16_bf16 v[96:111], v[160:163], v[120:123], v[96:111]
  v_cvt_pk_bf16_f32 v114, v20, v21
  v_exp_f32 v26, v26
  v_exp_f32 v27, v27
  v_cvt_pk_bf16_f32 v115, v22, v23
  v_exp_f32 v28, v28
  v_exp_f32 v29, v29
  v_mfma_f32_32x32x16_bf16 v[96:111], v[164:167], v[124:127], v[96:111]
  v_cvt_pk_bf16_f32 v116, v24, v25
  v_exp_f32 v30, v30
  v_exp_f32 v31, v31
  v_cvt_pk_bf16_f32 v117, v26, v27
  v_cvt_pk_bf16_f32 v118, v28, v29
  v_cvt_pk_bf16_f32 v119, v30, v31
  s_waitcnt lgkmcnt(0)
  v_mfma_f32_32x32x16_bf16 v[48:63], v[144:147], v[128:131], v[48:63]
  ds_read_b128 v[160:163], v11 offset:37696
  ds_read_b128 v[164:167], v11 offset:38304
  v_exp_f32 v32, v32
  v_exp_f32 v33, v33
  v_exp_f32 v34, v34
  v_exp_f32 v35, v35
  v_exp_f32 v36, v36
  v_exp_f32 v37, v37
  v_mfma_f32_32x32x16_bf16 v[64:79], v[144:147], v[132:135], v[64:79]
  v_cvt_pk_bf16_f32 v120, v32, v33
  v_exp_f32 v38, v38
  v_exp_f32 v39, v39
  v_cvt_pk_bf16_f32 v121, v34, v35
  v_exp_f32 v40, v40
  v_exp_f32 v41, v41
  v_mfma_f32_32x32x16_bf16 v[80:95], v[152:155], v[112:115], v[80:95]
  v_cvt_pk_bf16_f32 v122, v36, v37
  v_exp_f32 v42, v42
  v_exp_f32 v43, v43
  v_cvt_pk_bf16_f32 v123, v38, v39
  v_exp_f32 v44, v44
  v_exp_f32 v45, v45
  v_mfma_f32_32x32x16_bf16 v[80:95], v[156:159], v[116:119], v[80:95]
  v_cvt_pk_bf16_f32 v124, v40, v41
  v_exp_f32 v46, v46
  v_exp_f32 v47, v47
  v_cvt_pk_bf16_f32 v125, v42, v43
  v_cvt_pk_bf16_f32 v126, v44, v45
  v_cvt_pk_bf16_f32 v127, v46, v47
  v_mfma_f32_32x32x16_bf16 v[96:111], v[152:155], v[120:123], v[96:111]
  v_exp_f32 v48, v48
  v_exp_f32 v49, v49
  v_exp_f32 v50, v50
  v_exp_f32 v51, v51
  v_exp_f32 v52, v52
  v_exp_f32 v53, v53
  v_mfma_f32_32x32x16_bf16 v[96:111], v[156:159], v[124:127], v[96:111]
  v_cvt_pk_bf16_f32 v112, v48, v49
  v_exp_f32 v54, v54
  v_exp_f32 v55, v55
  v_cvt_pk_bf16_f32 v113, v50, v51
  v_exp_f32 v56, v56
  v_exp_f32 v57, v57
  v_cvt_pk_bf16_f32 v114, v52, v53
  v_exp_f32 v58, v58
  v_exp_f32 v59, v59
  v_cvt_pk_bf16_f32 v115, v54, v55
  v_exp_f32 v60, v60
  v_exp_f32 v61, v61
  v_cvt_pk_bf16_f32 v116, v56, v57
  v_exp_f32 v62, v62
  v_exp_f32 v63, v63
  v_cvt_pk_bf16_f32 v117, v58, v59
  v_cvt_pk_bf16_f32 v118, v60, v61
  v_cvt_pk_bf16_f32 v119, v62, v63
  s_waitcnt lgkmcnt(0)
  v_mfma_f32_32x32x16_bf16 v[80:95], v[160:163], v[112:115], v[80:95]
  v_exp_f32 v64, v64
  v_exp_f32 v65, v65
  v_exp_f32 v66, v66
  v_exp_f32 v67, v67
  v_exp_f32 v68, v68
  v_exp_f32 v69, v69
  v_mfma_f32_32x32x16_bf16 v[80:95], v[164:167], v[116:119], v[80:95]
  v_cvt_pk_bf16_f32 v120, v64, v65
  v_exp_f32 v70, v70
  v_exp_f32 v71, v71
  v_cvt_pk_bf16_f32 v121, v66, v67
  v_exp_f32 v72, v72
  v_exp_f32 v73, v73
  v_cvt_pk_bf16_f32 v122, v68, v69
  v_exp_f32 v74, v74
  v_exp_f32 v75, v75
  v_cvt_pk_bf16_f32 v123, v70, v71
  v_exp_f32 v76, v76
  v_exp_f32 v77, v77
  v_cvt_pk_bf16_f32 v124, v72, v73
  v_exp_f32 v78, v78
  v_exp_f32 v79, v79
  v_cvt_pk_bf16_f32 v125, v74, v75
  v_cvt_pk_bf16_f32 v126, v76, v77
  v_cvt_pk_bf16_f32 v127, v78, v79
  v_mfma_f32_32x32x16_bf16 v[96:111], v[160:163], v[120:123], v[96:111]
  s_nop 0
  v_mfma_f32_32x32x16_bf16 v[96:111], v[164:167], v[124:127], v[96:111]
  s_add_u32 s36, s20, 3264512
  s_addc_u32 s37, s21, 0
  s_and_b32 s37, s37, 0xffff
  s_mov_b32 s38, 2359296
  s_mov_b32 s39, 0x20000
  v_mov_b32 v9, 0x5f000000
  s_mul_i32 s17, s3, 3072
  v_add_u32 v15, s17, v2
  s_lshl_b32 s17, s3, 2
  v_mov_b32 v12, s17
  v_pk_add_f32 v[16:17], v[80:81], v[82:83]
  v_pk_add_f32 v[18:19], v[84:85], v[86:87]
  v_pk_add_f32 v[16:17], v[16:17], v[88:89]
  ds_write_b128 v15, v[96:99]
  ds_write_b128 v15, v[100:103] offset:1024
  ds_write_b128 v15, v[104:107] offset:2048
  v_pk_add_f32 v[20:21], v[96:97], v[98:99]
  v_pk_add_f32 v[22:23], v[100:101], v[102:103]
  v_pk_add_f32 v[16:17], v[16:17], v[104:105]
  v_pk_add_f32 v[18:19], v[18:19], v[20:21]
  v_pk_add_f32 v[16:17], v[16:17], v[22:23]
  v_cmp_nlt_f32 vcc, v90, v9
  v_pk_add_f32 v[16:17], v[16:17], v[18:19]
  v_cmp_nlt_f32 s[16:17], v106, v9
  v_cmp_u_f32 s[18:19], v16, v17
  s_or_b64 s[16:17], s[16:17], vcc
  s_or_b64 s[16:17], s[16:17], s[18:19]
  s_cmp_lg_u64 s[16:17], 0
  s_cselect_b32 s16, 1, 0
  v_mov_b32 v10, s16
  ds_write_b32 v12, v10 offset:32768
  s_xor_b32 s17, s3, 4
  s_mul_i32 s17, s17, 3072
  v_add_u32 v9, s17, v2
  v_and_b32 v12, 7, v1
  v_lshlrev_b32 v12, 2, v12
  s_waitcnt lgkmcnt(0)
  s_barrier
  ds_read_b32 v10, v12 offset:32768
  ds_read_b128 v[16:19], v9
  ds_read_b128 v[20:23], v9 offset:1024
  ds_read_b128 v[24:27], v9 offset:2048
  v_and_b32 v12, 15, v1
  v_lshlrev_b32 v12, 4, v12
  v_bfe_u32 v13, v1, 4, 1
  v_mul_u32_u24 v13, 18432, v13
  v_add_u32 v12, v12, v13
  v_lshrrev_b32 v14, 5, v1
  v_lshl_add_u32 v13, v14, 8, v12
  s_mul_i32 s16, s4, 36864
  s_lshr_b32 s17, s7, 1
  s_lshl_b32 s17, s17, 10
  s_and_b32 s18, s7, 1
  s_lshl_b32 s18, s18, 9
  s_add_u32 s17, s17, s18
  s_add_u32 s17, s17, s16
  s_lshr_b32 s18, s7, 2
  s_lshl_b32 s18, s18, 8
  s_and_b32 s19, s7, 3
  s_lshl_b32 s19, s19, 2
  s_add_u32 s18, s18, s19
  s_add_u32 s18, s18, s16
  s_add_u32 s18, s18, 16384
  s_waitcnt lgkmcnt(3)
  v_cmp_ne_u32 vcc, 0, v10
  s_nop 0
  s_cmp_lg_u64 vcc, 0
  s_cselect_b32 s16, 1, 0
  s_andn2_b32 s16, s16, s23
  s_cmp_eq_u32 s16, 0
  s_cbranch_scc1 kf_front_kernel_ok
  s_mov_b32 s23, 1
  s_waitcnt lgkmcnt(0)
  s_barrier
  s_branch kf_front_kernel_again
kf_front_kernel_ok:
  s_waitcnt lgkmcnt(0)
  v_pk_add_f32 v[80:81], v[80:81], v[16:17]
  v_pk_add_f32 v[82:83], v[82:83], v[18:19]
  v_pk_add_f32 v[84:85], v[84:85], v[20:21]
  v_pk_add_f32 v[86:87], v[86:87], v[22:23]
  v_pk_add_f32 v[88:89], v[88:89], v[24:25]
  v_pk_add_f32 v[90:91], v[90:91], v[26:27]
  v_rcp_f32 v10, v90
  s_nop 0
  v_pk_mul_f32 v[80:81], v[80:81], v[10:11] op_sel_hi:[1,0]
  v_pk_mul_f32 v[82:83], v[82:83], v[10:11] op_sel_hi:[1,0]
  v_pk_mul_f32 v[84:85], v[84:85], v[10:11] op_sel_hi:[1,0]
  v_pk_mul_f32 v[86:87], v[86:87], v[10:11] op_sel_hi:[1,0]
  v_pk_mul_f32 v[88:89], v[88:89], v[10:11] op_sel_hi:[1,0]
  v_cvt_pk_bf16_f32 v112, v80, v81
  v_cvt_pk_bf16_f32 v113, v82, v83
  v_cvt_pk_bf16_f32 v114, v84, v85
  v_cvt_pk_bf16_f32 v115, v86, v87
  v_cvt_pk_bf16_f32 v116, v88, v89
  buffer_store_dwordx4 v[112:115], v13, s[36:39], s17 offen sc1
  s_mov_b32 exec_hi, 0
  buffer_store_dword v116, v12, s[36:39], s18 offen
kf_front_kernel_end:
  s_endpgm
.text
.globl kt_tail_kernel
.p2align 8
.type kt_tail_kernel,@function
kt_tail_kernel:
  s_cmp_ge_u32 s2, 256
  s_cbranch_scc1 kt_tail_kernel_end
  s_load_dwordx2 s[20:21], s[0:1], 112
  s_load_dwordx2 s[64:65], s[0:1], 0
  s_load_dwordx4 s[68:71], s[0:1], 56
  s_load_dwordx2 s[66:67], s[0:1], 96
  v_lshrrev_b32 v1, 6, v0
  s_nop 0
  v_readfirstlane_b32 s3, v1
  v_and_b32 v1, 63, v0
  s_and_b32 s4, s2, 7
  s_lshl_b32 s4, s4, 2
  s_bfe_u32 s5, s2, 0x20003
  s_add_u32 s4, s4, s5
  s_lshr_b32 s5, s2, 5
  s_lshl_b32 s6, s4, 2
  s_add_u32 s6, s6, s3
  v_lshlrev_b32 v2, 4, v1
  s_mul_i32 s10, s6, 18432
  s_mul_i32 s11, s5, 82944
  s_lshl_b32 s17, s3, 10
  s_add_u32 s11, s11, s17
  s_mul_i32 s12, s5, 144
  s_add_u32 s12, s12, s10
  s_waitcnt lgkmcnt(0)
  s_add_u32 s28, s20, 3264512
  s_addc_u32 s29, s21, 0
  s_and_b32 s29, s29, 0xffff
  s_mov_b32 s30, 2359296
  s_mov_b32 s31, 0x20000
  s_add_u32 s32, s20, 5623808
  s_addc_u32 s33, s21, 0
  s_and_b32 s33, s33, 0xffff
  s_mov_b32 s34, 663552
  s_mov_b32 s35, 0x20000
  buffer_load_dwordx4 v[72:75], v2, s[28:31], s10 offen offset:0
  s_add_u32 m0, s17, 0
  s_add_u32 s11, s11, 0
  buffer_load_dwordx4 v2, s[32:35], s11 offen lds
  s_add_u32 m0, s17, 4096
  s_add_u32 s11, s11, 4096
  buffer_load_dwordx4 v2, s[32:35], s11 offen lds
  buffer_load_dwordx4 v[76:79], v2, s[28:31], s10 offen offset:1024
  s_add_u32 m0, s17, 8192
  s_add_u32 s11, s11, 4096
  buffer_load_dwordx4 v2, s[32:35], s11 offen lds
  buffer_load_dwordx4 v[80:83], v2, s[28:31], s10 offen offset:2048
  s_add_u32 m0, s17, 12288
  s_add_u32 s11, s11, 4096
  buffer_load_dwordx4 v2, s[32:35], s11 offen lds
  buffer_load_dwordx4 v[84:87], v2, s[28:31], s10 offen offset:3072
  s_add_u32 s10, s10, 4096
  s_add_u32 m0, s17, 16384
  s_add_u32 s11, s11, 4096
  buffer_load_dwordx4 v2, s[32:35], s11 offen lds
  buffer_load_dwordx4 v[88:91], v2, s[28:31], s10 offen offset:0
  s_add_u32 m0, s17, 20480
  s_add_u32 s11, s11, 4096
  buffer_load_dwordx4 v2, s[32:35], s11 offen lds
  buffer_load_dwordx4 v[92:95], v2, s[28:31], s10 offen offset:1024
  s_add_u32 m0, s17, 24576
  s_add_u32 s11, s11, 4096
  buffer_load_dwordx4 v2, s[32:35], s11 offen lds
  buffer_load_dwordx4 v[96:99], v2, s[28:31], s10 offen offset:2048
  s_add_u32 m0, s17, 28672
  s_add_u32 s11, s11, 4096
  buffer_load_dwordx4 v2, s[32:35], s11 offen lds
  buffer_load_dwordx4 v[100:103], v2, s[28:31], s10 offen offset:3072
  s_add_u32 s10, s10, 4096
  s_add_u32 m0, s17, 32768
  s_add_u32 s11, s11, 4096
  buffer_load_dwordx4 v2, s[32:35], s11 offen lds
  v_add_u32 v10, 0, v2
  v_add_u32 v11, 64512, v2
  v_lshrrev_b32 v13, 4, v1
  v_lshlrev_b32 v13, 7, v13
  v_and_b32 v14, 7, v1
  v_lshl_add_u32 v13, v14, 4, v13
  v_add_u32 v14, 68608, v13
  v_add_u32 v13, 4096, v13
  s_mov_b32 s24, s64
  s_and_b32 s25, s65, 0xffff
  s_mov_b32 s26, 2359296
  s_mov_b32 s27, 0x20000
  s_add_u32 s36, s20, 0
  s_addc_u32 s37, s21, 0
  s_and_b32 s37, s37, 0xffff
  s_mov_b32 s38, 13824
  s_mov_b32 s39, 0x20000
  s_add_u32 s72, s20, 35876864
  s_addc_u32 s73, s21, 0
  s_and_b32 s73, s73, 0xffff
  s_mov_b32 s74, 163840
  s_mov_b32 s75, 0x20000
  s_mov_b32 s64, s66
  s_mov_b32 s65, s67
  s_mov_b32 s66, s68
  s_mov_b32 s67, s69
  v_and_b32 v8, 15, v1
  v_lshrrev_b32 v9, 4, v1
  s_mul_i32 s18, s3, 4096
  s_add_u32 s18, s18, 86016
  v_and_b32 v4, 31, v1
  v_lshlrev_b32 v4, 4, v4
  v_lshrrev_b32 v5, 5, v1
  v_mul_u32_u24 v5, 4608, v5
  v_add_u32 v4, v4, v5
  s_mul_i32 s13, s5, 288
  s_add_u32 s13, s13, 4608
  s_and_b32 s76, s2, 1
  s_lshl_b32 s76, s76, 3
  s_bfe_u32 s14, s2, 0x30003
  s_add_u32 s76, s76, s14
  s_bfe_u32 s77, s2, 0x20001
  s_lshl_b32 s77, s77, 2
  s_lshr_b32 s14, s2, 6
  s_add_u32 s77, s77, s14
  s_lshl_b32 s78, s76, 2
  s_add_u32 s78, s78, s3
  s_lshr_b32 s79, s77, 1
  s_lshr_b32 s15, s6, 1
  s_mul_i32 s15, s15, 36864
  s_mul_i32 s14, s5, 4608
  s_add_u32 s15, s15, s14
  s_and_b32 s14, s6, 1
  s_lshl_b32 s14, s14, 4
  v_add_u32 v232, s14, v8
  v_lshlrev_b32 v232, 4, v232
  v_lshl_add_u32 v233, v9, 9, v232
  v_lshl_add_u32 v232, v9, 3, v232
  s_lshl_b32 s16, s5, 14
  s_lshl_b32 s14, s6, 6
  s_add_u32 s16, s16, s14
  v_lshrrev_b32 v234, 5, v1
  v_lshlrev_b32 v234, 13, v234
  v_lshl_add_u32 v234, v8, 2, v234
  s_add_u32 s23, s15, 4096
  v_mul_u32_u24 v235, 36864, v9
  v_lshl_add_u32 v235, v8, 4, v235
  s_lshl_b32 s22, s6, 3
  s_add_u32 s22, s22, s5
  s_lshl_b32 s22, s22, 7
  s_lshl_b32 s19, s78, 11
  s_mul_i32 s14, s77, 9
  s_add_u32 s14, s14, s3
  s_lshl_b32 s14, s14, 8
  v_mul_u32_u24 v236, 144, v8
  v_lshl_add_u32 v236, v9, 3, v236
  v_add_u32 v236, s18, v236
  v_lshl_add_u32 v237, v9, 4, s18
  v_add_u32 v6, 0, v1
  v_mul_u32_u24 v7, 57, v6
  v_lshrrev_b32 v7, 9, v7
  v_mul_u32_u24 v208, 1008, v7
  v_lshl_add_u32 v208, v6, 4, v208
  v_add_u32 v6, 64, v1
  v_mul_u32_u24 v7, 57, v6
  v_lshrrev_b32 v7, 9, v7
  v_mul_u32_u24 v209, 1008, v7
  v_lshl_add_u32 v209, v6, 4, v209
  v_add_u32 v6, 128, v1
  v_mul_u32_u24 v7, 57, v6
  v_lshrrev_b32 v7, 9, v7
  v_mul_u32_u24 v210, 1008, v7
  v_lshl_add_u32 v210, v6, 4, v210
  v_mov_b32 v144, 0
  v_mov_b32 v145, 0
  v_mov_b32 v146, 0
  v_mov_b32 v147, 0
  v_mov_b32 v148, 0
  v_mov_b32 v149, 0
  v_mov_b32 v150, 0
  v_mov_b32 v151, 0
  v_mov_b32 v152, 0
  v_mov_b32 v153, 0
  v_mov_b32 v154, 0
  v_mov_b32 v155, 0
  v_mov_b32 v156, 0
  v_mov_b32 v157, 0
  v_mov_b32 v158, 0
  v_mov_b32 v159, 0
  v_mov_b32 v160, 0
  v_mov_b32 v161, 0
  v_mov_b32 v162, 0
  v_mov_b32 v163, 0
  s_waitcnt vmcnt(10) lgkmcnt(0)
  s_barrier
  ds_read_b128 v[164:167], v10 offset:0
  ds_read_b128 v[168:171], v10 offset:1024
  ds_read_b128 v[172:175], v10 offset:2048
  ds_read_b128 v[176:179], v10 offset:3072
  ds_read_b128 v[180:183], v13 offset:0
  ds_read_b128 v[184:187], v10 offset:4608
  ds_read_b128 v[188:191], v10 offset:5632
  ds_read_b128 v[192:195], v10 offset:6656
  ds_read_b128 v[196:199], v10 offset:7680
  ds_read_b128 v[200:203], v13 offset:4608
  s_waitcnt lgkmcnt(5)
  v_mfma_f32_16x16x32_bf16 v[144:147], v[164:167], v[72:75], v[144:147]
  ds_read_b128 v[212:215], v10 offset:9216
  buffer_load_dwordx4 v[104:107], v2, s[28:31], s10 offen offset:0
  s_add_u32 m0, s17, 36864
  s_add_u32 s11, s11, 4096
  buffer_load_dwordx4 v2, s[32:35], s11 offen lds
  v_mfma_f32_16x16x32_bf16 v[148:151], v[168:171], v[72:75], v[148:151]
  ds_read_b128 v[216:219], v10 offset:10240
  s_add_u32 m0, s17, 40960
  s_add_u32 s11, s11, 4096
  buffer_load_dwordx4 v2, s[32:35], s11 offen lds
  buffer_load_dwordx4 v[108:111], v2, s[28:31], s10 offen offset:1024
  v_mfma_f32_16x16x32_bf16 v[152:155], v[172:175], v[72:75], v[152:155]
  ds_read_b128 v[220:223], v10 offset:11264
  s_add_u32 m0, s17, 45056
  s_add_u32 s11, s11, 4096
  buffer_load_dwordx4 v2, s[32:35], s11 offen lds
  buffer_load_dwordx4 v[112:115], v2, s[28:31], s10 offen offset:2048
  v_mfma_f32_16x16x32_bf16 v[156:159], v[176:179], v[72:75], v[156:159]
  ds_read_b128 v[224:227], v10 offset:12288
  s_add_u32 m0, s17, 49152
  s_add_u32 s11, s11, 4096
  buffer_load_dwordx4 v2, s[32:35], s11 offen lds
  buffer_load_dwordx4 v[116:119], v2, s[28:31], s10 offen offset:3072
  s_add_u32 s10, s10, 4096
  v_mfma_f32_16x16x32_bf16 v[160:163], v[180:183], v[72:75], v[160:163]
  ds_read_b128 v[228:231], v13 offset:9216
  s_add_u32 m0, s17, 53248
  s_add_u32 s11, s11, 4096
  buffer_load_dwordx4 v2, s[32:35], s11 offen lds
  buffer_load_dwordx4 v[120:123], v2, s[28:31], s10 offen offset:0
  s_add_u32 m0, s17, 57344
  s_add_u32 s11, s11, 4096
  buffer_load_dwordx4 v2, s[32:35], s11 offen lds
  s_waitcnt vmcnt(17) lgkmcnt(5)
  s_barrier
  v_mfma_f32_16x16x32_bf16 v[144:147], v[184:187], v[76:79], v[144:147]
  ds_read_b128 v[164:167], v10 offset:13824
  v_mfma_f32_16x16x32_bf16 v[148:151], v[188:191], v[76:79], v[148:151]
  ds_read_b128 v[168:171], v10 offset:14848
  v_mfma_f32_16x16x32_bf16 v[152:155], v[192:195], v[76:79], v[152:155]
  ds_read_b128 v[172:175], v10 offset:15872
  buffer_load_dwordx4 v[124:127], v2, s[28:31], s10 offen offset:1024
  v_mfma_f32_16x16x32_bf16 v[156:159], v[196:199], v[76:79], v[156:159]
  ds_read_b128 v[176:179], v10 offset:16896
  v_mfma_f32_16x16x32_bf16 v[160:163], v[200:203], v[76:79], v[160:163]
  ds_read_b128 v[180:183], v13 offset:13824
  s_add_u32 m0, s17, 61440
  s_add_u32 s11, s11, 4096
  buffer_load_dwordx4 v2, s[32:35], s11 offen lds
  s_waitcnt lgkmcnt(5)
  v_mfma_f32_16x16x32_bf16 v[144:147], v[212:215], v[80:83], v[144:147]
  ds_read_b128 v[184:187], v10 offset:18432
  v_mfma_f32_16x16x32_bf16 v[148:151], v[216:219], v[80:83], v[148:151]
  ds_read_b128 v[188:191], v10 offset:19456
  v_mfma_f32_16x16x32_bf16 v[152:155], v[220:223], v[80:83], v[152:155]
  ds_read_b128 v[192:195], v10 offset:20480
  buffer_load_dwordx4 v[128:131], v2, s[28:31], s10 offen offset:2048
  v_mfma_f32_16x16x32_bf16 v[156:159], v[224:227], v[80:83], v[156:159]
  ds_read_b128 v[196:199], v10 offset:21504
  v_mfma_f32_16x16x32_bf16 v[160:163], v[228:231], v[80:83], v[160:163]
  ds_read_b128 v[200:203], v13 offset:18432
  s_add_u32 m0, s17, 65536
  s_add_u32 s11, s11, 4096
  buffer_load_dwordx4 v2, s[32:35], s11 offen lds
  s_waitcnt vmcnt(15) lgkmcnt(5)
  s_barrier
  v_mfma_f32_16x16x32_bf16 v[144:147], v[164:167], v[84:87], v[144:147]
  ds_read_b128 v[212:215], v10 offset:23040
  v_mfma_f32_16x16x32_bf16 v[148:151], v[168:171], v[84:87], v[148:151]
  ds_read_b128 v[216:219], v10 offset:24064
  v_mfma_f32_16x16x32_bf16 v[152:155], v[172:175], v[84:87], v[152:155]
  ds_read_b128 v[220:223], v10 offset:25088
  buffer_load_dwordx4 v[132:135], v2, s[28:31], s10 offen offset:3072
  s_add_u32 s10, s10, 4096
  v_mfma_f32_16x16x32_bf16 v[156:159], v[176:179], v[84:87], v[156:159]
  ds_read_b128 v[224:227], v10 offset:26112
  v_mfma_f32_16x16x32_bf16 v[160:163], v[180:183], v[84:87], v[160:163]
  ds_read_b128 v[228:231], v13 offset:23040
  s_add_u32 m0, s17, 69632
  s_add_u32 s11, s11, 4096
  buffer_load_dwordx4 v2, s[32:35], s11 offen lds
  s_waitcnt lgkmcnt(5)
  v_mfma_f32_16x16x32_bf16 v[144:147], v[184:187], v[88:91], v[144:147]
  ds_read_b128 v[164:167], v10 offset:27648
  v_mfma_f32_16x16x32_bf16 v[148:151], v[188:191], v[88:91], v[148:151]
  ds_read_b128 v[168:171], v10 offset:28672
  buffer_load_dwordx4 v[136:139], v2, s[28:31], s10 offen offset:0
  v_mfma_f32_16x16x32_bf16 v[152:155], v[192:195], v[88:91], v[152:155]
  ds_read_b128 v[172:175], v10 offset:29696
  v_mfma_f32_16x16x32_bf16 v[156:159], v[196:199], v[88:91], v[156:159]
  ds_read_b128 v[176:179], v10 offset:30720
  s_add_u32 m0, s17, 73728
  s_add_u32 s11, s11, 4096
  buffer_load_dwordx4 v2, s[32:35], s11 offen lds
  v_mfma_f32_16x16x32_bf16 v[160:163], v[200:203], v[88:91], v[160:163]
  ds_read_b128 v[180:183], v13 offset:27648
  s_add_u32 m0, s17, 77824
  s_add_u32 s11, s11, 4096
  buffer_load_dwordx4 v2, s[32:35], s11 offen lds
  s_waitcnt lgkmcnt(5)
  v_mfma_f32_16x16x32_bf16 v[144:147], v[212:215], v[92:95], v[144:147]
  ds_read_b128 v[184:187], v10 offset:32256
  v_mfma_f32_16x16x32_bf16 v[148:151], v[216:219], v[92:95], v[148:151]
  ds_read_b128 v[188:191], v10 offset:33280
  v_mfma_f32_16x16x32_bf16 v[152:155], v[220:223], v[92:95], v[152:155]
  ds_read_b128 v[192:195], v10 offset:34304
  buffer_load_dwordx4 v[140:143], v2, s[28:31], s10 offen offset:1024
  v_mfma_f32_16x16x32_bf16 v[156:159], v[224:227], v[92:95], v[156:159]
  ds_read_b128 v[196:199], v10 offset:35328
  v_mfma_f32_16x16x32_bf16 v[160:163], v[228:231], v[92:95], v[160:163]
  ds_read_b128 v[200:203], v13 offset:32256
  s_add_u32 m0, s17, 81920
  s_add_u32 s11, s11, 4096
  buffer_load_dwordx4 v2, s[32:35], s11 offen lds
  s_waitcnt vmcnt(15) lgkmcnt(5)
  s_barrier
  v_mfma_f32_16x16x32_bf16 v[144:147], v[164:167], v[96:99], v[144:147]
  ds_read_b128 v[212:215], v10 offset:36864
  v_mfma_f32_16x16x32_bf16 v[148:151], v[168:171], v[96:99], v[148:151]
  ds_read_b128 v[216:219], v10 offset:37888
  v_mfma_f32_16x16x32_bf16 v[152:155], v[172:175], v[96:99], v[152:155]
  ds_read_b128 v[220:223], v10 offset:38912
  v_mfma_f32_16x16x32_bf16 v[156:159], v[176:179], v[96:99], v[156:159]
  ds_read_b128 v[224:227], v10 offset:39936
  v_mfma_f32_16x16x32_bf16 v[160:163], v[180:183], v[96:99], v[160:163]
  ds_read_b128 v[228:231], v13 offset:36864
  s_waitcnt lgkmcnt(5)
  v_mfma_f32_16x16x32_bf16 v[144:147], v[184:187], v[100:103], v[144:147]
  ds_read_b128 v[164:167], v10 offset:41472
  v_mfma_f32_16x16x32_bf16 v[148:151], v[188:191], v[100:103], v[148:151]
  ds_read_b128 v[168:171], v10 offset:42496
  v_mfma_f32_16x16x32_bf16 v[152:155], v[192:195], v[100:103], v[152:155]
  ds_read_b128 v[172:175], v10 offset:43520
  v_mfma_f32_16x16x32_bf16 v[156:159], v[196:199], v[100:103], v[156:159]
  ds_read_b128 v[176:179], v10 offset:44544
  v_mfma_f32_16x16x32_bf16 v[160:163], v[200:203], v[100:103], v[160:163]
  ds_read_b128 v[180:183], v13 offset:41472
  s_add_u32 m0, s18, 0
  s_nop 0
  buffer_load_dwordx4 v208, s[24:27], s12 offen lds
  s_waitcnt lgkmcnt(5)
  v_mfma_f32_16x16x32_bf16 v[144:147], v[212:215], v[104:107], v[144:147]
  ds_read_b128 v[184:187], v10 offset:46080
  v_mfma_f32_16x16x32_bf16 v[148:151], v[216:219], v[104:107], v[148:151]
  ds_read_b128 v[188:191], v10 offset:47104
  v_mfma_f32_16x16x32_bf16 v[152:155], v[220:223], v[104:107], v[152:155]
  ds_read_b128 v[192:195], v10 offset:48128
  v_mfma_f32_16x16x32_bf16 v[156:159], v[224:227], v[104:107], v[156:159]
  ds_read_b128 v[196:199], v10 offset:49152
  v_mfma_f32_16x16x32_bf16 v[160:163], v[228:231], v[104:107], v[160:163]
  ds_read_b128 v[200:203], v13 offset:46080
  s_add_u32 m0, s18, 1024
  s_nop 0
  buffer_load_dwordx4 v209, s[24:27], s12 offen lds
  s_waitcnt vmcnt(11) lgkmcnt(5)
  s_barrier
  v_mfma_f32_16x16x32_bf16 v[144:147], v[164:167], v[108:111], v[144:147]
  ds_read_b128 v[212:215], v10 offset:50688
  v_mfma_f32_16x16x32_bf16 v[148:151], v[168:171], v[108:111], v[148:151]
  ds_read_b128 v[216:219], v10 offset:51712
  v_mfma_f32_16x16x32_bf16 v[152:155], v[172:175], v[108:111], v[152:155]
  ds_read_b128 v[220:223], v10 offset:52736
  v_mfma_f32_16x16x32_bf16 v[156:159], v[176:179], v[108:111], v[156:159]
  ds_read_b128 v[224:227], v10 offset:53760
  v_mfma_f32_16x16x32_bf16 v[160:163], v[180:183], v[108:111], v[160:163]
  ds_read_b128 v[228:231], v13 offset:50688
  s_add_u32 m0, s18, 2048
  s_nop 0
  buffer_load_dwordx4 v210, s[24:27], s12 offen lds
  s_waitcnt lgkmcnt(5)
  v_mfma_f32_16x16x32_bf16 v[144:147], v[184:187], v[112:115], v[144:147]
  ds_read_b128 v[164:167], v10 offset:55296
  v_mfma_f32_16x16x32_bf16 v[148:151], v[188:191], v[112:115], v[148:151]
  ds_read_b128 v[168:171], v10 offset:56320
  v_mfma_f32_16x16x32_bf16 v[152:155], v[192:195], v[112:115], v[152:155]
  ds_read_b128 v[172:175], v10 offset:57344
  v_mfma_f32_16x16x32_bf16 v[156:159], v[196:199], v[112:115], v[156:159]
  ds_read_b128 v[176:179], v10 offset:58368
  v_mfma_f32_16x16x32_bf16 v[160:163], v[200:203], v[112:115], v[160:163]
  ds_read_b128 v[180:183], v13 offset:55296
  s_add_u32 m0, s18, 3072
  s_nop 0
  buffer_load_dwordx4 v4, s[36:39], s13 offen lds
  s_waitcnt lgkmcnt(5)
  v_mfma_f32_16x16x32_bf16 v[144:147], v[212:215], v[116:119], v[144:147]
  ds_read_b128 v[184:187], v10 offset:59904
  v_mfma_f32_16x16x32_bf16 v[148:151], v[216:219], v[116:119], v[148:151]
  ds_read_b128 v[188:191], v10 offset:60928
  v_mfma_f32_16x16x32_bf16 v[152:155], v[220:223], v[116:119], v[152:155]
  ds_read_b128 v[192:195], v10 offset:61952
  v_mfma_f32_16x16x32_bf16 v[156:159], v[224:227], v[116:119], v[156:159]
  ds_read_b128 v[196:199], v10 offset:62976
  v_mfma_f32_16x16x32_bf16 v[160:163], v[228:231], v[116:119], v[160:163]
  ds_read_b128 v[200:203], v13 offset:59904
  s_waitcnt vmcnt(6) lgkmcnt(5)
  s_barrier
  v_mfma_f32_16x16x32_bf16 v[144:147], v[164:167], v[120:123], v[144:147]
  ds_read_b128 v[212:215], v11 offset:0
  v_mfma_f32_16x16x32_bf16 v[148:151], v[168:171], v[120:123], v[148:151]
  ds_read_b128 v[216:219], v11 offset:1024
  v_mfma_f32_16x16x32_bf16 v[152:155], v[172:175], v[120:123], v[152:155]
  ds_read_b128 v[220:223], v11 offset:2048
  v_mfma_f32_16x16x32_bf16 v[156:159], v[176:179], v[120:123], v[156:159]
  ds_read_b128 v[224:227], v11 offset:3072
  v_mfma_f32_16x16x32_bf16 v[160:163], v[180:183], v[120:123], v[160:163]
  ds_read_b128 v[228:231], v14 offset:0
  s_waitcnt lgkmcnt(5)
  v_mfma_f32_16x16x32_bf16 v[144:147], v[184:187], v[124:127], v[144:147]
  ds_read_b128 v[164:167], v11 offset:4608
  v_mfma_f32_16x16x32_bf16 v[148:151], v[188:191], v[124:127], v[148:151]
  ds_read_b128 v[168:171], v11 offset:5632
  v_mfma_f32_16x16x32_bf16 v[152:155], v[192:195], v[124:127], v[152:155]
  ds_read_b128 v[172:175], v11 offset:6656
  v_mfma_f32_16x16x32_bf16 v[156:159], v[196:199], v[124:127], v[156:159]
  ds_read_b128 v[176:179], v11 offset:7680
  v_mfma_f32_16x16x32_bf16 v[160:163], v[200:203], v[124:127], v[160:163]
  ds_read_b128 v[180:183], v14 offset:4608
  s_waitcnt lgkmcnt(5)
  v_mfma_f32_16x16x32_bf16 v[144:147], v[212:215], v[128:131], v[144:147]
  ds_read_b128 v[184:187], v11 offset:9216
  v_mfma_f32_16x16x32_bf16 v[148:151], v[216:219], v[128:131], v[148:151]
  ds_read_b128 v[188:191], v11 offset:10240
  v_mfma_f32_16x16x32_bf16 v[152:155], v[220:223], v[128:131], v[152:155]
  ds_read_b128 v[192:195], v11 offset:11264
  v_mfma_f32_16x16x32_bf16 v[156:159], v[224:227], v[128:131], v[156:159]
  ds_read_b128 v[196:199], v11 offset:12288
  v_mfma_f32_16x16x32_bf16 v[160:163], v[228:231], v[128:131], v[160:163]
  ds_read_b128 v[200:203], v14 offset:9216
  s_waitcnt vmcnt(4) lgkmcnt(5)
  s_barrier
  v_mfma_f32_16x16x32_bf16 v[144:147], v[164:167], v[132:135], v[144:147]
  ds_read_b128 v[212:215], v11 offset:13824
  v_mfma_f32_16x16x32_bf16 v[148:151], v[168:171], v[132:135], v[148:151]
  ds_read_b128 v[216:219], v11 offset:14848
  v_mfma_f32_16x16x32_bf16 v[152:155], v[172:175], v[132:135], v[152:155]
  ds_read_b128 v[220:223], v11 offset:15872
  v_mfma_f32_16x16x32_bf16 v[156:159], v[176:179], v[132:135], v[156:159]
  ds_read_b128 v[224:227], v11 offset:16896
  v_mfma_f32_16x16x32_bf16 v[160:163], v[180:183], v[132:135], v[160:163]
  ds_read_b128 v[228:231], v14 offset:13824
  s_waitcnt lgkmcnt(5)
  v_mfma_f32_16x16x32_bf16 v[144:147], v[184:187], v[136:139], v[144:147]
  s_waitcnt vmcnt(0)
  ds_read_b64 v[16:17], v236 offset:0
  ds_read_b128 v[28:31], v237 offset:3072
  v_mfma_f32_16x16x32_bf16 v[148:151], v[188:191], v[136:139], v[148:151]
  ds_read_b128 v[48:51], v237 offset:3584
  v_mfma_f32_16x16x32_bf16 v[152:155], v[192:195], v[136:139], v[152:155]
  ds_read_b64 v[18:19], v236 offset:32
  ds_read_b128 v[32:35], v237 offset:3136
  v_mfma_f32_16x16x32_bf16 v[156:159], v[196:199], v[136:139], v[156:159]
  ds_read_b128 v[52:55], v237 offset:3648
  v_mfma_f32_16x16x32_bf16 v[160:163], v[200:203], v[136:139], v[160:163]
  ds_read_b64 v[20:21], v236 offset:64
  ds_read_b128 v[36:39], v237 offset:3200
  s_waitcnt lgkmcnt(8)
  v_mfma_f32_16x16x32_bf16 v[144:147], v[212:215], v[140:143], v[144:147]
  ds_read_b128 v[56:59], v237 offset:3712
  v_mfma_f32_16x16x32_bf16 v[148:151], v[216:219], v[140:143], v[148:151]
  ds_read_b64 v[22:23], v236 offset:96
  ds_read_b128 v[40:43], v237 offset:3264
  v_mfma_f32_16x16x32_bf16 v[152:155], v[220:223], v[140:143], v[152:155]
  ds_read_b128 v[60:63], v237 offset:3776
  v_mfma_f32_16x16x32_bf16 v[156:159], v[224:227], v[140:143], v[156:159]
  ds_read_b64 v[24:25], v236 offset:128
  ds_read_b128 v[44:47], v237 offset:3328
  v_mfma_f32_16x16x32_bf16 v[160:163], v[228:231], v[140:143], v[160:163]
  ds_read_b128 v[64:67], v237 offset:3840
  s_add_u32 s24, s20, 8646656
  s_addc_u32 s25, s21, 0
  s_and_b32 s25, s25, 0xffff
  s_mov_b32 s26, 131072
  s_mov_b32 s27, 0x20000
  s_add_u32 s28, s20, 6287360
  s_addc_u32 s29, s21, 0
  s_and_b32 s29, s29, 0xffff
  s_mov_b32 s30, 2359296
  s_mov_b32 s31, 0x20000
  s_add_u32 s32, s20, 8777728
  s_addc_u32 s33, s21, 0
  s_and_b32 s33, s33, 0xffff
  s_mov_b32 s34, 5308416
  s_mov_b32 s35, 0x20000
  s_add_u32 s36, s20, 36564992
  s_addc_u32 s37, s21, 0
  s_and_b32 s37, s37, 0xffff
  s_mov_b32 s38, 147456
  s_mov_b32 s39, 0x20000
  s_mul_i32 s11, s77, 331776
  s_add_u32 s11, s11, s17
  s_waitcnt lgkmcnt(0)
  v_lshlrev_b32 v72, 16, v16
  v_and_b32 v73, 0xffff0000, v16
  v_lshlrev_b32 v74, 16, v17
  v_and_b32 v75, 0xffff0000, v17
  v_lshlrev_b32 v76, 16, v18
  v_and_b32 v77, 0xffff0000, v18
  v_lshlrev_b32 v78, 16, v19
  v_and_b32 v79, 0xffff0000, v19
  v_lshlrev_b32 v80, 16, v20
  v_and_b32 v81, 0xffff0000, v20
  v_lshlrev_b32 v82, 16, v21
  v_and_b32 v83, 0xffff0000, v21
  v_lshlrev_b32 v84, 16, v22
  v_and_b32 v85, 0xffff0000, v22
  v_lshlrev_b32 v86, 16, v23
  v_and_b32 v87, 0xffff0000, v23
  v_lshlrev_b32 v88, 16, v24
  v_and_b32 v89, 0xffff0000, v24
  v_lshlrev_b32 v90, 16, v25
  v_and_b32 v91, 0xffff0000, v25
  v_pk_fma_f32 v[72:73], v[144:145], v[28:29], v[72:73]
  v_pk_fma_f32 v[74:75], v[146:147], v[30:31], v[74:75]
  v_pk_fma_f32 v[76:77], v[148:149], v[32:33], v[76:77]
  v_pk_fma_f32 v[78:79], v[150:151], v[34:35], v[78:79]
  v_pk_fma_f32 v[80:81], v[152:153], v[36:37], v[80:81]
  v_pk_fma_f32 v[82:83], v[154:155], v[38:39], v[82:83]
  v_pk_fma_f32 v[84:85], v[156:157], v[40:41], v[84:85]
  v_pk_fma_f32 v[86:87], v[158:159], v[42:43], v[86:87]
  v_pk_fma_f32 v[88:89], v[160:161], v[44:45], v[88:89]
  v_pk_fma_f32 v[90:91], v[162:163], v[46:47], v[90:91]
  v_pk_mul_f32 v[48:49], v[48:49], v[72:73]
  v_pk_mul_f32 v[50:51], v[50:51], v[74:75]
  v_pk_mul_f32 v[52:53], v[52:53], v[76:77]
  v_pk_mul_f32 v[54:55], v[54:55], v[78:79]
  v_pk_mul_f32 v[56:57], v[56:57], v[80:81]
  v_pk_mul_f32 v[58:59], v[58:59], v[82:83]
  v_pk_mul_f32 v[60:61], v[60:61], v[84:85]
  v_pk_mul_f32 v[62:63], v[62:63], v[86:87]
  v_pk_mul_f32 v[64:65], v[64:65], v[88:89]
  v_pk_mul_f32 v[66:67], v[66:67], v[90:91]
  v_cvt_pk_bf16_f32 v108, v48, v49
  v_cvt_pk_bf16_f32 v109, v50, v51
  v_cvt_pk_bf16_f32 v110, v52, v53
  v_cvt_pk_bf16_f32 v111, v54, v55
  v_cvt_pk_bf16_f32 v112, v56, v57
  v_cvt_pk_bf16_f32 v113, v58, v59
  v_cvt_pk_bf16_f32 v114, v60, v61
  v_cvt_pk_bf16_f32 v115, v62, v63
  v_cvt_pk_bf16_f32 v116, v64, v65
  v_cvt_pk_bf16_f32 v117, v66, v67
  buffer_store_dwordx4 v[108:111], v233, s[28:31], s15 offen sc1
  buffer_store_dwordx4 v[112:115], v233, s[28:31], s15 offen offset:2048 sc1
  v_pk_add_f32 v[12:13], v[72:73], v[74:75]
  v_pk_mul_f32 v[14:15], v[72:73], v[72:73]
  v_pk_fma_f32 v[14:15], v[74:75], v[74:75], v[14:15]
  v_pk_add_f32 v[12:13], v[12:13], v[76:77]
  v_pk_fma_f32 v[14:15], v[76:77], v[76:77], v[14:15]
  v_pk_add_f32 v[12:13], v[12:13], v[78:79]
  v_pk_fma_f32 v[14:15], v[78:79], v[78:79], v[14:15]
  v_pk_add_f32 v[12:13], v[12:13], v[80:81]
  v_pk_fma_f32 v[14:15], v[80:81], v[80:81], v[14:15]
  v_pk_add_f32 v[12:13], v[12:13], v[82:83]
  v_pk_fma_f32 v[14:15], v[82:83], v[82:83], v[14:15]
  v_pk_add_f32 v[12:13], v[12:13], v[84:85]
  v_pk_fma_f32 v[14:15], v[84:85], v[84:85], v[14:15]
  v_pk_add_f32 v[12:13], v[12:13], v[86:87]
  v_pk_fma_f32 v[14:15], v[86:87], v[86:87], v[14:15]
  s_mov_b32 exec_hi, 0
  buffer_store_dwordx2 v[116:117], v232, s[28:31], s23 offen sc1
  v_pk_add_f32 v[12:13], v[12:13], v[88:89]
  v_pk_fma_f32 v[14:15], v[88:89], v[88:89], v[14:15]
  v_pk_add_f32 v[12:13], v[12:13], v[90:91]
  v_pk_fma_f32 v[14:15], v[90:91], v[90:91], v[14:15]
  s_mov_b32 exec_hi, -1
  v_add_f32 v12, v12, v13
  v_add_f32 v14, v14, v15
  v_cvt_pk_bf16_f32 v96, v72, v73
  v_cvt_pk_bf16_f32 v97, v74, v75
  v_permlane32_swap_b32 v12, v14
  v_add_f32 v12, v12, v14
  v_mov_b32 v13, v12
  v_cvt_pk_bf16_f32 v98, v76, v77
  v_cvt_pk_bf16_f32 v99, v78, v79
  v_permlane16_swap_b32 v12, v13
  v_add_f32 v12, v12, v13
  buffer_store_dword v12, v234, s[24:27], s16 offen sc1
  s_barrier
  buffer_load_dwordx4 v[120:123], v235, s[36:39], s14 offen offset:0
  buffer_load_dwordx4 v[124:127], v235, s[36:39], s14 offen offset:1024
  buffer_load_dwordx4 v[128:131], v235, s[36:39], s14 offen offset:2048
  s_add_u32 m0, s17, 0
  s_add_u32 s12, s11, 0
  buffer_load_dwordx4 v2, s[32:35], s12 offen  lds
  s_add_u32 m0, s17, 36864
  s_add_u32 s12, s11, 36864
  buffer_load_dwordx4 v2, s[32:35], s12 offen  lds
  s_add_u32 m0, s17, 4096
  s_add_u32 s12, s11, 4096
  buffer_load_dwordx4 v2, s[32:35], s12 offen  lds
  s_add_u32 m0, s17, 40960
  s_add_u32 s12, s11, 40960
  buffer_load_dwordx4 v2, s[32:35], s12 offen  lds
  v_cvt_pk_bf16_f32 v100, v80, v81
  v_cvt_pk_bf16_f32 v101, v82, v83
  v_cvt_pk_bf16_f32 v102, v84, v85
  v_cvt_pk_bf16_f32 v103, v86, v87
  v_cvt_pk_bf16_f32 v104, v88, v89
  v_cvt_pk_bf16_f32 v105, v90, v91
  v_accvgpr_write_b32 a200, v96
  v_accvgpr_write_b32 a201, v97
  v_accvgpr_write_b32 a202, v98
  v_accvgpr_write_b32 a203, v99
  v_accvgpr_write_b32 a204, v100
  v_accvgpr_write_b32 a205, v101
  v_accvgpr_write_b32 a206, v102
  v_accvgpr_write_b32 a207, v103
  v_accvgpr_write_b32 a208, v104
  v_accvgpr_write_b32 a209, v105
  s_waitcnt vmcnt(7)
  s_nop 0
  s_nop 0
  v_mov_b32 v20, 0
  v_mov_b32 v21, 1
  s_mov_b64 exec, 1
  buffer_store_dword v21, v20, s[72:75], s22 offen sc1
  s_mov_b64 exec, -1
kt_tail_kernel_pf1:
  s_add_u32 s44, s20, 26177536
  s_addc_u32 s45, s21, 0
  s_and_b32 s45, s45, 0xffff
  s_mov_b32 s46, 262144
  s_mov_b32 s47, 0x20000
  s_add_u32 s56, s20, 16740352
  s_addc_u32 s57, s21, 0
  s_and_b32 s57, s57, 0xffff
  s_mov_b32 s58, 9437184
  s_mov_b32 s59, 0x20000
  s_add_u32 s60, s20, 36040704
  s_addc_u32 s61, s21, 0
  s_and_b32 s61, s61, 0xffff
  s_mov_b32 s62, 524288
  s_mov_b32 s63, 0x20000
  s_add_u32 m0, s17, 8192
  s_add_u32 s12, s11, 8192
  buffer_load_dwordx4 v2, s[32:35], s12 offen  lds
  v_mov_b32 v11, v2
  v_add_u32 v12, 65536, v2
  v_add_u32 v13, 131072, v2
  v_and_b32 v14, 31, v1
  s_add_u32 m0, s17, 45056
  s_add_u32 s12, s11, 45056
  buffer_load_dwordx4 v2, s[32:35], s12 offen  lds
  v_lshrrev_b32 v15, 5, v1
  v_lshlrev_b32 v3, 4, v14
  v_add_u32 v3, 147456, v3
  v_bfe_u32 v18, v1, 4, 1
  s_add_u32 m0, s17, 12288
  s_add_u32 s12, s11, 12288
  buffer_load_dwordx4 v2, s[32:35], s12 offen  lds
  v_and_b32 v17, 3, v1
  v_bfe_u32 v19, v1, 2, 1
  v_lshl_add_u32 v17, v19, 3, v17
  v_bfe_u32 v19, v1, 3, 1
  v_lshl_add_u32 v17, v19, 2, v17
  s_add_u32 m0, s17, 49152
  s_add_u32 s12, s11, 49152
  buffer_load_dwordx4 v2, s[32:35], s12 offen  lds
  v_lshlrev_b32 v19, 4, v17
  v_lshl_add_u32 v19, v15, 8, v19
  v_lshl_add_u32 v4, v18, 10, v19
  s_mov_b32 s14, 581632
  s_add_u32 m0, s17, 16384
  s_add_u32 s12, s11, 16384
  buffer_load_dwordx4 v2, s[32:35], s12 offen  lds
  v_mad_u32_u24 v5, v18, s14, v19
  s_mul_i32 s51, s79, 1179648
  s_mul_i32 s14, s78, 9216
  s_add_u32 s51, s51, s14
  s_lshl_b32 s43, s76, 14
  s_add_u32 m0, s17, 53248
  s_add_u32 s12, s11, 53248
  buffer_load_dwordx4 v2, s[32:35], s12 offen  lds
  s_lshl_b32 s14, s3, 7
  s_add_u32 s43, s43, s14
  s_lshl_b32 s14, s77, 10
  s_add_u32 s42, s43, s14
  s_add_u32 m0, s17, 20480
  s_add_u32 s12, s11, 20480
  buffer_load_dwordx4 v2, s[32:35], s12 offen  lds
  s_add_u32 s48, s43, 4096
  s_add_u32 s49, s43, 8192
  s_add_u32 s50, s43, 12288
  s_lshl_b32 s55, s78, 3
  s_add_u32 s55, s55, s79
  s_add_u32 m0, s17, 57344
  s_add_u32 s12, s11, 57344
  buffer_load_dwordx4 v2, s[32:35], s12 offen  lds
  s_lshl_b32 s55, s55, 10
  v_bfe_u32 v28, v1, 2, 2
  v_lshlrev_b32 v28, 5, v28
  v_lshl_add_u32 v28, v15, 4, v28
  s_add_u32 m0, s17, 24576
  s_add_u32 s12, s11, 24576
  buffer_load_dwordx4 v2, s[32:35], s12 offen  lds
  v_lshl_add_u32 v28, v18, 9, v28
  v_and_b32 v29, 3, v1
  v_cmp_eq_u32 vcc, 0, v29
  v_mov_b32 v29, 0x40000000
  s_add_u32 m0, s17, 61440
  s_add_u32 s12, s11, 61440
  buffer_load_dwordx4 v2, s[32:35], s12 offen  lds
  v_cndmask_b32 v6, v29, v28, vcc
  v_and_b32 v28, 7, v1
  v_bfe_u32 v29, v1, 3, 1
  v_lshrrev_b32 v30, 4, v1
  v_lshlrev_b32 v7, 4, v28
  s_add_u32 m0, s17, 28672
  s_add_u32 s12, s11, 28672
  buffer_load_dwordx4 v2, s[32:35], s12 offen  lds
  v_lshl_add_u32 v7, v29, 9, v7
  v_lshl_add_u32 v7, v30, 10, v7
  v_cmp_eq_u32 s[52:53], 1, v29
  s_lshl_b32 s14, s3, 9
  s_add_u32 m0, s17, 65536
  s_add_u32 s12, s11, 65536
  buffer_load_dwordx4 v2, s[32:35], s12 offen  lds
  s_add_u32 s40, s14, 152064
  v_lshlrev_b32 v31, 2, v28
  v_lshl_add_u32 v31, v15, 1, v31
  v_add_u32 v31, v31, v18
  v_lshl_add_u32 v31, v31, 2, s40
  s_add_u32 m0, s17, 32768
  s_add_u32 s12, s11, 32768
  buffer_load_dwordx4 v2, s[32:35], s12 offen  lds
  v_add_u32 v10, 256, v31
  v_lshl_add_u32 v9, v29, 7, v31
  v_lshl_add_u32 v8, v15, 4, s40
  v_lshl_add_u32 v30, v14, 2, s40
  s_add_u32 m0, s17, 69632
  s_add_u32 s12, s11, 69632
  buffer_load_dwordx4 v2, s[32:35], s12 offen  lds
  v_lshlrev_b32 v16, 13, v15
  v_lshl_add_u32 v16, v14, 2, v16
  s_lshl_b32 s8, s78, 7
  s_mov_b32 s41, 200000
  s_mul_i32 s10, s78, 36864
  s_nop 0
  s_nop 0
  v_and_b32 v20, 15, v1
  v_lshrrev_b32 v21, 0, v20
  v_and_b32 v20, 0, v20
  v_lshlrev_b32 v20, 2, v20
  v_lshl_add_u32 v20, v21, 7, v20
  s_mov_b32 s9, 200000
kt_tail_kernel_wf2:
  buffer_load_dword v21, v20, s[72:75], s19 offen sc1
  s_waitcnt vmcnt(0)
  v_cmp_eq_u32 vcc, 0, v21
  s_nop 4
  s_cbranch_vccz kt_tail_kernel_wf2d
  s_sleep 2
  s_sub_u32 s9, s9, 1
  s_cmp_lg_u32 s9, 0
  s_cbranch_scc1 kt_tail_kernel_wf2
kt_tail_kernel_wf2d:
  s_nop 0
  buffer_load_dwordx4 a[0:3], v2, s[28:31], s10 offen offset:0 sc1
  buffer_load_dwordx4 a[4:7], v2, s[28:31], s10 offen offset:1024 sc1
  buffer_load_dwordx4 a[8:11], v2, s[28:31], s10 offen offset:2048 sc1
  buffer_load_dwordx4 a[12:15], v2, s[28:31], s10 offen offset:3072 sc1
  s_add_u32 s10, s10, 4096
  buffer_load_dwordx4 a[16:19], v2, s[28:31], s10 offen offset:0 sc1
  buffer_load_dwordx4 a[20:23], v2, s[28:31], s10 offen offset:1024 sc1
  buffer_load_dwordx4 a[24:27], v2, s[28:31], s10 offen offset:2048 sc1
  buffer_load_dwordx4 a[28:31], v2, s[28:31], s10 offen offset:3072 sc1
  s_add_u32 s10, s10, 4096
  buffer_load_dword v20, v16, s[24:27], s8 offen sc1
  s_add_u32 s8, s8, 16384
  buffer_load_dword v21, v16, s[24:27], s8 offen sc1
  s_add_u32 s8, s8, 16384
  buffer_load_dword v22, v16, s[24:27], s8 offen sc1
  s_add_u32 s8, s8, 16384
  buffer_load_dword v23, v16, s[24:27], s8 offen sc1
  s_add_u32 s8, s8, 16384
  buffer_load_dword v24, v16, s[24:27], s8 offen sc1
  s_add_u32 s8, s8, 16384
  buffer_load_dword v25, v16, s[24:27], s8 offen sc1
  s_add_u32 s8, s8, 16384
  buffer_load_dword v26, v16, s[24:27], s8 offen sc1
  s_add_u32 s8, s8, 16384
  buffer_load_dword v27, v16, s[24:27], s8 offen sc1
  s_add_u32 s8, s8, 16384
  buffer_load_dwordx4 a[32:35], v2, s[28:31], s10 offen offset:0 sc1
  buffer_load_dwordx4 a[36:39], v2, s[28:31], s10 offen offset:1024 sc1
  buffer_load_dwordx4 a[40:43], v2, s[28:31], s10 offen offset:2048 sc1
  buffer_load_dwordx4 a[44:47], v2, s[28:31], s10 offen offset:3072 sc1
  s_add_u32 s10, s10, 4096
  buffer_load_dwordx4 a[48:51], v2, s[28:31], s10 offen offset:0 sc1
  buffer_load_dwordx4 a[52:55], v2, s[28:31], s10 offen offset:1024 sc1
  buffer_load_dwordx4 a[56:59], v2, s[28:31], s10 offen offset:2048 sc1
  buffer_load_dwordx4 a[60:63], v2, s[28:31], s10 offen offset:3072 sc1
  s_add_u32 s10, s10, 4096
  s_bitcmp1_b32 s77, 0
  s_cbranch_scc1 kt_tail_kernel_odd
  s_waitcnt vmcnt(20)
  s_barrier
  ds_read_b128 a[148:151], v11 offset:0
  ds_read_b128 a[152:155], v11 offset:36864
  ds_read_b128 a[156:159], v11 offset:1024
  ds_read_b128 a[160:163], v11 offset:37888
  ds_read_b128 a[164:167], v11 offset:2048
  ds_read_b128 a[168:171], v11 offset:38912
  ds_read_b128 a[172:175], v11 offset:3072
  ds_read_b128 a[176:179], v11 offset:39936
  s_waitcnt lgkmcnt(4)
  v_mfma_f32_32x32x16_bf16 v[48:63], a[0:3], a[148:151], 0
  s_waitcnt vmcnt(4)
  s_barrier
  ds_read_b128 a[180:183], v11 offset:4096
  buffer_load_dwordx4 a[64:67], v2, s[28:31], s10 offen offset:0 sc1
  v_and_b32 v32, 15, v1
  v_lshlrev_b32 v32, 5, v32
  v_lshl_add_u32 v32, v18, 4, v32
  s_lshl_b32 s14, s3, 9
  s_add_u32 s14, s14, 147456
  v_add_u32 v32, s14, v32
  v_mfma_f32_32x32x16_bf16 v[64:79], a[0:3], a[152:155], 0
  ds_read_b128 a[184:187], v11 offset:40960
  buffer_load_dwordx4 a[68:71], v2, s[28:31], s10 offen offset:1024 sc1
  v_permlane16_swap_b32 v120, v122
  v_permlane16_swap_b32 v121, v123
  v_permlane16_swap_b32 v124, v126
  v_permlane16_swap_b32 v125, v127
  v_mfma_f32_32x32x16_bf16 v[48:63], a[4:7], a[156:159], v[48:63]
  ds_read_b128 a[188:191], v11 offset:5120
  v_permlane16_swap_b32 v128, v130
  v_permlane16_swap_b32 v129, v131
  v_add_f32 v120, v120, v122
  v_add_f32 v121, v121, v123
  v_add_f32 v124, v124, v126
  v_add_f32 v125, v125, v127
  v_mfma_f32_32x32x16_bf16 v[64:79], a[4:7], a[160:163], v[64:79]
  ds_read_b128 a[192:195], v11 offset:41984
  buffer_load_dwordx4 a[72:75], v2, s[28:31], s10 offen offset:2048 sc1
  v_add_f32 v128, v128, v130
  v_add_f32 v129, v129, v131
  v_mov_b32 v122, v120
  v_mov_b32 v123, v121
  s_waitcnt lgkmcnt(4)
  v_mfma_f32_32x32x16_bf16 v[48:63], a[8:11], a[164:167], v[48:63]
  ds_read_b128 a[148:151], v11 offset:6144
  buffer_load_dwordx4 a[76:79], v2, s[28:31], s10 offen offset:3072 sc1
  s_add_u32 s10, s10, 4096
  v_mov_b32 v126, v124
  v_mov_b32 v127, v125
  v_mov_b32 v130, v128
  v_mov_b32 v131, v129
  v_mfma_f32_32x32x16_bf16 v[64:79], a[8:11], a[168:171], v[64:79]
  ds_read_b128 a[152:155], v11 offset:43008
  v_permlane32_swap_b32 v120, v122
  v_permlane32_swap_b32 v121, v123
  v_permlane32_swap_b32 v124, v126
  v_permlane32_swap_b32 v125, v127
  v_permlane32_swap_b32 v128, v130
  v_permlane32_swap_b32 v129, v131
  v_mfma_f32_32x32x16_bf16 v[48:63], a[12:15], a[172:175], v[48:63]
  ds_read_b128 a[156:159], v11 offset:7168
  buffer_load_dwordx4 a[80:83], v2, s[28:31], s10 offen offset:0 sc1
  v_add_f32 v120, v120, v122
  v_add_f32 v121, v121, v123
  v_add_f32 v124, v124, v126
  v_add_f32 v125, v125, v127
  v_mfma_f32_32x32x16_bf16 v[64:79], a[12:15], a[176:179], v[64:79]
  ds_read_b128 a[160:163], v11 offset:44032
  buffer_load_dwordx4 a[84:87], v2, s[28:31], s10 offen offset:1024 sc1
  v_add_f32 v128, v128, v130
  v_add_f32 v129, v129, v131
  v_cvt_pk_bf16_f32 v36, v120, v120
  v_cvt_pk_bf16_f32 v37, v121, v121
  s_waitcnt lgkmcnt(4)
  v_mfma_f32_32x32x16_bf16 v[48:63], a[16:19], a[180:183], v[48:63]
  ds_read_b128 a[164:167], v11 offset:8192
  v_and_b32 v38, 0xffff0000, v36
  v_and_b32 v39, 0xffff0000, v37
  v_sub_f32 v120, v120, v38
  v_sub_f32 v121, v121, v39
  v_cvt_pk_bf16_f32 v37, v120, v39
  v_cvt_pk_bf16_f32 v38, v39, v121
  v_mfma_f32_32x32x16_bf16 v[64:79], a[16:19], a[184:187], v[64:79]
  ds_read_b128 a[168:171], v11 offset:45056
  buffer_load_dwordx4 a[88:91], v2, s[28:31], s10 offen offset:2048 sc1
  v_mov_b32 v39, 0
  v_cvt_pk_bf16_f32 v40, v124, v124
  v_cvt_pk_bf16_f32 v41, v125, v125
  v_and_b32 v42, 0xffff0000, v40
  v_mfma_f32_32x32x16_bf16 v[48:63], a[20:23], a[188:191], v[48:63]
  ds_read_b128 a[172:175], v11 offset:9216
  buffer_load_dwordx4 a[92:95], v2, s[28:31], s10 offen offset:3072 sc1
  s_add_u32 s10, s10, 4096
  v_and_b32 v43, 0xffff0000, v41
  v_sub_f32 v124, v124, v42
  v_sub_f32 v125, v125, v43
  v_cvt_pk_bf16_f32 v41, v124, v43
  v_mfma_f32_32x32x16_bf16 v[64:79], a[20:23], a[192:195], v[64:79]
  ds_read_b128 a[176:179], v11 offset:46080
  v_cvt_pk_bf16_f32 v42, v43, v125
  v_mov_b32 v43, 0
  v_cvt_pk_bf16_f32 v44, v128, v128
  v_cvt_pk_bf16_f32 v45, v129, v129
  v_and_b32 v46, 0xffff0000, v44
  v_and_b32 v47, 0xffff0000, v45
  s_waitcnt lgkmcnt(4)
  v_mfma_f32_32x32x16_bf16 v[48:63], a[24:27], a[148:151], v[48:63]
  ds_read_b128 a[180:183], v11 offset:10240
  buffer_load_dwordx4 a[96:99], v2, s[28:31], s10 offen offset:0 sc1
  v_sub_f32 v128, v128, v46
  v_sub_f32 v129, v129, v47
  v_cvt_pk_bf16_f32 v45, v128, v47
  v_cvt_pk_bf16_f32 v46, v47, v129
  v_mfma_f32_32x32x16_bf16 v[64:79], a[24:27], a[152:155], v[64:79]
  ds_read_b128 a[184:187], v11 offset:47104
  buffer_load_dwordx4 a[100:103], v2, s[28:31], s10 offen offset:1024 sc1
  v_mov_b32 v47, 0
  v_mfma_f32_32x32x16_bf16 v[48:63], a[28:31], a[156:159], v[48:63]
  ds_read_b128 a[188:191], v11 offset:11264
  ds_write_b128 v32, v[36:39]
  v_mfma_f32_32x32x16_bf16 v[64:79], a[28:31], a[160:163], v[64:79]
  ds_read_b128 a[192:195], v11 offset:48128
  buffer_load_dwordx4 a[104:107], v2, s[28:31], s10 offen offset:2048 sc1
  ds_write_b128 v32, v[40:43] offset:2048
  s_cmp_eq_u32 s3, 0
  s_cselect_b64 exec, -1, 0
  ds_write_b128 v32, v[44:47] offset:4096
  s_mov_b64 exec, -1
  s_waitcnt lgkmcnt(0)
  v_add_f32 v20, v20, v21
  v_add_f32 v22, v22, v23
  v_add_f32 v24, v24, v25
  v_add_f32 v26, v26, v27
  s_waitcnt lgkmcnt(7)
  v_mfma_f32_32x32x16_bf16 v[48:63], a[32:35], a[164:167], v[48:63]
  s_waitcnt vmcnt(7)
  s_barrier
  ds_read_b128 a[148:151], v11 offset:12288
  buffer_load_dwordx4 a[108:111], v2, s[28:31], s10 offen offset:3072 sc1
  s_add_u32 s10, s10, 4096
  v_add_f32 v20, v20, v22
  v_add_f32 v24, v24, v26
  v_add_f32 v20, v20, v24
  v_mul_f32 v20, 0x3ae38e39, v20
  v_mfma_f32_32x32x16_bf16 v[64:79], a[32:35], a[168:171], v[64:79]
  ds_read_b128 a[152:155], v11 offset:49152
  v_mov_b32 v21, v20
  s_nop 1
  v_permlane32_swap_b32 v20, v21
  v_fma_f32 v21, -v20, v20, v21
  v_max_f32 v21, 0, v21
  v_add_f32 v21, 0x3727c5ac, v21
  v_mfma_f32_32x32x16_bf16 v[48:63], a[36:39], a[172:175], v[48:63]
  ds_read_b128 a[156:159], v11 offset:13312
  buffer_load_dwordx4 a[112:115], v2, s[28:31], s10 offen offset:0 sc1
  v_rsq_f32 v22, v21
  v_mul_f32 v24, 0x3727c5ac, v21
  v_mul_f32 v23, v21, v22
  v_mul_f32 v28, 0xc0135761, v22
  v_mfma_f32_32x32x16_bf16 v[64:79], a[36:39], a[176:179], v[64:79]
  ds_read_b128 a[160:163], v11 offset:50176
  buffer_load_dwordx4 a[116:119], v2, s[28:31], s10 offen offset:1024 sc1
  v_mul_f32 v25, v22, v22
  v_mul_f32 v29, 0x3d372713, v25
  v_mul_f32 v29, v29, v28
  s_waitcnt lgkmcnt(6)
  v_mfma_f32_32x32x16_bf16 v[48:63], a[40:43], a[180:183], v[48:63]
  ds_read_b128 a[164:167], v11 offset:14336
  ds_write_b32 v30, v28
  v_mfma_f32_32x32x16_bf16 v[64:79], a[40:43], a[184:187], v[64:79]
  ds_read_b128 a[168:171], v11 offset:51200
  buffer_load_dwordx4 a[120:123], v2, s[28:31], s10 offen offset:2048 sc1
  ds_write_b32 v30, v29 offset:128
  v_mfma_f32_32x32x16_bf16 v[48:63], a[44:47], a[188:191], v[48:63]
  ds_read_b128 a[172:175], v11 offset:15360
  buffer_load_dwordx4 a[124:127], v2, s[28:31], s10 offen offset:3072 sc1
  s_add_u32 s10, s10, 4096
  ds_write_b32 v30, v24 offset:256
  v_mfma_f32_32x32x16_bf16 v[64:79], a[44:47], a[192:195], v[64:79]
  ds_read_b128 a[176:179], v11 offset:52224
  ds_write_b32 v30, v22 offset:384
  v_cvt_pk_bf16_f32 v25, -v20, -v20
  v_cvt_pk_bf16_f32 v26, v23, v23
  v_and_b32 v25, 0xffff0000, v25
  v_and_b32 v26, 0xffff0000, v26
  v_sub_f32 v27, -v20, v25
  v_sub_f32 v23, v23, v26
  s_waitcnt lgkmcnt(8)
  v_mfma_f32_32x32x16_bf16 v[48:63], a[48:51], a[148:151], v[48:63]
  ds_read_b128 a[180:183], v11 offset:16384
  buffer_load_dwordx4 a[128:131], v2, s[28:31], s10 offen offset:0 sc1
  v_cvt_pk_bf16_f32 v27, v25, v27
  v_cvt_pk_bf16_f32 v25, v25, v26
  v_cvt_pk_bf16_f32 v26, v23, v26
  v_cmp_gt_u32 vcc, 32, v1
  v_mfma_f32_32x32x16_bf16 v[64:79], a[48:51], a[152:155], v[64:79]
  ds_read_b128 a[184:187], v11 offset:53248
  buffer_load_dwordx4 a[132:135], v2, s[28:31], s10 offen offset:1024 sc1
  v_cndmask_b32 v27, 0, v27, vcc
  v_cndmask_b32 v25, 0, v25, vcc
  v_cndmask_b32 v26, 0, v26, vcc
  v_accvgpr_write_b32 a144, v27
  v_mfma_f32_32x32x16_bf16 v[48:63], a[52:55], a[156:159], v[48:63]
  ds_read_b128 a[188:191], v11 offset:17408
  v_accvgpr_write_b32 a145, v25
  v_accvgpr_write_b32 a146, v26
  v_accvgpr_write_b32 a147, 0
  s_waitcnt lgkmcnt(3)
  v_mfma_f32_32x32x16_bf16 v[64:79], a[52:55], a[160:163], v[64:79]
  ds_read_b128 a[192:195], v11 offset:54272
  buffer_load_dwordx4 a[136:139], v2, s[28:31], s10 offen offset:2048 sc1
  ds_read_b128 v[128:131], v8 offset:0
  s_waitcnt lgkmcnt(6)
  v_mfma_f32_32x32x16_bf16 v[48:63], a[56:59], a[164:167], v[48:63]
  ds_read_b128 a[148:151], v11 offset:18432
  buffer_load_dwordx4 a[140:143], v2, s[28:31], s10 offen offset:3072 sc1
  s_add_u32 s10, s10, 4096
  ds_read_b128 v[144:147], v8 offset:128
  v_mfma_f32_32x32x16_bf16 v[64:79], a[56:59], a[168:171], v[64:79]
  ds_read_b128 a[152:155], v11 offset:55296
  ds_read_b128 v[132:135], v8 offset:32
  s_add_u32 m0, s17, 73728
  s_add_u32 s12, s11, 73728
  v_mfma_f32_32x32x16_bf16 v[48:63], a[60:63], a[172:175], v[48:63]
  buffer_load_dwordx4 v2, s[32:35], s12 offen  lds
  ds_read_b128 a[156:159], v11 offset:19456
  ds_read_b128 v[148:151], v8 offset:160
  s_add_u32 m0, s17, 77824
  s_add_u32 s12, s11, 77824
  v_mfma_f32_32x32x16_bf16 v[64:79], a[60:63], a[176:179], v[64:79]
  buffer_load_dwordx4 v2, s[32:35], s12 offen  lds
  ds_read_b128 a[160:163], v11 offset:56320
  ds_read_b128 v[136:139], v8 offset:64
  s_waitcnt lgkmcnt(9)
  v_mfma_f32_32x32x16_bf16 v[48:63], a[64:67], a[180:183], v[48:63]
  s_waitcnt vmcnt(10)
  s_barrier
  ds_read_b128 a[164:167], v11 offset:20480
  ds_read_b128 v[152:155], v8 offset:192
  s_add_u32 m0, s17, 81920
  s_add_u32 s12, s11, 81920
  v_mfma_f32_32x32x16_bf16 v[64:79], a[64:67], a[184:187], v[64:79]
  buffer_load_dwordx4 v2, s[32:35], s12 offen  lds
  ds_read_b128 a[168:171], v11 offset:57344
  ds_read_b128 v[140:143], v8 offset:96
  s_add_u32 m0, s17, 86016
  s_add_u32 s12, s11, 86016
  v_mfma_f32_32x32x16_bf16 v[48:63], a[68:71], a[188:191], v[48:63]
  buffer_load_dwordx4 v2, s[32:35], s12 offen  lds
  ds_read_b128 a[172:175], v11 offset:21504
  ds_read_b128 v[156:159], v8 offset:224
  s_add_u32 s36, s20, 14086144
  s_addc_u32 s37, s21, 0
  s_and_b32 s37, s37, 0xffff
  s_mov_b32 s38, 2654208
  s_mov_b32 s39, 0x20000
  s_mul_i32 s7, s5, 331776
  s_add_u32 s7, s7, s17
  v_mfma_f32_32x32x16_bf16 v[64:79], a[68:71], a[192:195], v[64:79]
  ds_read_b128 a[176:179], v11 offset:58368
  s_waitcnt lgkmcnt(8)
  s_add_u32 m0, s17, 90112
  s_add_u32 s12, s11, 90112
  v_mfma_f32_32x32x16_bf16 v[48:63], a[72:75], a[148:151], v[48:63]
  buffer_load_dwordx4 v2, s[32:35], s12 offen  lds
  ds_read_b128 a[180:183], v11 offset:22528
  s_add_u32 m0, s17, 94208
  s_add_u32 s12, s11, 94208
  v_mfma_f32_32x32x16_bf16 v[64:79], a[72:75], a[152:155], v[64:79]
  buffer_load_dwordx4 v2, s[32:35], s12 offen  lds
  ds_read_b128 a[184:187], v11 offset:59392
  v_mfma_f32_32x32x16_bf16 v[48:63], a[76:79], a[156:159], v[48:63]
  ds_read_b128 a[188:191], v11 offset:23552
  s_add_u32 m0, s17, 98304
  s_add_u32 s12, s11, 98304
  v_mfma_f32_32x32x16_bf16 v[64:79], a[76:79], a[160:163], v[64:79]
  buffer_load_dwordx4 v2, s[32:35], s12 offen  lds
  ds_read_b128 a[192:195], v11 offset:60416
  s_waitcnt lgkmcnt(4)
  s_add_u32 m0, s17, 102400
  s_add_u32 s12, s11, 102400
  v_mfma_f32_32x32x16_bf16 v[48:63], a[80:83], a[164:167], v[48:63]
  buffer_load_dwordx4 v2, s[32:35], s12 offen  lds
  ds_read_b128 a[148:151], v11 offset:24576
  v_mfma_f32_32x32x16_bf16 v[64:79], a[80:83], a[168:171], v[64:79]
  ds_read_b128 a[152:155], v11 offset:61440
  s_add_u32 m0, s17, 106496
  s_add_u32 s12, s11, 106496
  v_mfma_f32_32x32x16_bf16 v[48:63], a[84:87], a[172:175], v[48:63]
  buffer_load_dwordx4 v2, s[32:35], s12 offen  lds
  ds_read_b128 a[156:159], v11 offset:25600
  s_add_u32 m0, s17, 110592
  s_add_u32 s12, s11, 110592
  v_mfma_f32_32x32x16_bf16 v[64:79], a[84:87], a[176:179], v[64:79]
  buffer_load_dwordx4 v2, s[32:35], s12 offen  lds
  ds_read_b128 a[160:163], v11 offset:62464
  s_waitcnt lgkmcnt(4)
  v_mfma_f32_32x32x16_bf16 v[48:63], a[88:91], a[180:183], v[48:63]
  ds_read_b128 a[164:167], v11 offset:26624
  s_add_u32 m0, s17, 114688
  s_add_u32 s12, s11, 114688
  v_mfma_f32_32x32x16_bf16 v[64:79], a[88:91], a[184:187], v[64:79]
  buffer_load_dwordx4 v2, s[32:35], s12 offen  lds
  ds_read_b128 a[168:171], v11 offset:63488
  s_add_u32 m0, s17, 118784
  s_add_u32 s12, s11, 118784
  v_mfma_f32_32x32x16_bf16 v[48:63], a[92:95], a[188:191], v[48:63]
  buffer_load_dwordx4 v2, s[32:35], s12 offen  lds
  ds_read_b128 a[172:175], v11 offset:27648
  v_mfma_f32_32x32x16_bf16 v[64:79], a[92:95], a[192:195], v[64:79]
  ds_read_b128 a[176:179], v11 offset:64512
  s_waitcnt lgkmcnt(4)
  v_mfma_f32_32x32x16_bf16 v[48:63], a[96:99], a[148:151], v[48:63]
  s_waitcnt vmcnt(12)
  s_barrier
  ds_read_b128 a[180:183], v11 offset:28672
  s_add_u32 m0, s17, 122880
  s_add_u32 s12, s11, 122880
  buffer_load_dwordx4 v2, s[32:35], s12 offen  lds
  s_add_u32 m0, s17, 126976
  s_add_u32 s12, s11, 126976
  v_mfma_f32_32x32x16_bf16 v[64:79], a[96:99], a[152:155], v[64:79]
  buffer_load_dwordx4 v2, s[32:35], s12 offen  lds
  ds_read_b128 a[184:187], v12 offset:0
  v_mfma_f32_32x32x16_bf16 v[48:63], a[100:103], a[156:159], v[48:63]
  ds_read_b128 a[188:191], v11 offset:29696
  s_add_u32 m0, s17, 131072
  s_add_u32 s12, s11, 131072
  v_mfma_f32_32x32x16_bf16 v[64:79], a[100:103], a[160:163], v[64:79]
  buffer_load_dwordx4 v2, s[32:35], s12 offen  lds
  ds_read_b128 a[192:195], v12 offset:1024
  s_waitcnt lgkmcnt(4)
  s_add_u32 m0, s17, 135168
  s_add_u32 s12, s11, 135168
  v_mfma_f32_32x32x16_bf16 v[48:63], a[104:107], a[164:167], v[48:63]
  buffer_load_dwordx4 v2, s[32:35], s12 offen  lds
  ds_read_b128 a[148:151], v11 offset:30720
  v_mfma_f32_32x32x16_bf16 v[64:79], a[104:107], a[168:171], v[64:79]
  ds_read_b128 a[152:155], v12 offset:2048
  s_add_u32 m0, s17, 139264
  s_add_u32 s12, s11, 139264
  v_mfma_f32_32x32x16_bf16 v[48:63], a[108:111], a[172:175], v[48:63]
  buffer_load_dwordx4 v2, s[32:35], s12 offen  lds
  ds_read_b128 a[156:159], v11 offset:31744
  s_add_u32 m0, s17, 143360
  s_add_u32 s12, s11, 143360
  v_mfma_f32_32x32x16_bf16 v[64:79], a[108:111], a[176:179], v[64:79]
  buffer_load_dwordx4 v2, s[32:35], s12 offen  lds
  ds_read_b128 a[160:163], v12 offset:3072
  s_waitcnt lgkmcnt(4)
  v_mfma_f32_32x32x16_bf16 v[48:63], a[112:115], a[180:183], v[48:63]
  ds_read_b128 a[164:167], v11 offset:32768
  s_add_u32 m0, s17, 0
  s_add_u32 s12, s11, 147456
  v_mfma_f32_32x32x16_bf16 v[64:79], a[112:115], a[184:187], v[64:79]
  buffer_load_dwordx4 v2, s[32:35], s12 offen  lds
  ds_read_b128 a[168:171], v12 offset:4096
  s_add_u32 m0, s17, 4096
  s_add_u32 s12, s11, 151552
  v_mfma_f32_32x32x16_bf16 v[48:63], a[116:119], a[188:191], v[48:63]
  buffer_load_dwordx4 v2, s[32:35], s12 offen  lds
  ds_read_b128 a[172:175], v11 offset:33792
  v_mfma_f32_32x32x16_bf16 v[64:79], a[116:119], a[192:195], v[64:79]
  ds_read_b128 a[176:179], v12 offset:5120
  s_waitcnt lgkmcnt(4)
  s_add_u32 m0, s17, 8192
  s_add_u32 s12, s11, 155648
  v_mfma_f32_32x32x16_bf16 v[48:63], a[120:123], a[148:151], v[48:63]
  buffer_load_dwordx4 v2, s[32:35], s12 offen  lds
  ds_read_b128 a[180:183], v11 offset:34816
  s_add_u32 m0, s17, 12288
  s_add_u32 s12, s11, 159744
  v_mfma_f32_32x32x16_bf16 v[64:79], a[120:123], a[152:155], v[64:79]
  buffer_load_dwordx4 v2, s[32:35], s12 offen  lds
  ds_read_b128 a[184:187], v12 offset:6144
  v_mfma_f32_32x32x16_bf16 v[48:63], a[124:127], a[156:159], v[48:63]
  ds_read_b128 a[188:191], v11 offset:35840
  s_add_u32 m0, s17, 16384
  s_add_u32 s12, s11, 163840
  v_mfma_f32_32x32x16_bf16 v[64:79], a[124:127], a[160:163], v[64:79]
  buffer_load_dwordx4 v2, s[32:35], s12 offen  lds
  ds_read_b128 a[192:195], v12 offset:7168
  s_waitcnt lgkmcnt(4)
  v_mfma_f32_32x32x16_bf16 v[48:63], a[128:131], a[164:167], v[48:63]
  ds_read_b128 a[148:151], v3 offset:0
  v_mfma_f32_32x32x16_bf16 v[64:79], a[128:131], a[168:171], v[64:79]
  ds_read_b128 a[152:155], v3 offset:512
  v_mfma_f32_32x32x16_bf16 v[48:63], a[132:135], a[172:175], v[48:63]
  s_waitcnt vmcnt(14)
  s_barrier
  ds_read_b128 a[156:159], v12 offset:8192
  s_add_u32 m0, s17, 20480
  s_add_u32 s12, s11, 167936
  buffer_load_dwordx4 v2, s[32:35], s12 offen  lds
  s_add_u32 m0, s17, 24576
  s_add_u32 s12, s11, 172032
  v_mfma_f32_32x32x16_bf16 v[64:79], a[132:135], a[176:179], v[64:79]
  buffer_load_dwordx4 v2, s[32:35], s12 offen  lds
  ds_read_b128 a[160:163], v12 offset:9216
  s_waitcnt lgkmcnt(4)
  v_mfma_f32_32x32x16_bf16 v[48:63], a[136:139], a[180:183], v[48:63]
  ds_read_b128 a[164:167], v12 offset:10240
  v_mfma_f32_32x32x16_bf16 v[64:79], a[136:139], a[184:187], v[64:79]
  ds_read_b128 a[168:171], v12 offset:11264
  v_mfma_f32_32x32x16_bf16 v[48:63], a[140:143], a[188:191], v[48:63]
  ds_read_b128 a[172:175], v12 offset:12288
  v_mfma_f32_32x32x16_bf16 v[64:79], a[140:143], a[192:195], v[64:79]
  ds_read_b128 a[176:179], v12 offset:13312
  s_waitcnt lgkmcnt(4)
  v_mfma_f32_32x32x16_bf16 v[48:63], a[144:147], a[148:151], v[48:63]
  ds_read_b128 a[180:183], v12 offset:14336
  v_mfma_f32_32x32x16_bf16 v[64:79], a[144:147], a[152:155], v[64:79]
  ds_read_b128 a[184:187], v12 offset:15360
  v_mfma_f32_32x32x16_bf16 v[80:95], a[0:3], a[156:159], 0
  ds_read_b128 a[188:191], v12 offset:16384
  v_mfma_f32_32x32x16_bf16 v[80:95], a[4:7], a[160:163], v[80:95]
  ds_read_b128 a[192:195], v12 offset:17408
  s_waitcnt lgkmcnt(4)
  v_mfma_f32_32x32x16_bf16 v[80:95], a[8:11], a[164:167], v[80:95]
  ds_read_b128 a[148:151], v12 offset:18432
  s_nop 1
  v_mul_f32 v192, v48, v48
  v_mul_f32 v193, v49, v49
  v_fma_f32 v192, v192, v144, v128
  v_mul_f32 v194, v50, v50
  v_fma_f32 v193, v193, v145, v129
  v_mul_f32 v192, v192, v48
  v_mul_f32 v195, v51, v51
  v_mfma_f32_32x32x16_bf16 v[80:95], a[12:15], a[168:171], v[80:95]
  ds_read_b128 a[152:155], v12 offset:19456
  v_fma_f32 v194, v194, v146, v130
  v_exp_f32 v192, v192
  v_mul_f32 v193, v193, v49
  v_mul_f32 v196, v52, v52
  v_fma_f32 v195, v195, v147, v131
  v_mfma_f32_32x32x16_bf16 v[80:95], a[16:19], a[172:175], v[80:95]
  ds_read_b128 a[156:159], v12 offset:20480
  v_exp_f32 v193, v193
  v_mul_f32 v194, v194, v50
  v_add_f32 v192, 1.0, v192
  v_mul_f32 v197, v53, v53
  v_fma_f32 v196, v196, v148, v132
  v_mfma_f32_32x32x16_bf16 v[80:95], a[20:23], a[176:179], v[80:95]
  ds_read_b128 a[160:163], v12 offset:21504
  v_exp_f32 v194, v194
  v_mul_f32 v195, v195, v51
  v_add_f32 v193, 1.0, v193
  v_rcp_f32 v192, v192
  s_waitcnt lgkmcnt(4)
  v_mfma_f32_32x32x16_bf16 v[80:95], a[24:27], a[180:183], v[80:95]
  ds_read_b128 a[164:167], v12 offset:22528
  v_mul_f32 v198, v54, v54
  v_fma_f32 v197, v197, v149, v133
  v_exp_f32 v195, v195
  v_mul_f32 v196, v196, v52
  v_add_f32 v194, 1.0, v194
  v_mfma_f32_32x32x16_bf16 v[80:95], a[28:31], a[184:187], v[80:95]
  ds_read_b128 a[168:171], v12 offset:23552
  v_rcp_f32 v193, v193
  v_mul_f32 v48, v48, v192
  v_mul_f32 v199, v55, v55
  v_fma_f32 v198, v198, v150, v134
  v_mfma_f32_32x32x16_bf16 v[80:95], a[32:35], a[188:191], v[80:95]
  ds_read_b128 a[172:175], v12 offset:24576
  v_exp_f32 v196, v196
  v_mul_f32 v197, v197, v53
  v_add_f32 v195, 1.0, v195
  v_rcp_f32 v194, v194
  v_mul_f32 v49, v49, v193
  v_mfma_f32_32x32x16_bf16 v[80:95], a[36:39], a[192:195], v[80:95]
  ds_read_b128 a[176:179], v12 offset:25600
  v_mul_f32 v192, v56, v56
  v_fma_f32 v199, v199, v151, v135
  v_exp_f32 v197, v197
  v_mul_f32 v198, v198, v54
  v_add_f32 v196, 1.0, v196
  s_waitcnt lgkmcnt(4)
  v_mfma_f32_32x32x16_bf16 v[80:95], a[40:43], a[148:151], v[80:95]
  ds_read_b128 a[180:183], v12 offset:26624
  v_rcp_f32 v195, v195
  v_mul_f32 v50, v50, v194
  v_mul_f32 v193, v57, v57
  v_fma_f32 v192, v192, v152, v136
  v_mfma_f32_32x32x16_bf16 v[80:95], a[44:47], a[152:155], v[80:95]
  ds_read_b128 a[184:187], v12 offset:27648
  v_exp_f32 v198, v198
  v_mul_f32 v199, v199, v55
  v_add_f32 v197, 1.0, v197
  v_rcp_f32 v196, v196
  v_mul_f32 v51, v51, v195
  v_mfma_f32_32x32x16_bf16 v[80:95], a[48:51], a[156:159], v[80:95]
  ds_read_b128 a[188:191], v12 offset:28672
  v_mul_f32 v194, v58, v58
  v_fma_f32 v193, v193, v153, v137
  v_exp_f32 v199, v199
  v_mul_f32 v192, v192, v56
  v_add_f32 v198, 1.0, v198
  v_mfma_f32_32x32x16_bf16 v[80:95], a[52:55], a[160:163], v[80:95]
  ds_read_b128 a[192:195], v12 offset:29696
  v_rcp_f32 v197, v197
  v_mul_f32 v52, v52, v196
  v_mul_f32 v195, v59, v59
  v_fma_f32 v194, v194, v154, v138
  s_waitcnt lgkmcnt(4)
  v_mfma_f32_32x32x16_bf16 v[80:95], a[56:59], a[164:167], v[80:95]
  ds_read_b128 a[148:151], v12 offset:30720
  v_exp_f32 v192, v192
  v_mul_f32 v193, v193, v57
  v_add_f32 v199, 1.0, v199
  v_rcp_f32 v198, v198
  v_mul_f32 v53, v53, v197
  v_mfma_f32_32x32x16_bf16 v[80:95], a[60:63], a[168:171], v[80:95]
  ds_read_b128 a[152:155], v12 offset:31744
  v_mul_f32 v196, v60, v60
  v_fma_f32 v195, v195, v155, v139
  v_exp_f32 v193, v193
  v_mul_f32 v194, v194, v58
  v_add_f32 v192, 1.0, v192
  v_mfma_f32_32x32x16_bf16 v[80:95], a[64:67], a[172:175], v[80:95]
  ds_read_b128 a[156:159], v12 offset:32768
  v_rcp_f32 v199, v199
  v_mul_f32 v54, v54, v198
  v_mul_f32 v197, v61, v61
  v_fma_f32 v196, v196, v156, v140
  v_mfma_f32_32x32x16_bf16 v[80:95], a[68:71], a[176:179], v[80:95]
  ds_read_b128 a[160:163], v12 offset:33792
  v_exp_f32 v194, v194
  v_mul_f32 v195, v195, v59
  v_add_f32 v193, 1.0, v193
  v_rcp_f32 v192, v192
  v_mul_f32 v55, v55, v199
  s_waitcnt lgkmcnt(4)
  v_mfma_f32_32x32x16_bf16 v[80:95], a[72:75], a[180:183], v[80:95]
  ds_read_b128 a[164:167], v12 offset:34816
  v_mul_f32 v198, v62, v62
  v_fma_f32 v197, v197, v157, v141
  v_exp_f32 v195, v195
  v_mul_f32 v196, v196, v60
  v_add_f32 v194, 1.0, v194
  v_mfma_f32_32x32x16_bf16 v[80:95], a[76:79], a[184:187], v[80:95]
  ds_read_b128 a[168:171], v12 offset:35840
  v_rcp_f32 v193, v193
  v_mul_f32 v56, v56, v192
  v_mul_f32 v199, v63, v63
  v_fma_f32 v198, v198, v158, v142
  v_mfma_f32_32x32x16_bf16 v[80:95], a[80:83], a[188:191], v[80:95]
  ds_read_b128 a[172:175], v12 offset:36864
  v_exp_f32 v196, v196
  v_mul_f32 v197, v197, v61
  v_add_f32 v195, 1.0, v195
  v_rcp_f32 v194, v194
  v_mul_f32 v57, v57, v193
  v_mfma_f32_32x32x16_bf16 v[80:95], a[84:87], a[192:195], v[80:95]
  ds_read_b128 a[176:179], v12 offset:37888
  v_fma_f32 v199, v199, v159, v143
  v_exp_f32 v197, v197
  v_mul_f32 v198, v198, v62
  v_add_f32 v196, 1.0, v196
  s_waitcnt lgkmcnt(4)
  v_mfma_f32_32x32x16_bf16 v[80:95], a[88:91], a[148:151], v[80:95]
  ds_read_b128 a[180:183], v12 offset:38912
  v_rcp_f32 v195, v195
  v_mul_f32 v58, v58, v194
  v_exp_f32 v198, v198
  v_mul_f32 v199, v199, v63
  v_add_f32 v197, 1.0, v197
  v_mfma_f32_32x32x16_bf16 v[80:95], a[92:95], a[152:155], v[80:95]
  ds_read_b128 a[184:187], v12 offset:39936
  v_rcp_f32 v196, v196
  v_mul_f32 v59, v59, v195
  v_exp_f32 v199, v199
  v_add_f32 v198, 1.0, v198
  v_mfma_f32_32x32x16_bf16 v[80:95], a[96:99], a[156:159], v[80:95]
  ds_read_b128 a[188:191], v12 offset:40960
  v_rcp_f32 v197, v197
  v_mul_f32 v60, v60, v196
  v_add_f32 v199, 1.0, v199
  v_rcp_f32 v198, v198
  v_mfma_f32_32x32x16_bf16 v[80:95], a[100:103], a[160:163], v[80:95]
  ds_read_b128 a[192:195], v12 offset:41984
  v_mul_f32 v61, v61, v197
  v_rcp_f32 v199, v199
  v_mul_f32 v62, v62, v198
  v_mul_f32 v63, v63, v199
  v_mul_f32 v192, v64, v64
  s_waitcnt lgkmcnt(4)
  v_mfma_f32_32x32x16_bf16 v[80:95], a[104:107], a[164:167], v[80:95]
  ds_read_b128 a[148:151], v12 offset:43008
  v_mul_f32 v193, v65, v65
  v_fma_f32 v192, v192, v144, v128
  v_mul_f32 v194, v66, v66
  v_fma_f32 v193, v193, v145, v129
  v_mul_f32 v192, v192, v64
  v_mul_f32 v195, v67, v67
  v_mfma_f32_32x32x16_bf16 v[80:95], a[108:111], a[168:171], v[80:95]
  ds_read_b128 a[152:155], v12 offset:44032
  v_fma_f32 v194, v194, v146, v130
  v_exp_f32 v192, v192
  v_mul_f32 v193, v193, v65
  v_mul_f32 v196, v68, v68
  v_fma_f32 v195, v195, v147, v131
  v_mfma_f32_32x32x16_bf16 v[80:95], a[112:115], a[172:175], v[80:95]
  ds_read_b128 a[156:159], v3 offset:1024
  v_exp_f32 v193, v193
  v_mul_f32 v194, v194, v66
  v_add_f32 v192, 1.0, v192
  v_mul_f32 v197, v69, v69
  v_fma_f32 v196, v196, v148, v132
  v_mfma_f32_32x32x16_bf16 v[80:95], a[116:119], a[176:179], v[80:95]
  s_waitcnt vmcnt(7)
  s_barrier
  ds_read_b128 a[160:163], v12 offset:45056
  v_exp_f32 v194, v194
  v_mul_f32 v195, v195, v67
  v_add_f32 v193, 1.0, v193
  v_rcp_f32 v192, v192
  s_waitcnt lgkmcnt(4)
  v_mfma_f32_32x32x16_bf16 v[80:95], a[120:123], a[180:183], v[80:95]
  ds_read_b128 a[164:167], v12 offset:46080
  v_mul_f32 v198, v70, v70
  v_fma_f32 v197, v197, v149, v133
  v_exp_f32 v195, v195
  v_mul_f32 v196, v196, v68
  v_add_f32 v194, 1.0, v194
  s_add_u32 m0, s17, 28672
  s_add_u32 s12, s11, 176128
  v_mfma_f32_32x32x16_bf16 v[80:95], a[124:127], a[184:187], v[80:95]
  buffer_load_dwordx4 v2, s[32:35], s12 offen  lds
  ds_read_b128 a[168:171], v12 offset:47104
  v_rcp_f32 v193, v193
  v_mul_f32 v64, v64, v192
  v_mul_f32 v199, v71, v71
  v_mfma_f32_32x32x16_bf16 v[80:95], a[128:131], a[188:191], v[80:95]
  ds_read_b128 a[172:175], v12 offset:48128
  v_fma_f32 v198, v198, v150, v134
  v_exp_f32 v196, v196
  v_mul_f32 v197, v197, v69
  v_add_f32 v195, 1.0, v195
  v_mfma_f32_32x32x16_bf16 v[80:95], a[132:135], a[192:195], v[80:95]
  ds_read_b128 a[176:179], v12 offset:49152
  v_rcp_f32 v194, v194
  v_mul_f32 v65, v65, v193
  v_mul_f32 v192, v72, v72
  v_fma_f32 v199, v199, v151, v135
  v_exp_f32 v197, v197
  s_waitcnt lgkmcnt(4)
  s_add_u32 m0, s17, 32768
  s_add_u32 s12, s11, 180224
  v_mfma_f32_32x32x16_bf16 v[80:95], a[136:139], a[148:151], v[80:95]
  buffer_load_dwordx4 v2, s[32:35], s12 offen  lds
  ds_read_b128 a[180:183], v12 offset:50176
  v_mul_f32 v198, v198, v70
  v_add_f32 v196, 1.0, v196
  v_rcp_f32 v195, v195
  v_mfma_f32_32x32x16_bf16 v[80:95], a[140:143], a[152:155], v[80:95]
  ds_read_b128 a[184:187], v12 offset:51200
  v_mul_f32 v66, v66, v194
  v_mul_f32 v193, v73, v73
  v_fma_f32 v192, v192, v152, v136
  v_exp_f32 v198, v198
  v_mul_f32 v199, v199, v71
  v_mfma_f32_32x32x16_bf16 v[80:95], a[144:147], a[156:159], v[80:95]
  ds_read_b128 a[188:191], v12 offset:52224
  v_add_f32 v197, 1.0, v197
  v_rcp_f32 v196, v196
  v_mul_f32 v67, v67, v195
  v_mul_f32 v194, v74, v74
  v_fma_f32 v193, v193, v153, v137
  s_add_u32 m0, s17, 36864
  s_add_u32 s12, s11, 184320
  v_mfma_f32_32x32x16_bf16 v[96:111], a[0:3], a[160:163], 0
  buffer_load_dwordx4 v2, s[32:35], s12 offen  lds
  ds_read_b128 a[192:195], v12 offset:53248
  v_exp_f32 v199, v199
  v_mul_f32 v192, v192, v72
  v_add_f32 v198, 1.0, v198
  s_waitcnt lgkmcnt(4)
  v_mfma_f32_32x32x16_bf16 v[96:111], a[4:7], a[164:167], v[96:111]
  ds_read_b128 a[148:151], v12 offset:54272
  v_rcp_f32 v197, v197
  v_mul_f32 v68, v68, v196
  v_mul_f32 v195, v75, v75
  v_fma_f32 v194, v194, v154, v138
  v_mfma_f32_32x32x16_bf16 v[96:111], a[8:11], a[168:171], v[96:111]
  ds_read_b128 a[152:155], v12 offset:55296
  v_exp_f32 v192, v192
  v_mul_f32 v193, v193, v73
  v_add_f32 v199, 1.0, v199
  v_rcp_f32 v198, v198
  v_mul_f32 v69, v69, v197
  s_add_u32 m0, s17, 40960
  s_add_u32 s12, s11, 188416
  v_mfma_f32_32x32x16_bf16 v[96:111], a[12:15], a[172:175], v[96:111]
  buffer_load_dwordx4 v2, s[32:35], s12 offen  lds
  ds_read_b128 a[156:159], v12 offset:56320
  v_mul_f32 v196, v76, v76
  v_fma_f32 v195, v195, v155, v139
  v_exp_f32 v193, v193
  v_mfma_f32_32x32x16_bf16 v[96:111], a[16:19], a[176:179], v[96:111]
  ds_read_b128 a[160:163], v12 offset:57344
  v_mul_f32 v194, v194, v74
  v_add_f32 v192, 1.0, v192
  v_rcp_f32 v199, v199
  v_mul_f32 v70, v70, v198
  v_mul_f32 v197, v77, v77
  s_waitcnt lgkmcnt(4)
  v_mfma_f32_32x32x16_bf16 v[96:111], a[20:23], a[180:183], v[96:111]
  ds_read_b128 a[164:167], v12 offset:58368
  v_fma_f32 v196, v196, v156, v140
  v_exp_f32 v194, v194
  v_mul_f32 v195, v195, v75
  v_add_f32 v193, 1.0, v193
  s_add_u32 m0, s17, 45056
  s_add_u32 s12, s11, 192512
  v_mfma_f32_32x32x16_bf16 v[96:111], a[24:27], a[184:187], v[96:111]
  buffer_load_dwordx4 v2, s[32:35], s12 offen  lds
  ds_read_b128 a[168:171], v12 offset:59392
  v_rcp_f32 v192, v192
  v_mul_f32 v71, v71, v199
  v_mul_f32 v198, v78, v78
  v_fma_f32 v197, v197, v157, v141
  v_mfma_f32_32x32x16_bf16 v[96:111], a[28:31], a[188:191], v[96:111]
  ds_read_b128 a[172:175], v12 offset:60416
  v_exp_f32 v195, v195
  v_mul_f32 v196, v196, v76
  v_add_f32 v194, 1.0, v194
  v_rcp_f32 v193, v193
  v_mfma_f32_32x32x16_bf16 v[96:111], a[32:35], a[192:195], v[96:111]
  ds_read_b128 a[176:179], v12 offset:61440
  v_mul_f32 v72, v72, v192
  v_mul_f32 v199, v79, v79
  v_fma_f32 v198, v198, v158, v142
  v_exp_f32 v196, v196
  v_mul_f32 v197, v197, v77
  s_waitcnt lgkmcnt(4)
  s_add_u32 m0, s17, 49152
  s_add_u32 s12, s11, 196608
  v_mfma_f32_32x32x16_bf16 v[96:111], a[36:39], a[148:151], v[96:111]
  buffer_load_dwordx4 v2, s[32:35], s12 offen  lds
  ds_read_b128 a[180:183], v12 offset:62464
  v_add_f32 v195, 1.0, v195
  v_rcp_f32 v194, v194
  v_mul_f32 v73, v73, v193
  v_mfma_f32_32x32x16_bf16 v[96:111], a[40:43], a[152:155], v[96:111]
  ds_read_b128 a[184:187], v12 offset:63488
  v_fma_f32 v199, v199, v159, v143
  v_exp_f32 v197, v197
  v_mul_f32 v198, v198, v78
  v_add_f32 v196, 1.0, v196
  v_mfma_f32_32x32x16_bf16 v[96:111], a[44:47], a[156:159], v[96:111]
  ds_read_b128 a[188:191], v12 offset:64512
  v_rcp_f32 v195, v195
  v_mul_f32 v74, v74, v194
  v_exp_f32 v198, v198
  v_mul_f32 v199, v199, v79
  v_add_f32 v197, 1.0, v197
  s_add_u32 m0, s17, 53248
  s_add_u32 s12, s11, 200704
  v_mfma_f32_32x32x16_bf16 v[96:111], a[48:51], a[160:163], v[96:111]
  buffer_load_dwordx4 v2, s[32:35], s12 offen  lds
  ds_read_b128 a[192:195], v13 offset:0
  v_rcp_f32 v196, v196
  v_mul_f32 v75, v75, v195
  s_waitcnt lgkmcnt(4)
  v_mfma_f32_32x32x16_bf16 v[96:111], a[52:55], a[164:167], v[96:111]
  ds_read_b128 a[148:151], v13 offset:1024
  v_exp_f32 v199, v199
  v_add_f32 v198, 1.0, v198
  v_rcp_f32 v197, v197
  v_mul_f32 v76, v76, v196
  v_add_f32 v199, 1.0, v199
  v_mfma_f32_32x32x16_bf16 v[96:111], a[56:59], a[168:171], v[96:111]
  ds_read_b128 a[152:155], v13 offset:2048
  v_rcp_f32 v198, v198
  v_mul_f32 v77, v77, v197
  v_rcp_f32 v199, v199
  v_mul_f32 v78, v78, v198
  s_add_u32 m0, s17, 57344
  s_add_u32 s12, s11, 204800
  v_mfma_f32_32x32x16_bf16 v[96:111], a[60:63], a[172:175], v[96:111]
  buffer_load_dwordx4 v2, s[32:35], s12 offen  lds
  ds_read_b128 a[156:159], v13 offset:3072
  v_mul_f32 v79, v79, v199
  v_mul_f32 v192, v80, v80
  v_mul_f32 v193, v81, v81
  v_fma_f32 v192, v192, v144, v128
  v_mfma_f32_32x32x16_bf16 v[96:111], a[64:67], a[176:179], v[96:111]
  ds_read_b128 a[160:163], v13 offset:4096
  v_mul_f32 v194, v82, v82
  v_fma_f32 v193, v193, v145, v129
  v_mul_f32 v192, v192, v80
  v_mul_f32 v195, v83, v83
  v_fma_f32 v194, v194, v146, v130
  s_waitcnt lgkmcnt(4)
  v_mfma_f32_32x32x16_bf16 v[96:111], a[68:71], a[180:183], v[96:111]
  ds_read_b128 a[164:167], v13 offset:5120
  v_exp_f32 v192, v192
  v_mul_f32 v193, v193, v81
  v_mul_f32 v196, v84, v84
  v_fma_f32 v195, v195, v147, v131
  v_exp_f32 v193, v193
  s_add_u32 m0, s17, 61440
  s_add_u32 s12, s11, 208896
  v_mfma_f32_32x32x16_bf16 v[96:111], a[72:75], a[184:187], v[96:111]
  buffer_load_dwordx4 v2, s[32:35], s12 offen  lds
  ds_read_b128 a[168:171], v13 offset:6144
  v_mul_f32 v194, v194, v82
  v_add_f32 v192, 1.0, v192
  v_mul_f32 v197, v85, v85
  v_fma_f32 v196, v196, v148, v132
  v_mfma_f32_32x32x16_bf16 v[96:111], a[76:79], a[188:191], v[96:111]
  ds_read_b128 a[172:175], v13 offset:7168
  v_exp_f32 v194, v194
  v_mul_f32 v195, v195, v83
  v_add_f32 v193, 1.0, v193
  v_rcp_f32 v192, v192
  v_mfma_f32_32x32x16_bf16 v[96:111], a[80:83], a[192:195], v[96:111]
  ds_read_b128 a[176:179], v13 offset:8192
  v_mul_f32 v198, v86, v86
  v_fma_f32 v197, v197, v149, v133
  v_exp_f32 v195, v195
  v_mul_f32 v196, v196, v84
  v_add_f32 v194, 1.0, v194
  s_waitcnt lgkmcnt(4)
  s_add_u32 m0, s17, 65536
  s_add_u32 s12, s11, 212992
  v_mfma_f32_32x32x16_bf16 v[96:111], a[84:87], a[148:151], v[96:111]
  buffer_load_dwordx4 v2, s[32:35], s12 offen  lds
  ds_read_b128 a[180:183], v13 offset:9216
  v_rcp_f32 v193, v193
  v_mul_f32 v80, v80, v192
  v_mul_f32 v199, v87, v87
  v_mfma_f32_32x32x16_bf16 v[96:111], a[88:91], a[152:155], v[96:111]
  ds_read_b128 a[184:187], v13 offset:10240
  v_fma_f32 v198, v198, v150, v134
  v_exp_f32 v196, v196
  v_mul_f32 v197, v197, v85
  v_add_f32 v195, 1.0, v195
  v_mfma_f32_32x32x16_bf16 v[96:111], a[92:95], a[156:159], v[96:111]
  ds_read_b128 a[188:191], v13 offset:11264
  v_rcp_f32 v194, v194
  v_mul_f32 v81, v81, v193
  v_mul_f32 v192, v88, v88
  v_fma_f32 v199, v199, v151, v135
  v_exp_f32 v197, v197
  s_add_u32 m0, s17, 69632
  s_add_u32 s12, s11, 217088
  v_mfma_f32_32x32x16_bf16 v[96:111], a[96:99], a[160:163], v[96:111]
  buffer_load_dwordx4 v2, s[32:35], s12 offen  lds
  ds_read_b128 a[192:195], v13 offset:12288
  v_mul_f32 v198, v198, v86
  v_add_f32 v196, 1.0, v196
  v_rcp_f32 v195, v195
  s_waitcnt lgkmcnt(4)
  v_mfma_f32_32x32x16_bf16 v[96:111], a[100:103], a[164:167], v[96:111]
  ds_read_b128 a[148:151], v13 offset:13312
  v_mul_f32 v82, v82, v194
  v_mul_f32 v193, v89, v89
  v_fma_f32 v192, v192, v152, v136
  v_exp_f32 v198, v198
  v_mul_f32 v199, v199, v87
  v_mfma_f32_32x32x16_bf16 v[96:111], a[104:107], a[168:171], v[96:111]
  ds_read_b128 a[152:155], v13 offset:14336
  v_add_f32 v197, 1.0, v197
  v_rcp_f32 v196, v196
  v_mul_f32 v83, v83, v195
  v_mul_f32 v194, v90, v90
  v_fma_f32 v193, v193, v153, v137
  s_add_u32 m0, s17, 73728
  s_add_u32 s12, s11, 221184
  v_mfma_f32_32x32x16_bf16 v[96:111], a[108:111], a[172:175], v[96:111]
  buffer_load_dwordx4 v2, s[32:35], s12 offen  lds
  ds_read_b128 a[156:159], v13 offset:15360
  v_exp_f32 v199, v199
  v_mul_f32 v192, v192, v88
  v_add_f32 v198, 1.0, v198
  v_mfma_f32_32x32x16_bf16 v[96:111], a[112:115], a[176:179], v[96:111]
  ds_read_b128 a[160:163], v3 offset:1536
  v_rcp_f32 v197, v197
  v_mul_f32 v84, v84, v196
  v_mul_f32 v195, v91, v91
  v_fma_f32 v194, v194, v154, v138
  s_waitcnt lgkmcnt(4)
  v_mfma_f32_32x32x16_bf16 v[96:111], a[116:119], a[180:183], v[96:111]
  s_waitcnt vmcnt(10)
  s_barrier
  ds_read_b128 a[164:167], v11 offset:0
  v_exp_f32 v192, v192
  v_mul_f32 v193, v193, v89
  v_add_f32 v199, 1.0, v199
  v_rcp_f32 v198, v198
  v_mul_f32 v85, v85, v197
  s_add_u32 m0, s17, 77824
  s_add_u32 s12, s11, 225280
  v_mfma_f32_32x32x16_bf16 v[96:111], a[120:123], a[184:187], v[96:111]
  buffer_load_dwordx4 v2, s[32:35], s12 offen  lds
  ds_read_b128 a[168:171], v11 offset:1024
  v_mul_f32 v196, v92, v92
  v_fma_f32 v195, v195, v155, v139
  v_exp_f32 v193, v193
  v_mfma_f32_32x32x16_bf16 v[96:111], a[124:127], a[188:191], v[96:111]
  ds_read_b128 a[172:175], v11 offset:2048
  v_mul_f32 v194, v194, v90
  v_add_f32 v192, 1.0, v192
  v_rcp_f32 v199, v199
  v_mul_f32 v86, v86, v198
  v_mul_f32 v197, v93, v93
  v_mfma_f32_32x32x16_bf16 v[96:111], a[128:131], a[192:195], v[96:111]
  ds_read_b128 a[176:179], v11 offset:3072
  v_fma_f32 v196, v196, v156, v140
  v_exp_f32 v194, v194
  v_mul_f32 v195, v195, v91
  v_add_f32 v193, 1.0, v193
  s_waitcnt lgkmcnt(4)
  s_add_u32 m0, s17, 81920
  s_add_u32 s12, s11, 229376
  v_mfma_f32_32x32x16_bf16 v[96:111], a[132:135], a[148:151], v[96:111]
  buffer_load_dwordx4 v2, s[32:35], s12 offen  lds
  ds_read_b128 a[180:183], v11 offset:4096
  v_rcp_f32 v192, v192
  v_mul_f32 v87, v87, v199
  v_mul_f32 v198, v94, v94
  v_fma_f32 v197, v197, v157, v141
  v_mfma_f32_32x32x16_bf16 v[96:111], a[136:139], a[152:155], v[96:111]
  ds_read_b128 a[184:187], v11 offset:5120
  v_exp_f32 v195, v195
  v_mul_f32 v196, v196, v92
  v_add_f32 v194, 1.0, v194
  v_rcp_f32 v193, v193
  v_mfma_f32_32x32x16_bf16 v[96:111], a[140:143], a[156:159], v[96:111]
  ds_read_b128 a[188:191], v11 offset:6144
  v_mul_f32 v88, v88, v192
  v_mul_f32 v199, v95, v95
  v_fma_f32 v198, v198, v158, v142
  v_exp_f32 v196, v196
  v_mul_f32 v197, v197, v93
  s_add_u32 m0, s17, 86016
  s_add_u32 s12, s11, 233472
  v_mfma_f32_32x32x16_bf16 v[96:111], a[144:147], a[160:163], v[96:111]
  buffer_load_dwordx4 v2, s[32:35], s12 offen  lds
  ds_read_b128 a[192:195], v11 offset:7168
  v_add_f32 v195, 1.0, v195
  v_rcp_f32 v194, v194
  v_mul_f32 v89, v89, v193
  s_waitcnt lgkmcnt(4)
  v_mfma_f32_32x32x16_bf16 v[112:127], a[0:3], a[164:167], 0
  ds_read_b128 a[148:151], v11 offset:8192
  v_fma_f32 v199, v199, v159, v143
  v_exp_f32 v197, v197
  v_mul_f32 v198, v198, v94
  v_add_f32 v196, 1.0, v196
  v_mfma_f32_32x32x16_bf16 v[112:127], a[4:7], a[168:171], v[112:127]
  ds_read_b128 a[152:155], v11 offset:9216
  v_rcp_f32 v195, v195
  v_mul_f32 v90, v90, v194
  v_exp_f32 v198, v198
  v_mul_f32 v199, v199, v95
  v_add_f32 v197, 1.0, v197
  s_add_u32 m0, s17, 90112
  s_add_u32 s12, s11, 237568
  v_mfma_f32_32x32x16_bf16 v[112:127], a[8:11], a[172:175], v[112:127]
  buffer_load_dwordx4 v2, s[32:35], s12 offen  lds
  ds_read_b128 a[156:159], v11 offset:10240
  v_rcp_f32 v196, v196
  v_mul_f32 v91, v91, v195
  v_mfma_f32_32x32x16_bf16 v[112:127], a[12:15], a[176:179], v[112:127]
  ds_read_b128 a[160:163], v11 offset:11264
  v_exp_f32 v199, v199
  v_add_f32 v198, 1.0, v198
  v_rcp_f32 v197, v197
  v_mul_f32 v92, v92, v196
  v_add_f32 v199, 1.0, v199
  s_waitcnt lgkmcnt(4)
  v_mfma_f32_32x32x16_bf16 v[112:127], a[16:19], a[180:183], v[112:127]
  ds_read_b128 a[164:167], v11 offset:12288
  v_rcp_f32 v198, v198
  v_mul_f32 v93, v93, v197
  v_rcp_f32 v199, v199
  v_mul_f32 v94, v94, v198
  s_add_u32 m0, s17, 94208
  s_add_u32 s12, s11, 241664
  v_mfma_f32_32x32x16_bf16 v[112:127], a[20:23], a[184:187], v[112:127]
  buffer_load_dwordx4 v2, s[32:35], s12 offen  lds
  ds_read_b128 a[168:171], v11 offset:13312
  v_mul_f32 v95, v95, v199
  v_mul_f32 v192, v96, v96
  v_mul_f32 v193, v97, v97
  v_fma_f32 v192, v192, v144, v128
  v_mfma_f32_32x32x16_bf16 v[112:127], a[24:27], a[188:191], v[112:127]
  ds_read_b128 a[172:175], v11 offset:14336
  v_mul_f32 v194, v98, v98
  v_fma_f32 v193, v193, v145, v129
  v_mul_f32 v192, v192, v96
  v_mul_f32 v195, v99, v99
  v_fma_f32 v194, v194, v146, v130
  v_mfma_f32_32x32x16_bf16 v[112:127], a[28:31], a[192:195], v[112:127]
  ds_read_b128 a[176:179], v11 offset:15360
  v_exp_f32 v192, v192
  v_mul_f32 v193, v193, v97
  v_mul_f32 v196, v100, v100
  v_fma_f32 v195, v195, v147, v131
  v_exp_f32 v193, v193
  s_waitcnt lgkmcnt(4)
  s_add_u32 m0, s17, 98304
  s_add_u32 s12, s11, 245760
  v_mfma_f32_32x32x16_bf16 v[112:127], a[32:35], a[148:151], v[112:127]
  buffer_load_dwordx4 v2, s[32:35], s12 offen  lds
  ds_read_b128 a[180:183], v11 offset:16384
  v_mul_f32 v194, v194, v98
  v_add_f32 v192, 1.0, v192
  v_mul_f32 v197, v101, v101
  v_fma_f32 v196, v196, v148, v132
  v_mfma_f32_32x32x16_bf16 v[112:127], a[36:39], a[152:155], v[112:127]
  ds_read_b128 a[184:187], v11 offset:17408
  v_exp_f32 v194, v194
  v_mul_f32 v195, v195, v99
  v_add_f32 v193, 1.0, v193
  v_rcp_f32 v192, v192
  v_mfma_f32_32x32x16_bf16 v[112:127], a[40:43], a[156:159], v[112:127]
  ds_read_b128 a[188:191], v11 offset:18432
  v_mul_f32 v198, v102, v102
  v_fma_f32 v197, v197, v149, v133
  v_exp_f32 v195, v195
  v_mul_f32 v196, v196, v100
  v_add_f32 v194, 1.0, v194
  s_add_u32 m0, s17, 102400
  s_add_u32 s12, s11, 249856
  v_mfma_f32_32x32x16_bf16 v[112:127], a[44:47], a[160:163], v[112:127]
  buffer_load_dwordx4 v2, s[32:35], s12 offen  lds
  ds_read_b128 a[192:195], v11 offset:19456
  v_rcp_f32 v193, v193
  v_mul_f32 v96, v96, v192
  v_mul_f32 v199, v103, v103
  s_waitcnt lgkmcnt(4)
  v_mfma_f32_32x32x16_bf16 v[112:127], a[48:51], a[164:167], v[112:127]
  ds_read_b128 a[148:151], v11 offset:20480
  v_fma_f32 v198, v198, v150, v134
  v_exp_f32 v196, v196
  v_mul_f32 v197, v197, v101
  v_add_f32 v195, 1.0, v195
  v_mfma_f32_32x32x16_bf16 v[112:127], a[52:55], a[168:171], v[112:127]
  ds_read_b128 a[152:155], v11 offset:21504
  v_rcp_f32 v194, v194
  v_mul_f32 v97, v97, v193
  v_mul_f32 v192, v104, v104
  v_fma_f32 v199, v199, v151, v135
  v_exp_f32 v197, v197
  s_add_u32 m0, s17, 106496
  s_add_u32 s12, s11, 253952
  v_mfma_f32_32x32x16_bf16 v[112:127], a[56:59], a[172:175], v[112:127]
  buffer_load_dwordx4 v2, s[32:35], s12 offen  lds
  ds_read_b128 a[156:159], v11 offset:22528
  v_mul_f32 v198, v198, v102
  v_add_f32 v196, 1.0, v196
  v_rcp_f32 v195, v195
  v_mfma_f32_32x32x16_bf16 v[112:127], a[60:63], a[176:179], v[112:127]
  ds_read_b128 a[160:163], v11 offset:23552
  v_mul_f32 v98, v98, v194
  v_mul_f32 v193, v105, v105
  v_fma_f32 v192, v192, v152, v136
  v_exp_f32 v198, v198
  v_mul_f32 v199, v199, v103
  s_waitcnt lgkmcnt(4)
  v_mfma_f32_32x32x16_bf16 v[112:127], a[64:67], a[180:183], v[112:127]
  ds_read_b128 a[164:167], v11 offset:24576
  v_add_f32 v197, 1.0, v197
  v_rcp_f32 v196, v196
  v_mul_f32 v99, v99, v195
  v_mul_f32 v194, v106, v106
  v_fma_f32 v193, v193, v153, v137
  s_add_u32 m0, s17, 110592
  s_add_u32 s12, s11, 258048
  v_mfma_f32_32x32x16_bf16 v[112:127], a[68:71], a[184:187], v[112:127]
  buffer_load_dwordx4 v2, s[32:35], s12 offen  lds
  ds_read_b128 a[168:171], v11 offset:25600
  v_exp_f32 v199, v199
  v_mul_f32 v192, v192, v104
  v_add_f32 v198, 1.0, v198
  v_mfma_f32_32x32x16_bf16 v[112:127], a[72:75], a[188:191], v[112:127]
  ds_read_b128 a[172:175], v11 offset:26624
  v_rcp_f32 v197, v197
  v_mul_f32 v100, v100, v196
  v_mul_f32 v195, v107, v107
  v_fma_f32 v194, v194, v154, v138
  v_mfma_f32_32x32x16_bf16 v[112:127], a[76:79], a[192:195], v[112:127]
  ds_read_b128 a[176:179], v11 offset:27648
  v_exp_f32 v192, v192
  v_mul_f32 v193, v193, v105
  v_add_f32 v199, 1.0, v199
  v_rcp_f32 v198, v198
  v_mul_f32 v101, v101, v197
  s_waitcnt lgkmcnt(4)
  s_add_u32 m0, s17, 114688
  s_add_u32 s12, s11, 262144
  v_mfma_f32_32x32x16_bf16 v[112:127], a[80:83], a[148:151], v[112:127]
  buffer_load_dwordx4 v2, s[32:35], s12 offen  lds
  ds_read_b128 a[180:183], v11 offset:28672
  v_mul_f32 v196, v108, v108
  v_fma_f32 v195, v195, v155, v139
  v_exp_f32 v193, v193
  v_mfma_f32_32x32x16_bf16 v[112:127], a[84:87], a[152:155], v[112:127]
  ds_read_b128 a[184:187], v11 offset:29696
  v_mul_f32 v194, v194, v106
  v_add_f32 v192, 1.0, v192
  v_rcp_f32 v199, v199
  v_mul_f32 v102, v102, v198
  v_mul_f32 v197, v109, v109
  v_mfma_f32_32x32x16_bf16 v[112:127], a[88:91], a[156:159], v[112:127]
  ds_read_b128 a[188:191], v11 offset:30720
  v_fma_f32 v196, v196, v156, v140
  v_exp_f32 v194, v194
  v_mul_f32 v195, v195, v107
  v_add_f32 v193, 1.0, v193
  s_add_u32 m0, s17, 118784
  s_add_u32 s12, s11, 266240
  v_mfma_f32_32x32x16_bf16 v[112:127], a[92:95], a[160:163], v[112:127]
  buffer_load_dwordx4 v2, s[32:35], s12 offen  lds
  ds_read_b128 a[192:195], v11 offset:31744
  v_rcp_f32 v192, v192
  v_mul_f32 v103, v103, v199
  v_mul_f32 v198, v110, v110
  v_fma_f32 v197, v197, v157, v141
  s_waitcnt lgkmcnt(4)
  v_mfma_f32_32x32x16_bf16 v[112:127], a[96:99], a[164:167], v[112:127]
  ds_read_b128 a[148:151], v11 offset:32768
  v_exp_f32 v195, v195
  v_mul_f32 v196, v196, v108
  v_add_f32 v194, 1.0, v194
  v_rcp_f32 v193, v193
  v_mfma_f32_32x32x16_bf16 v[112:127], a[100:103], a[168:171], v[112:127]
  ds_read_b128 a[152:155], v11 offset:33792
  v_mul_f32 v104, v104, v192
  v_mul_f32 v199, v111, v111
  v_fma_f32 v198, v198, v158, v142
  v_exp_f32 v196, v196
  v_mul_f32 v197, v197, v109
  s_add_u32 m0, s17, 122880
  s_add_u32 s12, s11, 270336
  v_mfma_f32_32x32x16_bf16 v[112:127], a[104:107], a[172:175], v[112:127]
  buffer_load_dwordx4 v2, s[32:35], s12 offen  lds
  ds_read_b128 a[156:159], v11 offset:34816
  v_add_f32 v195, 1.0, v195
  v_rcp_f32 v194, v194
  v_mul_f32 v105, v105, v193
  v_mfma_f32_32x32x16_bf16 v[112:127], a[108:111], a[176:179], v[112:127]
  ds_read_b128 a[160:163], v11 offset:35840
  v_fma_f32 v199, v199, v159, v143
  v_exp_f32 v197, v197
  v_mul_f32 v198, v198, v110
  v_add_f32 v196, 1.0, v196
  s_waitcnt lgkmcnt(4)
  v_mfma_f32_32x32x16_bf16 v[112:127], a[112:115], a[180:183], v[112:127]
  ds_read_b128 a[164:167], v3 offset:2048
  v_rcp_f32 v195, v195
  v_mul_f32 v106, v106, v194
  v_exp_f32 v198, v198
  v_mul_f32 v199, v199, v111
  v_add_f32 v197, 1.0, v197
  v_mfma_f32_32x32x16_bf16 v[112:127], a[116:119], a[184:187], v[112:127]
  s_waitcnt vmcnt(13)
  s_barrier
  ds_read_b128 a[168:171], v11 offset:36864
  s_add_u32 m0, s17, 126976
  s_add_u32 s12, s11, 274432
  buffer_load_dwordx4 v2, s[32:35], s12 offen  lds
  v_rcp_f32 v196, v196
  v_mul_f32 v107, v107, v195
  v_mfma_f32_32x32x16_bf16 v[112:127], a[120:123], a[188:191], v[112:127]
  ds_read_b128 a[172:175], v11 offset:37888
  v_exp_f32 v199, v199
  v_add_f32 v198, 1.0, v198
  v_rcp_f32 v197, v197
  v_mul_f32 v108, v108, v196
  v_add_f32 v199, 1.0, v199
  v_mfma_f32_32x32x16_bf16 v[112:127], a[124:127], a[192:195], v[112:127]
  ds_read_b128 a[176:179], v11 offset:38912
  v_rcp_f32 v198, v198
  v_mul_f32 v109, v109, v197
  v_rcp_f32 v199, v199
  v_mul_f32 v110, v110, v198
  s_waitcnt lgkmcnt(4)
  s_add_u32 m0, s17, 131072
  s_add_u32 s12, s11, 278528
  v_mfma_f32_32x32x16_bf16 v[112:127], a[128:131], a[148:151], v[112:127]
  buffer_load_dwordx4 v2, s[32:35], s12 offen  lds
  ds_read_b128 a[180:183], v11 offset:39936
  v_mul_f32 v111, v111, v199
  s_nop 0
  v_pk_add_f32 v[160:161], v[48:49], v[64:65]
  v_pk_mul_f32 v[176:177], v[48:49], v[48:49]
  v_pk_add_f32 v[162:163], v[50:51], v[66:67]
  v_pk_mul_f32 v[178:179], v[50:51], v[50:51]
  v_pk_add_f32 v[164:165], v[52:53], v[68:69]
  v_pk_mul_f32 v[180:181], v[52:53], v[52:53]
  v_pk_add_f32 v[166:167], v[54:55], v[70:71]
  v_pk_mul_f32 v[182:183], v[54:55], v[54:55]
  v_pk_add_f32 v[168:169], v[56:57], v[72:73]
  v_pk_mul_f32 v[184:185], v[56:57], v[56:57]
  v_pk_add_f32 v[170:171], v[58:59], v[74:75]
  v_pk_mul_f32 v[186:187], v[58:59], v[58:59]
  v_pk_add_f32 v[172:173], v[60:61], v[76:77]
  v_pk_mul_f32 v[188:189], v[60:61], v[60:61]
  v_pk_add_f32 v[174:175], v[62:63], v[78:79]
  v_pk_mul_f32 v[190:191], v[62:63], v[62:63]
  v_pk_fma_f32 v[176:177], v[64:65], v[64:65], v[176:177]
  v_pk_fma_f32 v[178:179], v[66:67], v[66:67], v[178:179]
  v_pk_fma_f32 v[180:181], v[68:69], v[68:69], v[180:181]
  v_pk_fma_f32 v[182:183], v[70:71], v[70:71], v[182:183]
  v_pk_fma_f32 v[184:185], v[72:73], v[72:73], v[184:185]
  v_pk_fma_f32 v[186:187], v[74:75], v[74:75], v[186:187]
  v_pk_fma_f32 v[188:189], v[76:77], v[76:77], v[188:189]
  v_pk_fma_f32 v[190:191], v[78:79], v[78:79], v[190:191]
  v_pk_add_f32 v[160:161], v[160:161], v[80:81]
  v_pk_fma_f32 v[176:177], v[80:81], v[80:81], v[176:177]
  v_pk_add_f32 v[162:163], v[162:163], v[82:83]
  v_pk_fma_f32 v[178:179], v[82:83], v[82:83], v[178:179]
  v_pk_add_f32 v[164:165], v[164:165], v[84:85]
  v_pk_fma_f32 v[180:181], v[84:85], v[84:85], v[180:181]
  v_pk_add_f32 v[166:167], v[166:167], v[86:87]
  v_pk_fma_f32 v[182:183], v[86:87], v[86:87], v[182:183]
  v_pk_add_f32 v[168:169], v[168:169], v[88:89]
  v_pk_fma_f32 v[184:185], v[88:89], v[88:89], v[184:185]
  v_pk_add_f32 v[170:171], v[170:171], v[90:91]
  v_pk_fma_f32 v[186:187], v[90:91], v[90:91], v[186:187]
  v_pk_add_f32 v[172:173], v[172:173], v[92:93]
  v_pk_fma_f32 v[188:189], v[92:93], v[92:93], v[188:189]
  v_pk_add_f32 v[174:175], v[174:175], v[94:95]
  v_pk_fma_f32 v[190:191], v[94:95], v[94:95], v[190:191]
  v_pk_add_f32 v[160:161], v[160:161], v[96:97]
  v_pk_fma_f32 v[176:177], v[96:97], v[96:97], v[176:177]
  v_pk_add_f32 v[162:163], v[162:163], v[98:99]
  v_pk_fma_f32 v[178:179], v[98:99], v[98:99], v[178:179]
  v_pk_add_f32 v[164:165], v[164:165], v[100:101]
  v_pk_fma_f32 v[180:181], v[100:101], v[100:101], v[180:181]
  v_pk_add_f32 v[166:167], v[166:167], v[102:103]
  v_pk_fma_f32 v[182:183], v[102:103], v[102:103], v[182:183]
  v_pk_add_f32 v[168:169], v[168:169], v[104:105]
  v_pk_fma_f32 v[184:185], v[104:105], v[104:105], v[184:185]
  v_pk_add_f32 v[170:171], v[170:171], v[106:107]
  v_pk_fma_f32 v[186:187], v[106:107], v[106:107], v[186:187]
  v_pk_add_f32 v[172:173], v[172:173], v[108:109]
  v_pk_fma_f32 v[188:189], v[108:109], v[108:109], v[188:189]
  v_pk_add_f32 v[174:175], v[174:175], v[110:111]
  v_pk_fma_f32 v[190:191], v[110:111], v[110:111], v[190:191]
  v_mfma_f32_32x32x16_bf16 v[112:127], a[132:135], a[152:155], v[112:127]
  ds_read_b128 a[184:187], v11 offset:40960
  v_mfma_f32_32x32x16_bf16 v[112:127], a[136:139], a[156:159], v[112:127]
  ds_read_b128 a[188:191], v11 offset:41984
  s_add_u32 m0, s17, 135168
  s_add_u32 s12, s11, 282624
  v_mfma_f32_32x32x16_bf16 v[112:127], a[140:143], a[160:163], v[112:127]
  buffer_load_dwordx4 v2, s[32:35], s12 offen  lds
  ds_read_b128 a[192:195], v11 offset:43008
  s_waitcnt lgkmcnt(4)
  v_mfma_f32_32x32x16_bf16 v[112:127], a[144:147], a[164:167], v[112:127]
  ds_read_b128 a[148:151], v11 offset:44032
  v_mfma_f32_32x32x16_bf16 v[32:47], a[168:171], a[0:3], 0
  ds_read_b128 a[152:155], v11 offset:45056
  s_add_u32 m0, s17, 139264
  s_add_u32 s12, s11, 286720
  v_mfma_f32_32x32x16_bf16 v[32:47], a[172:175], a[4:7], v[32:47]
  buffer_load_dwordx4 v2, s[32:35], s12 offen  lds
  ds_read_b128 a[156:159], v11 offset:46080
  v_mfma_f32_32x32x16_bf16 v[32:47], a[176:179], a[8:11], v[32:47]
  ds_read_b128 a[160:163], v11 offset:47104
  s_waitcnt lgkmcnt(4)
  v_mfma_f32_32x32x16_bf16 v[32:47], a[180:183], a[12:15], v[32:47]
  ds_read_b128 a[164:167], v11 offset:48128
  v_mul_f32 v192, v112, v112
  v_mul_f32 v193, v113, v113
  v_fma_f32 v192, v192, v144, v128
  v_mul_f32 v194, v114, v114
  v_fma_f32 v193, v193, v145, v129
  v_mul_f32 v192, v192, v112
  v_mul_f32 v195, v115, v115
  s_add_u32 m0, s17, 143360
  s_add_u32 s12, s11, 290816
  v_mfma_f32_32x32x16_bf16 v[32:47], a[184:187], a[16:19], v[32:47]
  buffer_load_dwordx4 v2, s[32:35], s12 offen  lds
  ds_read_b128 a[168:171], v11 offset:49152
  v_fma_f32 v194, v194, v146, v130
  v_exp_f32 v192, v192
  v_mul_f32 v193, v193, v113
  v_mfma_f32_32x32x16_bf16 v[32:47], a[188:191], a[20:23], v[32:47]
  ds_read_b128 a[172:175], v11 offset:50176
  v_mul_f32 v196, v116, v116
  v_fma_f32 v195, v195, v147, v131
  v_exp_f32 v193, v193
  v_mul_f32 v194, v194, v114
  v_add_f32 v192, 1.0, v192
  v_mfma_f32_32x32x16_bf16 v[32:47], a[192:195], a[24:27], v[32:47]
  ds_read_b128 a[176:179], v11 offset:51200
  v_mul_f32 v197, v117, v117
  v_fma_f32 v196, v196, v148, v132
  v_exp_f32 v194, v194
  v_mul_f32 v195, v195, v115
  v_add_f32 v193, 1.0, v193
  s_waitcnt lgkmcnt(4)
  s_add_u32 m0, s17, 0
  s_add_u32 s12, s11, 294912
  v_mfma_f32_32x32x16_bf16 v[32:47], a[148:151], a[28:31], v[32:47]
  buffer_load_dwordx4 v2, s[32:35], s12 offen  lds
  ds_read_b128 a[180:183], v11 offset:52224
  v_rcp_f32 v192, v192
  v_mul_f32 v198, v118, v118
  v_fma_f32 v197, v197, v149, v133
  v_mfma_f32_32x32x16_bf16 v[32:47], a[152:155], a[32:35], v[32:47]
  ds_read_b128 a[184:187], v11 offset:53248
  v_exp_f32 v195, v195
  v_mul_f32 v196, v196, v116
  v_add_f32 v194, 1.0, v194
  v_rcp_f32 v193, v193
  v_mfma_f32_32x32x16_bf16 v[32:47], a[156:159], a[36:39], v[32:47]
  ds_read_b128 a[188:191], v11 offset:54272
  v_mul_f32 v112, v112, v192
  v_mul_f32 v199, v119, v119
  v_fma_f32 v198, v198, v150, v134
  v_exp_f32 v196, v196
  v_mul_f32 v197, v197, v117
  s_add_u32 m0, s17, 4096
  s_add_u32 s12, s11, 299008
  v_mfma_f32_32x32x16_bf16 v[32:47], a[160:163], a[40:43], v[32:47]
  buffer_load_dwordx4 v2, s[32:35], s12 offen  lds
  ds_read_b128 a[192:195], v11 offset:55296
  v_add_f32 v195, 1.0, v195
  v_rcp_f32 v194, v194
  v_mul_f32 v113, v113, v193
  s_waitcnt lgkmcnt(4)
  v_mfma_f32_32x32x16_bf16 v[32:47], a[164:167], a[44:47], v[32:47]
  ds_read_b128 a[148:151], v11 offset:56320
  v_mul_f32 v192, v120, v120
  v_fma_f32 v199, v199, v151, v135
  v_exp_f32 v197, v197
  v_mul_f32 v198, v198, v118
  v_add_f32 v196, 1.0, v196
  v_mfma_f32_32x32x16_bf16 v[32:47], a[168:171], a[48:51], v[32:47]
  ds_read_b128 a[152:155], v11 offset:57344
  v_rcp_f32 v195, v195
  v_mul_f32 v114, v114, v194
  v_mul_f32 v193, v121, v121
  v_fma_f32 v192, v192, v152, v136
  s_add_u32 m0, s17, 8192
  s_add_u32 s12, s11, 303104
  v_mfma_f32_32x32x16_bf16 v[32:47], a[172:175], a[52:55], v[32:47]
  buffer_load_dwordx4 v2, s[32:35], s12 offen  lds
  ds_read_b128 a[156:159], v11 offset:58368
  v_exp_f32 v198, v198
  v_mul_f32 v199, v199, v119
  v_add_f32 v197, 1.0, v197
  v_mfma_f32_32x32x16_bf16 v[32:47], a[176:179], a[56:59], v[32:47]
  ds_read_b128 a[160:163], v11 offset:59392
  v_rcp_f32 v196, v196
  v_mul_f32 v115, v115, v195
  v_mul_f32 v194, v122, v122
  v_fma_f32 v193, v193, v153, v137
  v_exp_f32 v199, v199
  s_waitcnt lgkmcnt(4)
  v_mfma_f32_32x32x16_bf16 v[32:47], a[180:183], a[60:63], v[32:47]
  ds_read_b128 a[164:167], v11 offset:60416
  v_mul_f32 v192, v192, v120
  v_add_f32 v198, 1.0, v198
  v_rcp_f32 v197, v197
  v_mul_f32 v116, v116, v196
  v_mul_f32 v195, v123, v123
  s_add_u32 m0, s17, 12288
  s_add_u32 s12, s11, 307200
  v_mfma_f32_32x32x16_bf16 v[32:47], a[184:187], a[64:67], v[32:47]
  buffer_load_dwordx4 v2, s[32:35], s12 offen  lds
  ds_read_b128 a[168:171], v11 offset:61440
  v_fma_f32 v194, v194, v154, v138
  v_exp_f32 v192, v192
  v_mul_f32 v193, v193, v121
  v_mfma_f32_32x32x16_bf16 v[32:47], a[188:191], a[68:71], v[32:47]
  ds_read_b128 a[172:175], v11 offset:62464
  v_add_f32 v199, 1.0, v199
  v_rcp_f32 v198, v198
  v_mul_f32 v117, v117, v197
  v_mul_f32 v196, v124, v124
  v_fma_f32 v195, v195, v155, v139
  v_mfma_f32_32x32x16_bf16 v[32:47], a[192:195], a[72:75], v[32:47]
  ds_read_b128 a[176:179], v11 offset:63488
  v_exp_f32 v193, v193
  v_mul_f32 v194, v194, v122
  v_add_f32 v192, 1.0, v192
  v_rcp_f32 v199, v199
  s_waitcnt lgkmcnt(4)
  s_add_u32 m0, s17, 16384
  s_add_u32 s12, s11, 311296
  v_mfma_f32_32x32x16_bf16 v[32:47], a[148:151], a[76:79], v[32:47]
  buffer_load_dwordx4 v2, s[32:35], s12 offen  lds
  ds_read_b128 a[180:183], v11 offset:64512
  v_mul_f32 v118, v118, v198
  v_mul_f32 v197, v125, v125
  v_fma_f32 v196, v196, v156, v140
  v_mfma_f32_32x32x16_bf16 v[32:47], a[152:155], a[80:83], v[32:47]
  ds_read_b128 a[184:187], v12 offset:0
  v_exp_f32 v194, v194
  v_mul_f32 v195, v195, v123
  v_add_f32 v193, 1.0, v193
  v_rcp_f32 v192, v192
  v_mul_f32 v119, v119, v199
  v_mfma_f32_32x32x16_bf16 v[32:47], a[156:159], a[84:87], v[32:47]
  ds_read_b128 a[188:191], v12 offset:1024
  v_mul_f32 v198, v126, v126
  v_fma_f32 v197, v197, v157, v141
  v_exp_f32 v195, v195
  v_mul_f32 v196, v196, v124
  v_add_f32 v194, 1.0, v194
  s_add_u32 m0, s17, 20480
  s_add_u32 s12, s11, 315392
  v_mfma_f32_32x32x16_bf16 v[32:47], a[160:163], a[88:91], v[32:47]
  buffer_load_dwordx4 v2, s[32:35], s12 offen  lds
  ds_read_b128 a[192:195], v12 offset:2048
  v_rcp_f32 v193, v193
  v_mul_f32 v120, v120, v192
  v_mul_f32 v199, v127, v127
  s_waitcnt lgkmcnt(4)
  v_mfma_f32_32x32x16_bf16 v[32:47], a[164:167], a[92:95], v[32:47]
  ds_read_b128 a[148:151], v12 offset:3072
  v_fma_f32 v198, v198, v158, v142
  v_exp_f32 v196, v196
  v_mul_f32 v197, v197, v125
  v_add_f32 v195, 1.0, v195
  v_mfma_f32_32x32x16_bf16 v[32:47], a[168:171], a[96:99], v[32:47]
  ds_read_b128 a[152:155], v12 offset:4096
  v_rcp_f32 v194, v194
  v_mul_f32 v121, v121, v193
  v_fma_f32 v199, v199, v159, v143
  v_exp_f32 v197, v197
  v_mul_f32 v198, v198, v126
  v_mfma_f32_32x32x16_bf16 v[32:47], a[172:175], a[100:103], v[32:47]
  ds_read_b128 a[156:159], v12 offset:5120
  v_add_f32 v196, 1.0, v196
  v_rcp_f32 v195, v195
  v_mul_f32 v122, v122, v194
  v_exp_f32 v198, v198
  v_mfma_f32_32x32x16_bf16 v[32:47], a[176:179], a[104:107], v[32:47]
  ds_read_b128 a[160:163], v12 offset:6144
  v_mul_f32 v199, v199, v127
  v_add_f32 v197, 1.0, v197
  v_rcp_f32 v196, v196
  v_mul_f32 v123, v123, v195
  s_waitcnt lgkmcnt(4)
  v_mfma_f32_32x32x16_bf16 v[32:47], a[180:183], a[108:111], v[32:47]
  ds_read_b128 a[164:167], v12 offset:7168
  v_exp_f32 v199, v199
  v_add_f32 v198, 1.0, v198
  v_rcp_f32 v197, v197
  v_mul_f32 v124, v124, v196
  v_add_f32 v199, 1.0, v199
  v_mfma_f32_32x32x16_bf16 v[32:47], a[184:187], a[112:115], v[32:47]
  ds_read_b128 a[168:171], v3 offset:2560
  v_rcp_f32 v198, v198
  v_mul_f32 v125, v125, v197
  v_rcp_f32 v199, v199
  v_mul_f32 v126, v126, v198
  v_mfma_f32_32x32x16_bf16 v[32:47], a[188:191], a[116:119], v[32:47]
  s_waitcnt vmcnt(15)
  s_barrier
  ds_read_b128 a[172:175], v12 offset:8192
  v_mul_f32 v127, v127, v199
  s_nop 0
  v_pk_add_f32 v[160:161], v[160:161], v[112:113]
  v_pk_fma_f32 v[176:177], v[112:113], v[112:113], v[176:177]
  v_pk_add_f32 v[162:163], v[162:163], v[114:115]
  v_pk_fma_f32 v[178:179], v[114:115], v[114:115], v[178:179]
  v_pk_add_f32 v[164:165], v[164:165], v[116:117]
  v_pk_fma_f32 v[180:181], v[116:117], v[116:117], v[180:181]
  v_pk_add_f32 v[166:167], v[166:167], v[118:119]
  v_pk_fma_f32 v[182:183], v[118:119], v[118:119], v[182:183]
  v_pk_add_f32 v[168:169], v[168:169], v[120:121]
  v_pk_fma_f32 v[184:185], v[120:121], v[120:121], v[184:185]
  v_pk_add_f32 v[170:171], v[170:171], v[122:123]
  v_pk_fma_f32 v[186:187], v[122:123], v[122:123], v[186:187]
  v_pk_add_f32 v[172:173], v[172:173], v[124:125]
  v_pk_fma_f32 v[188:189], v[124:125], v[124:125], v[188:189]
  v_pk_add_f32 v[174:175], v[174:175], v[126:127]
  v_pk_fma_f32 v[190:191], v[126:127], v[126:127], v[190:191]
  v_permlane16_swap_b32 v160, v176
  v_permlane16_swap_b32 v161, v177
  v_permlane16_swap_b32 v162, v178
  v_permlane16_swap_b32 v163, v179
  v_permlane16_swap_b32 v164, v180
  v_mfma_f32_32x32x16_bf16 v[32:47], a[192:195], a[120:123], v[32:47]
  ds_read_b128 a[176:179], v12 offset:9216
  v_permlane16_swap_b32 v165, v181
  v_permlane16_swap_b32 v166, v182
  v_permlane16_swap_b32 v167, v183
  v_permlane16_swap_b32 v168, v184
  v_permlane16_swap_b32 v169, v185
  v_permlane16_swap_b32 v170, v186
  s_waitcnt lgkmcnt(4)
  s_add_u32 m0, s17, 24576
  s_add_u32 s12, s11, 319488
  v_mfma_f32_32x32x16_bf16 v[32:47], a[148:151], a[124:127], v[32:47]
  buffer_load_dwordx4 v2, s[32:35], s12 offen  lds
  ds_read_b128 a[180:183], v12 offset:10240
  v_permlane16_swap_b32 v171, v187
  v_permlane16_swap_b32 v172, v188
  v_permlane16_swap_b32 v173, v189
  v_permlane16_swap_b32 v174, v190
  v_mfma_f32_32x32x16_bf16 v[32:47], a[152:155], a[128:131], v[32:47]
  ds_read_b128 a[184:187], v12 offset:11264
  v_permlane16_swap_b32 v175, v191
  v_add_f32 v160, v160, v176
  v_add_f32 v161, v161, v177
  v_add_f32 v162, v162, v178
  v_add_f32 v163, v163, v179
  v_add_f32 v164, v164, v180
  v_mfma_f32_32x32x16_bf16 v[32:47], a[156:159], a[132:135], v[32:47]
  ds_read_b128 a[188:191], v12 offset:12288
  v_add_f32 v165, v165, v181
  v_add_f32 v166, v166, v182
  v_add_f32 v167, v167, v183
  v_add_f32 v168, v168, v184
  v_add_f32 v169, v169, v185
  v_add_f32 v170, v170, v186
  s_add_u32 m0, s17, 28672
  s_add_u32 s12, s11, 323584
  v_mfma_f32_32x32x16_bf16 v[32:47], a[160:163], a[136:139], v[32:47]
  buffer_load_dwordx4 v2, s[32:35], s12 offen  lds
  ds_read_b128 a[192:195], v12 offset:13312
  v_add_f32 v171, v171, v187
  v_add_f32 v172, v172, v188
  v_add_f32 v173, v173, v189
  v_add_f32 v174, v174, v190
  s_waitcnt lgkmcnt(4)
  v_mfma_f32_32x32x16_bf16 v[32:47], a[164:167], a[140:143], v[32:47]
  ds_read_b128 a[148:151], v12 offset:14336
  v_add_f32 v175, v175, v191
  v_add_f32_dpp v160, v160, v160 row_ror:8 row_mask:0xf bank_mask:0x3
  v_add_f32_dpp v161, v161, v161 row_ror:8 row_mask:0xf bank_mask:0x3
  v_add_f32_dpp v162, v162, v162 row_ror:8 row_mask:0xf bank_mask:0x3
  v_add_f32_dpp v163, v163, v163 row_ror:8 row_mask:0xf bank_mask:0x3
  v_add_f32_dpp v164, v164, v164 row_ror:8 row_mask:0xf bank_mask:0x3
  v_mfma_f32_32x32x16_bf16 v[32:47], a[168:171], a[144:147], v[32:47]
  ds_read_b128 a[152:155], v12 offset:15360
  v_add_f32_dpp v165, v165, v165 row_ror:8 row_mask:0xf bank_mask:0x3
  v_add_f32_dpp v166, v166, v166 row_ror:8 row_mask:0xf bank_mask:0x3
  v_add_f32_dpp v167, v167, v167 row_ror:8 row_mask:0xf bank_mask:0x3
  v_add_f32_dpp v160, v168, v168 row_ror:8 row_mask:0xf bank_mask:0xc
  v_add_f32_dpp v161, v169, v169 row_ror:8 row_mask:0xf bank_mask:0xc
  v_add_f32_dpp v162, v170, v170 row_ror:8 row_mask:0xf bank_mask:0xc
  s_add_u32 m0, s17, 32768
  s_add_u32 s12, s11, 327680
  v_mfma_f32_32x32x16_bf16 v[16:31], a[172:175], a[0:3], 0
  buffer_load_dwordx4 v2, s[32:35], s12 offen  lds
  ds_read_b128 a[156:159], v12 offset:16384
  v_add_f32_dpp v163, v171, v171 row_ror:8 row_mask:0xf bank_mask:0xc
  v_add_f32_dpp v164, v172, v172 row_ror:8 row_mask:0xf bank_mask:0xc
  v_add_f32_dpp v165, v173, v173 row_ror:8 row_mask:0xf bank_mask:0xc
  v_add_f32_dpp v166, v174, v174 row_ror:8 row_mask:0xf bank_mask:0xc
  v_mfma_f32_32x32x16_bf16 v[16:31], a[176:179], a[4:7], v[16:31]
  ds_read_b128 a[160:163], v12 offset:17408
  v_add_f32_dpp v167, v175, v175 row_ror:8 row_mask:0xf bank_mask:0xc
  v_add_f32_dpp v160, v160, v160 row_half_mirror row_mask:0xf bank_mask:0x5
  v_add_f32_dpp v161, v161, v161 row_half_mirror row_mask:0xf bank_mask:0x5
  v_add_f32_dpp v162, v162, v162 row_half_mirror row_mask:0xf bank_mask:0x5
  v_add_f32_dpp v163, v163, v163 row_half_mirror row_mask:0xf bank_mask:0x5
  v_add_f32_dpp v160, v164, v164 row_half_mirror row_mask:0xf bank_mask:0xa
  s_waitcnt lgkmcnt(4)
  v_mfma_f32_32x32x16_bf16 v[16:31], a[180:183], a[8:11], v[16:31]
  ds_read_b128 a[164:167], v12 offset:18432
  v_add_f32_dpp v161, v165, v165 row_half_mirror row_mask:0xf bank_mask:0xa
  v_add_f32_dpp v162, v166, v166 row_half_mirror row_mask:0xf bank_mask:0xa
  v_add_f32_dpp v163, v167, v167 row_half_mirror row_mask:0xf bank_mask:0xa
  v_add_f32_dpp v160, v160, v160 quad_perm:[1,0,3,2] row_mask:0xf bank_mask:0xf
  v_add_f32_dpp v161, v161, v161 quad_perm:[1,0,3,2] row_mask:0xf bank_mask:0xf
  v_add_f32_dpp v162, v162, v162 quad_perm:[1,0,3,2] row_mask:0xf bank_mask:0xf
  v_mfma_f32_32x32x16_bf16 v[16:31], a[184:187], a[12:15], v[16:31]
  ds_read_b128 a[168:171], v12 offset:19456
  v_add_f32_dpp v163, v163, v163 quad_perm:[1,0,3,2] row_mask:0xf bank_mask:0xf
  v_add_f32_dpp v160, v160, v160 quad_perm:[2,3,0,1] row_mask:0xf bank_mask:0xf
  v_add_f32_dpp v161, v161, v161 quad_perm:[2,3,0,1] row_mask:0xf bank_mask:0xf
  v_add_f32_dpp v162, v162, v162 quad_perm:[2,3,0,1] row_mask:0xf bank_mask:0xf
  v_add_f32_dpp v163, v163, v163 quad_perm:[2,3,0,1] row_mask:0xf bank_mask:0xf
  v_min_u32 v160, -2, v160
  v_mfma_f32_32x32x16_bf16 v[16:31], a[188:191], a[16:19], v[16:31]
  ds_read_b128 a[172:175], v12 offset:20480
  v_min_u32 v161, -2, v161
  v_min_u32 v162, -2, v162
  v_min_u32 v163, -2, v163
  v_mfma_f32_32x32x16_bf16 v[16:31], a[192:195], a[20:23], v[16:31]
  ds_read_b128 a[176:179], v12 offset:21504
  v_cvt_pk_bf16_f32 v204, v32, v33
  v_cvt_pk_bf16_f32 v205, v34, v35
  v_cvt_pk_bf16_f32 v206, v36, v37
  v_cvt_pk_bf16_f32 v207, v38, v39
  v_cvt_pk_bf16_f32 v208, v40, v41
  v_cvt_pk_bf16_f32 v209, v42, v43
  v_cvt_pk_bf16_f32 v210, v44, v45
  s_waitcnt lgkmcnt(4)
  v_mfma_f32_32x32x16_bf16 v[16:31], a[148:151], a[24:27], v[16:31]
  ds_read_b128 a[180:183], v12 offset:22528
  v_cvt_pk_bf16_f32 v211, v46, v47
  v_permlane16_swap_b32 v204, v206
  v_permlane16_swap_b32 v205, v207
  v_permlane16_swap_b32 v208, v210
  v_permlane16_swap_b32 v209, v211
  v_mfma_f32_32x32x16_bf16 v[16:31], a[152:155], a[28:31], v[16:31]
  ds_read_b128 a[184:187], v12 offset:23552
  buffer_store_dwordx4 v[160:163], v6, s[44:47], s42 offen sc1
  v_mfma_f32_32x32x16_bf16 v[16:31], a[156:159], a[32:35], v[16:31]
  ds_read_b128 a[188:191], v12 offset:24576
  v_mfma_f32_32x32x16_bf16 v[16:31], a[160:163], a[36:39], v[16:31]
  ds_read_b128 a[192:195], v12 offset:25600
  s_waitcnt lgkmcnt(4)
  v_mfma_f32_32x32x16_bf16 v[16:31], a[164:167], a[40:43], v[16:31]
  ds_read_b128 a[148:151], v12 offset:26624
  v_mfma_f32_32x32x16_bf16 v[16:31], a[168:171], a[44:47], v[16:31]
  ds_read_b128 a[152:155], v12 offset:27648
  v_mfma_f32_32x32x16_bf16 v[16:31], a[172:175], a[48:51], v[16:31]
  ds_read_b128 a[156:159], v12 offset:28672
  v_mfma_f32_32x32x16_bf16 v[16:31], a[176:179], a[52:55], v[16:31]
  ds_read_b128 a[160:163], v12 offset:29696
  s_waitcnt lgkmcnt(4)
  v_mfma_f32_32x32x16_bf16 v[16:31], a[180:183], a[56:59], v[16:31]
  ds_read_b128 a[164:167], v12 offset:30720
  v_mfma_f32_32x32x16_bf16 v[16:31], a[184:187], a[60:63], v[16:31]
  ds_read_b128 a[168:171], v12 offset:31744
  v_mfma_f32_32x32x16_bf16 v[16:31], a[188:191], a[64:67], v[16:31]
  ds_read_b128 a[172:175], v12 offset:32768
  v_mfma_f32_32x32x16_bf16 v[16:31], a[192:195], a[68:71], v[16:31]
  ds_read_b128 a[176:179], v12 offset:33792
  s_waitcnt lgkmcnt(4)
  v_mfma_f32_32x32x16_bf16 v[16:31], a[148:151], a[72:75], v[16:31]
  ds_read_b128 a[180:183], v12 offset:34816
  v_mfma_f32_32x32x16_bf16 v[16:31], a[152:155], a[76:79], v[16:31]
  ds_read_b128 a[184:187], v12 offset:35840
  v_mfma_f32_32x32x16_bf16 v[16:31], a[156:159], a[80:83], v[16:31]
  ds_read_b128 a[188:191], v12 offset:36864
  v_mfma_f32_32x32x16_bf16 v[16:31], a[160:163], a[84:87], v[16:31]
  ds_read_b128 a[192:195], v12 offset:37888
  s_waitcnt lgkmcnt(4)
  v_mfma_f32_32x32x16_bf16 v[16:31], a[164:167], a[88:91], v[16:31]
  ds_read_b128 a[148:151], v12 offset:38912
  v_mfma_f32_32x32x16_bf16 v[16:31], a[168:171], a[92:95], v[16:31]
  ds_read_b128 a[152:155], v12 offset:39936
  v_mfma_f32_32x32x16_bf16 v[16:31], a[172:175], a[96:99], v[16:31]
  ds_read_b128 a[156:159], v12 offset:40960
  v_mfma_f32_32x32x16_bf16 v[16:31], a[176:179], a[100:103], v[16:31]
  ds_read_b128 a[160:163], v12 offset:41984
  s_waitcnt lgkmcnt(4)
  v_mfma_f32_32x32x16_bf16 v[16:31], a[180:183], a[104:107], v[16:31]
  ds_read_b128 a[164:167], v12 offset:43008
  v_mfma_f32_32x32x16_bf16 v[16:31], a[184:187], a[108:111], v[16:31]
  ds_read_b128 a[168:171], v12 offset:44032
  v_mfma_f32_32x32x16_bf16 v[16:31], a[188:191], a[112:115], v[16:31]
  ds_read_b128 a[172:175], v3 offset:3072
  v_mfma_f32_32x32x16_bf16 v[16:31], a[192:195], a[116:119], v[16:31]
  s_waitcnt vmcnt(10)
  s_barrier
  ds_read_b128 a[176:179], v12 offset:45056
  s_waitcnt lgkmcnt(4)
  v_mfma_f32_32x32x16_bf16 v[16:31], a[148:151], a[120:123], v[16:31]
  ds_read_b128 a[180:183], v12 offset:46080
  v_mfma_f32_32x32x16_bf16 v[16:31], a[152:155], a[124:127], v[16:31]
  ds_read_b128 a[184:187], v12 offset:47104
  v_mfma_f32_32x32x16_bf16 v[16:31], a[156:159], a[128:131], v[16:31]
  ds_read_b128 a[188:191], v12 offset:48128
  buffer_load_dwordx4 v[176:179], v7, s[44:47], s43 offen sc1
  v_mfma_f32_32x32x16_bf16 v[16:31], a[160:163], a[132:135], v[16:31]
  ds_read_b128 a[192:195], v12 offset:49152
  buffer_load_dwordx4 v[180:183], v7, s[44:47], s48 offen sc1
  s_waitcnt lgkmcnt(4)
  v_mfma_f32_32x32x16_bf16 v[16:31], a[164:167], a[136:139], v[16:31]
  ds_read_b128 a[148:151], v12 offset:50176
  buffer_load_dwordx4 v[184:187], v7, s[44:47], s49 offen sc1
  v_mfma_f32_32x32x16_bf16 v[16:31], a[168:171], a[140:143], v[16:31]
  ds_read_b128 a[152:155], v12 offset:51200
  buffer_load_dwordx4 v[188:191], v7, s[44:47], s50 offen sc1
  v_mfma_f32_32x32x16_bf16 v[16:31], a[172:175], a[144:147], v[16:31]
  ds_read_b128 a[156:159], v12 offset:52224
  v_mfma_f32_32x32x16_bf16 v[32:47], a[176:179], a[0:3], 0
  ds_read_b128 a[160:163], v12 offset:53248
  s_waitcnt lgkmcnt(4)
  v_mfma_f32_32x32x16_bf16 v[32:47], a[180:183], a[4:7], v[32:47]
  ds_read_b128 a[164:167], v12 offset:54272
  v_mfma_f32_32x32x16_bf16 v[32:47], a[184:187], a[8:11], v[32:47]
  ds_read_b128 a[168:171], v12 offset:55296
  v_mfma_f32_32x32x16_bf16 v[32:47], a[188:191], a[12:15], v[32:47]
  ds_read_b128 a[172:175], v12 offset:56320
  v_mfma_f32_32x32x16_bf16 v[32:47], a[192:195], a[16:19], v[32:47]
  ds_read_b128 a[176:179], v12 offset:57344
  buffer_load_dwordx4 a[212:215], v2, s[36:39], s7 offen
  s_add_u32 s7, s7, 4096
  s_waitcnt lgkmcnt(4)
  v_mfma_f32_32x32x16_bf16 v[32:47], a[148:151], a[20:23], v[32:47]
  ds_read_b128 a[180:183], v12 offset:58368
  v_cvt_pk_bf16_f32 v212, v16, v17
  v_cvt_pk_bf16_f32 v213, v18, v19
  v_cvt_pk_bf16_f32 v214, v20, v21
  v_cvt_pk_bf16_f32 v215, v22, v23
  v_cvt_pk_bf16_f32 v216, v24, v25
  v_cvt_pk_bf16_f32 v217, v26, v27
  v_cvt_pk_bf16_f32 v218, v28, v29
  v_mfma_f32_32x32x16_bf16 v[32:47], a[152:155], a[24:27], v[32:47]
  ds_read_b128 a[184:187], v12 offset:59392
  v_cvt_pk_bf16_f32 v219, v30, v31
  v_permlane16_swap_b32 v212, v214
  v_permlane16_swap_b32 v213, v215
  v_permlane16_swap_b32 v216, v218
  v_permlane16_swap_b32 v217, v219
  v_mfma_f32_32x32x16_bf16 v[32:47], a[156:159], a[28:31], v[32:47]
  ds_read_b128 a[188:191], v12 offset:60416
  buffer_load_dwordx4 a[216:219], v2, s[36:39], s7 offen
  s_add_u32 s7, s7, 4096
  v_mfma_f32_32x32x16_bf16 v[32:47], a[160:163], a[32:35], v[32:47]
  ds_read_b128 a[192:195], v12 offset:61440
  s_waitcnt lgkmcnt(4)
  v_mfma_f32_32x32x16_bf16 v[32:47], a[164:167], a[36:39], v[32:47]
  ds_read_b128 a[148:151], v12 offset:62464
  v_mfma_f32_32x32x16_bf16 v[32:47], a[168:171], a[40:43], v[32:47]
  ds_read_b128 a[152:155], v12 offset:63488
  buffer_load_dwordx4 a[220:223], v2, s[36:39], s7 offen
  s_add_u32 s7, s7, 4096
  v_mfma_f32_32x32x16_bf16 v[32:47], a[172:175], a[44:47], v[32:47]
  ds_read_b128 a[156:159], v12 offset:64512
  v_mfma_f32_32x32x16_bf16 v[32:47], a[176:179], a[48:51], v[32:47]
  ds_read_b128 a[160:163], v13 offset:0
  s_waitcnt lgkmcnt(4)
  v_mfma_f32_32x32x16_bf16 v[32:47], a[180:183], a[52:55], v[32:47]
  ds_read_b128 a[164:167], v13 offset:1024
  buffer_load_dwordx4 a[224:227], v2, s[36:39], s7 offen
  s_add_u32 s7, s7, 4096
  v_mfma_f32_32x32x16_bf16 v[32:47], a[184:187], a[56:59], v[32:47]
  ds_read_b128 a[168:171], v13 offset:2048
  v_mfma_f32_32x32x16_bf16 v[32:47], a[188:191], a[60:63], v[32:47]
  ds_read_b128 a[172:175], v13 offset:3072
  s_waitcnt vmcnt(4)
  ds_read_b32 v165, v10
  v_max3_u32 v164, v176, v177, v178
  v_max3_u32 v164, v179, v180, v164
  v_max3_u32 v164, v181, v182, v164
  v_max3_u32 v164, v183, v184, v164
  v_max3_u32 v164, v185, v186, v164
  v_max3_u32 v164, v187, v188, v164
  v_mfma_f32_32x32x16_bf16 v[32:47], a[192:195], a[64:67], v[32:47]
  ds_read_b128 a[176:179], v13 offset:4096
  buffer_load_dwordx4 a[228:231], v2, s[36:39], s7 offen
  s_add_u32 s7, s7, 4096
  v_max3_u32 v164, v189, v190, v164
  v_max_u32 v164, v191, v164
  v_cmp_eq_u32 vcc, -1, v164
  s_nop 4
  s_cbranch_vccnz kt_tail_kernel_retrye
kt_tail_kernel_chke:
  v_add_f32 v176, v176, v184
  s_waitcnt lgkmcnt(5)
  v_mfma_f32_32x32x16_bf16 v[32:47], a[148:151], a[68:71], v[32:47]
  ds_read_b128 a[180:183], v13 offset:5120
  v_add_f32 v177, v177, v185
  v_add_f32 v178, v178, v186
  v_add_f32 v179, v179, v187
  v_add_f32 v180, v180, v188
  v_add_f32 v181, v181, v189
  v_add_f32 v182, v182, v190
  v_mfma_f32_32x32x16_bf16 v[32:47], a[152:155], a[72:75], v[32:47]
  ds_read_b128 a[184:187], v13 offset:6144
  v_add_f32 v183, v183, v191
  v_add_f32 v176, v176, v180
  v_add_f32 v177, v177, v181
  v_add_f32 v178, v178, v182
  v_add_f32 v179, v179, v183
  v_permlane16_swap_b32 v176, v177
  v_mfma_f32_32x32x16_bf16 v[32:47], a[156:159], a[76:79], v[32:47]
  ds_read_b128 a[188:191], v13 offset:7168
  buffer_load_dwordx4 a[232:235], v2, s[36:39], s7 offen
  s_add_u32 s7, s7, 4096
  v_permlane16_swap_b32 v178, v179
  v_add_f32 v176, v176, v177
  v_add_f32 v178, v178, v179
  s_nop 1
  v_permlane32_swap_b32 v176, v178
  v_mfma_f32_32x32x16_bf16 v[32:47], a[160:163], a[80:83], v[32:47]
  ds_read_b128 a[192:195], v13 offset:8192
  v_add_f32 v176, v176, v178
  v_mul_f32 v176, 0x39e38e39, v176
  v_mov_b32 v177, v176
  v_mov_b32 v178, v176
  s_nop 0
  v_mov_b32_dpp v177, v176 row_ror:8 row_mask:0xf bank_mask:0xc
  v_mov_b32_dpp v178, v176 row_ror:8 row_mask:0xf bank_mask:0x3
  s_waitcnt lgkmcnt(4)
  v_mfma_f32_32x32x16_bf16 v[32:47], a[164:167], a[84:87], v[32:47]
  ds_read_b128 a[148:151], v13 offset:9216
  v_fma_f32 v178, -v177, v177, v178
  v_max_f32 v178, 0, v178
  s_waitcnt lgkmcnt(6)
  v_add_f32 v178, v178, v165
  v_rsq_f32 v178, v178
  s_nop 0
  v_mul_f32 v177, -v177, v178
  v_mfma_f32_32x32x16_bf16 v[32:47], a[168:171], a[88:91], v[32:47]
  ds_read_b128 a[152:155], v13 offset:10240
  buffer_load_dwordx4 a[236:239], v2, s[36:39], s7 offen
  s_add_u32 s7, s7, 4096
  v_cndmask_b32 v178, v178, v177, s[52:53]
  v_mfma_f32_32x32x16_bf16 v[32:47], a[172:175], a[92:95], v[32:47]
  ds_read_b128 a[156:159], v13 offset:11264
  ds_write_b32 v9, v178
  s_waitcnt lgkmcnt(0)
  v_mfma_f32_32x32x16_bf16 v[32:47], a[176:179], a[96:99], v[32:47]
  ds_read_b128 a[160:163], v13 offset:12288
  ds_read_b128 v[128:131], v8 offset:0
  s_waitcnt lgkmcnt(6)
  v_mfma_f32_32x32x16_bf16 v[32:47], a[180:183], a[100:103], v[32:47]
  ds_read_b128 a[164:167], v13 offset:13312
  buffer_load_dwordx4 a[240:243], v2, s[36:39], s7 offen
  s_add_u32 s7, s7, 4096
  ds_read_b128 v[144:147], v8 offset:128
  v_mfma_f32_32x32x16_bf16 v[32:47], a[184:187], a[104:107], v[32:47]
  ds_read_b128 a[168:171], v13 offset:14336
  ds_read_b128 v[132:135], v8 offset:32
  v_mfma_f32_32x32x16_bf16 v[32:47], a[188:191], a[108:111], v[32:47]
  ds_read_b128 a[172:175], v13 offset:15360
  ds_read_b128 v[148:151], v8 offset:160
  v_mfma_f32_32x32x16_bf16 v[32:47], a[192:195], a[112:115], v[32:47]
  ds_read_b128 a[176:179], v3 offset:3584
  buffer_load_dwordx4 a[244:247], v2, s[36:39], s7 offen
  s_add_u32 s7, s7, 4096
  ds_read_b128 v[136:139], v8 offset:64
  s_waitcnt lgkmcnt(9)
  v_mfma_f32_32x32x16_bf16 v[32:47], a[148:151], a[116:119], v[32:47]
  s_barrier
  ds_read_b128 a[180:183], v11 offset:0
  ds_read_b128 v[152:155], v8 offset:192
  v_mfma_f32_32x32x16_bf16 v[32:47], a[152:155], a[120:123], v[32:47]
  ds_read_b128 a[184:187], v11 offset:1024
  ds_read_b128 v[140:143], v8 offset:96
  v_mfma_f32_32x32x16_bf16 v[32:47], a[156:159], a[124:127], v[32:47]
  ds_read_b128 a[188:191], v11 offset:2048
  buffer_load_dwordx4 a[248:251], v2, s[36:39], s7 offen
  s_add_u32 s7, s7, 4096
  ds_read_b128 v[156:159], v8 offset:224
  s_waitcnt lgkmcnt(0)
  v_fma_f32 v48, v48, v128, v144
  v_fma_f32 v49, v49, v129, v145
  v_fma_f32 v50, v50, v130, v146
  v_fma_f32 v51, v51, v131, v147
  v_mfma_f32_32x32x16_bf16 v[32:47], a[160:163], a[128:131], v[32:47]
  ds_read_b128 a[192:195], v11 offset:3072
  v_fma_f32 v52, v52, v132, v148
  v_fma_f32 v53, v53, v133, v149
  v_fma_f32 v54, v54, v134, v150
  v_fma_f32 v55, v55, v135, v151
  v_fma_f32 v56, v56, v136, v152
  v_fma_f32 v57, v57, v137, v153
  s_waitcnt lgkmcnt(8)
  v_mfma_f32_32x32x16_bf16 v[32:47], a[164:167], a[132:135], v[32:47]
  ds_read_b128 a[148:151], v11 offset:4096
  v_fma_f32 v58, v58, v138, v154
  v_fma_f32 v59, v59, v139, v155
  v_fma_f32 v60, v60, v140, v156
  v_fma_f32 v61, v61, v141, v157
  v_fma_f32 v62, v62, v142, v158
  v_fma_f32 v63, v63, v143, v159
  v_mfma_f32_32x32x16_bf16 v[32:47], a[168:171], a[136:139], v[32:47]
  ds_read_b128 a[152:155], v11 offset:5120
  buffer_load_dwordx4 a[252:255], v2, s[36:39], s7 offen
  s_add_u32 s7, s7, 4096
  v_cvt_pk_bf16_f32 v48, v48, v49
  v_cvt_pk_bf16_f32 v49, v50, v51
  v_cvt_pk_bf16_f32 v50, v52, v53
  v_cvt_pk_bf16_f32 v51, v54, v55
  v_mfma_f32_32x32x16_bf16 v[32:47], a[172:175], a[140:143], v[32:47]
  ds_read_b128 a[156:159], v11 offset:6144
  v_cvt_pk_bf16_f32 v52, v56, v57
  v_cvt_pk_bf16_f32 v53, v58, v59
  v_cvt_pk_bf16_f32 v54, v60, v61
  v_cvt_pk_bf16_f32 v55, v62, v63
  s_add_u32 s54, s51, 0
  v_permlane32_swap_b32 v48, v50
  v_permlane32_swap_b32 v49, v51
  v_mfma_f32_32x32x16_bf16 v[32:47], a[176:179], a[144:147], v[32:47]
  ds_read_b128 a[160:163], v11 offset:7168
  v_permlane32_swap_b32 v52, v54
  v_permlane32_swap_b32 v53, v55
  s_waitcnt lgkmcnt(4)
  v_mfma_f32_32x32x16_bf16 v[16:31], a[180:183], a[0:3], 0
  ds_read_b128 a[164:167], v11 offset:8192
  buffer_store_dwordx4 v[48:51], v4, s[56:59], s54 offen sc1
  v_mfma_f32_32x32x16_bf16 v[16:31], a[184:187], a[4:7], v[16:31]
  ds_read_b128 a[168:171], v11 offset:9216
  buffer_store_dwordx4 v[52:55], v4, s[56:59], s54 offen offset:512 sc1
  v_fma_f32 v64, v64, v128, v144
  v_fma_f32 v65, v65, v129, v145
  v_fma_f32 v66, v66, v130, v146
  v_fma_f32 v67, v67, v131, v147
  v_fma_f32 v68, v68, v132, v148
  v_mfma_f32_32x32x16_bf16 v[16:31], a[188:191], a[8:11], v[16:31]
  ds_read_b128 a[172:175], v11 offset:10240
  v_fma_f32 v69, v69, v133, v149
  v_fma_f32 v70, v70, v134, v150
  v_fma_f32 v71, v71, v135, v151
  v_fma_f32 v72, v72, v136, v152
  v_fma_f32 v73, v73, v137, v153
  v_fma_f32 v74, v74, v138, v154
  v_mfma_f32_32x32x16_bf16 v[16:31], a[192:195], a[12:15], v[16:31]
  ds_read_b128 a[176:179], v11 offset:11264
  v_fma_f32 v75, v75, v139, v155
  v_fma_f32 v76, v76, v140, v156
  v_fma_f32 v77, v77, v141, v157
  v_fma_f32 v78, v78, v142, v158
  v_fma_f32 v79, v79, v143, v159
  v_cvt_pk_bf16_f32 v64, v64, v65
  s_waitcnt lgkmcnt(4)
  v_mfma_f32_32x32x16_bf16 v[16:31], a[148:151], a[16:19], v[16:31]
  ds_read_b128 a[180:183], v11 offset:12288
  v_cvt_pk_bf16_f32 v65, v66, v67
  v_cvt_pk_bf16_f32 v66, v68, v69
  v_cvt_pk_bf16_f32 v67, v70, v71
  v_cvt_pk_bf16_f32 v68, v72, v73
  v_cvt_pk_bf16_f32 v69, v74, v75
  v_cvt_pk_bf16_f32 v70, v76, v77
  v_mfma_f32_32x32x16_bf16 v[16:31], a[152:155], a[20:23], v[16:31]
  ds_read_b128 a[184:187], v11 offset:13312
  v_cvt_pk_bf16_f32 v220, v32, v33
  v_cvt_pk_bf16_f32 v221, v34, v35
  v_cvt_pk_bf16_f32 v222, v36, v37
  v_cvt_pk_bf16_f32 v223, v38, v39
  v_cvt_pk_bf16_f32 v224, v40, v41
  v_cvt_pk_bf16_f32 v225, v42, v43
  v_mfma_f32_32x32x16_bf16 v[16:31], a[156:159], a[24:27], v[16:31]
  ds_read_b128 a[188:191], v11 offset:14336
  v_cvt_pk_bf16_f32 v226, v44, v45
  v_cvt_pk_bf16_f32 v227, v46, v47
  v_permlane16_swap_b32 v220, v222
  v_permlane16_swap_b32 v221, v223
  v_permlane16_swap_b32 v224, v226
  v_permlane16_swap_b32 v225, v227
  v_mfma_f32_32x32x16_bf16 v[16:31], a[160:163], a[28:31], v[16:31]
  ds_read_b128 a[192:195], v11 offset:15360
  v_cvt_pk_bf16_f32 v71, v78, v79
  s_add_u32 s54, s51, 2048
  v_permlane32_swap_b32 v64, v66
  v_permlane32_swap_b32 v65, v67
  v_permlane32_swap_b32 v68, v70
  v_permlane32_swap_b32 v69, v71
  s_waitcnt lgkmcnt(4)
  v_mfma_f32_32x32x16_bf16 v[16:31], a[164:167], a[32:35], v[16:31]
  ds_read_b128 a[148:151], v11 offset:16384
  buffer_store_dwordx4 v[64:67], v4, s[56:59], s54 offen sc1
  v_mfma_f32_32x32x16_bf16 v[16:31], a[168:171], a[36:39], v[16:31]
  ds_read_b128 a[152:155], v11 offset:17408
  buffer_store_dwordx4 v[68:71], v4, s[56:59], s54 offen offset:512 sc1
  v_fma_f32 v80, v80, v128, v144
  v_fma_f32 v81, v81, v129, v145
  v_fma_f32 v82, v82, v130, v146
  v_fma_f32 v83, v83, v131, v147
  v_fma_f32 v84, v84, v132, v148
  v_mfma_f32_32x32x16_bf16 v[16:31], a[172:175], a[40:43], v[16:31]
  ds_read_b128 a[156:159], v11 offset:18432
  v_fma_f32 v85, v85, v133, v149
  v_fma_f32 v86, v86, v134, v150
  v_fma_f32 v87, v87, v135, v151
  v_fma_f32 v88, v88, v136, v152
  v_fma_f32 v89, v89, v137, v153
  v_fma_f32 v90, v90, v138, v154
  v_mfma_f32_32x32x16_bf16 v[16:31], a[176:179], a[44:47], v[16:31]
  ds_read_b128 a[160:163], v11 offset:19456
  v_fma_f32 v91, v91, v139, v155
  v_fma_f32 v92, v92, v140, v156
  v_fma_f32 v93, v93, v141, v157
  v_fma_f32 v94, v94, v142, v158
  v_fma_f32 v95, v95, v143, v159
  v_cvt_pk_bf16_f32 v80, v80, v81
  s_waitcnt lgkmcnt(4)
  v_mfma_f32_32x32x16_bf16 v[16:31], a[180:183], a[48:51], v[16:31]
  ds_read_b128 a[164:167], v11 offset:20480
  v_cvt_pk_bf16_f32 v81, v82, v83
  v_cvt_pk_bf16_f32 v82, v84, v85
  v_cvt_pk_bf16_f32 v83, v86, v87
  v_cvt_pk_bf16_f32 v84, v88, v89
  v_cvt_pk_bf16_f32 v85, v90, v91
  v_cvt_pk_bf16_f32 v86, v92, v93
  v_mfma_f32_32x32x16_bf16 v[16:31], a[184:187], a[52:55], v[16:31]
  ds_read_b128 a[168:171], v11 offset:21504
  v_cvt_pk_bf16_f32 v87, v94, v95
  s_add_u32 s54, s51, 4096
  v_permlane32_swap_b32 v80, v82
  v_permlane32_swap_b32 v81, v83
  v_permlane32_swap_b32 v84, v86
  v_permlane32_swap_b32 v85, v87
  v_mfma_f32_32x32x16_bf16 v[16:31], a[188:191], a[56:59], v[16:31]
  ds_read_b128 a[172:175], v11 offset:22528
  buffer_store_dwordx4 v[80:83], v4, s[56:59], s54 offen sc1
  v_mfma_f32_32x32x16_bf16 v[16:31], a[192:195], a[60:63], v[16:31]
  ds_read_b128 a[176:179], v11 offset:23552
  buffer_store_dwordx4 v[84:87], v4, s[56:59], s54 offen offset:512 sc1
  v_fma_f32 v96, v96, v128, v144
  v_fma_f32 v97, v97, v129, v145
  v_fma_f32 v98, v98, v130, v146
  v_fma_f32 v99, v99, v131, v147
  v_fma_f32 v100, v100, v132, v148
  s_waitcnt lgkmcnt(4)
  v_mfma_f32_32x32x16_bf16 v[16:31], a[148:151], a[64:67], v[16:31]
  ds_read_b128 a[180:183], v11 offset:24576
  v_fma_f32 v101, v101, v133, v149
  v_fma_f32 v102, v102, v134, v150
  v_fma_f32 v103, v103, v135, v151
  v_fma_f32 v104, v104, v136, v152
  v_fma_f32 v105, v105, v137, v153
  v_fma_f32 v106, v106, v138, v154
  v_mfma_f32_32x32x16_bf16 v[16:31], a[152:155], a[68:71], v[16:31]
  ds_read_b128 a[184:187], v11 offset:25600
  v_fma_f32 v107, v107, v139, v155
  v_fma_f32 v108, v108, v140, v156
  v_fma_f32 v109, v109, v141, v157
  v_fma_f32 v110, v110, v142, v158
  v_fma_f32 v111, v111, v143, v159
  v_cvt_pk_bf16_f32 v96, v96, v97
  v_mfma_f32_32x32x16_bf16 v[16:31], a[156:159], a[72:75], v[16:31]
  ds_read_b128 a[188:191], v11 offset:26624
  v_cvt_pk_bf16_f32 v97, v98, v99
  v_cvt_pk_bf16_f32 v98, v100, v101
  v_cvt_pk_bf16_f32 v99, v102, v103
  v_cvt_pk_bf16_f32 v100, v104, v105
  v_cvt_pk_bf16_f32 v101, v106, v107
  v_cvt_pk_bf16_f32 v102, v108, v109
  v_mfma_f32_32x32x16_bf16 v[16:31], a[160:163], a[76:79], v[16:31]
  ds_read_b128 a[192:195], v11 offset:27648
  v_cvt_pk_bf16_f32 v103, v110, v111
  s_add_u32 s54, s51, 6144
  v_permlane32_swap_b32 v96, v98
  v_permlane32_swap_b32 v97, v99
  v_permlane32_swap_b32 v100, v102
  v_permlane32_swap_b32 v101, v103
  s_waitcnt lgkmcnt(4)
  v_mfma_f32_32x32x16_bf16 v[16:31], a[164:167], a[80:83], v[16:31]
  ds_read_b128 a[148:151], v11 offset:28672
  buffer_store_dwordx4 v[96:99], v4, s[56:59], s54 offen sc1
  v_mfma_f32_32x32x16_bf16 v[16:31], a[168:171], a[84:87], v[16:31]
  ds_read_b128 a[152:155], v11 offset:29696
  buffer_store_dwordx4 v[100:103], v4, s[56:59], s54 offen offset:512 sc1
  v_fma_f32 v112, v112, v128, v144
  v_fma_f32 v113, v113, v129, v145
  v_fma_f32 v114, v114, v130, v146
  v_fma_f32 v115, v115, v131, v147
  v_fma_f32 v116, v116, v132, v148
  v_mfma_f32_32x32x16_bf16 v[16:31], a[172:175], a[88:91], v[16:31]
  ds_read_b128 a[156:159], v11 offset:30720
  v_fma_f32 v117, v117, v133, v149
  v_fma_f32 v118, v118, v134, v150
  v_fma_f32 v119, v119, v135, v151
  v_fma_f32 v120, v120, v136, v152
  v_fma_f32 v121, v121, v137, v153
  v_fma_f32 v122, v122, v138, v154
  v_mfma_f32_32x32x16_bf16 v[16:31], a[176:179], a[92:95], v[16:31]
  ds_read_b128 a[160:163], v11 offset:31744
  v_fma_f32 v123, v123, v139, v155
  v_fma_f32 v124, v124, v140, v156
  v_fma_f32 v125, v125, v141, v157
  v_fma_f32 v126, v126, v142, v158
  v_fma_f32 v127, v127, v143, v159
  v_cvt_pk_bf16_f32 v112, v112, v113
  s_waitcnt lgkmcnt(4)
  v_mfma_f32_32x32x16_bf16 v[16:31], a[180:183], a[96:99], v[16:31]
  ds_read_b128 a[164:167], v11 offset:32768
  v_cvt_pk_bf16_f32 v113, v114, v115
  v_cvt_pk_bf16_f32 v114, v116, v117
  v_cvt_pk_bf16_f32 v115, v118, v119
  v_cvt_pk_bf16_f32 v116, v120, v121
  v_cvt_pk_bf16_f32 v117, v122, v123
  v_cvt_pk_bf16_f32 v118, v124, v125
  v_mfma_f32_32x32x16_bf16 v[16:31], a[184:187], a[100:103], v[16:31]
  ds_read_b128 a[168:171], v11 offset:33792
  v_cvt_pk_bf16_f32 v119, v126, v127
  s_add_u32 s54, s51, 8192
  v_permlane32_swap_b32 v112, v114
  v_permlane32_swap_b32 v113, v115
  v_permlane32_swap_b32 v116, v118
  v_permlane32_swap_b32 v117, v119
  v_mfma_f32_32x32x16_bf16 v[16:31], a[188:191], a[104:107], v[16:31]
  ds_read_b128 a[172:175], v11 offset:34816
  buffer_store_dwordx4 v[112:115], v5, s[56:59], s54 offen sc1
  v_mfma_f32_32x32x16_bf16 v[16:31], a[192:195], a[108:111], v[16:31]
  ds_read_b128 a[176:179], v11 offset:35840
  buffer_store_dwordx4 v[116:119], v5, s[56:59], s54 offen offset:512 sc1
  s_waitcnt lgkmcnt(4)
  v_mfma_f32_32x32x16_bf16 v[16:31], a[148:151], a[112:115], v[16:31]
  ds_read_b128 a[180:183], v3 offset:4096
  v_mfma_f32_32x32x16_bf16 v[16:31], a[152:155], a[116:119], v[16:31]
  v_mfma_f32_32x32x16_bf16 v[16:31], a[156:159], a[120:123], v[16:31]
  v_mfma_f32_32x32x16_bf16 v[16:31], a[160:163], a[124:127], v[16:31]
  s_waitcnt lgkmcnt(1)
  v_mfma_f32_32x32x16_bf16 v[16:31], a[164:167], a[128:131], v[16:31]
  v_mfma_f32_32x32x16_bf16 v[16:31], a[168:171], a[132:135], v[16:31]
  v_mfma_f32_32x32x16_bf16 v[16:31], a[172:175], a[136:139], v[16:31]
  v_mfma_f32_32x32x16_bf16 v[16:31], a[176:179], a[140:143], v[16:31]
  s_waitcnt lgkmcnt(0)
  v_mfma_f32_32x32x16_bf16 v[16:31], a[180:183], a[144:147], v[16:31]
  s_nop 11
  v_cvt_pk_bf16_f32 v228, v16, v17
  v_cvt_pk_bf16_f32 v229, v18, v19
  v_cvt_pk_bf16_f32 v230, v20, v21
  v_cvt_pk_bf16_f32 v231, v22, v23
  v_cvt_pk_bf16_f32 v232, v24, v25
  v_cvt_pk_bf16_f32 v233, v26, v27
  v_cvt_pk_bf16_f32 v234, v28, v29
  v_cvt_pk_bf16_f32 v235, v30, v31
  v_permlane16_swap_b32 v228, v230
  v_permlane16_swap_b32 v229, v231
  v_permlane16_swap_b32 v232, v234
  v_permlane16_swap_b32 v233, v235
  s_mov_b32 s28, s66
  s_and_b32 s29, s67, 0xffff
  s_mov_b32 s30, 8388608
  s_mov_b32 s31, 0x20000
  v_lshrrev_b32 v248, 3, v1
  v_and_b32 v249, 6, v248
  v_and_b32 v250, 7, v1
  v_xor_b32 v249, v249, v250
  v_lshlrev_b32 v249, 4, v249
  v_lshl_add_u32 v252, v248, 12, v249
  v_add_u32 v253, 32768, v252
  v_add_u32 v254, 65536, v252
  v_add_u32 v255, 98304, v252
  s_lshl_b32 s11, s78, 17
  s_lshl_b32 s13, s3, 12
  s_add_u32 s13, s13, 73728
  s_lshl_b32 s18, s79, 12
  s_add_u32 s19, s18, 131072
  s_and_b32 s12, s77, 1
  s_lshl_b32 s12, s12, 4
  s_add_u32 s12, s12, s76
  s_lshr_b32 s18, s12, 0
  s_lshl_b32 s18, s18, 7
  s_add_u32 s18, s18, s19
  s_and_b32 s12, s12, 0
  s_lshl_b32 s12, s12, 2
  s_add_u32 s18, s18, s12
  s_barrier
  s_add_u32 m0, s13, 0
  s_nop 0
  buffer_load_dwordx4 v252, s[28:31], s11 offen  lds
  s_add_u32 m0, s13, 1024
  s_nop 0
  buffer_load_dwordx4 v253, s[28:31], s11 offen  lds
  s_add_u32 m0, s13, 2048
  s_nop 0
  buffer_load_dwordx4 v254, s[28:31], s11 offen  lds
  s_add_u32 m0, s13, 3072
  s_nop 0
  buffer_load_dwordx4 v255, s[28:31], s11 offen  lds
  s_add_u32 m0, s13, 16384
  s_add_u32 s11, s11, 128
  buffer_load_dwordx4 v252, s[28:31], s11 offen  lds
  s_add_u32 m0, s13, 17408
  s_nop 0
  buffer_load_dwordx4 v253, s[28:31], s11 offen  lds
  s_add_u32 m0, s13, 18432
  s_nop 0
  buffer_load_dwordx4 v254, s[28:31], s11 offen  lds
  s_add_u32 m0, s13, 19456
  s_nop 0
  buffer_load_dwordx4 v255, s[28:31], s11 offen  lds
  v_and_b32 v192, 15, v1
  v_lshl_add_u32 v192, v192, 2, s40
  ds_read_b32 v14, v192 offset:384
  ds_read_b32 v15, v192 offset:448
  s_waitcnt lgkmcnt(0)
  v_mul_f32 v6, 0xc0135761, v14
  v_mul_f32 v10, v14, v14
  v_rcp_f32 v194, v14
  v_mul_f32 v10, 0x3d372713, v10
  v_mul_f32 v10, v10, v6
  v_mul_f32 v8, 0xc0135761, v15
  v_mul_f32 v12, v15, v15
  v_rcp_f32 v196, v15
  v_mul_f32 v12, 0x3d372713, v12
  v_mul_f32 v12, v12, v8
  v_lshlrev_b32 v88, 16, v204
  v_and_b32 v89, 0xffff0000, v204
  v_lshlrev_b32 v90, 16, v205
  v_and_b32 v91, 0xffff0000, v205
  v_lshlrev_b32 v92, 16, v208
  v_and_b32 v93, 0xffff0000, v208
  v_lshlrev_b32 v94, 16, v209
  v_and_b32 v95, 0xffff0000, v209
  v_pk_mul_f32 v[160:161], v[88:89], v[88:89]
  v_pk_mul_f32 v[162:163], v[90:91], v[90:91]
  v_pk_mul_f32 v[164:165], v[92:93], v[92:93]
  v_pk_mul_f32 v[166:167], v[94:95], v[94:95]
  v_pk_fma_f32 v[160:161], v[160:161], v[10:11], v[6:7] op_sel_hi:[1,0,0]
  v_pk_fma_f32 v[162:163], v[162:163], v[10:11], v[6:7] op_sel_hi:[1,0,0]
  v_pk_fma_f32 v[164:165], v[164:165], v[10:11], v[6:7] op_sel_hi:[1,0,0]
  v_pk_fma_f32 v[166:167], v[166:167], v[10:11], v[6:7] op_sel_hi:[1,0,0]
  v_pk_mul_f32 v[160:161], v[160:161], v[88:89]
  v_pk_mul_f32 v[162:163], v[162:163], v[90:91]
  v_pk_mul_f32 v[164:165], v[164:165], v[92:93]
  v_pk_mul_f32 v[166:167], v[166:167], v[94:95]
  v_exp_f32 v160, v160
  v_exp_f32 v161, v161
  v_exp_f32 v162, v162
  v_exp_f32 v163, v163
  v_exp_f32 v164, v164
  v_exp_f32 v165, v165
  v_exp_f32 v166, v166
  v_exp_f32 v167, v167
  v_pk_fma_f32 v[160:161], v[160:161], v[194:195], v[194:195] op_sel_hi:[1,0,0]
  v_pk_fma_f32 v[162:163], v[162:163], v[194:195], v[194:195] op_sel_hi:[1,0,0]
  v_pk_fma_f32 v[164:165], v[164:165], v[194:195], v[194:195] op_sel_hi:[1,0,0]
  v_pk_fma_f32 v[166:167], v[166:167], v[194:195], v[194:195] op_sel_hi:[1,0,0]
  v_rcp_f32 v160, v160
  v_rcp_f32 v161, v161
  v_rcp_f32 v162, v162
  v_rcp_f32 v163, v163
  v_rcp_f32 v164, v164
  v_rcp_f32 v165, v165
  v_rcp_f32 v166, v166
  v_rcp_f32 v167, v167
  v_pk_mul_f32 v[88:89], v[88:89], v[160:161]
  v_pk_mul_f32 v[90:91], v[90:91], v[162:163]
  v_pk_mul_f32 v[92:93], v[92:93], v[164:165]
  v_pk_mul_f32 v[94:95], v[94:95], v[166:167]
  v_lshlrev_b32 v96, 16, v212
  v_and_b32 v97, 0xffff0000, v212
  v_lshlrev_b32 v98, 16, v213
  v_and_b32 v99, 0xffff0000, v213
  v_lshlrev_b32 v100, 16, v216
  v_and_b32 v101, 0xffff0000, v216
  v_lshlrev_b32 v102, 16, v217
  v_and_b32 v103, 0xffff0000, v217
  v_pk_mul_f32 v[168:169], v[96:97], v[96:97]
  v_pk_mul_f32 v[170:171], v[98:99], v[98:99]
  v_pk_mul_f32 v[172:173], v[100:101], v[100:101]
  v_pk_mul_f32 v[174:175], v[102:103], v[102:103]
  v_pk_fma_f32 v[168:169], v[168:169], v[10:11], v[6:7] op_sel_hi:[1,0,0]
  v_pk_fma_f32 v[170:171], v[170:171], v[10:11], v[6:7] op_sel_hi:[1,0,0]
  v_pk_fma_f32 v[172:173], v[172:173], v[10:11], v[6:7] op_sel_hi:[1,0,0]
  v_pk_fma_f32 v[174:175], v[174:175], v[10:11], v[6:7] op_sel_hi:[1,0,0]
  v_pk_mul_f32 v[168:169], v[168:169], v[96:97]
  v_pk_mul_f32 v[170:171], v[170:171], v[98:99]
  v_pk_mul_f32 v[172:173], v[172:173], v[100:101]
  v_pk_mul_f32 v[174:175], v[174:175], v[102:103]
  v_exp_f32 v168, v168
  v_exp_f32 v169, v169
  v_exp_f32 v170, v170
  v_exp_f32 v171, v171
  v_exp_f32 v172, v172
  v_exp_f32 v173, v173
  v_exp_f32 v174, v174
  v_exp_f32 v175, v175
  v_pk_fma_f32 v[168:169], v[168:169], v[194:195], v[194:195] op_sel_hi:[1,0,0]
  v_pk_fma_f32 v[170:171], v[170:171], v[194:195], v[194:195] op_sel_hi:[1,0,0]
  v_pk_fma_f32 v[172:173], v[172:173], v[194:195], v[194:195] op_sel_hi:[1,0,0]
  v_pk_fma_f32 v[174:175], v[174:175], v[194:195], v[194:195] op_sel_hi:[1,0,0]
  v_rcp_f32 v168, v168
  v_rcp_f32 v169, v169
  v_rcp_f32 v170, v170
  v_rcp_f32 v171, v171
  v_rcp_f32 v172, v172
  v_rcp_f32 v173, v173
  v_rcp_f32 v174, v174
  v_rcp_f32 v175, v175
  v_pk_mul_f32 v[96:97], v[96:97], v[168:169]
  v_pk_mul_f32 v[98:99], v[98:99], v[170:171]
  v_pk_mul_f32 v[100:101], v[100:101], v[172:173]
  v_pk_mul_f32 v[102:103], v[102:103], v[174:175]
  v_lshlrev_b32 v104, 16, v220
  v_and_b32 v105, 0xffff0000, v220
  v_lshlrev_b32 v106, 16, v221
  v_and_b32 v107, 0xffff0000, v221
  v_lshlrev_b32 v108, 16, v224
  v_and_b32 v109, 0xffff0000, v224
  v_lshlrev_b32 v110, 16, v225
  v_and_b32 v111, 0xffff0000, v225
  v_pk_mul_f32 v[160:161], v[104:105], v[104:105]
  v_pk_mul_f32 v[162:163], v[106:107], v[106:107]
  v_pk_mul_f32 v[164:165], v[108:109], v[108:109]
  v_pk_mul_f32 v[166:167], v[110:111], v[110:111]
  v_pk_fma_f32 v[160:161], v[160:161], v[10:11], v[6:7] op_sel_hi:[1,0,0]
  v_pk_fma_f32 v[162:163], v[162:163], v[10:11], v[6:7] op_sel_hi:[1,0,0]
  v_pk_fma_f32 v[164:165], v[164:165], v[10:11], v[6:7] op_sel_hi:[1,0,0]
  v_pk_fma_f32 v[166:167], v[166:167], v[10:11], v[6:7] op_sel_hi:[1,0,0]
  v_pk_mul_f32 v[160:161], v[160:161], v[104:105]
  v_pk_mul_f32 v[162:163], v[162:163], v[106:107]
  v_pk_mul_f32 v[164:165], v[164:165], v[108:109]
  v_pk_mul_f32 v[166:167], v[166:167], v[110:111]
  v_exp_f32 v160, v160
  v_exp_f32 v161, v161
  v_exp_f32 v162, v162
  v_exp_f32 v163, v163
  v_exp_f32 v164, v164
  v_exp_f32 v165, v165
  v_exp_f32 v166, v166
  s_waitcnt vmcnt(8)
  s_barrier
  s_cmp_lg_u32 s3, 0
  s_cbranch_scc1 kt_tail_kernel_pf3
  v_mov_b32 v248, 0
  v_mov_b32 v249, 1
  s_mov_b64 exec, 1
  buffer_store_dword v249, v248, s[72:75], s18 offen sc1
  s_mov_b64 exec, -1
kt_tail_kernel_pf3:
  s_mov_b32 s44, s70
  s_and_b32 s45, s71, 0xffff
  s_mov_b32 s46, 4096
  s_mov_b32 s47, 0x20000
  s_lshl_b32 s22, s78, 6
  v_and_b32 v248, 15, v1
  v_lshlrev_b32 v248, 1, v248
  buffer_load_ushort v249, v248, s[44:47], s22 offen
  buffer_load_ushort v250, v248, s[44:47], s22 offen offset:32
  s_add_u32 m0, s13, 32768
  s_add_u32 s11, s11, 128
  buffer_load_dwordx4 v252, s[28:31], s11 offen  lds
  s_add_u32 m0, s13, 33792
  s_nop 0
  buffer_load_dwordx4 v253, s[28:31], s11 offen  lds
  s_add_u32 m0, s13, 34816
  s_nop 0
  buffer_load_dwordx4 v254, s[28:31], s11 offen  lds
  s_add_u32 m0, s13, 35840
  s_nop 0
  buffer_load_dwordx4 v255, s[28:31], s11 offen  lds
  s_add_u32 m0, s13, 49152
  s_add_u32 s11, s11, 128
  buffer_load_dwordx4 v252, s[28:31], s11 offen  lds
  s_add_u32 m0, s13, 50176
  s_nop 0
  buffer_load_dwordx4 v253, s[28:31], s11 offen  lds
  s_add_u32 m0, s13, 51200
  s_nop 0
  buffer_load_dwordx4 v254, s[28:31], s11 offen  lds
  s_add_u32 m0, s13, 52224
  s_nop 0
  buffer_load_dwordx4 v255, s[28:31], s11 offen  lds
  buffer_load_dwordx4 a[0:3], v2, s[36:39], s7 offen
  s_add_u32 s7, s7, 4096
  v_exp_f32 v167, v167
  v_pk_fma_f32 v[160:161], v[160:161], v[194:195], v[194:195] op_sel_hi:[1,0,0]
  v_pk_fma_f32 v[162:163], v[162:163], v[194:195], v[194:195] op_sel_hi:[1,0,0]
  v_pk_fma_f32 v[164:165], v[164:165], v[194:195], v[194:195] op_sel_hi:[1,0,0]
  v_pk_fma_f32 v[166:167], v[166:167], v[194:195], v[194:195] op_sel_hi:[1,0,0]
  v_rcp_f32 v160, v160
  v_rcp_f32 v161, v161
  v_rcp_f32 v162, v162
  v_rcp_f32 v163, v163
  v_rcp_f32 v164, v164
  v_rcp_f32 v165, v165
  v_rcp_f32 v166, v166
  v_rcp_f32 v167, v167
  v_pk_mul_f32 v[104:105], v[104:105], v[160:161]
  v_pk_mul_f32 v[106:107], v[106:107], v[162:163]
  v_pk_mul_f32 v[108:109], v[108:109], v[164:165]
  v_pk_mul_f32 v[110:111], v[110:111], v[166:167]
  v_lshlrev_b32 v112, 16, v228
  v_and_b32 v113, 0xffff0000, v228
  v_lshlrev_b32 v114, 16, v229
  buffer_load_dwordx4 a[4:7], v2, s[36:39], s7 offen
  s_add_u32 s7, s7, 4096
  v_and_b32 v115, 0xffff0000, v229
  v_lshlrev_b32 v116, 16, v232
  v_and_b32 v117, 0xffff0000, v232
  v_lshlrev_b32 v118, 16, v233
  v_and_b32 v119, 0xffff0000, v233
  v_pk_mul_f32 v[168:169], v[112:113], v[112:113]
  v_pk_mul_f32 v[170:171], v[114:115], v[114:115]
  v_pk_mul_f32 v[172:173], v[116:117], v[116:117]
  v_pk_mul_f32 v[174:175], v[118:119], v[118:119]
  v_pk_fma_f32 v[168:169], v[168:169], v[10:11], v[6:7] op_sel_hi:[1,0,0]
  v_pk_fma_f32 v[170:171], v[170:171], v[10:11], v[6:7] op_sel_hi:[1,0,0]
  v_pk_fma_f32 v[172:173], v[172:173], v[10:11], v[6:7] op_sel_hi:[1,0,0]
  v_pk_fma_f32 v[174:175], v[174:175], v[10:11], v[6:7] op_sel_hi:[1,0,0]
  v_pk_mul_f32 v[168:169], v[168:169], v[112:113]
  v_pk_mul_f32 v[170:171], v[170:171], v[114:115]
  v_pk_mul_f32 v[172:173], v[172:173], v[116:117]
  v_pk_mul_f32 v[174:175], v[174:175], v[118:119]
  v_exp_f32 v168, v168
  v_exp_f32 v169, v169
  v_exp_f32 v170, v170
  buffer_load_dwordx4 a[8:11], v2, s[36:39], s7 offen
  s_add_u32 s7, s7, 4096
  v_exp_f32 v171, v171
  v_exp_f32 v172, v172
  v_exp_f32 v173, v173
  v_exp_f32 v174, v174
  v_exp_f32 v175, v175
  v_pk_fma_f32 v[168:169], v[168:169], v[194:195], v[194:195] op_sel_hi:[1,0,0]
  v_pk_fma_f32 v[170:171], v[170:171], v[194:195], v[194:195] op_sel_hi:[1,0,0]
  v_pk_fma_f32 v[172:173], v[172:173], v[194:195], v[194:195] op_sel_hi:[1,0,0]
  v_pk_fma_f32 v[174:175], v[174:175], v[194:195], v[194:195] op_sel_hi:[1,0,0]
  v_rcp_f32 v168, v168
  v_rcp_f32 v169, v169
  v_rcp_f32 v170, v170
  v_rcp_f32 v171, v171
  v_rcp_f32 v172, v172
  v_rcp_f32 v173, v173
  v_rcp_f32 v174, v174
  v_rcp_f32 v175, v175
  v_pk_mul_f32 v[112:113], v[112:113], v[168:169]
  v_pk_mul_f32 v[114:115], v[114:115], v[170:171]
  v_pk_mul_f32 v[116:117], v[116:117], v[172:173]
  buffer_load_dwordx4 a[12:15], v2, s[36:39], s7 offen
  s_add_u32 s7, s7, 4096
  v_pk_mul_f32 v[118:119], v[118:119], v[174:175]
  v_lshlrev_b32 v124, 16, v206
  v_and_b32 v125, 0xffff0000, v206
  v_lshlrev_b32 v126, 16, v207
  v_and_b32 v127, 0xffff0000, v207
  v_lshlrev_b32 v128, 16, v210
  v_and_b32 v129, 0xffff0000, v210
  v_lshlrev_b32 v130, 16, v211
  v_and_b32 v131, 0xffff0000, v211
  v_pk_mul_f32 v[160:161], v[124:125], v[124:125]
  v_pk_mul_f32 v[162:163], v[126:127], v[126:127]
  v_pk_mul_f32 v[164:165], v[128:129], v[128:129]
  v_pk_mul_f32 v[166:167], v[130:131], v[130:131]
  v_pk_fma_f32 v[160:161], v[160:161], v[12:13], v[8:9] op_sel_hi:[1,0,0]
  v_pk_fma_f32 v[162:163], v[162:163], v[12:13], v[8:9] op_sel_hi:[1,0,0]
  v_pk_fma_f32 v[164:165], v[164:165], v[12:13], v[8:9] op_sel_hi:[1,0,0]
  v_pk_fma_f32 v[166:167], v[166:167], v[12:13], v[8:9] op_sel_hi:[1,0,0]
  v_pk_mul_f32 v[160:161], v[160:161], v[124:125]
  v_pk_mul_f32 v[162:163], v[162:163], v[126:127]
  v_pk_mul_f32 v[164:165], v[164:165], v[128:129]
  v_pk_mul_f32 v[166:167], v[166:167], v[130:131]
  buffer_load_dwordx4 a[16:19], v2, s[36:39], s7 offen
  s_add_u32 s7, s7, 4096
  v_exp_f32 v160, v160
  v_exp_f32 v161, v161
  v_exp_f32 v162, v162
  v_exp_f32 v163, v163
  v_exp_f32 v164, v164
  v_exp_f32 v165, v165
  v_exp_f32 v166, v166
  v_exp_f32 v167, v167
  v_pk_fma_f32 v[160:161], v[160:161], v[196:197], v[196:197] op_sel_hi:[1,0,0]
  v_pk_fma_f32 v[162:163], v[162:163], v[196:197], v[196:197] op_sel_hi:[1,0,0]
  v_pk_fma_f32 v[164:165], v[164:165], v[196:197], v[196:197] op_sel_hi:[1,0,0]
  v_pk_fma_f32 v[166:167], v[166:167], v[196:197], v[196:197] op_sel_hi:[1,0,0]
  v_rcp_f32 v160, v160
  v_rcp_f32 v161, v161
  v_rcp_f32 v162, v162
  v_rcp_f32 v163, v163
  v_rcp_f32 v164, v164
  v_rcp_f32 v165, v165
  v_rcp_f32 v166, v166
  v_rcp_f32 v167, v167
  buffer_load_dwordx4 a[20:23], v2, s[36:39], s7 offen
  s_add_u32 s7, s7, 4096
  v_pk_mul_f32 v[124:125], v[124:125], v[160:161]
  v_pk_mul_f32 v[126:127], v[126:127], v[162:163]
  v_pk_mul_f32 v[128:129], v[128:129], v[164:165]
  v_pk_mul_f32 v[130:131], v[130:131], v[166:167]
  v_lshlrev_b32 v132, 16, v214
  v_and_b32 v133, 0xffff0000, v214
  v_lshlrev_b32 v134, 16, v215
  v_and_b32 v135, 0xffff0000, v215
  v_lshlrev_b32 v136, 16, v218
  v_and_b32 v137, 0xffff0000, v218
  v_lshlrev_b32 v138, 16, v219
  v_and_b32 v139, 0xffff0000, v219
  v_pk_mul_f32 v[168:169], v[132:133], v[132:133]
  v_pk_mul_f32 v[170:171], v[134:135], v[134:135]
  v_pk_mul_f32 v[172:173], v[136:137], v[136:137]
  v_pk_mul_f32 v[174:175], v[138:139], v[138:139]
  v_pk_fma_f32 v[168:169], v[168:169], v[12:13], v[8:9] op_sel_hi:[1,0,0]
  v_pk_fma_f32 v[170:171], v[170:171], v[12:13], v[8:9] op_sel_hi:[1,0,0]
  v_pk_fma_f32 v[172:173], v[172:173], v[12:13], v[8:9] op_sel_hi:[1,0,0]
  v_pk_fma_f32 v[174:175], v[174:175], v[12:13], v[8:9] op_sel_hi:[1,0,0]
  v_pk_mul_f32 v[168:169], v[168:169], v[132:133]
  v_pk_mul_f32 v[170:171], v[170:171], v[134:135]
  v_pk_mul_f32 v[172:173], v[172:173], v[136:137]
  v_pk_mul_f32 v[174:175], v[174:175], v[138:139]
  v_exp_f32 v168, v168
  v_exp_f32 v169, v169
  v_exp_f32 v170, v170
  v_exp_f32 v171, v171
  v_exp_f32 v172, v172
  v_exp_f32 v173, v173
  v_exp_f32 v174, v174
  v_exp_f32 v175, v175
  v_pk_fma_f32 v[168:169], v[168:169], v[196:197], v[196:197] op_sel_hi:[1,0,0]
  v_pk_fma_f32 v[170:171], v[170:171], v[196:197], v[196:197] op_sel_hi:[1,0,0]
  v_pk_fma_f32 v[172:173], v[172:173], v[196:197], v[196:197] op_sel_hi:[1,0,0]
  v_pk_fma_f32 v[174:175], v[174:175], v[196:197], v[196:197] op_sel_hi:[1,0,0]
  v_rcp_f32 v168, v168
  v_rcp_f32 v169, v169
  v_rcp_f32 v170, v170
  v_rcp_f32 v171, v171
  v_rcp_f32 v172, v172
  v_rcp_f32 v173, v173
  v_rcp_f32 v174, v174
  v_rcp_f32 v175, v175
  v_pk_mul_f32 v[132:133], v[132:133], v[168:169]
  v_pk_mul_f32 v[134:135], v[134:135], v[170:171]
  v_pk_mul_f32 v[136:137], v[136:137], v[172:173]
  v_pk_mul_f32 v[138:139], v[138:139], v[174:175]
  v_lshlrev_b32 v140, 16, v222
  v_and_b32 v141, 0xffff0000, v222
  v_lshlrev_b32 v142, 16, v223
  v_and_b32 v143, 0xffff0000, v223
  v_lshlrev_b32 v144, 16, v226
  v_and_b32 v145, 0xffff0000, v226
  v_lshlrev_b32 v146, 16, v227
  v_and_b32 v147, 0xffff0000, v227
  v_pk_mul_f32 v[160:161], v[140:141], v[140:141]
  v_pk_mul_f32 v[162:163], v[142:143], v[142:143]
  v_pk_mul_f32 v[164:165], v[144:145], v[144:145]
  v_pk_mul_f32 v[166:167], v[146:147], v[146:147]
  v_pk_fma_f32 v[160:161], v[160:161], v[12:13], v[8:9] op_sel_hi:[1,0,0]
  v_pk_fma_f32 v[162:163], v[162:163], v[12:13], v[8:9] op_sel_hi:[1,0,0]
  v_pk_fma_f32 v[164:165], v[164:165], v[12:13], v[8:9] op_sel_hi:[1,0,0]
  v_pk_fma_f32 v[166:167], v[166:167], v[12:13], v[8:9] op_sel_hi:[1,0,0]
  v_pk_mul_f32 v[160:161], v[160:161], v[140:141]
  v_pk_mul_f32 v[162:163], v[162:163], v[142:143]
  v_pk_mul_f32 v[164:165], v[164:165], v[144:145]
  v_pk_mul_f32 v[166:167], v[166:167], v[146:147]
  v_exp_f32 v160, v160
  v_exp_f32 v161, v161
  v_exp_f32 v162, v162
  v_exp_f32 v163, v163
  v_exp_f32 v164, v164
  v_exp_f32 v165, v165
  v_exp_f32 v166, v166
  v_exp_f32 v167, v167
  v_pk_fma_f32 v[160:161], v[160:161], v[196:197], v[196:197] op_sel_hi:[1,0,0]
  v_pk_fma_f32 v[162:163], v[162:163], v[196:197], v[196:197] op_sel_hi:[1,0,0]
  v_pk_fma_f32 v[164:165], v[164:165], v[196:197], v[196:197] op_sel_hi:[1,0,0]
  v_pk_fma_f32 v[166:167], v[166:167], v[196:197], v[196:197] op_sel_hi:[1,0,0]
  v_rcp_f32 v160, v160
  v_rcp_f32 v161, v161
  v_rcp_f32 v162, v162
  v_rcp_f32 v163, v163
  v_rcp_f32 v164, v164
  v_rcp_f32 v165, v165
  v_rcp_f32 v166, v166
  v_rcp_f32 v167, v167
  v_pk_mul_f32 v[140:141], v[140:141], v[160:161]
  v_pk_mul_f32 v[142:143], v[142:143], v[162:163]
  v_pk_mul_f32 v[144:145], v[144:145], v[164:165]
  v_pk_mul_f32 v[146:147], v[146:147], v[166:167]
  v_lshlrev_b32 v148, 16, v230
  v_and_b32 v149, 0xffff0000, v230
  v_lshlrev_b32 v150, 16, v231
  v_and_b32 v151, 0xffff0000, v231
  v_lshlrev_b32 v152, 16, v234
  v_and_b32 v153, 0xffff0000, v234
  v_lshlrev_b32 v154, 16, v235
  v_and_b32 v155, 0xffff0000, v235
  v_pk_mul_f32 v[168:169], v[148:149], v[148:149]
  v_pk_mul_f32 v[170:171], v[150:151], v[150:151]
  v_pk_mul_f32 v[172:173], v[152:153], v[152:153]
  v_pk_mul_f32 v[174:175], v[154:155], v[154:155]
  v_pk_fma_f32 v[168:169], v[168:169], v[12:13], v[8:9] op_sel_hi:[1,0,0]
  v_pk_fma_f32 v[170:171], v[170:171], v[12:13], v[8:9] op_sel_hi:[1,0,0]
  v_pk_fma_f32 v[172:173], v[172:173], v[12:13], v[8:9] op_sel_hi:[1,0,0]
  v_pk_fma_f32 v[174:175], v[174:175], v[12:13], v[8:9] op_sel_hi:[1,0,0]
  v_pk_mul_f32 v[168:169], v[168:169], v[148:149]
  v_pk_mul_f32 v[170:171], v[170:171], v[150:151]
  v_pk_mul_f32 v[172:173], v[172:173], v[152:153]
  v_pk_mul_f32 v[174:175], v[174:175], v[154:155]
  v_exp_f32 v168, v168
  v_exp_f32 v169, v169
  v_exp_f32 v170, v170
  v_exp_f32 v171, v171
  v_exp_f32 v172, v172
  v_exp_f32 v173, v173
  v_exp_f32 v174, v174
  v_exp_f32 v175, v175
  v_pk_fma_f32 v[168:169], v[168:169], v[196:197], v[196:197] op_sel_hi:[1,0,0]
  v_pk_fma_f32 v[170:171], v[170:171], v[196:197], v[196:197] op_sel_hi:[1,0,0]
  v_pk_fma_f32 v[172:173], v[172:173], v[196:197], v[196:197] op_sel_hi:[1,0,0]
  v_pk_fma_f32 v[174:175], v[174:175], v[196:197], v[196:197] op_sel_hi:[1,0,0]
  v_rcp_f32 v168, v168
  v_rcp_f32 v169, v169
  v_rcp_f32 v170, v170
  v_rcp_f32 v171, v171
  v_rcp_f32 v172, v172
  v_rcp_f32 v173, v173
  v_rcp_f32 v174, v174
  v_rcp_f32 v175, v175
  v_pk_mul_f32 v[148:149], v[148:149], v[168:169]
  v_pk_mul_f32 v[150:151], v[150:151], v[170:171]
  v_pk_mul_f32 v[152:153], v[152:153], v[172:173]
  v_pk_mul_f32 v[154:155], v[154:155], v[174:175]
  v_mov_b32 v14, v194
  v_mov_b32 v208, v196
  v_mov_b32 v210, v252
  v_mov_b32 v211, v253
  v_mov_b32 v212, v254
  v_mov_b32 v213, v255
  s_waitcnt vmcnt(14)
  v_lshlrev_b32 v249, 16, v249
  v_lshlrev_b32 v250, 16, v250
  v_mov_b32 v216, v249
  v_mov_b32 v217, v249
  v_mov_b32 v218, v249
  v_mov_b32 v219, v249
  v_mov_b32 v220, v250
  v_mov_b32 v221, v250
  v_mov_b32 v222, v250
  v_mov_b32 v223, v250
  s_branch kt_tail_kernel_join
kt_tail_kernel_retrye:
  s_sleep 2
  s_sub_u32 s41, s41, 1
  s_cmp_eq_u32 s41, 0
  s_cbranch_scc1 kt_tail_kernel_chke
  buffer_load_dwordx4 v[176:179], v7, s[44:47], s43 offen sc1
  buffer_load_dwordx4 v[180:183], v7, s[44:47], s48 offen sc1
  buffer_load_dwordx4 v[184:187], v7, s[44:47], s49 offen sc1
  buffer_load_dwordx4 v[188:191], v7, s[44:47], s50 offen sc1
  s_waitcnt vmcnt(0)
  v_max3_u32 v164, v176, v177, v178
  v_max3_u32 v164, v179, v180, v164
  v_max3_u32 v164, v181, v182, v164
  v_max3_u32 v164, v183, v184, v164
  v_max3_u32 v164, v185, v186, v164
  v_max3_u32 v164, v187, v188, v164
  v_max3_u32 v164, v189, v190, v164
  v_max_u32 v164, v191, v164
  v_cmp_eq_u32 vcc, -1, v164
  s_nop 4
  s_cbranch_vccnz kt_tail_kernel_retrye
  s_branch kt_tail_kernel_chke
kt_tail_kernel_retryo:
  s_sleep 2
  s_sub_u32 s41, s41, 1
  s_cmp_eq_u32 s41, 0
  s_cbranch_scc1 kt_tail_kernel_chko
  buffer_load_dwordx4 v[176:179], v7, s[44:47], s43 offen sc1
  buffer_load_dwordx4 v[180:183], v7, s[44:47], s48 offen sc1
  buffer_load_dwordx4 v[184:187], v7, s[44:47], s49 offen sc1
  buffer_load_dwordx4 v[188:191], v7, s[44:47], s50 offen sc1
  s_waitcnt vmcnt(0)
  v_max3_u32 v164, v176, v177, v178
  v_max3_u32 v164, v179, v180, v164
  v_max3_u32 v164, v181, v182, v164
  v_max3_u32 v164, v183, v184, v164
  v_max3_u32 v164, v185, v186, v164
  v_max3_u32 v164, v187, v188, v164
  v_max3_u32 v164, v189, v190, v164
  v_max_u32 v164, v191, v164
  v_cmp_eq_u32 vcc, -1, v164
  s_nop 4
  s_cbranch_vccnz kt_tail_kernel_retryo
  s_branch kt_tail_kernel_chko
kt_tail_kernel_odd:
  s_waitcnt vmcnt(20)
  s_barrier
  ds_read_b128 a[148:151], v11 offset:0
  ds_read_b128 a[152:155], v11 offset:36864
  ds_read_b128 a[156:159], v11 offset:1024
  ds_read_b128 a[160:163], v11 offset:37888
  ds_read_b128 a[164:167], v11 offset:2048
  ds_read_b128 a[168:171], v11 offset:38912
  ds_read_b128 a[172:175], v11 offset:3072
  ds_read_b128 a[176:179], v11 offset:39936
  s_waitcnt lgkmcnt(4)
  v_mfma_f32_32x32x16_bf16 v[48:63], a[0:3], a[148:151], 0
  s_waitcnt vmcnt(4)
  s_barrier
  ds_read_b128 a[180:183], v11 offset:4096
  buffer_load_dwordx4 a[64:67], v2, s[28:31], s10 offen offset:0 sc1
  v_and_b32 v32, 15, v1
  v_lshlrev_b32 v32, 5, v32
  v_lshl_add_u32 v32, v18, 4, v32
  s_lshl_b32 s14, s3, 9
  s_add_u32 s14, s14, 147456
  v_add_u32 v32, s14, v32
  v_mfma_f32_32x32x16_bf16 v[64:79], a[0:3], a[152:155], 0
  ds_read_b128 a[184:187], v11 offset:40960
  buffer_load_dwordx4 a[68:71], v2, s[28:31], s10 offen offset:1024 sc1
  v_permlane16_swap_b32 v120, v122
  v_permlane16_swap_b32 v121, v123
  v_permlane16_swap_b32 v124, v126
  v_permlane16_swap_b32 v125, v127
  v_mfma_f32_32x32x16_bf16 v[48:63], a[4:7], a[156:159], v[48:63]
  ds_read_b128 a[188:191], v11 offset:5120
  v_permlane16_swap_b32 v128, v130
  v_permlane16_swap_b32 v129, v131
  v_add_f32 v120, v120, v122
  v_add_f32 v121, v121, v123
  v_add_f32 v124, v124, v126
  v_add_f32 v125, v125, v127
  v_mfma_f32_32x32x16_bf16 v[64:79], a[4:7], a[160:163], v[64:79]
  ds_read_b128 a[192:195], v11 offset:41984
  buffer_load_dwordx4 a[72:75], v2, s[28:31], s10 offen offset:2048 sc1
  v_add_f32 v128, v128, v130
  v_add_f32 v129, v129, v131
  v_mov_b32 v122, v120
  v_mov_b32 v123, v121
  s_waitcnt lgkmcnt(4)
  v_mfma_f32_32x32x16_bf16 v[48:63], a[8:11], a[164:167], v[48:63]
  ds_read_b128 a[148:151], v11 offset:6144
  buffer_load_dwordx4 a[76:79], v2, s[28:31], s10 offen offset:3072 sc1
  s_add_u32 s10, s10, 4096
  v_mov_b32 v126, v124
  v_mov_b32 v127, v125
  v_mov_b32 v130, v128
  v_mov_b32 v131, v129
  v_mfma_f32_32x32x16_bf16 v[64:79], a[8:11], a[168:171], v[64:79]
  ds_read_b128 a[152:155], v11 offset:43008
  v_permlane32_swap_b32 v120, v122
  v_permlane32_swap_b32 v121, v123
  v_permlane32_swap_b32 v124, v126
  v_permlane32_swap_b32 v125, v127
  v_permlane32_swap_b32 v128, v130
  v_permlane32_swap_b32 v129, v131
  v_mfma_f32_32x32x16_bf16 v[48:63], a[12:15], a[172:175], v[48:63]
  ds_read_b128 a[156:159], v11 offset:7168
  buffer_load_dwordx4 a[80:83], v2, s[28:31], s10 offen offset:0 sc1
  v_add_f32 v120, v120, v122
  v_add_f32 v121, v121, v123
  v_add_f32 v124, v124, v126
  v_add_f32 v125, v125, v127
  v_mfma_f32_32x32x16_bf16 v[64:79], a[12:15], a[176:179], v[64:79]
  ds_read_b128 a[160:163], v11 offset:44032
  buffer_load_dwordx4 a[84:87], v2, s[28:31], s10 offen offset:1024 sc1
  v_add_f32 v128, v128, v130
  v_add_f32 v129, v129, v131
  v_cvt_pk_bf16_f32 v36, v120, v120
  v_cvt_pk_bf16_f32 v37, v121, v121
  s_waitcnt lgkmcnt(4)
  v_mfma_f32_32x32x16_bf16 v[48:63], a[16:19], a[180:183], v[48:63]
  ds_read_b128 a[164:167], v11 offset:8192
  v_and_b32 v38, 0xffff0000, v36
  v_and_b32 v39, 0xffff0000, v37
  v_sub_f32 v120, v120, v38
  v_sub_f32 v121, v121, v39
  v_cvt_pk_bf16_f32 v37, v120, v39
  v_cvt_pk_bf16_f32 v38, v39, v121
  v_mfma_f32_32x32x16_bf16 v[64:79], a[16:19], a[184:187], v[64:79]
  ds_read_b128 a[168:171], v11 offset:45056
  buffer_load_dwordx4 a[88:91], v2, s[28:31], s10 offen offset:2048 sc1
  v_mov_b32 v39, 0
  v_cvt_pk_bf16_f32 v40, v124, v124
  v_cvt_pk_bf16_f32 v41, v125, v125
  v_and_b32 v42, 0xffff0000, v40
  v_mfma_f32_32x32x16_bf16 v[48:63], a[20:23], a[188:191], v[48:63]
  ds_read_b128 a[172:175], v11 offset:9216
  buffer_load_dwordx4 a[92:95], v2, s[28:31], s10 offen offset:3072 sc1
  s_add_u32 s10, s10, 4096
  v_and_b32 v43, 0xffff0000, v41
  v_sub_f32 v124, v124, v42
  v_sub_f32 v125, v125, v43
  v_cvt_pk_bf16_f32 v41, v124, v43
  v_mfma_f32_32x32x16_bf16 v[64:79], a[20:23], a[192:195], v[64:79]
  ds_read_b128 a[176:179], v11 offset:46080
  v_cvt_pk_bf16_f32 v42, v43, v125
  v_mov_b32 v43, 0
  v_cvt_pk_bf16_f32 v44, v128, v128
  v_cvt_pk_bf16_f32 v45, v129, v129
  v_and_b32 v46, 0xffff0000, v44
  v_and_b32 v47, 0xffff0000, v45
  s_waitcnt lgkmcnt(4)
  v_mfma_f32_32x32x16_bf16 v[48:63], a[24:27], a[148:151], v[48:63]
  ds_read_b128 a[180:183], v11 offset:10240
  buffer_load_dwordx4 a[96:99], v2, s[28:31], s10 offen offset:0 sc1
  v_sub_f32 v128, v128, v46
  v_sub_f32 v129, v129, v47
  v_cvt_pk_bf16_f32 v45, v128, v47
  v_cvt_pk_bf16_f32 v46, v47, v129
  v_mfma_f32_32x32x16_bf16 v[64:79], a[24:27], a[152:155], v[64:79]
  ds_read_b128 a[184:187], v11 offset:47104
  buffer_load_dwordx4 a[100:103], v2, s[28:31], s10 offen offset:1024 sc1
  v_mov_b32 v47, 0
  v_mfma_f32_32x32x16_bf16 v[48:63], a[28:31], a[156:159], v[48:63]
  ds_read_b128 a[188:191], v11 offset:11264
  ds_write_b128 v32, v[36:39]
  v_mfma_f32_32x32x16_bf16 v[64:79], a[28:31], a[160:163], v[64:79]
  ds_read_b128 a[192:195], v11 offset:48128
  buffer_load_dwordx4 a[104:107], v2, s[28:31], s10 offen offset:2048 sc1
  ds_write_b128 v32, v[40:43] offset:2048
  s_cmp_eq_u32 s3, 0
  s_cselect_b64 exec, -1, 0
  ds_write_b128 v32, v[44:47] offset:4096
  s_mov_b64 exec, -1
  s_waitcnt lgkmcnt(0)
  v_add_f32 v20, v20, v21
  v_add_f32 v22, v22, v23
  v_add_f32 v24, v24, v25
  v_add_f32 v26, v26, v27
  s_waitcnt lgkmcnt(7)
  v_mfma_f32_32x32x16_bf16 v[48:63], a[32:35], a[164:167], v[48:63]
  s_waitcnt vmcnt(7)
  s_barrier
  ds_read_b128 a[148:151], v11 offset:12288
  buffer_load_dwordx4 a[108:111], v2, s[28:31], s10 offen offset:3072 sc1
  s_add_u32 s10, s10, 4096
  v_add_f32 v20, v20, v22
  v_add_f32 v24, v24, v26
  v_add_f32 v20, v20, v24
  v_mul_f32 v20, 0x3ae38e39, v20
  v_mfma_f32_32x32x16_bf16 v[64:79], a[32:35], a[168:171], v[64:79]
  ds_read_b128 a[152:155], v11 offset:49152
  v_mov_b32 v21, v20
  s_nop 1
  v_permlane32_swap_b32 v20, v21
  v_fma_f32 v21, -v20, v20, v21
  v_max_f32 v21, 0, v21
  v_add_f32 v21, 0x3727c5ac, v21
  v_mfma_f32_32x32x16_bf16 v[48:63], a[36:39], a[172:175], v[48:63]
  ds_read_b128 a[156:159], v11 offset:13312
  buffer_load_dwordx4 a[112:115], v2, s[28:31], s10 offen offset:0 sc1
  v_rsq_f32 v22, v21
  v_mul_f32 v24, 0x3727c5ac, v21
  v_mul_f32 v23, v21, v22
  v_mul_f32 v28, 0xc0135761, v22
  v_mfma_f32_32x32x16_bf16 v[64:79], a[36:39], a[176:179], v[64:79]
  ds_read_b128 a[160:163], v11 offset:50176
  buffer_load_dwordx4 a[116:119], v2, s[28:31], s10 offen offset:1024 sc1
  v_mul_f32 v25, v22, v22
  v_mul_f32 v29, 0x3d372713, v25
  v_mul_f32 v29, v29, v28
  s_waitcnt lgkmcnt(6)
  v_mfma_f32_32x32x16_bf16 v[48:63], a[40:43], a[180:183], v[48:63]
  ds_read_b128 a[164:167], v11 offset:14336
  ds_write_b32 v30, v28
  v_mfma_f32_32x32x16_bf16 v[64:79], a[40:43], a[184:187], v[64:79]
  ds_read_b128 a[168:171], v11 offset:51200
  buffer_load_dwordx4 a[120:123], v2, s[28:31], s10 offen offset:2048 sc1
  ds_write_b32 v30, v29 offset:128
  v_mfma_f32_32x32x16_bf16 v[48:63], a[44:47], a[188:191], v[48:63]
  ds_read_b128 a[172:175], v11 offset:15360
  buffer_load_dwordx4 a[124:127], v2, s[28:31], s10 offen offset:3072 sc1
  s_add_u32 s10, s10, 4096
  ds_write_b32 v30, v24 offset:256
  v_mfma_f32_32x32x16_bf16 v[64:79], a[44:47], a[192:195], v[64:79]
  ds_read_b128 a[176:179], v11 offset:52224
  ds_write_b32 v30, v22 offset:384
  v_cvt_pk_bf16_f32 v25, -v20, -v20
  v_cvt_pk_bf16_f32 v26, v23, v23
  v_and_b32 v25, 0xffff0000, v25
  v_and_b32 v26, 0xffff0000, v26
  v_sub_f32 v27, -v20, v25
  v_sub_f32 v23, v23, v26
  s_waitcnt lgkmcnt(8)
  v_mfma_f32_32x32x16_bf16 v[48:63], a[48:51], a[148:151], v[48:63]
  ds_read_b128 a[180:183], v11 offset:16384
  buffer_load_dwordx4 a[128:131], v2, s[28:31], s10 offen offset:0 sc1
  v_cvt_pk_bf16_f32 v27, v25, v27
  v_cvt_pk_bf16_f32 v25, v25, v26
  v_cvt_pk_bf16_f32 v26, v23, v26
  v_cmp_gt_u32 vcc, 32, v1
  v_mfma_f32_32x32x16_bf16 v[64:79], a[48:51], a[152:155], v[64:79]
  ds_read_b128 a[184:187], v11 offset:53248
  buffer_load_dwordx4 a[132:135], v2, s[28:31], s10 offen offset:1024 sc1
  v_cndmask_b32 v27, 0, v27, vcc
  v_cndmask_b32 v25, 0, v25, vcc
  v_cndmask_b32 v26, 0, v26, vcc
  v_accvgpr_write_b32 a144, v27
  v_mfma_f32_32x32x16_bf16 v[48:63], a[52:55], a[156:159], v[48:63]
  ds_read_b128 a[188:191], v11 offset:17408
  v_accvgpr_write_b32 a145, v25
  v_accvgpr_write_b32 a146, v26
  v_accvgpr_write_b32 a147, 0
  s_waitcnt lgkmcnt(3)
  v_mfma_f32_32x32x16_bf16 v[64:79], a[52:55], a[160:163], v[64:79]
  ds_read_b128 a[192:195], v11 offset:54272
  buffer_load_dwordx4 a[136:139], v2, s[28:31], s10 offen offset:2048 sc1
  ds_read_b128 v[128:131], v8 offset:0
  s_waitcnt lgkmcnt(6)
  v_mfma_f32_32x32x16_bf16 v[48:63], a[56:59], a[164:167], v[48:63]
  ds_read_b128 a[148:151], v11 offset:18432
  buffer_load_dwordx4 a[140:143], v2, s[28:31], s10 offen offset:3072 sc1
  s_add_u32 s10, s10, 4096
  ds_read_b128 v[144:147], v8 offset:128
  v_mfma_f32_32x32x16_bf16 v[64:79], a[56:59], a[168:171], v[64:79]
  ds_read_b128 a[152:155], v11 offset:55296
  ds_read_b128 v[132:135], v8 offset:32
  s_add_u32 m0, s17, 73728
  s_add_u32 s12, s11, 73728
  v_mfma_f32_32x32x16_bf16 v[48:63], a[60:63], a[172:175], v[48:63]
  buffer_load_dwordx4 v2, s[32:35], s12 offen  lds
  ds_read_b128 a[156:159], v11 offset:19456
  ds_read_b128 v[148:151], v8 offset:160
  s_add_u32 m0, s17, 77824
  s_add_u32 s12, s11, 77824
  v_mfma_f32_32x32x16_bf16 v[64:79], a[60:63], a[176:179], v[64:79]
  buffer_load_dwordx4 v2, s[32:35], s12 offen  lds
  ds_read_b128 a[160:163], v11 offset:56320
  ds_read_b128 v[136:139], v8 offset:64
  s_waitcnt lgkmcnt(9)
  v_mfma_f32_32x32x16_bf16 v[48:63], a[64:67], a[180:183], v[48:63]
  s_waitcnt vmcnt(10)
  s_barrier
  ds_read_b128 a[164:167], v11 offset:20480
  ds_read_b128 v[152:155], v8 offset:192
  s_add_u32 m0, s17, 81920
  s_add_u32 s12, s11, 81920
  v_mfma_f32_32x32x16_bf16 v[64:79], a[64:67], a[184:187], v[64:79]
  buffer_load_dwordx4 v2, s[32:35], s12 offen  lds
  ds_read_b128 a[168:171], v11 offset:57344
  ds_read_b128 v[140:143], v8 offset:96
  s_add_u32 m0, s17, 86016
  s_add_u32 s12, s11, 86016
  v_mfma_f32_32x32x16_bf16 v[48:63], a[68:71], a[188:191], v[48:63]
  buffer_load_dwordx4 v2, s[32:35], s12 offen  lds
  ds_read_b128 a[172:175], v11 offset:21504
  ds_read_b128 v[156:159], v8 offset:224
  s_add_u32 s36, s20, 14086144
  s_addc_u32 s37, s21, 0
  s_and_b32 s37, s37, 0xffff
  s_mov_b32 s38, 2654208
  s_mov_b32 s39, 0x20000
  s_mul_i32 s7, s5, 331776
  s_add_u32 s7, s7, s17
  v_mfma_f32_32x32x16_bf16 v[64:79], a[68:71], a[192:195], v[64:79]
  ds_read_b128 a[176:179], v11 offset:58368
  s_waitcnt lgkmcnt(8)
  s_add_u32 m0, s17, 90112
  s_add_u32 s12, s11, 90112
  v_mfma_f32_32x32x16_bf16 v[48:63], a[72:75], a[148:151], v[48:63]
  buffer_load_dwordx4 v2, s[32:35], s12 offen  lds
  ds_read_b128 a[180:183], v11 offset:22528
  s_add_u32 m0, s17, 94208
  s_add_u32 s12, s11, 94208
  v_mfma_f32_32x32x16_bf16 v[64:79], a[72:75], a[152:155], v[64:79]
  buffer_load_dwordx4 v2, s[32:35], s12 offen  lds
  ds_read_b128 a[184:187], v11 offset:59392
  v_mfma_f32_32x32x16_bf16 v[48:63], a[76:79], a[156:159], v[48:63]
  ds_read_b128 a[188:191], v11 offset:23552
  s_add_u32 m0, s17, 98304
  s_add_u32 s12, s11, 98304
  v_mfma_f32_32x32x16_bf16 v[64:79], a[76:79], a[160:163], v[64:79]
  buffer_load_dwordx4 v2, s[32:35], s12 offen  lds
  ds_read_b128 a[192:195], v11 offset:60416
  s_waitcnt lgkmcnt(4)
  s_add_u32 m0, s17, 102400
  s_add_u32 s12, s11, 102400
  v_mfma_f32_32x32x16_bf16 v[48:63], a[80:83], a[164:167], v[48:63]
  buffer_load_dwordx4 v2, s[32:35], s12 offen  lds
  ds_read_b128 a[148:151], v11 offset:24576
  v_mfma_f32_32x32x16_bf16 v[64:79], a[80:83], a[168:171], v[64:79]
  ds_read_b128 a[152:155], v11 offset:61440
  s_add_u32 m0, s17, 106496
  s_add_u32 s12, s11, 106496
  v_mfma_f32_32x32x16_bf16 v[48:63], a[84:87], a[172:175], v[48:63]
  buffer_load_dwordx4 v2, s[32:35], s12 offen  lds
  ds_read_b128 a[156:159], v11 offset:25600
  s_add_u32 m0, s17, 110592
  s_add_u32 s12, s11, 110592
  v_mfma_f32_32x32x16_bf16 v[64:79], a[84:87], a[176:179], v[64:79]
  buffer_load_dwordx4 v2, s[32:35], s12 offen  lds
  ds_read_b128 a[160:163], v11 offset:62464
  s_waitcnt lgkmcnt(4)
  v_mfma_f32_32x32x16_bf16 v[48:63], a[88:91], a[180:183], v[48:63]
  ds_read_b128 a[164:167], v11 offset:26624
  s_add_u32 m0, s17, 114688
  s_add_u32 s12, s11, 114688
  v_mfma_f32_32x32x16_bf16 v[64:79], a[88:91], a[184:187], v[64:79]
  buffer_load_dwordx4 v2, s[32:35], s12 offen  lds
  ds_read_b128 a[168:171], v11 offset:63488
  s_add_u32 m0, s17, 118784
  s_add_u32 s12, s11, 118784
  v_mfma_f32_32x32x16_bf16 v[48:63], a[92:95], a[188:191], v[48:63]
  buffer_load_dwordx4 v2, s[32:35], s12 offen  lds
  ds_read_b128 a[172:175], v11 offset:27648
  v_mfma_f32_32x32x16_bf16 v[64:79], a[92:95], a[192:195], v[64:79]
  ds_read_b128 a[176:179], v11 offset:64512
  s_waitcnt lgkmcnt(4)
  v_mfma_f32_32x32x16_bf16 v[48:63], a[96:99], a[148:151], v[48:63]
  s_waitcnt vmcnt(12)
  s_barrier
  ds_read_b128 a[180:183], v11 offset:28672
  s_add_u32 m0, s17, 122880
  s_add_u32 s12, s11, 122880
  buffer_load_dwordx4 v2, s[32:35], s12 offen  lds
  s_add_u32 m0, s17, 126976
  s_add_u32 s12, s11, 126976
  v_mfma_f32_32x32x16_bf16 v[64:79], a[96:99], a[152:155], v[64:79]
  buffer_load_dwordx4 v2, s[32:35], s12 offen  lds
  ds_read_b128 a[184:187], v12 offset:0
  v_mfma_f32_32x32x16_bf16 v[48:63], a[100:103], a[156:159], v[48:63]
  ds_read_b128 a[188:191], v11 offset:29696
  s_add_u32 m0, s17, 131072
  s_add_u32 s12, s11, 131072
  v_mfma_f32_32x32x16_bf16 v[64:79], a[100:103], a[160:163], v[64:79]
  buffer_load_dwordx4 v2, s[32:35], s12 offen  lds
  ds_read_b128 a[192:195], v12 offset:1024
  s_waitcnt lgkmcnt(4)
  s_add_u32 m0, s17, 135168
  s_add_u32 s12, s11, 135168
  v_mfma_f32_32x32x16_bf16 v[48:63], a[104:107], a[164:167], v[48:63]
  buffer_load_dwordx4 v2, s[32:35], s12 offen  lds
  ds_read_b128 a[148:151], v11 offset:30720
  v_mfma_f32_32x32x16_bf16 v[64:79], a[104:107], a[168:171], v[64:79]
  ds_read_b128 a[152:155], v12 offset:2048
  s_add_u32 m0, s17, 139264
  s_add_u32 s12, s11, 139264
  v_mfma_f32_32x32x16_bf16 v[48:63], a[108:111], a[172:175], v[48:63]
  buffer_load_dwordx4 v2, s[32:35], s12 offen  lds
  ds_read_b128 a[156:159], v11 offset:31744
  s_add_u32 m0, s17, 143360
  s_add_u32 s12, s11, 143360
  v_mfma_f32_32x32x16_bf16 v[64:79], a[108:111], a[176:179], v[64:79]
  buffer_load_dwordx4 v2, s[32:35], s12 offen  lds
  ds_read_b128 a[160:163], v12 offset:3072
  s_waitcnt lgkmcnt(4)
  v_mfma_f32_32x32x16_bf16 v[48:63], a[112:115], a[180:183], v[48:63]
  ds_read_b128 a[164:167], v11 offset:32768
  s_add_u32 m0, s17, 0
  s_add_u32 s12, s11, 147456
  v_mfma_f32_32x32x16_bf16 v[64:79], a[112:115], a[184:187], v[64:79]
  buffer_load_dwordx4 v2, s[32:35], s12 offen  lds
  ds_read_b128 a[168:171], v12 offset:4096
  s_add_u32 m0, s17, 4096
  s_add_u32 s12, s11, 151552
  v_mfma_f32_32x32x16_bf16 v[48:63], a[116:119], a[188:191], v[48:63]
  buffer_load_dwordx4 v2, s[32:35], s12 offen  lds
  ds_read_b128 a[172:175], v11 offset:33792
  v_mfma_f32_32x32x16_bf16 v[64:79], a[116:119], a[192:195], v[64:79]
  ds_read_b128 a[176:179], v12 offset:5120
  s_waitcnt lgkmcnt(4)
  s_add_u32 m0, s17, 8192
  s_add_u32 s12, s11, 155648
  v_mfma_f32_32x32x16_bf16 v[48:63], a[120:123], a[148:151], v[48:63]
  buffer_load_dwordx4 v2, s[32:35], s12 offen  lds
  ds_read_b128 a[180:183], v11 offset:34816
  s_add_u32 m0, s17, 12288
  s_add_u32 s12, s11, 159744
  v_mfma_f32_32x32x16_bf16 v[64:79], a[120:123], a[152:155], v[64:79]
  buffer_load_dwordx4 v2, s[32:35], s12 offen  lds
  ds_read_b128 a[184:187], v12 offset:6144
  v_mfma_f32_32x32x16_bf16 v[48:63], a[124:127], a[156:159], v[48:63]
  ds_read_b128 a[188:191], v11 offset:35840
  s_add_u32 m0, s17, 16384
  s_add_u32 s12, s11, 163840
  v_mfma_f32_32x32x16_bf16 v[64:79], a[124:127], a[160:163], v[64:79]
  buffer_load_dwordx4 v2, s[32:35], s12 offen  lds
  ds_read_b128 a[192:195], v12 offset:7168
  s_waitcnt lgkmcnt(4)
  v_mfma_f32_32x32x16_bf16 v[48:63], a[128:131], a[164:167], v[48:63]
  ds_read_b128 a[148:151], v3 offset:0
  v_mfma_f32_32x32x16_bf16 v[64:79], a[128:131], a[168:171], v[64:79]
  ds_read_b128 a[152:155], v3 offset:512
  v_mfma_f32_32x32x16_bf16 v[48:63], a[132:135], a[172:175], v[48:63]
  s_waitcnt vmcnt(14)
  s_barrier
  ds_read_b128 a[156:159], v12 offset:8192
  s_add_u32 m0, s17, 20480
  s_add_u32 s12, s11, 167936
  buffer_load_dwordx4 v2, s[32:35], s12 offen  lds
  s_add_u32 m0, s17, 24576
  s_add_u32 s12, s11, 172032
  v_mfma_f32_32x32x16_bf16 v[64:79], a[132:135], a[176:179], v[64:79]
  buffer_load_dwordx4 v2, s[32:35], s12 offen  lds
  ds_read_b128 a[160:163], v12 offset:9216
  s_waitcnt lgkmcnt(4)
  v_mfma_f32_32x32x16_bf16 v[48:63], a[136:139], a[180:183], v[48:63]
  ds_read_b128 a[164:167], v12 offset:10240
  v_mfma_f32_32x32x16_bf16 v[64:79], a[136:139], a[184:187], v[64:79]
  ds_read_b128 a[168:171], v12 offset:11264
  v_mfma_f32_32x32x16_bf16 v[48:63], a[140:143], a[188:191], v[48:63]
  ds_read_b128 a[172:175], v12 offset:12288
  v_mfma_f32_32x32x16_bf16 v[64:79], a[140:143], a[192:195], v[64:79]
  ds_read_b128 a[176:179], v12 offset:13312
  s_waitcnt lgkmcnt(4)
  v_mfma_f32_32x32x16_bf16 v[48:63], a[144:147], a[148:151], v[48:63]
  ds_read_b128 a[180:183], v12 offset:14336
  v_mfma_f32_32x32x16_bf16 v[64:79], a[144:147], a[152:155], v[64:79]
  ds_read_b128 a[184:187], v12 offset:15360
  v_mfma_f32_32x32x16_bf16 v[80:95], a[0:3], a[156:159], 0
  ds_read_b128 a[188:191], v12 offset:16384
  v_mfma_f32_32x32x16_bf16 v[80:95], a[4:7], a[160:163], v[80:95]
  ds_read_b128 a[192:195], v12 offset:17408
  s_waitcnt lgkmcnt(4)
  v_mfma_f32_32x32x16_bf16 v[80:95], a[8:11], a[164:167], v[80:95]
  ds_read_b128 a[148:151], v12 offset:18432
  s_nop 1
  v_mul_f32 v192, v48, v48
  v_mul_f32 v193, v49, v49
  v_fma_f32 v192, v192, v144, v128
  v_mul_f32 v194, v50, v50
  v_fma_f32 v193, v193, v145, v129
  v_mul_f32 v192, v192, v48
  v_mul_f32 v195, v51, v51
  v_mfma_f32_32x32x16_bf16 v[80:95], a[12:15], a[168:171], v[80:95]
  ds_read_b128 a[152:155], v12 offset:19456
  v_fma_f32 v194, v194, v146, v130
  v_exp_f32 v192, v192
  v_mul_f32 v193, v193, v49
  v_mul_f32 v196, v52, v52
  v_fma_f32 v195, v195, v147, v131
  v_mfma_f32_32x32x16_bf16 v[80:95], a[16:19], a[172:175], v[80:95]
  ds_read_b128 a[156:159], v12 offset:20480
  v_exp_f32 v193, v193
  v_mul_f32 v194, v194, v50
  v_add_f32 v192, 1.0, v192
  v_mul_f32 v197, v53, v53
  v_fma_f32 v196, v196, v148, v132
  v_mfma_f32_32x32x16_bf16 v[80:95], a[20:23], a[176:179], v[80:95]
  ds_read_b128 a[160:163], v12 offset:21504
  v_exp_f32 v194, v194
  v_mul_f32 v195, v195, v51
  v_add_f32 v193, 1.0, v193
  v_rcp_f32 v192, v192
  s_waitcnt lgkmcnt(4)
  v_mfma_f32_32x32x16_bf16 v[80:95], a[24:27], a[180:183], v[80:95]
  ds_read_b128 a[164:167], v12 offset:22528
  v_mul_f32 v198, v54, v54
  v_fma_f32 v197, v197, v149, v133
  v_exp_f32 v195, v195
  v_mul_f32 v196, v196, v52
  v_add_f32 v194, 1.0, v194
  v_mfma_f32_32x32x16_bf16 v[80:95], a[28:31], a[184:187], v[80:95]
  ds_read_b128 a[168:171], v12 offset:23552
  v_rcp_f32 v193, v193
  v_mul_f32 v48, v48, v192
  v_mul_f32 v199, v55, v55
  v_fma_f32 v198, v198, v150, v134
  v_mfma_f32_32x32x16_bf16 v[80:95], a[32:35], a[188:191], v[80:95]
  ds_read_b128 a[172:175], v12 offset:24576
  v_exp_f32 v196, v196
  v_mul_f32 v197, v197, v53
  v_add_f32 v195, 1.0, v195
  v_rcp_f32 v194, v194
  v_mul_f32 v49, v49, v193
  v_mfma_f32_32x32x16_bf16 v[80:95], a[36:39], a[192:195], v[80:95]
  ds_read_b128 a[176:179], v12 offset:25600
  v_mul_f32 v192, v56, v56
  v_fma_f32 v199, v199, v151, v135
  v_exp_f32 v197, v197
  v_mul_f32 v198, v198, v54
  v_add_f32 v196, 1.0, v196
  s_waitcnt lgkmcnt(4)
  v_mfma_f32_32x32x16_bf16 v[80:95], a[40:43], a[148:151], v[80:95]
  ds_read_b128 a[180:183], v12 offset:26624
  v_rcp_f32 v195, v195
  v_mul_f32 v50, v50, v194
  v_mul_f32 v193, v57, v57
  v_fma_f32 v192, v192, v152, v136
  v_mfma_f32_32x32x16_bf16 v[80:95], a[44:47], a[152:155], v[80:95]
  ds_read_b128 a[184:187], v12 offset:27648
  v_exp_f32 v198, v198
  v_mul_f32 v199, v199, v55
  v_add_f32 v197, 1.0, v197
  v_rcp_f32 v196, v196
  v_mul_f32 v51, v51, v195
  v_mfma_f32_32x32x16_bf16 v[80:95], a[48:51], a[156:159], v[80:95]
  ds_read_b128 a[188:191], v12 offset:28672
  v_mul_f32 v194, v58, v58
  v_fma_f32 v193, v193, v153, v137
  v_exp_f32 v199, v199
  v_mul_f32 v192, v192, v56
  v_add_f32 v198, 1.0, v198
  v_mfma_f32_32x32x16_bf16 v[80:95], a[52:55], a[160:163], v[80:95]
  ds_read_b128 a[192:195], v12 offset:29696
  v_rcp_f32 v197, v197
  v_mul_f32 v52, v52, v196
  v_mul_f32 v195, v59, v59
  v_fma_f32 v194, v194, v154, v138
  s_waitcnt lgkmcnt(4)
  v_mfma_f32_32x32x16_bf16 v[80:95], a[56:59], a[164:167], v[80:95]
  ds_read_b128 a[148:151], v12 offset:30720
  v_exp_f32 v192, v192
  v_mul_f32 v193, v193, v57
  v_add_f32 v199, 1.0, v199
  v_rcp_f32 v198, v198
  v_mul_f32 v53, v53, v197
  v_mfma_f32_32x32x16_bf16 v[80:95], a[60:63], a[168:171], v[80:95]
  ds_read_b128 a[152:155], v12 offset:31744
  v_mul_f32 v196, v60, v60
  v_fma_f32 v195, v195, v155, v139
  v_exp_f32 v193, v193
  v_mul_f32 v194, v194, v58
  v_add_f32 v192, 1.0, v192
  v_mfma_f32_32x32x16_bf16 v[80:95], a[64:67], a[172:175], v[80:95]
  ds_read_b128 a[156:159], v12 offset:32768
  v_rcp_f32 v199, v199
  v_mul_f32 v54, v54, v198
  v_mul_f32 v197, v61, v61
  v_fma_f32 v196, v196, v156, v140
  v_mfma_f32_32x32x16_bf16 v[80:95], a[68:71], a[176:179], v[80:95]
  ds_read_b128 a[160:163], v12 offset:33792
  v_exp_f32 v194, v194
  v_mul_f32 v195, v195, v59
  v_add_f32 v193, 1.0, v193
  v_rcp_f32 v192, v192
  v_mul_f32 v55, v55, v199
  s_waitcnt lgkmcnt(4)
  v_mfma_f32_32x32x16_bf16 v[80:95], a[72:75], a[180:183], v[80:95]
  ds_read_b128 a[164:167], v12 offset:34816
  v_mul_f32 v198, v62, v62
  v_fma_f32 v197, v197, v157, v141
  v_exp_f32 v195, v195
  v_mul_f32 v196, v196, v60
  v_add_f32 v194, 1.0, v194
  v_mfma_f32_32x32x16_bf16 v[80:95], a[76:79], a[184:187], v[80:95]
  ds_read_b128 a[168:171], v12 offset:35840
  v_rcp_f32 v193, v193
  v_mul_f32 v56, v56, v192
  v_mul_f32 v199, v63, v63
  v_fma_f32 v198, v198, v158, v142
  v_mfma_f32_32x32x16_bf16 v[80:95], a[80:83], a[188:191], v[80:95]
  ds_read_b128 a[172:175], v12 offset:36864
  v_exp_f32 v196, v196
  v_mul_f32 v197, v197, v61
  v_add_f32 v195, 1.0, v195
  v_rcp_f32 v194, v194
  v_mul_f32 v57, v57, v193
  v_mfma_f32_32x32x16_bf16 v[80:95], a[84:87], a[192:195], v[80:95]
  ds_read_b128 a[176:179], v12 offset:37888
  v_fma_f32 v199, v199, v159, v143
  v_exp_f32 v197, v197
  v_mul_f32 v198, v198, v62
  v_add_f32 v196, 1.0, v196
  s_waitcnt lgkmcnt(4)
  v_mfma_f32_32x32x16_bf16 v[80:95], a[88:91], a[148:151], v[80:95]
  ds_read_b128 a[180:183], v12 offset:38912
  v_rcp_f32 v195, v195
  v_mul_f32 v58, v58, v194
  v_exp_f32 v198, v198
  v_mul_f32 v199, v199, v63
  v_add_f32 v197, 1.0, v197
  v_mfma_f32_32x32x16_bf16 v[80:95], a[92:95], a[152:155], v[80:95]
  ds_read_b128 a[184:187], v12 offset:39936
  v_rcp_f32 v196, v196
  v_mul_f32 v59, v59, v195
  v_exp_f32 v199, v199
  v_add_f32 v198, 1.0, v198
  v_mfma_f32_32x32x16_bf16 v[80:95], a[96:99], a[156:159], v[80:95]
  ds_read_b128 a[188:191], v12 offset:40960
  v_rcp_f32 v197, v197
  v_mul_f32 v60, v60, v196
  v_add_f32 v199, 1.0, v199
  v_rcp_f32 v198, v198
  v_mfma_f32_32x32x16_bf16 v[80:95], a[100:103], a[160:163], v[80:95]
  ds_read_b128 a[192:195], v12 offset:41984
  v_mul_f32 v61, v61, v197
  v_rcp_f32 v199, v199
  v_mul_f32 v62, v62, v198
  v_mul_f32 v63, v63, v199
  v_mul_f32 v192, v64, v64
  s_waitcnt lgkmcnt(4)
  v_mfma_f32_32x32x16_bf16 v[80:95], a[104:107], a[164:167], v[80:95]
  ds_read_b128 a[148:151], v12 offset:43008
  v_mul_f32 v193, v65, v65
  v_fma_f32 v192, v192, v144, v128
  v_mul_f32 v194, v66, v66
  v_fma_f32 v193, v193, v145, v129
  v_mul_f32 v192, v192, v64
  v_mul_f32 v195, v67, v67
  v_mfma_f32_32x32x16_bf16 v[80:95], a[108:111], a[168:171], v[80:95]
  ds_read_b128 a[152:155], v12 offset:44032
  v_fma_f32 v194, v194, v146, v130
  v_exp_f32 v192, v192
  v_mul_f32 v193, v193, v65
  v_mul_f32 v196, v68, v68
  v_fma_f32 v195, v195, v147, v131
  v_mfma_f32_32x32x16_bf16 v[80:95], a[112:115], a[172:175], v[80:95]
  ds_read_b128 a[156:159], v3 offset:1024
  v_exp_f32 v193, v193
  v_mul_f32 v194, v194, v66
  v_add_f32 v192, 1.0, v192
  v_mul_f32 v197, v69, v69
  v_fma_f32 v196, v196, v148, v132
  v_mfma_f32_32x32x16_bf16 v[80:95], a[116:119], a[176:179], v[80:95]
  s_waitcnt vmcnt(7)
  s_barrier
  ds_read_b128 a[160:163], v12 offset:45056
  v_exp_f32 v194, v194
  v_mul_f32 v195, v195, v67
  v_add_f32 v193, 1.0, v193
  v_rcp_f32 v192, v192
  s_waitcnt lgkmcnt(4)
  v_mfma_f32_32x32x16_bf16 v[80:95], a[120:123], a[180:183], v[80:95]
  ds_read_b128 a[164:167], v12 offset:46080
  v_mul_f32 v198, v70, v70
  v_fma_f32 v197, v197, v149, v133
  v_exp_f32 v195, v195
  v_mul_f32 v196, v196, v68
  v_add_f32 v194, 1.0, v194
  s_add_u32 m0, s17, 28672
  s_add_u32 s12, s11, 176128
  v_mfma_f32_32x32x16_bf16 v[80:95], a[124:127], a[184:187], v[80:95]
  buffer_load_dwordx4 v2, s[32:35], s12 offen  lds
  ds_read_b128 a[168:171], v12 offset:47104
  v_rcp_f32 v193, v193
  v_mul_f32 v64, v64, v192
  v_mul_f32 v199, v71, v71
  v_mfma_f32_32x32x16_bf16 v[80:95], a[128:131], a[188:191], v[80:95]
  ds_read_b128 a[172:175], v12 offset:48128
  v_fma_f32 v198, v198, v150, v134
  v_exp_f32 v196, v196
  v_mul_f32 v197, v197, v69
  v_add_f32 v195, 1.0, v195
  v_mfma_f32_32x32x16_bf16 v[80:95], a[132:135], a[192:195], v[80:95]
  ds_read_b128 a[176:179], v12 offset:49152
  v_rcp_f32 v194, v194
  v_mul_f32 v65, v65, v193
  v_mul_f32 v192, v72, v72
  v_fma_f32 v199, v199, v151, v135
  v_exp_f32 v197, v197
  s_waitcnt lgkmcnt(4)
  s_add_u32 m0, s17, 32768
  s_add_u32 s12, s11, 180224
  v_mfma_f32_32x32x16_bf16 v[80:95], a[136:139], a[148:151], v[80:95]
  buffer_load_dwordx4 v2, s[32:35], s12 offen  lds
  ds_read_b128 a[180:183], v12 offset:50176
  v_mul_f32 v198, v198, v70
  v_add_f32 v196, 1.0, v196
  v_rcp_f32 v195, v195
  v_mfma_f32_32x32x16_bf16 v[80:95], a[140:143], a[152:155], v[80:95]
  ds_read_b128 a[184:187], v12 offset:51200
  v_mul_f32 v66, v66, v194
  v_mul_f32 v193, v73, v73
  v_fma_f32 v192, v192, v152, v136
  v_exp_f32 v198, v198
  v_mul_f32 v199, v199, v71
  v_mfma_f32_32x32x16_bf16 v[80:95], a[144:147], a[156:159], v[80:95]
  ds_read_b128 a[188:191], v12 offset:52224
  v_add_f32 v197, 1.0, v197
  v_rcp_f32 v196, v196
  v_mul_f32 v67, v67, v195
  v_mul_f32 v194, v74, v74
  v_fma_f32 v193, v193, v153, v137
  s_add_u32 m0, s17, 36864
  s_add_u32 s12, s11, 184320
  v_mfma_f32_32x32x16_bf16 v[96:111], a[0:3], a[160:163], 0
  buffer_load_dwordx4 v2, s[32:35], s12 offen  lds
  ds_read_b128 a[192:195], v12 offset:53248
  v_exp_f32 v199, v199
  v_mul_f32 v192, v192, v72
  v_add_f32 v198, 1.0, v198
  s_waitcnt lgkmcnt(4)
  v_mfma_f32_32x32x16_bf16 v[96:111], a[4:7], a[164:167], v[96:111]
  ds_read_b128 a[148:151], v12 offset:54272
  v_rcp_f32 v197, v197
  v_mul_f32 v68, v68, v196
  v_mul_f32 v195, v75, v75
  v_fma_f32 v194, v194, v154, v138
  v_mfma_f32_32x32x16_bf16 v[96:111], a[8:11], a[168:171], v[96:111]
  ds_read_b128 a[152:155], v12 offset:55296
  v_exp_f32 v192, v192
  v_mul_f32 v193, v193, v73
  v_add_f32 v199, 1.0, v199
  v_rcp_f32 v198, v198
  v_mul_f32 v69, v69, v197
  s_add_u32 m0, s17, 40960
  s_add_u32 s12, s11, 188416
  v_mfma_f32_32x32x16_bf16 v[96:111], a[12:15], a[172:175], v[96:111]
  buffer_load_dwordx4 v2, s[32:35], s12 offen  lds
  ds_read_b128 a[156:159], v12 offset:56320
  v_mul_f32 v196, v76, v76
  v_fma_f32 v195, v195, v155, v139
  v_exp_f32 v193, v193
  v_mfma_f32_32x32x16_bf16 v[96:111], a[16:19], a[176:179], v[96:111]
  ds_read_b128 a[160:163], v12 offset:57344
  v_mul_f32 v194, v194, v74
  v_add_f32 v192, 1.0, v192
  v_rcp_f32 v199, v199
  v_mul_f32 v70, v70, v198
  v_mul_f32 v197, v77, v77
  s_waitcnt lgkmcnt(4)
  v_mfma_f32_32x32x16_bf16 v[96:111], a[20:23], a[180:183], v[96:111]
  ds_read_b128 a[164:167], v12 offset:58368
  v_fma_f32 v196, v196, v156, v140
  v_exp_f32 v194, v194
  v_mul_f32 v195, v195, v75
  v_add_f32 v193, 1.0, v193
  s_add_u32 m0, s17, 45056
  s_add_u32 s12, s11, 192512
  v_mfma_f32_32x32x16_bf16 v[96:111], a[24:27], a[184:187], v[96:111]
  buffer_load_dwordx4 v2, s[32:35], s12 offen  lds
  ds_read_b128 a[168:171], v12 offset:59392
  v_rcp_f32 v192, v192
  v_mul_f32 v71, v71, v199
  v_mul_f32 v198, v78, v78
  v_fma_f32 v197, v197, v157, v141
  v_mfma_f32_32x32x16_bf16 v[96:111], a[28:31], a[188:191], v[96:111]
  ds_read_b128 a[172:175], v12 offset:60416
  v_exp_f32 v195, v195
  v_mul_f32 v196, v196, v76
  v_add_f32 v194, 1.0, v194
  v_rcp_f32 v193, v193
  v_mfma_f32_32x32x16_bf16 v[96:111], a[32:35], a[192:195], v[96:111]
  ds_read_b128 a[176:179], v12 offset:61440
  v_mul_f32 v72, v72, v192
  v_mul_f32 v199, v79, v79
  v_fma_f32 v198, v198, v158, v142
  v_exp_f32 v196, v196
  v_mul_f32 v197, v197, v77
  s_waitcnt lgkmcnt(4)
  s_add_u32 m0, s17, 49152
  s_add_u32 s12, s11, 196608
  v_mfma_f32_32x32x16_bf16 v[96:111], a[36:39], a[148:151], v[96:111]
  buffer_load_dwordx4 v2, s[32:35], s12 offen  lds
  ds_read_b128 a[180:183], v12 offset:62464
  v_add_f32 v195, 1.0, v195
  v_rcp_f32 v194, v194
  v_mul_f32 v73, v73, v193
  v_mfma_f32_32x32x16_bf16 v[96:111], a[40:43], a[152:155], v[96:111]
  ds_read_b128 a[184:187], v12 offset:63488
  v_fma_f32 v199, v199, v159, v143
  v_exp_f32 v197, v197
  v_mul_f32 v198, v198, v78
  v_add_f32 v196, 1.0, v196
  v_mfma_f32_32x32x16_bf16 v[96:111], a[44:47], a[156:159], v[96:111]
  ds_read_b128 a[188:191], v12 offset:64512
  v_rcp_f32 v195, v195
  v_mul_f32 v74, v74, v194
  v_exp_f32 v198, v198
  v_mul_f32 v199, v199, v79
  v_add_f32 v197, 1.0, v197
  s_add_u32 m0, s17, 53248
  s_add_u32 s12, s11, 200704
  v_mfma_f32_32x32x16_bf16 v[96:111], a[48:51], a[160:163], v[96:111]
  buffer_load_dwordx4 v2, s[32:35], s12 offen  lds
  ds_read_b128 a[192:195], v13 offset:0
  v_rcp_f32 v196, v196
  v_mul_f32 v75, v75, v195
  s_waitcnt lgkmcnt(4)
  v_mfma_f32_32x32x16_bf16 v[96:111], a[52:55], a[164:167], v[96:111]
  ds_read_b128 a[148:151], v13 offset:1024
  v_exp_f32 v199, v199
  v_add_f32 v198, 1.0, v198
  v_rcp_f32 v197, v197
  v_mul_f32 v76, v76, v196
  v_add_f32 v199, 1.0, v199
  v_mfma_f32_32x32x16_bf16 v[96:111], a[56:59], a[168:171], v[96:111]
  ds_read_b128 a[152:155], v13 offset:2048
  v_rcp_f32 v198, v198
  v_mul_f32 v77, v77, v197
  v_rcp_f32 v199, v199
  v_mul_f32 v78, v78, v198
  s_add_u32 m0, s17, 57344
  s_add_u32 s12, s11, 204800
  v_mfma_f32_32x32x16_bf16 v[96:111], a[60:63], a[172:175], v[96:111]
  buffer_load_dwordx4 v2, s[32:35], s12 offen  lds
  ds_read_b128 a[156:159], v13 offset:3072
  v_mul_f32 v79, v79, v199
  v_mul_f32 v192, v80, v80
  v_mul_f32 v193, v81, v81
  v_fma_f32 v192, v192, v144, v128
  v_mfma_f32_32x32x16_bf16 v[96:111], a[64:67], a[176:179], v[96:111]
  ds_read_b128 a[160:163], v13 offset:4096
  v_mul_f32 v194, v82, v82
  v_fma_f32 v193, v193, v145, v129
  v_mul_f32 v192, v192, v80
  v_mul_f32 v195, v83, v83
  v_fma_f32 v194, v194, v146, v130
  s_waitcnt lgkmcnt(4)
  v_mfma_f32_32x32x16_bf16 v[96:111], a[68:71], a[180:183], v[96:111]
  ds_read_b128 a[164:167], v13 offset:5120
  v_exp_f32 v192, v192
  v_mul_f32 v193, v193, v81
  v_mul_f32 v196, v84, v84
  v_fma_f32 v195, v195, v147, v131
  v_exp_f32 v193, v193
  s_add_u32 m0, s17, 61440
  s_add_u32 s12, s11, 208896
  v_mfma_f32_32x32x16_bf16 v[96:111], a[72:75], a[184:187], v[96:111]
  buffer_load_dwordx4 v2, s[32:35], s12 offen  lds
  ds_read_b128 a[168:171], v13 offset:6144
  v_mul_f32 v194, v194, v82
  v_add_f32 v192, 1.0, v192
  v_mul_f32 v197, v85, v85
  v_fma_f32 v196, v196, v148, v132
  v_mfma_f32_32x32x16_bf16 v[96:111], a[76:79], a[188:191], v[96:111]
  ds_read_b128 a[172:175], v13 offset:7168
  v_exp_f32 v194, v194
  v_mul_f32 v195, v195, v83
  v_add_f32 v193, 1.0, v193
  v_rcp_f32 v192, v192
  v_mfma_f32_32x32x16_bf16 v[96:111], a[80:83], a[192:195], v[96:111]
  ds_read_b128 a[176:179], v13 offset:8192
  v_mul_f32 v198, v86, v86
  v_fma_f32 v197, v197, v149, v133
  v_exp_f32 v195, v195
  v_mul_f32 v196, v196, v84
  v_add_f32 v194, 1.0, v194
  s_waitcnt lgkmcnt(4)
  s_add_u32 m0, s17, 65536
  s_add_u32 s12, s11, 212992
  v_mfma_f32_32x32x16_bf16 v[96:111], a[84:87], a[148:151], v[96:111]
  buffer_load_dwordx4 v2, s[32:35], s12 offen  lds
  ds_read_b128 a[180:183], v13 offset:9216
  v_rcp_f32 v193, v193
  v_mul_f32 v80, v80, v192
  v_mul_f32 v199, v87, v87
  v_mfma_f32_32x32x16_bf16 v[96:111], a[88:91], a[152:155], v[96:111]
  ds_read_b128 a[184:187], v13 offset:10240
  v_fma_f32 v198, v198, v150, v134
  v_exp_f32 v196, v196
  v_mul_f32 v197, v197, v85
  v_add_f32 v195, 1.0, v195
  v_mfma_f32_32x32x16_bf16 v[96:111], a[92:95], a[156:159], v[96:111]
  ds_read_b128 a[188:191], v13 offset:11264
  v_rcp_f32 v194, v194
  v_mul_f32 v81, v81, v193
  v_mul_f32 v192, v88, v88
  v_fma_f32 v199, v199, v151, v135
  v_exp_f32 v197, v197
  s_add_u32 m0, s17, 69632
  s_add_u32 s12, s11, 217088
  v_mfma_f32_32x32x16_bf16 v[96:111], a[96:99], a[160:163], v[96:111]
  buffer_load_dwordx4 v2, s[32:35], s12 offen  lds
  ds_read_b128 a[192:195], v13 offset:12288
  v_mul_f32 v198, v198, v86
  v_add_f32 v196, 1.0, v196
  v_rcp_f32 v195, v195
  s_waitcnt lgkmcnt(4)
  v_mfma_f32_32x32x16_bf16 v[96:111], a[100:103], a[164:167], v[96:111]
  ds_read_b128 a[148:151], v13 offset:13312
  v_mul_f32 v82, v82, v194
  v_mul_f32 v193, v89, v89
  v_fma_f32 v192, v192, v152, v136
  v_exp_f32 v198, v198
  v_mul_f32 v199, v199, v87
  v_mfma_f32_32x32x16_bf16 v[96:111], a[104:107], a[168:171], v[96:111]
  ds_read_b128 a[152:155], v13 offset:14336
  v_add_f32 v197, 1.0, v197
  v_rcp_f32 v196, v196
  v_mul_f32 v83, v83, v195
  v_mul_f32 v194, v90, v90
  v_fma_f32 v193, v193, v153, v137
  s_add_u32 m0, s17, 73728
  s_add_u32 s12, s11, 221184
  v_mfma_f32_32x32x16_bf16 v[96:111], a[108:111], a[172:175], v[96:111]
  buffer_load_dwordx4 v2, s[32:35], s12 offen  lds
  ds_read_b128 a[156:159], v13 offset:15360
  v_exp_f32 v199, v199
  v_mul_f32 v192, v192, v88
  v_add_f32 v198, 1.0, v198
  v_mfma_f32_32x32x16_bf16 v[96:111], a[112:115], a[176:179], v[96:111]
  ds_read_b128 a[160:163], v3 offset:1536
  v_rcp_f32 v197, v197
  v_mul_f32 v84, v84, v196
  v_mul_f32 v195, v91, v91
  v_fma_f32 v194, v194, v154, v138
  s_waitcnt lgkmcnt(4)
  v_mfma_f32_32x32x16_bf16 v[96:111], a[116:119], a[180:183], v[96:111]
  s_waitcnt vmcnt(10)
  s_barrier
  ds_read_b128 a[164:167], v11 offset:0
  v_exp_f32 v192, v192
  v_mul_f32 v193, v193, v89
  v_add_f32 v199, 1.0, v199
  v_rcp_f32 v198, v198
  v_mul_f32 v85, v85, v197
  s_add_u32 m0, s17, 77824
  s_add_u32 s12, s11, 225280
  v_mfma_f32_32x32x16_bf16 v[96:111], a[120:123], a[184:187], v[96:111]
  buffer_load_dwordx4 v2, s[32:35], s12 offen  lds
  ds_read_b128 a[168:171], v11 offset:1024
  v_mul_f32 v196, v92, v92
  v_fma_f32 v195, v195, v155, v139
  v_exp_f32 v193, v193
  v_mfma_f32_32x32x16_bf16 v[96:111], a[124:127], a[188:191], v[96:111]
  ds_read_b128 a[172:175], v11 offset:2048
  v_mul_f32 v194, v194, v90
  v_add_f32 v192, 1.0, v192
  v_rcp_f32 v199, v199
  v_mul_f32 v86, v86, v198
  v_mul_f32 v197, v93, v93
  v_mfma_f32_32x32x16_bf16 v[96:111], a[128:131], a[192:195], v[96:111]
  ds_read_b128 a[176:179], v11 offset:3072
  v_fma_f32 v196, v196, v156, v140
  v_exp_f32 v194, v194
  v_mul_f32 v195, v195, v91
  v_add_f32 v193, 1.0, v193
  s_waitcnt lgkmcnt(4)
  s_add_u32 m0, s17, 81920
  s_add_u32 s12, s11, 229376
  v_mfma_f32_32x32x16_bf16 v[96:111], a[132:135], a[148:151], v[96:111]
  buffer_load_dwordx4 v2, s[32:35], s12 offen  lds
  ds_read_b128 a[180:183], v11 offset:4096
  v_rcp_f32 v192, v192
  v_mul_f32 v87, v87, v199
  v_mul_f32 v198, v94, v94
  v_fma_f32 v197, v197, v157, v141
  v_mfma_f32_32x32x16_bf16 v[96:111], a[136:139], a[152:155], v[96:111]
  ds_read_b128 a[184:187], v11 offset:5120
  v_exp_f32 v195, v195
  v_mul_f32 v196, v196, v92
  v_add_f32 v194, 1.0, v194
  v_rcp_f32 v193, v193
  v_mfma_f32_32x32x16_bf16 v[96:111], a[140:143], a[156:159], v[96:111]
  ds_read_b128 a[188:191], v11 offset:6144
  v_mul_f32 v88, v88, v192
  v_mul_f32 v199, v95, v95
  v_fma_f32 v198, v198, v158, v142
  v_exp_f32 v196, v196
  v_mul_f32 v197, v197, v93
  s_add_u32 m0, s17, 86016
  s_add_u32 s12, s11, 233472
  v_mfma_f32_32x32x16_bf16 v[96:111], a[144:147], a[160:163], v[96:111]
  buffer_load_dwordx4 v2, s[32:35], s12 offen  lds
  ds_read_b128 a[192:195], v11 offset:7168
  v_add_f32 v195, 1.0, v195
  v_rcp_f32 v194, v194
  v_mul_f32 v89, v89, v193
  s_waitcnt lgkmcnt(4)
  v_mfma_f32_32x32x16_bf16 v[16:31], a[164:167], a[0:3], 0
  ds_read_b128 a[148:151], v11 offset:8192
  v_fma_f32 v199, v199, v159, v143
  v_exp_f32 v197, v197
  v_mul_f32 v198, v198, v94
  v_add_f32 v196, 1.0, v196
  v_mfma_f32_32x32x16_bf16 v[16:31], a[168:171], a[4:7], v[16:31]
  ds_read_b128 a[152:155], v11 offset:9216
  v_rcp_f32 v195, v195
  v_mul_f32 v90, v90, v194
  v_exp_f32 v198, v198
  v_mul_f32 v199, v199, v95
  v_add_f32 v197, 1.0, v197
  s_add_u32 m0, s17, 90112
  s_add_u32 s12, s11, 237568
  v_mfma_f32_32x32x16_bf16 v[16:31], a[172:175], a[8:11], v[16:31]
  buffer_load_dwordx4 v2, s[32:35], s12 offen  lds
  ds_read_b128 a[156:159], v11 offset:10240
  v_rcp_f32 v196, v196
  v_mul_f32 v91, v91, v195
  v_mfma_f32_32x32x16_bf16 v[16:31], a[176:179], a[12:15], v[16:31]
  ds_read_b128 a[160:163], v11 offset:11264
  v_exp_f32 v199, v199
  v_add_f32 v198, 1.0, v198
  v_rcp_f32 v197, v197
  v_mul_f32 v92, v92, v196
  v_add_f32 v199, 1.0, v199
  s_waitcnt lgkmcnt(4)
  v_mfma_f32_32x32x16_bf16 v[16:31], a[180:183], a[16:19], v[16:31]
  ds_read_b128 a[164:167], v11 offset:12288
  v_rcp_f32 v198, v198
  v_mul_f32 v93, v93, v197
  v_rcp_f32 v199, v199
  v_mul_f32 v94, v94, v198
  s_add_u32 m0, s17, 94208
  s_add_u32 s12, s11, 241664
  v_mfma_f32_32x32x16_bf16 v[16:31], a[184:187], a[20:23], v[16:31]
  buffer_load_dwordx4 v2, s[32:35], s12 offen  lds
  ds_read_b128 a[168:171], v11 offset:13312
  v_mul_f32 v95, v95, v199
  s_nop 0
  v_pk_add_f32 v[160:161], v[48:49], v[64:65]
  v_pk_mul_f32 v[176:177], v[48:49], v[48:49]
  v_pk_add_f32 v[162:163], v[50:51], v[66:67]
  v_pk_mul_f32 v[178:179], v[50:51], v[50:51]
  v_pk_add_f32 v[164:165], v[52:53], v[68:69]
  v_pk_mul_f32 v[180:181], v[52:53], v[52:53]
  v_pk_add_f32 v[166:167], v[54:55], v[70:71]
  v_pk_mul_f32 v[182:183], v[54:55], v[54:55]
  v_pk_add_f32 v[168:169], v[56:57], v[72:73]
  v_pk_mul_f32 v[184:185], v[56:57], v[56:57]
  v_pk_add_f32 v[170:171], v[58:59], v[74:75]
  v_pk_mul_f32 v[186:187], v[58:59], v[58:59]
  v_pk_add_f32 v[172:173], v[60:61], v[76:77]
  v_pk_mul_f32 v[188:189], v[60:61], v[60:61]
  v_pk_add_f32 v[174:175], v[62:63], v[78:79]
  v_pk_mul_f32 v[190:191], v[62:63], v[62:63]
  v_pk_fma_f32 v[176:177], v[64:65], v[64:65], v[176:177]
  v_pk_fma_f32 v[178:179], v[66:67], v[66:67], v[178:179]
  v_pk_fma_f32 v[180:181], v[68:69], v[68:69], v[180:181]
  v_pk_fma_f32 v[182:183], v[70:71], v[70:71], v[182:183]
  v_pk_fma_f32 v[184:185], v[72:73], v[72:73], v[184:185]
  v_pk_fma_f32 v[186:187], v[74:75], v[74:75], v[186:187]
  v_pk_fma_f32 v[188:189], v[76:77], v[76:77], v[188:189]
  v_pk_fma_f32 v[190:191], v[78:79], v[78:79], v[190:191]
  v_pk_add_f32 v[160:161], v[160:161], v[80:81]
  v_pk_fma_f32 v[176:177], v[80:81], v[80:81], v[176:177]
  v_pk_add_f32 v[162:163], v[162:163], v[82:83]
  v_pk_fma_f32 v[178:179], v[82:83], v[82:83], v[178:179]
  v_pk_add_f32 v[164:165], v[164:165], v[84:85]
  v_pk_fma_f32 v[180:181], v[84:85], v[84:85], v[180:181]
  v_pk_add_f32 v[166:167], v[166:167], v[86:87]
  v_pk_fma_f32 v[182:183], v[86:87], v[86:87], v[182:183]
  v_pk_add_f32 v[168:169], v[168:169], v[88:89]
  v_pk_fma_f32 v[184:185], v[88:89], v[88:89], v[184:185]
  v_pk_add_f32 v[170:171], v[170:171], v[90:91]
  v_pk_fma_f32 v[186:187], v[90:91], v[90:91], v[186:187]
  v_pk_add_f32 v[172:173], v[172:173], v[92:93]
  v_pk_fma_f32 v[188:189], v[92:93], v[92:93], v[188:189]
  v_pk_add_f32 v[174:175], v[174:175], v[94:95]
  v_pk_fma_f32 v[190:191], v[94:95], v[94:95], v[190:191]
  v_mul_f32 v192, v96, v96
  v_mul_f32 v193, v97, v97
  v_fma_f32 v192, v192, v144, v128
  v_mfma_f32_32x32x16_bf16 v[16:31], a[188:191], a[24:27], v[16:31]
  ds_read_b128 a[172:175], v11 offset:14336
  v_mul_f32 v194, v98, v98
  v_fma_f32 v193, v193, v145, v129
  v_mul_f32 v192, v192, v96
  v_mul_f32 v195, v99, v99
  v_fma_f32 v194, v194, v146, v130
  v_mfma_f32_32x32x16_bf16 v[16:31], a[192:195], a[28:31], v[16:31]
  ds_read_b128 a[176:179], v11 offset:15360
  v_exp_f32 v192, v192
  v_mul_f32 v193, v193, v97
  v_mul_f32 v196, v100, v100
  v_fma_f32 v195, v195, v147, v131
  v_exp_f32 v193, v193
  s_waitcnt lgkmcnt(4)
  s_add_u32 m0, s17, 98304
  s_add_u32 s12, s11, 245760
  v_mfma_f32_32x32x16_bf16 v[16:31], a[148:151], a[32:35], v[16:31]
  buffer_load_dwordx4 v2, s[32:35], s12 offen  lds
  ds_read_b128 a[180:183], v11 offset:16384
  v_mul_f32 v194, v194, v98
  v_add_f32 v192, 1.0, v192
  v_mul_f32 v197, v101, v101
  v_fma_f32 v196, v196, v148, v132
  v_mfma_f32_32x32x16_bf16 v[16:31], a[152:155], a[36:39], v[16:31]
  ds_read_b128 a[184:187], v11 offset:17408
  v_exp_f32 v194, v194
  v_mul_f32 v195, v195, v99
  v_add_f32 v193, 1.0, v193
  v_rcp_f32 v192, v192
  v_mfma_f32_32x32x16_bf16 v[16:31], a[156:159], a[40:43], v[16:31]
  ds_read_b128 a[188:191], v11 offset:18432
  v_mul_f32 v198, v102, v102
  v_fma_f32 v197, v197, v149, v133
  v_exp_f32 v195, v195
  v_mul_f32 v196, v196, v100
  v_add_f32 v194, 1.0, v194
  s_add_u32 m0, s17, 102400
  s_add_u32 s12, s11, 249856
  v_mfma_f32_32x32x16_bf16 v[16:31], a[160:163], a[44:47], v[16:31]
  buffer_load_dwordx4 v2, s[32:35], s12 offen  lds
  ds_read_b128 a[192:195], v11 offset:19456
  v_rcp_f32 v193, v193
  v_mul_f32 v96, v96, v192
  v_mul_f32 v199, v103, v103
  s_waitcnt lgkmcnt(4)
  v_mfma_f32_32x32x16_bf16 v[16:31], a[164:167], a[48:51], v[16:31]
  ds_read_b128 a[148:151], v11 offset:20480
  v_fma_f32 v198, v198, v150, v134
  v_exp_f32 v196, v196
  v_mul_f32 v197, v197, v101
  v_add_f32 v195, 1.0, v195
  v_mfma_f32_32x32x16_bf16 v[16:31], a[168:171], a[52:55], v[16:31]
  ds_read_b128 a[152:155], v11 offset:21504
  v_rcp_f32 v194, v194
  v_mul_f32 v97, v97, v193
  v_mul_f32 v192, v104, v104
  v_fma_f32 v199, v199, v151, v135
  v_exp_f32 v197, v197
  s_add_u32 m0, s17, 106496
  s_add_u32 s12, s11, 253952
  v_mfma_f32_32x32x16_bf16 v[16:31], a[172:175], a[56:59], v[16:31]
  buffer_load_dwordx4 v2, s[32:35], s12 offen  lds
  ds_read_b128 a[156:159], v11 offset:22528
  v_mul_f32 v198, v198, v102
  v_add_f32 v196, 1.0, v196
  v_rcp_f32 v195, v195
  v_mfma_f32_32x32x16_bf16 v[16:31], a[176:179], a[60:63], v[16:31]
  ds_read_b128 a[160:163], v11 offset:23552
  v_mul_f32 v98, v98, v194
  v_mul_f32 v193, v105, v105
  v_fma_f32 v192, v192, v152, v136
  v_exp_f32 v198, v198
  v_mul_f32 v199, v199, v103
  s_waitcnt lgkmcnt(4)
  v_mfma_f32_32x32x16_bf16 v[16:31], a[180:183], a[64:67], v[16:31]
  ds_read_b128 a[164:167], v11 offset:24576
  v_add_f32 v197, 1.0, v197
  v_rcp_f32 v196, v196
  v_mul_f32 v99, v99, v195
  v_mul_f32 v194, v106, v106
  v_fma_f32 v193, v193, v153, v137
  s_add_u32 m0, s17, 110592
  s_add_u32 s12, s11, 258048
  v_mfma_f32_32x32x16_bf16 v[16:31], a[184:187], a[68:71], v[16:31]
  buffer_load_dwordx4 v2, s[32:35], s12 offen  lds
  ds_read_b128 a[168:171], v11 offset:25600
  v_exp_f32 v199, v199
  v_mul_f32 v192, v192, v104
  v_add_f32 v198, 1.0, v198
  v_mfma_f32_32x32x16_bf16 v[16:31], a[188:191], a[72:75], v[16:31]
  ds_read_b128 a[172:175], v11 offset:26624
  v_rcp_f32 v197, v197
  v_mul_f32 v100, v100, v196
  v_mul_f32 v195, v107, v107
  v_fma_f32 v194, v194, v154, v138
  v_mfma_f32_32x32x16_bf16 v[16:31], a[192:195], a[76:79], v[16:31]
  ds_read_b128 a[176:179], v11 offset:27648
  v_exp_f32 v192, v192
  v_mul_f32 v193, v193, v105
  v_add_f32 v199, 1.0, v199
  v_rcp_f32 v198, v198
  v_mul_f32 v101, v101, v197
  s_waitcnt lgkmcnt(4)
  s_add_u32 m0, s17, 114688
  s_add_u32 s12, s11, 262144
  v_mfma_f32_32x32x16_bf16 v[16:31], a[148:151], a[80:83], v[16:31]
  buffer_load_dwordx4 v2, s[32:35], s12 offen  lds
  ds_read_b128 a[180:183], v11 offset:28672
  v_mul_f32 v196, v108, v108
  v_fma_f32 v195, v195, v155, v139
  v_exp_f32 v193, v193
  v_mfma_f32_32x32x16_bf16 v[16:31], a[152:155], a[84:87], v[16:31]
  ds_read_b128 a[184:187], v11 offset:29696
  v_mul_f32 v194, v194, v106
  v_add_f32 v192, 1.0, v192
  v_rcp_f32 v199, v199
  v_mul_f32 v102, v102, v198
  v_mul_f32 v197, v109, v109
  v_mfma_f32_32x32x16_bf16 v[16:31], a[156:159], a[88:91], v[16:31]
  ds_read_b128 a[188:191], v11 offset:30720
  v_fma_f32 v196, v196, v156, v140
  v_exp_f32 v194, v194
  v_mul_f32 v195, v195, v107
  v_add_f32 v193, 1.0, v193
  s_add_u32 m0, s17, 118784
  s_add_u32 s12, s11, 266240
  v_mfma_f32_32x32x16_bf16 v[16:31], a[160:163], a[92:95], v[16:31]
  buffer_load_dwordx4 v2, s[32:35], s12 offen  lds
  ds_read_b128 a[192:195], v11 offset:31744
  v_rcp_f32 v192, v192
  v_mul_f32 v103, v103, v199
  v_mul_f32 v198, v110, v110
  v_fma_f32 v197, v197, v157, v141
  s_waitcnt lgkmcnt(4)
  v_mfma_f32_32x32x16_bf16 v[16:31], a[164:167], a[96:99], v[16:31]
  ds_read_b128 a[148:151], v11 offset:32768
  v_exp_f32 v195, v195
  v_mul_f32 v196, v196, v108
  v_add_f32 v194, 1.0, v194
  v_rcp_f32 v193, v193
  v_mfma_f32_32x32x16_bf16 v[16:31], a[168:171], a[100:103], v[16:31]
  ds_read_b128 a[152:155], v11 offset:33792
  v_mul_f32 v104, v104, v192
  v_mul_f32 v199, v111, v111
  v_fma_f32 v198, v198, v158, v142
  v_exp_f32 v196, v196
  v_mul_f32 v197, v197, v109
  s_add_u32 m0, s17, 122880
  s_add_u32 s12, s11, 270336
  v_mfma_f32_32x32x16_bf16 v[16:31], a[172:175], a[104:107], v[16:31]
  buffer_load_dwordx4 v2, s[32:35], s12 offen  lds
  ds_read_b128 a[156:159], v11 offset:34816
  v_add_f32 v195, 1.0, v195
  v_rcp_f32 v194, v194
  v_mul_f32 v105, v105, v193
  v_mfma_f32_32x32x16_bf16 v[16:31], a[176:179], a[108:111], v[16:31]
  ds_read_b128 a[160:163], v11 offset:35840
  v_fma_f32 v199, v199, v159, v143
  v_exp_f32 v197, v197
  v_mul_f32 v198, v198, v110
  v_add_f32 v196, 1.0, v196
  s_waitcnt lgkmcnt(4)
  v_mfma_f32_32x32x16_bf16 v[16:31], a[180:183], a[112:115], v[16:31]
  ds_read_b128 a[164:167], v3 offset:2048
  v_rcp_f32 v195, v195
  v_mul_f32 v106, v106, v194
  v_exp_f32 v198, v198
  v_mul_f32 v199, v199, v111
  v_add_f32 v197, 1.0, v197
  v_mfma_f32_32x32x16_bf16 v[16:31], a[184:187], a[116:119], v[16:31]
  s_waitcnt vmcnt(13)
  s_barrier
  ds_read_b128 a[168:171], v11 offset:36864
  s_add_u32 m0, s17, 126976
  s_add_u32 s12, s11, 274432
  buffer_load_dwordx4 v2, s[32:35], s12 offen  lds
  v_rcp_f32 v196, v196
  v_mul_f32 v107, v107, v195
  v_mfma_f32_32x32x16_bf16 v[16:31], a[188:191], a[120:123], v[16:31]
  ds_read_b128 a[172:175], v11 offset:37888
  v_exp_f32 v199, v199
  v_add_f32 v198, 1.0, v198
  v_rcp_f32 v197, v197
  v_mul_f32 v108, v108, v196
  v_add_f32 v199, 1.0, v199
  v_mfma_f32_32x32x16_bf16 v[16:31], a[192:195], a[124:127], v[16:31]
  ds_read_b128 a[176:179], v11 offset:38912
  v_rcp_f32 v198, v198
  v_mul_f32 v109, v109, v197
  v_rcp_f32 v199, v199
  v_mul_f32 v110, v110, v198
  s_waitcnt lgkmcnt(4)
  s_add_u32 m0, s17, 131072
  s_add_u32 s12, s11, 278528
  v_mfma_f32_32x32x16_bf16 v[16:31], a[148:151], a[128:131], v[16:31]
  buffer_load_dwordx4 v2, s[32:35], s12 offen  lds
  ds_read_b128 a[180:183], v11 offset:39936
  v_mul_f32 v111, v111, v199
  s_nop 0
  v_pk_add_f32 v[160:161], v[160:161], v[96:97]
  v_pk_fma_f32 v[176:177], v[96:97], v[96:97], v[176:177]
  v_pk_add_f32 v[162:163], v[162:163], v[98:99]
  v_pk_fma_f32 v[178:179], v[98:99], v[98:99], v[178:179]
  v_pk_add_f32 v[164:165], v[164:165], v[100:101]
  v_pk_fma_f32 v[180:181], v[100:101], v[100:101], v[180:181]
  v_pk_add_f32 v[166:167], v[166:167], v[102:103]
  v_pk_fma_f32 v[182:183], v[102:103], v[102:103], v[182:183]
  v_pk_add_f32 v[168:169], v[168:169], v[104:105]
  v_pk_fma_f32 v[184:185], v[104:105], v[104:105], v[184:185]
  v_pk_add_f32 v[170:171], v[170:171], v[106:107]
  v_pk_fma_f32 v[186:187], v[106:107], v[106:107], v[186:187]
  v_pk_add_f32 v[172:173], v[172:173], v[108:109]
  v_pk_fma_f32 v[188:189], v[108:109], v[108:109], v[188:189]
  v_pk_add_f32 v[174:175], v[174:175], v[110:111]
  v_pk_fma_f32 v[190:191], v[110:111], v[110:111], v[190:191]
  v_permlane16_swap_b32 v160, v176
  v_permlane16_swap_b32 v161, v177
  v_permlane16_swap_b32 v162, v178
  v_mfma_f32_32x32x16_bf16 v[16:31], a[152:155], a[132:135], v[16:31]
  ds_read_b128 a[184:187], v11 offset:40960
  v_permlane16_swap_b32 v163, v179
  v_permlane16_swap_b32 v164, v180
  v_permlane16_swap_b32 v165, v181
  v_permlane16_swap_b32 v166, v182
  v_permlane16_swap_b32 v167, v183
  v_permlane16_swap_b32 v168, v184
  v_mfma_f32_32x32x16_bf16 v[16:31], a[156:159], a[136:139], v[16:31]
  ds_read_b128 a[188:191], v11 offset:41984
  v_permlane16_swap_b32 v169, v185
  v_permlane16_swap_b32 v170, v186
  v_permlane16_swap_b32 v171, v187
  v_permlane16_swap_b32 v172, v188
  v_permlane16_swap_b32 v173, v189
  v_permlane16_swap_b32 v174, v190
  s_add_u32 m0, s17, 135168
  s_add_u32 s12, s11, 282624
  v_mfma_f32_32x32x16_bf16 v[16:31], a[160:163], a[140:143], v[16:31]
  buffer_load_dwordx4 v2, s[32:35], s12 offen  lds
  ds_read_b128 a[192:195], v11 offset:43008
  v_permlane16_swap_b32 v175, v191
  v_add_f32 v160, v160, v176
  v_add_f32 v161, v161, v177
  v_add_f32 v162, v162, v178
  s_waitcnt lgkmcnt(4)
  v_mfma_f32_32x32x16_bf16 v[16:31], a[164:167], a[144:147], v[16:31]
  ds_read_b128 a[148:151], v11 offset:44032
  v_add_f32 v163, v163, v179
  v_add_f32 v164, v164, v180
  v_add_f32 v165, v165, v181
  v_add_f32 v166, v166, v182
  v_add_f32 v167, v167, v183
  v_add_f32 v168, v168, v184
  v_mfma_f32_32x32x16_bf16 v[32:47], a[168:171], a[0:3], 0
  ds_read_b128 a[152:155], v11 offset:45056
  v_add_f32 v169, v169, v185
  v_add_f32 v170, v170, v186
  v_add_f32 v171, v171, v187
  v_add_f32 v172, v172, v188
  v_add_f32 v173, v173, v189
  v_add_f32 v174, v174, v190
  s_add_u32 m0, s17, 139264
  s_add_u32 s12, s11, 286720
  v_mfma_f32_32x32x16_bf16 v[32:47], a[172:175], a[4:7], v[32:47]
  buffer_load_dwordx4 v2, s[32:35], s12 offen  lds
  ds_read_b128 a[156:159], v11 offset:46080
  v_add_f32 v175, v175, v191
  v_add_f32_dpp v160, v160, v160 row_ror:8 row_mask:0xf bank_mask:0x3
  v_add_f32_dpp v161, v161, v161 row_ror:8 row_mask:0xf bank_mask:0x3
  v_add_f32_dpp v162, v162, v162 row_ror:8 row_mask:0xf bank_mask:0x3
  v_mfma_f32_32x32x16_bf16 v[32:47], a[176:179], a[8:11], v[32:47]
  ds_read_b128 a[160:163], v11 offset:47104
  v_add_f32_dpp v163, v163, v163 row_ror:8 row_mask:0xf bank_mask:0x3
  v_add_f32_dpp v164, v164, v164 row_ror:8 row_mask:0xf bank_mask:0x3
  v_add_f32_dpp v165, v165, v165 row_ror:8 row_mask:0xf bank_mask:0x3
  v_add_f32_dpp v166, v166, v166 row_ror:8 row_mask:0xf bank_mask:0x3
  v_add_f32_dpp v167, v167, v167 row_ror:8 row_mask:0xf bank_mask:0x3
  v_add_f32_dpp v160, v168, v168 row_ror:8 row_mask:0xf bank_mask:0xc
  s_waitcnt lgkmcnt(4)
  v_mfma_f32_32x32x16_bf16 v[32:47], a[180:183], a[12:15], v[32:47]
  ds_read_b128 a[164:167], v11 offset:48128
  v_add_f32_dpp v161, v169, v169 row_ror:8 row_mask:0xf bank_mask:0xc
  v_add_f32_dpp v162, v170, v170 row_ror:8 row_mask:0xf bank_mask:0xc
  v_add_f32_dpp v163, v171, v171 row_ror:8 row_mask:0xf bank_mask:0xc
  v_add_f32_dpp v164, v172, v172 row_ror:8 row_mask:0xf bank_mask:0xc
  v_add_f32_dpp v165, v173, v173 row_ror:8 row_mask:0xf bank_mask:0xc
  v_add_f32_dpp v166, v174, v174 row_ror:8 row_mask:0xf bank_mask:0xc
  s_add_u32 m0, s17, 143360
  s_add_u32 s12, s11, 290816
  v_mfma_f32_32x32x16_bf16 v[32:47], a[184:187], a[16:19], v[32:47]
  buffer_load_dwordx4 v2, s[32:35], s12 offen  lds
  ds_read_b128 a[168:171], v11 offset:49152
  v_add_f32_dpp v167, v175, v175 row_ror:8 row_mask:0xf bank_mask:0xc
  v_add_f32_dpp v160, v160, v160 row_half_mirror row_mask:0xf bank_mask:0x5
  v_add_f32_dpp v161, v161, v161 row_half_mirror row_mask:0xf bank_mask:0x5
  v_add_f32_dpp v162, v162, v162 row_half_mirror row_mask:0xf bank_mask:0x5
  v_mfma_f32_32x32x16_bf16 v[32:47], a[188:191], a[20:23], v[32:47]
  ds_read_b128 a[172:175], v11 offset:50176
  v_cvt_pk_bf16_f32 v204, v16, v17
  v_cvt_pk_bf16_f32 v205, v18, v19
  v_cvt_pk_bf16_f32 v206, v20, v21
  v_cvt_pk_bf16_f32 v207, v22, v23
  v_cvt_pk_bf16_f32 v208, v24, v25
  v_cvt_pk_bf16_f32 v209, v26, v27
  v_mfma_f32_32x32x16_bf16 v[32:47], a[192:195], a[24:27], v[32:47]
  ds_read_b128 a[176:179], v11 offset:51200
  v_cvt_pk_bf16_f32 v210, v28, v29
  v_cvt_pk_bf16_f32 v211, v30, v31
  v_permlane16_swap_b32 v204, v206
  v_permlane16_swap_b32 v205, v207
  v_permlane16_swap_b32 v208, v210
  v_permlane16_swap_b32 v209, v211
  s_waitcnt lgkmcnt(4)
  s_add_u32 m0, s17, 0
  s_add_u32 s12, s11, 294912
  v_mfma_f32_32x32x16_bf16 v[32:47], a[148:151], a[28:31], v[32:47]
  buffer_load_dwordx4 v2, s[32:35], s12 offen  lds
  ds_read_b128 a[180:183], v11 offset:52224
  buffer_store_dwordx4 v[204:207], v2, s[60:63], s55 offen sc1
  v_add_f32_dpp v163, v163, v163 row_half_mirror row_mask:0xf bank_mask:0x5
  v_add_f32_dpp v160, v164, v164 row_half_mirror row_mask:0xf bank_mask:0xa
  v_mfma_f32_32x32x16_bf16 v[32:47], a[152:155], a[32:35], v[32:47]
  ds_read_b128 a[184:187], v11 offset:53248
  v_add_f32_dpp v161, v165, v165 row_half_mirror row_mask:0xf bank_mask:0xa
  v_add_f32_dpp v162, v166, v166 row_half_mirror row_mask:0xf bank_mask:0xa
  v_add_f32_dpp v163, v167, v167 row_half_mirror row_mask:0xf bank_mask:0xa
  v_add_f32_dpp v160, v160, v160 quad_perm:[1,0,3,2] row_mask:0xf bank_mask:0xf
  v_add_f32_dpp v161, v161, v161 quad_perm:[1,0,3,2] row_mask:0xf bank_mask:0xf
  v_add_f32_dpp v162, v162, v162 quad_perm:[1,0,3,2] row_mask:0xf bank_mask:0xf
  v_mfma_f32_32x32x16_bf16 v[32:47], a[156:159], a[36:39], v[32:47]
  ds_read_b128 a[188:191], v11 offset:54272
  v_add_f32_dpp v163, v163, v163 quad_perm:[1,0,3,2] row_mask:0xf bank_mask:0xf
  v_add_f32_dpp v160, v160, v160 quad_perm:[2,3,0,1] row_mask:0xf bank_mask:0xf
  v_add_f32_dpp v161, v161, v161 quad_perm:[2,3,0,1] row_mask:0xf bank_mask:0xf
  v_add_f32_dpp v162, v162, v162 quad_perm:[2,3,0,1] row_mask:0xf bank_mask:0xf
  v_add_f32_dpp v163, v163, v163 quad_perm:[2,3,0,1] row_mask:0xf bank_mask:0xf
  v_min_u32 v160, -2, v160
  s_add_u32 m0, s17, 4096
  s_add_u32 s12, s11, 299008
  v_mfma_f32_32x32x16_bf16 v[32:47], a[160:163], a[40:43], v[32:47]
  buffer_load_dwordx4 v2, s[32:35], s12 offen  lds
  ds_read_b128 a[192:195], v11 offset:55296
  v_min_u32 v161, -2, v161
  v_min_u32 v162, -2, v162
  v_min_u32 v163, -2, v163
  s_waitcnt lgkmcnt(4)
  v_mfma_f32_32x32x16_bf16 v[32:47], a[164:167], a[44:47], v[32:47]
  ds_read_b128 a[148:151], v11 offset:56320
  buffer_store_dwordx4 v[160:163], v6, s[44:47], s42 offen sc1
  v_mfma_f32_32x32x16_bf16 v[32:47], a[168:171], a[48:51], v[32:47]
  ds_read_b128 a[152:155], v11 offset:57344
  s_add_u32 m0, s17, 8192
  s_add_u32 s12, s11, 303104
  v_mfma_f32_32x32x16_bf16 v[32:47], a[172:175], a[52:55], v[32:47]
  buffer_load_dwordx4 v2, s[32:35], s12 offen  lds
  ds_read_b128 a[156:159], v11 offset:58368
  v_mfma_f32_32x32x16_bf16 v[32:47], a[176:179], a[56:59], v[32:47]
  ds_read_b128 a[160:163], v11 offset:59392
  s_waitcnt lgkmcnt(4)
  v_mfma_f32_32x32x16_bf16 v[32:47], a[180:183], a[60:63], v[32:47]
  ds_read_b128 a[164:167], v11 offset:60416
  s_add_u32 m0, s17, 12288
  s_add_u32 s12, s11, 307200
  v_mfma_f32_32x32x16_bf16 v[32:47], a[184:187], a[64:67], v[32:47]
  buffer_load_dwordx4 v2, s[32:35], s12 offen  lds
  ds_read_b128 a[168:171], v11 offset:61440
  v_mfma_f32_32x32x16_bf16 v[32:47], a[188:191], a[68:71], v[32:47]
  ds_read_b128 a[172:175], v11 offset:62464
  v_mfma_f32_32x32x16_bf16 v[32:47], a[192:195], a[72:75], v[32:47]
  ds_read_b128 a[176:179], v11 offset:63488
  s_waitcnt lgkmcnt(4)
  s_add_u32 m0, s17, 16384
  s_add_u32 s12, s11, 311296
  v_mfma_f32_32x32x16_bf16 v[32:47], a[148:151], a[76:79], v[32:47]
  buffer_load_dwordx4 v2, s[32:35], s12 offen  lds
  ds_read_b128 a[180:183], v11 offset:64512
  v_mfma_f32_32x32x16_bf16 v[32:47], a[152:155], a[80:83], v[32:47]
  ds_read_b128 a[184:187], v12 offset:0
  v_mfma_f32_32x32x16_bf16 v[32:47], a[156:159], a[84:87], v[32:47]
  ds_read_b128 a[188:191], v12 offset:1024
  s_add_u32 m0, s17, 20480
  s_add_u32 s12, s11, 315392
  v_mfma_f32_32x32x16_bf16 v[32:47], a[160:163], a[88:91], v[32:47]
  buffer_load_dwordx4 v2, s[32:35], s12 offen  lds
  ds_read_b128 a[192:195], v12 offset:2048
  s_waitcnt lgkmcnt(4)
  v_mfma_f32_32x32x16_bf16 v[32:47], a[164:167], a[92:95], v[32:47]
  ds_read_b128 a[148:151], v12 offset:3072
  v_mfma_f32_32x32x16_bf16 v[32:47], a[168:171], a[96:99], v[32:47]
  ds_read_b128 a[152:155], v12 offset:4096
  v_mfma_f32_32x32x16_bf16 v[32:47], a[172:175], a[100:103], v[32:47]
  ds_read_b128 a[156:159], v12 offset:5120
  v_mfma_f32_32x32x16_bf16 v[32:47], a[176:179], a[104:107], v[32:47]
  ds_read_b128 a[160:163], v12 offset:6144
  s_waitcnt lgkmcnt(4)
  v_mfma_f32_32x32x16_bf16 v[32:47], a[180:183], a[108:111], v[32:47]
  ds_read_b128 a[164:167], v12 offset:7168
  v_mfma_f32_32x32x16_bf16 v[32:47], a[184:187], a[112:115], v[32:47]
  ds_read_b128 a[168:171], v3 offset:2560
  v_mfma_f32_32x32x16_bf16 v[32:47], a[188:191], a[116:119], v[32:47]
  s_waitcnt vmcnt(17)
  s_barrier
  ds_read_b128 a[172:175], v12 offset:8192
  v_mfma_f32_32x32x16_bf16 v[32:47], a[192:195], a[120:123], v[32:47]
  ds_read_b128 a[176:179], v12 offset:9216
  s_waitcnt lgkmcnt(4)
  s_add_u32 m0, s17, 24576
  s_add_u32 s12, s11, 319488
  v_mfma_f32_32x32x16_bf16 v[32:47], a[148:151], a[124:127], v[32:47]
  buffer_load_dwordx4 v2, s[32:35], s12 offen  lds
  ds_read_b128 a[180:183], v12 offset:10240
  v_mfma_f32_32x32x16_bf16 v[32:47], a[152:155], a[128:131], v[32:47]
  ds_read_b128 a[184:187], v12 offset:11264
  v_mfma_f32_32x32x16_bf16 v[32:47], a[156:159], a[132:135], v[32:47]
  ds_read_b128 a[188:191], v12 offset:12288
  s_add_u32 m0, s17, 28672
  s_add_u32 s12, s11, 323584
  v_mfma_f32_32x32x16_bf16 v[32:47], a[160:163], a[136:139], v[32:47]
  buffer_load_dwordx4 v2, s[32:35], s12 offen  lds
  ds_read_b128 a[192:195], v12 offset:13312
  s_waitcnt lgkmcnt(4)
  v_mfma_f32_32x32x16_bf16 v[32:47], a[164:167], a[140:143], v[32:47]
  ds_read_b128 a[148:151], v12 offset:14336
  v_mfma_f32_32x32x16_bf16 v[32:47], a[168:171], a[144:147], v[32:47]
  ds_read_b128 a[152:155], v12 offset:15360
  s_add_u32 m0, s17, 32768
  s_add_u32 s12, s11, 327680
  v_mfma_f32_32x32x16_bf16 v[16:31], a[172:175], a[0:3], 0
  buffer_load_dwordx4 v2, s[32:35], s12 offen  lds
  ds_read_b128 a[156:159], v12 offset:16384
  v_mfma_f32_32x32x16_bf16 v[16:31], a[176:179], a[4:7], v[16:31]
  ds_read_b128 a[160:163], v12 offset:17408
  s_waitcnt lgkmcnt(4)
  v_mfma_f32_32x32x16_bf16 v[16:31], a[180:183], a[8:11], v[16:31]
  ds_read_b128 a[164:167], v12 offset:18432
  v_mfma_f32_32x32x16_bf16 v[16:31], a[184:187], a[12:15], v[16:31]
  ds_read_b128 a[168:171], v12 offset:19456
  v_mfma_f32_32x32x16_bf16 v[16:31], a[188:191], a[16:19], v[16:31]
  ds_read_b128 a[172:175], v12 offset:20480
  v_mfma_f32_32x32x16_bf16 v[16:31], a[192:195], a[20:23], v[16:31]
  ds_read_b128 a[176:179], v12 offset:21504
  v_cvt_pk_bf16_f32 v212, v32, v33
  v_cvt_pk_bf16_f32 v213, v34, v35
  v_cvt_pk_bf16_f32 v214, v36, v37
  v_cvt_pk_bf16_f32 v215, v38, v39
  v_cvt_pk_bf16_f32 v216, v40, v41
  v_cvt_pk_bf16_f32 v217, v42, v43
  v_cvt_pk_bf16_f32 v218, v44, v45
  s_waitcnt lgkmcnt(4)
  v_mfma_f32_32x32x16_bf16 v[16:31], a[148:151], a[24:27], v[16:31]
  ds_read_b128 a[180:183], v12 offset:22528
  v_cvt_pk_bf16_f32 v219, v46, v47
  v_permlane16_swap_b32 v212, v214
  v_permlane16_swap_b32 v213, v215
  v_permlane16_swap_b32 v216, v218
  v_permlane16_swap_b32 v217, v219
  v_mfma_f32_32x32x16_bf16 v[16:31], a[152:155], a[28:31], v[16:31]
  ds_read_b128 a[184:187], v12 offset:23552
  v_mfma_f32_32x32x16_bf16 v[16:31], a[156:159], a[32:35], v[16:31]
  ds_read_b128 a[188:191], v12 offset:24576
  v_mfma_f32_32x32x16_bf16 v[16:31], a[160:163], a[36:39], v[16:31]
  ds_read_b128 a[192:195], v12 offset:25600
  s_waitcnt lgkmcnt(4)
  v_mfma_f32_32x32x16_bf16 v[16:31], a[164:167], a[40:43], v[16:31]
  ds_read_b128 a[148:151], v12 offset:26624
  v_mfma_f32_32x32x16_bf16 v[16:31], a[168:171], a[44:47], v[16:31]
  ds_read_b128 a[152:155], v12 offset:27648
  v_mfma_f32_32x32x16_bf16 v[16:31], a[172:175], a[48:51], v[16:31]
  ds_read_b128 a[156:159], v12 offset:28672
  v_mfma_f32_32x32x16_bf16 v[16:31], a[176:179], a[52:55], v[16:31]
  ds_read_b128 a[160:163], v12 offset:29696
  s_waitcnt lgkmcnt(4)
  v_mfma_f32_32x32x16_bf16 v[16:31], a[180:183], a[56:59], v[16:31]
  ds_read_b128 a[164:167], v12 offset:30720
  v_mfma_f32_32x32x16_bf16 v[16:31], a[184:187], a[60:63], v[16:31]
  ds_read_b128 a[168:171], v12 offset:31744
  v_mfma_f32_32x32x16_bf16 v[16:31], a[188:191], a[64:67], v[16:31]
  ds_read_b128 a[172:175], v12 offset:32768
  v_mfma_f32_32x32x16_bf16 v[16:31], a[192:195], a[68:71], v[16:31]
  ds_read_b128 a[176:179], v12 offset:33792
  s_waitcnt lgkmcnt(4)
  v_mfma_f32_32x32x16_bf16 v[16:31], a[148:151], a[72:75], v[16:31]
  ds_read_b128 a[180:183], v12 offset:34816
  v_mfma_f32_32x32x16_bf16 v[16:31], a[152:155], a[76:79], v[16:31]
  ds_read_b128 a[184:187], v12 offset:35840
  v_mfma_f32_32x32x16_bf16 v[16:31], a[156:159], a[80:83], v[16:31]
  ds_read_b128 a[188:191], v12 offset:36864
  v_mfma_f32_32x32x16_bf16 v[16:31], a[160:163], a[84:87], v[16:31]
  ds_read_b128 a[192:195], v12 offset:37888
  s_waitcnt lgkmcnt(4)
  v_mfma_f32_32x32x16_bf16 v[16:31], a[164:167], a[88:91], v[16:31]
  ds_read_b128 a[148:151], v12 offset:38912
  v_mfma_f32_32x32x16_bf16 v[16:31], a[168:171], a[92:95], v[16:31]
  ds_read_b128 a[152:155], v12 offset:39936
  v_mfma_f32_32x32x16_bf16 v[16:31], a[172:175], a[96:99], v[16:31]
  ds_read_b128 a[156:159], v12 offset:40960
  v_mfma_f32_32x32x16_bf16 v[16:31], a[176:179], a[100:103], v[16:31]
  ds_read_b128 a[160:163], v12 offset:41984
  s_waitcnt lgkmcnt(4)
  v_mfma_f32_32x32x16_bf16 v[16:31], a[180:183], a[104:107], v[16:31]
  ds_read_b128 a[164:167], v12 offset:43008
  v_mfma_f32_32x32x16_bf16 v[16:31], a[184:187], a[108:111], v[16:31]
  ds_read_b128 a[168:171], v12 offset:44032
  v_mfma_f32_32x32x16_bf16 v[16:31], a[188:191], a[112:115], v[16:31]
  ds_read_b128 a[172:175], v3 offset:3072
  v_mfma_f32_32x32x16_bf16 v[16:31], a[192:195], a[116:119], v[16:31]
  s_waitcnt vmcnt(11)
  s_barrier
  ds_read_b128 a[176:179], v12 offset:45056
  s_waitcnt lgkmcnt(4)
  v_mfma_f32_32x32x16_bf16 v[16:31], a[148:151], a[120:123], v[16:31]
  ds_read_b128 a[180:183], v12 offset:46080
  v_mfma_f32_32x32x16_bf16 v[16:31], a[152:155], a[124:127], v[16:31]
  ds_read_b128 a[184:187], v12 offset:47104
  v_mfma_f32_32x32x16_bf16 v[16:31], a[156:159], a[128:131], v[16:31]
  ds_read_b128 a[188:191], v12 offset:48128
  buffer_load_dwordx4 v[176:179], v7, s[44:47], s43 offen sc1
  v_mfma_f32_32x32x16_bf16 v[16:31], a[160:163], a[132:135], v[16:31]
  ds_read_b128 a[192:195], v12 offset:49152
  buffer_load_dwordx4 v[180:183], v7, s[44:47], s48 offen sc1
  s_waitcnt lgkmcnt(4)
  v_mfma_f32_32x32x16_bf16 v[16:31], a[164:167], a[136:139], v[16:31]
  ds_read_b128 a[148:151], v12 offset:50176
  buffer_load_dwordx4 v[184:187], v7, s[44:47], s49 offen sc1
  v_mfma_f32_32x32x16_bf16 v[16:31], a[168:171], a[140:143], v[16:31]
  ds_read_b128 a[152:155], v12 offset:51200
  buffer_load_dwordx4 v[188:191], v7, s[44:47], s50 offen sc1
  v_mfma_f32_32x32x16_bf16 v[16:31], a[172:175], a[144:147], v[16:31]
  ds_read_b128 a[156:159], v12 offset:52224
  v_mfma_f32_32x32x16_bf16 v[32:47], a[176:179], a[0:3], 0
  ds_read_b128 a[160:163], v12 offset:53248
  s_waitcnt lgkmcnt(4)
  v_mfma_f32_32x32x16_bf16 v[32:47], a[180:183], a[4:7], v[32:47]
  ds_read_b128 a[164:167], v12 offset:54272
  v_mfma_f32_32x32x16_bf16 v[32:47], a[184:187], a[8:11], v[32:47]
  ds_read_b128 a[168:171], v12 offset:55296
  v_mfma_f32_32x32x16_bf16 v[32:47], a[188:191], a[12:15], v[32:47]
  ds_read_b128 a[172:175], v12 offset:56320
  v_mfma_f32_32x32x16_bf16 v[32:47], a[192:195], a[16:19], v[32:47]
  ds_read_b128 a[176:179], v12 offset:57344
  buffer_load_dwordx4 a[212:215], v2, s[36:39], s7 offen
  s_add_u32 s7, s7, 4096
  s_waitcnt lgkmcnt(4)
  v_mfma_f32_32x32x16_bf16 v[32:47], a[148:151], a[20:23], v[32:47]
  ds_read_b128 a[180:183], v12 offset:58368
  v_cvt_pk_bf16_f32 v220, v16, v17
  v_cvt_pk_bf16_f32 v221, v18, v19
  v_cvt_pk_bf16_f32 v222, v20, v21
  v_cvt_pk_bf16_f32 v223, v22, v23
  v_cvt_pk_bf16_f32 v224, v24, v25
  v_cvt_pk_bf16_f32 v225, v26, v27
  v_cvt_pk_bf16_f32 v226, v28, v29
  v_mfma_f32_32x32x16_bf16 v[32:47], a[152:155], a[24:27], v[32:47]
  ds_read_b128 a[184:187], v12 offset:59392
  v_cvt_pk_bf16_f32 v227, v30, v31
  v_permlane16_swap_b32 v220, v222
  v_permlane16_swap_b32 v221, v223
  v_permlane16_swap_b32 v224, v226
  v_permlane16_swap_b32 v225, v227
  v_mfma_f32_32x32x16_bf16 v[32:47], a[156:159], a[28:31], v[32:47]
  ds_read_b128 a[188:191], v12 offset:60416
  buffer_load_dwordx4 a[216:219], v2, s[36:39], s7 offen
  s_add_u32 s7, s7, 4096
  v_mfma_f32_32x32x16_bf16 v[32:47], a[160:163], a[32:35], v[32:47]
  ds_read_b128 a[192:195], v12 offset:61440
  s_waitcnt lgkmcnt(4)
  v_mfma_f32_32x32x16_bf16 v[32:47], a[164:167], a[36:39], v[32:47]
  ds_read_b128 a[148:151], v12 offset:62464
  v_mfma_f32_32x32x16_bf16 v[32:47], a[168:171], a[40:43], v[32:47]
  ds_read_b128 a[152:155], v12 offset:63488
  buffer_load_dwordx4 a[220:223], v2, s[36:39], s7 offen
  s_add_u32 s7, s7, 4096
  v_mfma_f32_32x32x16_bf16 v[32:47], a[172:175], a[44:47], v[32:47]
  ds_read_b128 a[156:159], v12 offset:64512
  v_mfma_f32_32x32x16_bf16 v[32:47], a[176:179], a[48:51], v[32:47]
  ds_read_b128 a[160:163], v13 offset:0
  s_waitcnt lgkmcnt(4)
  v_mfma_f32_32x32x16_bf16 v[32:47], a[180:183], a[52:55], v[32:47]
  ds_read_b128 a[164:167], v13 offset:1024
  buffer_load_dwordx4 a[224:227], v2, s[36:39], s7 offen
  s_add_u32 s7, s7, 4096
  v_mfma_f32_32x32x16_bf16 v[32:47], a[184:187], a[56:59], v[32:47]
  ds_read_b128 a[168:171], v13 offset:2048
  v_mfma_f32_32x32x16_bf16 v[32:47], a[188:191], a[60:63], v[32:47]
  ds_read_b128 a[172:175], v13 offset:3072
  s_waitcnt vmcnt(4)
  ds_read_b32 v165, v10
  v_max3_u32 v164, v176, v177, v178
  v_max3_u32 v164, v179, v180, v164
  v_max3_u32 v164, v181, v182, v164
  v_max3_u32 v164, v183, v184, v164
  v_max3_u32 v164, v185, v186, v164
  v_max3_u32 v164, v187, v188, v164
  v_mfma_f32_32x32x16_bf16 v[32:47], a[192:195], a[64:67], v[32:47]
  ds_read_b128 a[176:179], v13 offset:4096
  buffer_load_dwordx4 a[228:231], v2, s[36:39], s7 offen
  s_add_u32 s7, s7, 4096
  v_max3_u32 v164, v189, v190, v164
  v_max_u32 v164, v191, v164
  v_cmp_eq_u32 vcc, -1, v164
  s_nop 4
  s_cbranch_vccnz kt_tail_kernel_retryo
kt_tail_kernel_chko:
  v_add_f32 v176, v176, v184
  s_waitcnt lgkmcnt(5)
  v_mfma_f32_32x32x16_bf16 v[32:47], a[148:151], a[68:71], v[32:47]
  ds_read_b128 a[180:183], v13 offset:5120
  v_add_f32 v177, v177, v185
  v_add_f32 v178, v178, v186
  v_add_f32 v179, v179, v187
  v_add_f32 v180, v180, v188
  v_add_f32 v181, v181, v189
  v_add_f32 v182, v182, v190
  v_mfma_f32_32x32x16_bf16 v[32:47], a[152:155], a[72:75], v[32:47]
  ds_read_b128 a[184:187], v13 offset:6144
  v_add_f32 v183, v183, v191
  v_add_f32 v176, v176, v180
  v_add_f32 v177, v177, v181
  v_add_f32 v178, v178, v182
  v_add_f32 v179, v179, v183
  v_permlane16_swap_b32 v176, v177
  v_mfma_f32_32x32x16_bf16 v[32:47], a[156:159], a[76:79], v[32:47]
  ds_read_b128 a[188:191], v13 offset:7168
  buffer_load_dwordx4 a[232:235], v2, s[36:39], s7 offen
  s_add_u32 s7, s7, 4096
  v_permlane16_swap_b32 v178, v179
  v_add_f32 v176, v176, v177
  v_add_f32 v178, v178, v179
  s_nop 1
  v_permlane32_swap_b32 v176, v178
  v_mfma_f32_32x32x16_bf16 v[32:47], a[160:163], a[80:83], v[32:47]
  ds_read_b128 a[192:195], v13 offset:8192
  v_add_f32 v176, v176, v178
  v_mul_f32 v176, 0x39e38e39, v176
  v_mov_b32 v177, v176
  v_mov_b32 v178, v176
  s_nop 0
  v_mov_b32_dpp v177, v176 row_ror:8 row_mask:0xf bank_mask:0xc
  v_mov_b32_dpp v178, v176 row_ror:8 row_mask:0xf bank_mask:0x3
  s_waitcnt lgkmcnt(4)
  v_mfma_f32_32x32x16_bf16 v[32:47], a[164:167], a[84:87], v[32:47]
  ds_read_b128 a[148:151], v13 offset:9216
  v_fma_f32 v178, -v177, v177, v178
  v_max_f32 v178, 0, v178
  s_waitcnt lgkmcnt(6)
  v_add_f32 v178, v178, v165
  v_rsq_f32 v178, v178
  s_nop 0
  v_mul_f32 v177, -v177, v178
  v_mfma_f32_32x32x16_bf16 v[32:47], a[168:171], a[88:91], v[32:47]
  ds_read_b128 a[152:155], v13 offset:10240
  buffer_load_dwordx4 a[236:239], v2, s[36:39], s7 offen
  s_add_u32 s7, s7, 4096
  v_cndmask_b32 v178, v178, v177, s[52:53]
  v_mfma_f32_32x32x16_bf16 v[32:47], a[172:175], a[92:95], v[32:47]
  ds_read_b128 a[156:159], v13 offset:11264
  ds_write_b32 v9, v178
  s_waitcnt lgkmcnt(0)
  v_mfma_f32_32x32x16_bf16 v[32:47], a[176:179], a[96:99], v[32:47]
  ds_read_b128 a[160:163], v13 offset:12288
  ds_read_b128 v[128:131], v8 offset:0
  s_waitcnt lgkmcnt(6)
  v_mfma_f32_32x32x16_bf16 v[32:47], a[180:183], a[100:103], v[32:47]
  ds_read_b128 a[164:167], v13 offset:13312
  buffer_load_dwordx4 a[240:243], v2, s[36:39], s7 offen
  s_add_u32 s7, s7, 4096
  ds_read_b128 v[144:147], v8 offset:128
  v_mfma_f32_32x32x16_bf16 v[32:47], a[184:187], a[104:107], v[32:47]
  ds_read_b128 a[168:171], v13 offset:14336
  ds_read_b128 v[132:135], v8 offset:32
  v_mfma_f32_32x32x16_bf16 v[32:47], a[188:191], a[108:111], v[32:47]
  ds_read_b128 a[172:175], v13 offset:15360
  ds_read_b128 v[148:151], v8 offset:160
  v_mfma_f32_32x32x16_bf16 v[32:47], a[192:195], a[112:115], v[32:47]
  ds_read_b128 a[176:179], v3 offset:3584
  buffer_load_dwordx4 a[244:247], v2, s[36:39], s7 offen
  s_add_u32 s7, s7, 4096
  ds_read_b128 v[136:139], v8 offset:64
  s_waitcnt lgkmcnt(9)
  v_mfma_f32_32x32x16_bf16 v[32:47], a[148:151], a[116:119], v[32:47]
  s_barrier
  ds_read_b128 a[180:183], v11 offset:0
  ds_read_b128 v[152:155], v8 offset:192
  v_mfma_f32_32x32x16_bf16 v[32:47], a[152:155], a[120:123], v[32:47]
  ds_read_b128 a[184:187], v11 offset:1024
  ds_read_b128 v[140:143], v8 offset:96
  v_mfma_f32_32x32x16_bf16 v[32:47], a[156:159], a[124:127], v[32:47]
  ds_read_b128 a[188:191], v11 offset:2048
  buffer_load_dwordx4 a[248:251], v2, s[36:39], s7 offen
  s_add_u32 s7, s7, 4096
  ds_read_b128 v[156:159], v8 offset:224
  s_waitcnt lgkmcnt(0)
  v_fma_f32 v48, v48, v128, v144
  v_fma_f32 v49, v49, v129, v145
  v_fma_f32 v50, v50, v130, v146
  v_fma_f32 v51, v51, v131, v147
  v_mfma_f32_32x32x16_bf16 v[32:47], a[160:163], a[128:131], v[32:47]
  ds_read_b128 a[192:195], v11 offset:3072
  v_fma_f32 v52, v52, v132, v148
  v_fma_f32 v53, v53, v133, v149
  v_fma_f32 v54, v54, v134, v150
  v_fma_f32 v55, v55, v135, v151
  v_fma_f32 v56, v56, v136, v152
  v_fma_f32 v57, v57, v137, v153
  s_waitcnt lgkmcnt(8)
  v_mfma_f32_32x32x16_bf16 v[32:47], a[164:167], a[132:135], v[32:47]
  ds_read_b128 a[148:151], v11 offset:4096
  v_fma_f32 v58, v58, v138, v154
  v_fma_f32 v59, v59, v139, v155
  v_fma_f32 v60, v60, v140, v156
  v_fma_f32 v61, v61, v141, v157
  v_fma_f32 v62, v62, v142, v158
  v_fma_f32 v63, v63, v143, v159
  v_mfma_f32_32x32x16_bf16 v[32:47], a[168:171], a[136:139], v[32:47]
  ds_read_b128 a[152:155], v11 offset:5120
  buffer_load_dwordx4 a[252:255], v2, s[36:39], s7 offen
  s_add_u32 s7, s7, 4096
  v_cvt_pk_bf16_f32 v48, v48, v49
  v_cvt_pk_bf16_f32 v49, v50, v51
  v_cvt_pk_bf16_f32 v50, v52, v53
  v_cvt_pk_bf16_f32 v51, v54, v55
  v_mfma_f32_32x32x16_bf16 v[32:47], a[172:175], a[140:143], v[32:47]
  ds_read_b128 a[156:159], v11 offset:6144
  v_cvt_pk_bf16_f32 v52, v56, v57
  v_cvt_pk_bf16_f32 v53, v58, v59
  v_cvt_pk_bf16_f32 v54, v60, v61
  v_cvt_pk_bf16_f32 v55, v62, v63
  s_add_u32 s54, s51, 590848
  v_permlane32_swap_b32 v48, v50
  v_permlane32_swap_b32 v49, v51
  v_mfma_f32_32x32x16_bf16 v[32:47], a[176:179], a[144:147], v[32:47]
  ds_read_b128 a[160:163], v11 offset:7168
  v_permlane32_swap_b32 v52, v54
  v_permlane32_swap_b32 v53, v55
  s_waitcnt lgkmcnt(4)
  v_mfma_f32_32x32x16_bf16 v[16:31], a[180:183], a[0:3], 0
  ds_read_b128 a[164:167], v11 offset:8192
  buffer_store_dwordx4 v[48:51], v4, s[56:59], s54 offen sc1
  v_mfma_f32_32x32x16_bf16 v[16:31], a[184:187], a[4:7], v[16:31]
  ds_read_b128 a[168:171], v11 offset:9216
  buffer_store_dwordx4 v[52:55], v4, s[56:59], s54 offen offset:512 sc1
  v_fma_f32 v64, v64, v128, v144
  v_fma_f32 v65, v65, v129, v145
  v_fma_f32 v66, v66, v130, v146
  v_fma_f32 v67, v67, v131, v147
  v_fma_f32 v68, v68, v132, v148
  v_mfma_f32_32x32x16_bf16 v[16:31], a[188:191], a[8:11], v[16:31]
  ds_read_b128 a[172:175], v11 offset:10240
  v_fma_f32 v69, v69, v133, v149
  v_fma_f32 v70, v70, v134, v150
  v_fma_f32 v71, v71, v135, v151
  v_fma_f32 v72, v72, v136, v152
  v_fma_f32 v73, v73, v137, v153
  v_fma_f32 v74, v74, v138, v154
  v_mfma_f32_32x32x16_bf16 v[16:31], a[192:195], a[12:15], v[16:31]
  ds_read_b128 a[176:179], v11 offset:11264
  v_fma_f32 v75, v75, v139, v155
  v_fma_f32 v76, v76, v140, v156
  v_fma_f32 v77, v77, v141, v157
  v_fma_f32 v78, v78, v142, v158
  v_fma_f32 v79, v79, v143, v159
  v_cvt_pk_bf16_f32 v64, v64, v65
  s_waitcnt lgkmcnt(4)
  v_mfma_f32_32x32x16_bf16 v[16:31], a[148:151], a[16:19], v[16:31]
  ds_read_b128 a[180:183], v11 offset:12288
  v_cvt_pk_bf16_f32 v65, v66, v67
  v_cvt_pk_bf16_f32 v66, v68, v69
  v_cvt_pk_bf16_f32 v67, v70, v71
  v_cvt_pk_bf16_f32 v68, v72, v73
  v_cvt_pk_bf16_f32 v69, v74, v75
  v_cvt_pk_bf16_f32 v70, v76, v77
  v_mfma_f32_32x32x16_bf16 v[16:31], a[152:155], a[20:23], v[16:31]
  ds_read_b128 a[184:187], v11 offset:13312
  v_cvt_pk_bf16_f32 v228, v32, v33
  v_cvt_pk_bf16_f32 v229, v34, v35
  v_cvt_pk_bf16_f32 v230, v36, v37
  v_cvt_pk_bf16_f32 v231, v38, v39
  v_cvt_pk_bf16_f32 v232, v40, v41
  v_cvt_pk_bf16_f32 v233, v42, v43
  v_mfma_f32_32x32x16_bf16 v[16:31], a[156:159], a[24:27], v[16:31]
  ds_read_b128 a[188:191], v11 offset:14336
  v_cvt_pk_bf16_f32 v234, v44, v45
  v_cvt_pk_bf16_f32 v235, v46, v47
  v_permlane16_swap_b32 v228, v230
  v_permlane16_swap_b32 v229, v231
  v_permlane16_swap_b32 v232, v234
  v_permlane16_swap_b32 v233, v235
  v_mfma_f32_32x32x16_bf16 v[16:31], a[160:163], a[28:31], v[16:31]
  ds_read_b128 a[192:195], v11 offset:15360
  v_cvt_pk_bf16_f32 v71, v78, v79
  s_add_u32 s54, s51, 592896
  v_permlane32_swap_b32 v64, v66
  v_permlane32_swap_b32 v65, v67
  v_permlane32_swap_b32 v68, v70
  v_permlane32_swap_b32 v69, v71
  s_waitcnt lgkmcnt(4)
  v_mfma_f32_32x32x16_bf16 v[16:31], a[164:167], a[32:35], v[16:31]
  ds_read_b128 a[148:151], v11 offset:16384
  buffer_store_dwordx4 v[64:67], v4, s[56:59], s54 offen sc1
  v_mfma_f32_32x32x16_bf16 v[16:31], a[168:171], a[36:39], v[16:31]
  ds_read_b128 a[152:155], v11 offset:17408
  buffer_store_dwordx4 v[68:71], v4, s[56:59], s54 offen offset:512 sc1
  v_fma_f32 v80, v80, v128, v144
  v_fma_f32 v81, v81, v129, v145
  v_fma_f32 v82, v82, v130, v146
  v_fma_f32 v83, v83, v131, v147
  v_fma_f32 v84, v84, v132, v148
  v_mfma_f32_32x32x16_bf16 v[16:31], a[172:175], a[40:43], v[16:31]
  ds_read_b128 a[156:159], v11 offset:18432
  v_fma_f32 v85, v85, v133, v149
  v_fma_f32 v86, v86, v134, v150
  v_fma_f32 v87, v87, v135, v151
  v_fma_f32 v88, v88, v136, v152
  v_fma_f32 v89, v89, v137, v153
  v_fma_f32 v90, v90, v138, v154
  v_mfma_f32_32x32x16_bf16 v[16:31], a[176:179], a[44:47], v[16:31]
  ds_read_b128 a[160:163], v11 offset:19456
  v_fma_f32 v91, v91, v139, v155
  v_fma_f32 v92, v92, v140, v156
  v_fma_f32 v93, v93, v141, v157
  v_fma_f32 v94, v94, v142, v158
  v_fma_f32 v95, v95, v143, v159
  v_cvt_pk_bf16_f32 v80, v80, v81
  s_waitcnt lgkmcnt(4)
  v_mfma_f32_32x32x16_bf16 v[16:31], a[180:183], a[48:51], v[16:31]
  ds_read_b128 a[164:167], v11 offset:20480
  v_cvt_pk_bf16_f32 v81, v82, v83
  v_cvt_pk_bf16_f32 v82, v84, v85
  v_cvt_pk_bf16_f32 v83, v86, v87
  v_cvt_pk_bf16_f32 v84, v88, v89
  v_cvt_pk_bf16_f32 v85, v90, v91
  v_cvt_pk_bf16_f32 v86, v92, v93
  v_mfma_f32_32x32x16_bf16 v[16:31], a[184:187], a[52:55], v[16:31]
  ds_read_b128 a[168:171], v11 offset:21504
  v_cvt_pk_bf16_f32 v87, v94, v95
  s_add_u32 s54, s51, 594944
  v_permlane32_swap_b32 v80, v82
  v_permlane32_swap_b32 v81, v83
  v_permlane32_swap_b32 v84, v86
  v_permlane32_swap_b32 v85, v87
  v_mfma_f32_32x32x16_bf16 v[16:31], a[188:191], a[56:59], v[16:31]
  ds_read_b128 a[172:175], v11 offset:22528
  buffer_store_dwordx4 v[80:83], v4, s[56:59], s54 offen sc1
  v_mfma_f32_32x32x16_bf16 v[16:31], a[192:195], a[60:63], v[16:31]
  ds_read_b128 a[176:179], v11 offset:23552
  buffer_store_dwordx4 v[84:87], v4, s[56:59], s54 offen offset:512 sc1
  v_fma_f32 v96, v96, v128, v144
  v_fma_f32 v97, v97, v129, v145
  v_fma_f32 v98, v98, v130, v146
  v_fma_f32 v99, v99, v131, v147
  v_fma_f32 v100, v100, v132, v148
  s_waitcnt lgkmcnt(4)
  v_mfma_f32_32x32x16_bf16 v[16:31], a[148:151], a[64:67], v[16:31]
  ds_read_b128 a[180:183], v11 offset:24576
  v_fma_f32 v101, v101, v133, v149
  v_fma_f32 v102, v102, v134, v150
  v_fma_f32 v103, v103, v135, v151
  v_fma_f32 v104, v104, v136, v152
  v_fma_f32 v105, v105, v137, v153
  v_fma_f32 v106, v106, v138, v154
  v_mfma_f32_32x32x16_bf16 v[16:31], a[152:155], a[68:71], v[16:31]
  ds_read_b128 a[184:187], v11 offset:25600
  v_fma_f32 v107, v107, v139, v155
  v_fma_f32 v108, v108, v140, v156
  v_fma_f32 v109, v109, v141, v157
  v_fma_f32 v110, v110, v142, v158
  v_fma_f32 v111, v111, v143, v159
  v_cvt_pk_bf16_f32 v96, v96, v97
  v_mfma_f32_32x32x16_bf16 v[16:31], a[156:159], a[72:75], v[16:31]
  ds_read_b128 a[188:191], v11 offset:26624
  v_cvt_pk_bf16_f32 v97, v98, v99
  v_cvt_pk_bf16_f32 v98, v100, v101
  v_cvt_pk_bf16_f32 v99, v102, v103
  v_cvt_pk_bf16_f32 v100, v104, v105
  v_cvt_pk_bf16_f32 v101, v106, v107
  v_cvt_pk_bf16_f32 v102, v108, v109
  v_mfma_f32_32x32x16_bf16 v[16:31], a[160:163], a[76:79], v[16:31]
  ds_read_b128 a[192:195], v11 offset:27648
  v_cvt_pk_bf16_f32 v103, v110, v111
  s_add_u32 s54, s51, 596992
  v_permlane32_swap_b32 v96, v98
  v_permlane32_swap_b32 v97, v99
  v_permlane32_swap_b32 v100, v102
  v_permlane32_swap_b32 v101, v103
  s_waitcnt lgkmcnt(4)
  v_mfma_f32_32x32x16_bf16 v[16:31], a[164:167], a[80:83], v[16:31]
  ds_read_b128 a[148:151], v11 offset:28672
  buffer_store_dwordx4 v[96:99], v4, s[56:59], s54 offen sc1
  v_mfma_f32_32x32x16_bf16 v[16:31], a[168:171], a[84:87], v[16:31]
  ds_read_b128 a[152:155], v11 offset:29696
  buffer_store_dwordx4 v[100:103], v4, s[56:59], s54 offen offset:512 sc1
  v_mfma_f32_32x32x16_bf16 v[16:31], a[172:175], a[88:91], v[16:31]
  ds_read_b128 a[156:159], v11 offset:30720
  v_mfma_f32_32x32x16_bf16 v[16:31], a[176:179], a[92:95], v[16:31]
  ds_read_b128 a[160:163], v11 offset:31744
  s_waitcnt lgkmcnt(4)
  v_mfma_f32_32x32x16_bf16 v[16:31], a[180:183], a[96:99], v[16:31]
  ds_read_b128 a[164:167], v11 offset:32768
  v_mfma_f32_32x32x16_bf16 v[16:31], a[184:187], a[100:103], v[16:31]
  ds_read_b128 a[168:171], v11 offset:33792
  v_mfma_f32_32x32x16_bf16 v[16:31], a[188:191], a[104:107], v[16:31]
  ds_read_b128 a[172:175], v11 offset:34816
  v_mfma_f32_32x32x16_bf16 v[16:31], a[192:195], a[108:111], v[16:31]
  ds_read_b128 a[176:179], v11 offset:35840
  s_waitcnt lgkmcnt(4)
  v_mfma_f32_32x32x16_bf16 v[16:31], a[148:151], a[112:115], v[16:31]
  ds_read_b128 a[180:183], v3 offset:4096
  v_mfma_f32_32x32x16_bf16 v[16:31], a[152:155], a[116:119], v[16:31]
  v_mfma_f32_32x32x16_bf16 v[16:31], a[156:159], a[120:123], v[16:31]
  v_mfma_f32_32x32x16_bf16 v[16:31], a[160:163], a[124:127], v[16:31]
  s_waitcnt lgkmcnt(1)
  v_mfma_f32_32x32x16_bf16 v[16:31], a[164:167], a[128:131], v[16:31]
  v_mfma_f32_32x32x16_bf16 v[16:31], a[168:171], a[132:135], v[16:31]
  v_mfma_f32_32x32x16_bf16 v[16:31], a[172:175], a[136:139], v[16:31]
  v_mfma_f32_32x32x16_bf16 v[16:31], a[176:179], a[140:143], v[16:31]
  s_waitcnt lgkmcnt(0)
  v_mfma_f32_32x32x16_bf16 v[16:31], a[180:183], a[144:147], v[16:31]
  s_nop 11
  v_cvt_pk_bf16_f32 v236, v16, v17
  v_cvt_pk_bf16_f32 v237, v18, v19
  v_cvt_pk_bf16_f32 v238, v20, v21
  v_cvt_pk_bf16_f32 v239, v22, v23
  v_cvt_pk_bf16_f32 v240, v24, v25
  v_cvt_pk_bf16_f32 v241, v26, v27
  v_cvt_pk_bf16_f32 v242, v28, v29
  v_cvt_pk_bf16_f32 v243, v30, v31
  v_permlane16_swap_b32 v236, v238
  v_permlane16_swap_b32 v237, v239
  v_permlane16_swap_b32 v240, v242
  v_permlane16_swap_b32 v241, v243
  s_mov_b32 s28, s66
  s_and_b32 s29, s67, 0xffff
  s_mov_b32 s30, 8388608
  s_mov_b32 s31, 0x20000
  v_lshrrev_b32 v248, 3, v1
  v_and_b32 v249, 6, v248
  v_and_b32 v250, 7, v1
  v_xor_b32 v249, v249, v250
  v_lshlrev_b32 v249, 4, v249
  v_lshl_add_u32 v252, v248, 12, v249
  v_add_u32 v253, 32768, v252
  v_add_u32 v254, 65536, v252
  v_add_u32 v255, 98304, v252
  s_lshl_b32 s11, s78, 17
  s_lshl_b32 s13, s3, 12
  s_add_u32 s13, s13, 73728
  s_lshl_b32 s18, s79, 12
  s_add_u32 s19, s18, 131072
  s_and_b32 s12, s77, 1
  s_lshl_b32 s12, s12, 4
  s_add_u32 s12, s12, s76
  s_lshr_b32 s18, s12, 0
  s_lshl_b32 s18, s18, 7
  s_add_u32 s18, s18, s19
  s_and_b32 s12, s12, 0
  s_lshl_b32 s12, s12, 2
  s_add_u32 s18, s18, s12
  s_barrier
  s_add_u32 m0, s13, 0
  s_nop 0
  buffer_load_dwordx4 v252, s[28:31], s11 offen  lds
  s_add_u32 m0, s13, 1024
  s_nop 0
  buffer_load_dwordx4 v253, s[28:31], s11 offen  lds
  s_add_u32 m0, s13, 2048
  s_nop 0
  buffer_load_dwordx4 v254, s[28:31], s11 offen  lds
  s_add_u32 m0, s13, 3072
  s_nop 0
  buffer_load_dwordx4 v255, s[28:31], s11 offen  lds
  s_add_u32 m0, s13, 16384
  s_add_u32 s11, s11, 128
  buffer_load_dwordx4 v252, s[28:31], s11 offen  lds
  s_add_u32 m0, s13, 17408
  s_nop 0
  buffer_load_dwordx4 v253, s[28:31], s11 offen  lds
  s_add_u32 m0, s13, 18432
  s_nop 0
  buffer_load_dwordx4 v254, s[28:31], s11 offen  lds
  s_add_u32 m0, s13, 19456
  s_nop 0
  buffer_load_dwordx4 v255, s[28:31], s11 offen  lds
  v_and_b32 v192, 15, v1
  v_lshl_add_u32 v192, v192, 2, s40
  ds_read_b32 v14, v192 offset:384
  ds_read_b32 v15, v192 offset:448
  s_waitcnt lgkmcnt(0)
  v_mul_f32 v6, 0xc0135761, v14
  v_mul_f32 v10, v14, v14
  v_rcp_f32 v194, v14
  v_mul_f32 v10, 0x3d372713, v10
  v_mul_f32 v10, v10, v6
  v_mul_f32 v8, 0xc0135761, v15
  v_mul_f32 v12, v15, v15
  v_rcp_f32 v196, v15
  v_mul_f32 v12, 0x3d372713, v12
  v_mul_f32 v12, v12, v8
  v_lshlrev_b32 v88, 16, v208
  v_and_b32 v89, 0xffff0000, v208
  v_lshlrev_b32 v90, 16, v209
  v_and_b32 v91, 0xffff0000, v209
  v_lshlrev_b32 v92, 16, v212
  v_and_b32 v93, 0xffff0000, v212
  v_lshlrev_b32 v94, 16, v213
  v_and_b32 v95, 0xffff0000, v213
  v_pk_mul_f32 v[160:161], v[88:89], v[88:89]
  v_pk_mul_f32 v[162:163], v[90:91], v[90:91]
  v_pk_mul_f32 v[164:165], v[92:93], v[92:93]
  v_pk_mul_f32 v[166:167], v[94:95], v[94:95]
  v_pk_fma_f32 v[160:161], v[160:161], v[10:11], v[6:7] op_sel_hi:[1,0,0]
  v_pk_fma_f32 v[162:163], v[162:163], v[10:11], v[6:7] op_sel_hi:[1,0,0]
  v_pk_fma_f32 v[164:165], v[164:165], v[10:11], v[6:7] op_sel_hi:[1,0,0]
  v_pk_fma_f32 v[166:167], v[166:167], v[10:11], v[6:7] op_sel_hi:[1,0,0]
  v_pk_mul_f32 v[160:161], v[160:161], v[88:89]
  v_pk_mul_f32 v[162:163], v[162:163], v[90:91]
  v_pk_mul_f32 v[164:165], v[164:165], v[92:93]
  v_pk_mul_f32 v[166:167], v[166:167], v[94:95]
  v_exp_f32 v160, v160
  v_exp_f32 v161, v161
  v_exp_f32 v162, v162
  v_exp_f32 v163, v163
  v_exp_f32 v164, v164
  v_exp_f32 v165, v165
  v_exp_f32 v166, v166
  v_exp_f32 v167, v167
  v_pk_fma_f32 v[160:161], v[160:161], v[194:195], v[194:195] op_sel_hi:[1,0,0]
  v_pk_fma_f32 v[162:163], v[162:163], v[194:195], v[194:195] op_sel_hi:[1,0,0]
  v_pk_fma_f32 v[164:165], v[164:165], v[194:195], v[194:195] op_sel_hi:[1,0,0]
  v_pk_fma_f32 v[166:167], v[166:167], v[194:195], v[194:195] op_sel_hi:[1,0,0]
  v_rcp_f32 v160, v160
  v_rcp_f32 v161, v161
  v_rcp_f32 v162, v162
  v_rcp_f32 v163, v163
  v_rcp_f32 v164, v164
  v_rcp_f32 v165, v165
  v_rcp_f32 v166, v166
  v_rcp_f32 v167, v167
  v_pk_mul_f32 v[88:89], v[88:89], v[160:161]
  v_pk_mul_f32 v[90:91], v[90:91], v[162:163]
  v_pk_mul_f32 v[92:93], v[92:93], v[164:165]
  v_pk_mul_f32 v[94:95], v[94:95], v[166:167]
  v_lshlrev_b32 v96, 16, v216
  v_and_b32 v97, 0xffff0000, v216
  v_lshlrev_b32 v98, 16, v217
  v_and_b32 v99, 0xffff0000, v217
  v_lshlrev_b32 v100, 16, v220
  v_and_b32 v101, 0xffff0000, v220
  v_lshlrev_b32 v102, 16, v221
  v_and_b32 v103, 0xffff0000, v221
  v_pk_mul_f32 v[168:169], v[96:97], v[96:97]
  v_pk_mul_f32 v[170:171], v[98:99], v[98:99]
  v_pk_mul_f32 v[172:173], v[100:101], v[100:101]
  v_pk_mul_f32 v[174:175], v[102:103], v[102:103]
  v_pk_fma_f32 v[168:169], v[168:169], v[10:11], v[6:7] op_sel_hi:[1,0,0]
  v_pk_fma_f32 v[170:171], v[170:171], v[10:11], v[6:7] op_sel_hi:[1,0,0]
  v_pk_fma_f32 v[172:173], v[172:173], v[10:11], v[6:7] op_sel_hi:[1,0,0]
  v_pk_fma_f32 v[174:175], v[174:175], v[10:11], v[6:7] op_sel_hi:[1,0,0]
  v_pk_mul_f32 v[168:169], v[168:169], v[96:97]
  v_pk_mul_f32 v[170:171], v[170:171], v[98:99]
  v_pk_mul_f32 v[172:173], v[172:173], v[100:101]
  v_pk_mul_f32 v[174:175], v[174:175], v[102:103]
  v_exp_f32 v168, v168
  v_exp_f32 v169, v169
  v_exp_f32 v170, v170
  v_exp_f32 v171, v171
  v_exp_f32 v172, v172
  v_exp_f32 v173, v173
  v_exp_f32 v174, v174
  v_exp_f32 v175, v175
  v_pk_fma_f32 v[168:169], v[168:169], v[194:195], v[194:195] op_sel_hi:[1,0,0]
  v_pk_fma_f32 v[170:171], v[170:171], v[194:195], v[194:195] op_sel_hi:[1,0,0]
  v_pk_fma_f32 v[172:173], v[172:173], v[194:195], v[194:195] op_sel_hi:[1,0,0]
  v_pk_fma_f32 v[174:175], v[174:175], v[194:195], v[194:195] op_sel_hi:[1,0,0]
  v_rcp_f32 v168, v168
  v_rcp_f32 v169, v169
  v_rcp_f32 v170, v170
  v_rcp_f32 v171, v171
  v_rcp_f32 v172, v172
  v_rcp_f32 v173, v173
  v_rcp_f32 v174, v174
  v_rcp_f32 v175, v175
  v_pk_mul_f32 v[96:97], v[96:97], v[168:169]
  v_pk_mul_f32 v[98:99], v[98:99], v[170:171]
  v_pk_mul_f32 v[100:101], v[100:101], v[172:173]
  v_pk_mul_f32 v[102:103], v[102:103], v[174:175]
  v_lshlrev_b32 v104, 16, v224
  v_and_b32 v105, 0xffff0000, v224
  v_lshlrev_b32 v106, 16, v225
  v_and_b32 v107, 0xffff0000, v225
  v_lshlrev_b32 v108, 16, v228
  v_and_b32 v109, 0xffff0000, v228
  v_lshlrev_b32 v110, 16, v229
  v_and_b32 v111, 0xffff0000, v229
  v_pk_mul_f32 v[160:161], v[104:105], v[104:105]
  v_pk_mul_f32 v[162:163], v[106:107], v[106:107]
  v_pk_mul_f32 v[164:165], v[108:109], v[108:109]
  v_pk_mul_f32 v[166:167], v[110:111], v[110:111]
  v_pk_fma_f32 v[160:161], v[160:161], v[10:11], v[6:7] op_sel_hi:[1,0,0]
  v_pk_fma_f32 v[162:163], v[162:163], v[10:11], v[6:7] op_sel_hi:[1,0,0]
  v_pk_fma_f32 v[164:165], v[164:165], v[10:11], v[6:7] op_sel_hi:[1,0,0]
  v_pk_fma_f32 v[166:167], v[166:167], v[10:11], v[6:7] op_sel_hi:[1,0,0]
  v_pk_mul_f32 v[160:161], v[160:161], v[104:105]
  v_pk_mul_f32 v[162:163], v[162:163], v[106:107]
  v_pk_mul_f32 v[164:165], v[164:165], v[108:109]
  v_pk_mul_f32 v[166:167], v[166:167], v[110:111]
  v_exp_f32 v160, v160
  v_exp_f32 v161, v161
  v_exp_f32 v162, v162
  v_exp_f32 v163, v163
  v_exp_f32 v164, v164
  v_exp_f32 v165, v165
  v_exp_f32 v166, v166
  v_exp_f32 v167, v167
  s_waitcnt vmcnt(8)
  s_barrier
  s_cmp_lg_u32 s3, 0
  s_cbranch_scc1 kt_tail_kernel_pf4
  v_mov_b32 v248, 0
  v_mov_b32 v249, 1
  s_mov_b64 exec, 1
  buffer_store_dword v249, v248, s[72:75], s18 offen sc1
  s_mov_b64 exec, -1
kt_tail_kernel_pf4:
  s_mov_b32 s44, s70
  s_and_b32 s45, s71, 0xffff
  s_mov_b32 s46, 4096
  s_mov_b32 s47, 0x20000
  s_lshl_b32 s22, s78, 6
  v_and_b32 v248, 15, v1
  v_lshlrev_b32 v248, 1, v248
  buffer_load_ushort v249, v248, s[44:47], s22 offen
  buffer_load_ushort v250, v248, s[44:47], s22 offen offset:32
  s_add_u32 m0, s13, 32768
  s_add_u32 s11, s11, 128
  buffer_load_dwordx4 v252, s[28:31], s11 offen  lds
  s_add_u32 m0, s13, 33792
  s_nop 0
  buffer_load_dwordx4 v253, s[28:31], s11 offen  lds
  s_add_u32 m0, s13, 34816
  s_nop 0
  buffer_load_dwordx4 v254, s[28:31], s11 offen  lds
  s_add_u32 m0, s13, 35840
  s_nop 0
  buffer_load_dwordx4 v255, s[28:31], s11 offen  lds
  s_add_u32 m0, s13, 49152
  s_add_u32 s11, s11, 128
  buffer_load_dwordx4 v252, s[28:31], s11 offen  lds
  s_add_u32 m0, s13, 50176
  s_nop 0
  buffer_load_dwordx4 v253, s[28:31], s11 offen  lds
  s_add_u32 m0, s13, 51200
  s_nop 0
  buffer_load_dwordx4 v254, s[28:31], s11 offen  lds
  s_add_u32 m0, s13, 52224
  s_nop 0
  buffer_load_dwordx4 v255, s[28:31], s11 offen  lds
  buffer_load_dwordx4 a[0:3], v2, s[36:39], s7 offen
  s_add_u32 s7, s7, 4096
  v_pk_fma_f32 v[160:161], v[160:161], v[194:195], v[194:195] op_sel_hi:[1,0,0]
  v_pk_fma_f32 v[162:163], v[162:163], v[194:195], v[194:195] op_sel_hi:[1,0,0]
  v_pk_fma_f32 v[164:165], v[164:165], v[194:195], v[194:195] op_sel_hi:[1,0,0]
  v_pk_fma_f32 v[166:167], v[166:167], v[194:195], v[194:195] op_sel_hi:[1,0,0]
  v_rcp_f32 v160, v160
  v_rcp_f32 v161, v161
  v_rcp_f32 v162, v162
  v_rcp_f32 v163, v163
  v_rcp_f32 v164, v164
  v_rcp_f32 v165, v165
  v_rcp_f32 v166, v166
  v_rcp_f32 v167, v167
  v_pk_mul_f32 v[104:105], v[104:105], v[160:161]
  v_pk_mul_f32 v[106:107], v[106:107], v[162:163]
  v_pk_mul_f32 v[108:109], v[108:109], v[164:165]
  v_pk_mul_f32 v[110:111], v[110:111], v[166:167]
  v_lshlrev_b32 v112, 16, v232
  v_and_b32 v113, 0xffff0000, v232
  v_lshlrev_b32 v114, 16, v233
  v_and_b32 v115, 0xffff0000, v233
  buffer_load_dwordx4 a[4:7], v2, s[36:39], s7 offen
  s_add_u32 s7, s7, 4096
  v_lshlrev_b32 v116, 16, v236
  v_and_b32 v117, 0xffff0000, v236
  v_lshlrev_b32 v118, 16, v237
  v_and_b32 v119, 0xffff0000, v237
  v_pk_mul_f32 v[168:169], v[112:113], v[112:113]
  v_pk_mul_f32 v[170:171], v[114:115], v[114:115]
  v_pk_mul_f32 v[172:173], v[116:117], v[116:117]
  v_pk_mul_f32 v[174:175], v[118:119], v[118:119]
  v_pk_fma_f32 v[168:169], v[168:169], v[10:11], v[6:7] op_sel_hi:[1,0,0]
  v_pk_fma_f32 v[170:171], v[170:171], v[10:11], v[6:7] op_sel_hi:[1,0,0]
  v_pk_fma_f32 v[172:173], v[172:173], v[10:11], v[6:7] op_sel_hi:[1,0,0]
  v_pk_fma_f32 v[174:175], v[174:175], v[10:11], v[6:7] op_sel_hi:[1,0,0]
  v_pk_mul_f32 v[168:169], v[168:169], v[112:113]
  v_pk_mul_f32 v[170:171], v[170:171], v[114:115]
  v_pk_mul_f32 v[172:173], v[172:173], v[116:117]
  v_pk_mul_f32 v[174:175], v[174:175], v[118:119]
  v_exp_f32 v168, v168
  v_exp_f32 v169, v169
  v_exp_f32 v170, v170
  v_exp_f32 v171, v171
  v_exp_f32 v172, v172
  buffer_load_dwordx4 a[8:11], v2, s[36:39], s7 offen
  s_add_u32 s7, s7, 4096
  v_exp_f32 v173, v173
  v_exp_f32 v174, v174
  v_exp_f32 v175, v175
  v_pk_fma_f32 v[168:169], v[168:169], v[194:195], v[194:195] op_sel_hi:[1,0,0]
  v_pk_fma_f32 v[170:171], v[170:171], v[194:195], v[194:195] op_sel_hi:[1,0,0]
  v_pk_fma_f32 v[172:173], v[172:173], v[194:195], v[194:195] op_sel_hi:[1,0,0]
  v_pk_fma_f32 v[174:175], v[174:175], v[194:195], v[194:195] op_sel_hi:[1,0,0]
  v_rcp_f32 v168, v168
  v_rcp_f32 v169, v169
  v_rcp_f32 v170, v170
  v_rcp_f32 v171, v171
  v_rcp_f32 v172, v172
  v_rcp_f32 v173, v173
  v_rcp_f32 v174, v174
  v_rcp_f32 v175, v175
  v_pk_mul_f32 v[112:113], v[112:113], v[168:169]
  v_pk_mul_f32 v[114:115], v[114:115], v[170:171]
  v_pk_mul_f32 v[116:117], v[116:117], v[172:173]
  v_pk_mul_f32 v[118:119], v[118:119], v[174:175]
  v_lshlrev_b32 v124, 16, v210
  buffer_load_dwordx4 a[12:15], v2, s[36:39], s7 offen
  s_add_u32 s7, s7, 4096
  v_and_b32 v125, 0xffff0000, v210
  v_lshlrev_b32 v126, 16, v211
  v_and_b32 v127, 0xffff0000, v211
  v_lshlrev_b32 v128, 16, v214
  v_and_b32 v129, 0xffff0000, v214
  v_lshlrev_b32 v130, 16, v215
  v_and_b32 v131, 0xffff0000, v215
  v_pk_mul_f32 v[160:161], v[124:125], v[124:125]
  v_pk_mul_f32 v[162:163], v[126:127], v[126:127]
  v_pk_mul_f32 v[164:165], v[128:129], v[128:129]
  v_pk_mul_f32 v[166:167], v[130:131], v[130:131]
  v_pk_fma_f32 v[160:161], v[160:161], v[12:13], v[8:9] op_sel_hi:[1,0,0]
  v_pk_fma_f32 v[162:163], v[162:163], v[12:13], v[8:9] op_sel_hi:[1,0,0]
  v_pk_fma_f32 v[164:165], v[164:165], v[12:13], v[8:9] op_sel_hi:[1,0,0]
  v_pk_fma_f32 v[166:167], v[166:167], v[12:13], v[8:9] op_sel_hi:[1,0,0]
  v_pk_mul_f32 v[160:161], v[160:161], v[124:125]
  v_pk_mul_f32 v[162:163], v[162:163], v[126:127]
  v_pk_mul_f32 v[164:165], v[164:165], v[128:129]
  v_pk_mul_f32 v[166:167], v[166:167], v[130:131]
  v_exp_f32 v160, v160
  v_exp_f32 v161, v161
  buffer_load_dwordx4 a[16:19], v2, s[36:39], s7 offen
  s_add_u32 s7, s7, 4096
  v_exp_f32 v162, v162
  v_exp_f32 v163, v163
  v_exp_f32 v164, v164
  v_exp_f32 v165, v165
  v_exp_f32 v166, v166
  v_exp_f32 v167, v167
  v_pk_fma_f32 v[160:161], v[160:161], v[196:197], v[196:197] op_sel_hi:[1,0,0]
  v_pk_fma_f32 v[162:163], v[162:163], v[196:197], v[196:197] op_sel_hi:[1,0,0]
  v_pk_fma_f32 v[164:165], v[164:165], v[196:197], v[196:197] op_sel_hi:[1,0,0]
  v_pk_fma_f32 v[166:167], v[166:167], v[196:197], v[196:197] op_sel_hi:[1,0,0]
  v_rcp_f32 v160, v160
  v_rcp_f32 v161, v161
  v_rcp_f32 v162, v162
  v_rcp_f32 v163, v163
  v_rcp_f32 v164, v164
  v_rcp_f32 v165, v165
  v_rcp_f32 v166, v166
  v_rcp_f32 v167, v167
  v_pk_mul_f32 v[124:125], v[124:125], v[160:161]
  v_pk_mul_f32 v[126:127], v[126:127], v[162:163]
  buffer_load_dwordx4 a[20:23], v2, s[36:39], s7 offen
  s_add_u32 s7, s7, 4096
  v_pk_mul_f32 v[128:129], v[128:129], v[164:165]
  v_pk_mul_f32 v[130:131], v[130:131], v[166:167]
  v_lshlrev_b32 v132, 16, v218
  v_and_b32 v133, 0xffff0000, v218
  v_lshlrev_b32 v134, 16, v219
  v_and_b32 v135, 0xffff0000, v219
  v_lshlrev_b32 v136, 16, v222
  v_and_b32 v137, 0xffff0000, v222
  v_lshlrev_b32 v138, 16, v223
  v_and_b32 v139, 0xffff0000, v223
  v_pk_mul_f32 v[168:169], v[132:133], v[132:133]
  v_pk_mul_f32 v[170:171], v[134:135], v[134:135]
  v_pk_mul_f32 v[172:173], v[136:137], v[136:137]
  v_pk_mul_f32 v[174:175], v[138:139], v[138:139]
  v_pk_fma_f32 v[168:169], v[168:169], v[12:13], v[8:9] op_sel_hi:[1,0,0]
  v_pk_fma_f32 v[170:171], v[170:171], v[12:13], v[8:9] op_sel_hi:[1,0,0]
  v_pk_fma_f32 v[172:173], v[172:173], v[12:13], v[8:9] op_sel_hi:[1,0,0]
  v_pk_fma_f32 v[174:175], v[174:175], v[12:13], v[8:9] op_sel_hi:[1,0,0]
  v_pk_mul_f32 v[168:169], v[168:169], v[132:133]
  v_pk_mul_f32 v[170:171], v[170:171], v[134:135]
  v_pk_mul_f32 v[172:173], v[172:173], v[136:137]
  v_pk_mul_f32 v[174:175], v[174:175], v[138:139]
  v_exp_f32 v168, v168
  v_exp_f32 v169, v169
  v_exp_f32 v170, v170
  v_exp_f32 v171, v171
  v_exp_f32 v172, v172
  v_exp_f32 v173, v173
  v_exp_f32 v174, v174
  v_exp_f32 v175, v175
  v_pk_fma_f32 v[168:169], v[168:169], v[196:197], v[196:197] op_sel_hi:[1,0,0]
  v_pk_fma_f32 v[170:171], v[170:171], v[196:197], v[196:197] op_sel_hi:[1,0,0]
  v_pk_fma_f32 v[172:173], v[172:173], v[196:197], v[196:197] op_sel_hi:[1,0,0]
  v_pk_fma_f32 v[174:175], v[174:175], v[196:197], v[196:197] op_sel_hi:[1,0,0]
  v_rcp_f32 v168, v168
  v_rcp_f32 v169, v169
  v_rcp_f32 v170, v170
  v_rcp_f32 v171, v171
  v_rcp_f32 v172, v172
  v_rcp_f32 v173, v173
  v_rcp_f32 v174, v174
  v_rcp_f32 v175, v175
  v_pk_mul_f32 v[132:133], v[132:133], v[168:169]
  v_pk_mul_f32 v[134:135], v[134:135], v[170:171]
  v_pk_mul_f32 v[136:137], v[136:137], v[172:173]
  v_pk_mul_f32 v[138:139], v[138:139], v[174:175]
  v_lshlrev_b32 v140, 16, v226
  v_and_b32 v141, 0xffff0000, v226
  v_lshlrev_b32 v142, 16, v227
  v_and_b32 v143, 0xffff0000, v227
  v_lshlrev_b32 v144, 16, v230
  v_and_b32 v145, 0xffff0000, v230
  v_lshlrev_b32 v146, 16, v231
  v_and_b32 v147, 0xffff0000, v231
  v_pk_mul_f32 v[160:161], v[140:141], v[140:141]
  v_pk_mul_f32 v[162:163], v[142:143], v[142:143]
  v_pk_mul_f32 v[164:165], v[144:145], v[144:145]
  v_pk_mul_f32 v[166:167], v[146:147], v[146:147]
  v_pk_fma_f32 v[160:161], v[160:161], v[12:13], v[8:9] op_sel_hi:[1,0,0]
  v_pk_fma_f32 v[162:163], v[162:163], v[12:13], v[8:9] op_sel_hi:[1,0,0]
  v_pk_fma_f32 v[164:165], v[164:165], v[12:13], v[8:9] op_sel_hi:[1,0,0]
  v_pk_fma_f32 v[166:167], v[166:167], v[12:13], v[8:9] op_sel_hi:[1,0,0]
  v_pk_mul_f32 v[160:161], v[160:161], v[140:141]
  v_pk_mul_f32 v[162:163], v[162:163], v[142:143]
  v_pk_mul_f32 v[164:165], v[164:165], v[144:145]
  v_pk_mul_f32 v[166:167], v[166:167], v[146:147]
  v_exp_f32 v160, v160
  v_exp_f32 v161, v161
  v_exp_f32 v162, v162
  v_exp_f32 v163, v163
  v_exp_f32 v164, v164
  v_exp_f32 v165, v165
  v_exp_f32 v166, v166
  v_exp_f32 v167, v167
  v_pk_fma_f32 v[160:161], v[160:161], v[196:197], v[196:197] op_sel_hi:[1,0,0]
  v_pk_fma_f32 v[162:163], v[162:163], v[196:197], v[196:197] op_sel_hi:[1,0,0]
  v_pk_fma_f32 v[164:165], v[164:165], v[196:197], v[196:197] op_sel_hi:[1,0,0]
  v_pk_fma_f32 v[166:167], v[166:167], v[196:197], v[196:197] op_sel_hi:[1,0,0]
  v_rcp_f32 v160, v160
  v_rcp_f32 v161, v161
  v_rcp_f32 v162, v162
  v_rcp_f32 v163, v163
  v_rcp_f32 v164, v164
  v_rcp_f32 v165, v165
  v_rcp_f32 v166, v166
  v_rcp_f32 v167, v167
  v_pk_mul_f32 v[140:141], v[140:141], v[160:161]
  v_pk_mul_f32 v[142:143], v[142:143], v[162:163]
  v_pk_mul_f32 v[144:145], v[144:145], v[164:165]
  v_pk_mul_f32 v[146:147], v[146:147], v[166:167]
  v_lshlrev_b32 v148, 16, v234
  v_and_b32 v149, 0xffff0000, v234
  v_lshlrev_b32 v150, 16, v235
  v_and_b32 v151, 0xffff0000, v235
  v_lshlrev_b32 v152, 16, v238
  v_and_b32 v153, 0xffff0000, v238
  v_lshlrev_b32 v154, 16, v239
  v_and_b32 v155, 0xffff0000, v239
  v_pk_mul_f32 v[168:169], v[148:149], v[148:149]
  v_pk_mul_f32 v[170:171], v[150:151], v[150:151]
  v_pk_mul_f32 v[172:173], v[152:153], v[152:153]
  v_pk_mul_f32 v[174:175], v[154:155], v[154:155]
  v_pk_fma_f32 v[168:169], v[168:169], v[12:13], v[8:9] op_sel_hi:[1,0,0]
  v_pk_fma_f32 v[170:171], v[170:171], v[12:13], v[8:9] op_sel_hi:[1,0,0]
  v_pk_fma_f32 v[172:173], v[172:173], v[12:13], v[8:9] op_sel_hi:[1,0,0]
  v_pk_fma_f32 v[174:175], v[174:175], v[12:13], v[8:9] op_sel_hi:[1,0,0]
  v_pk_mul_f32 v[168:169], v[168:169], v[148:149]
  v_pk_mul_f32 v[170:171], v[170:171], v[150:151]
  v_pk_mul_f32 v[172:173], v[172:173], v[152:153]
  v_pk_mul_f32 v[174:175], v[174:175], v[154:155]
  v_exp_f32 v168, v168
  v_exp_f32 v169, v169
  v_exp_f32 v170, v170
  v_exp_f32 v171, v171
  v_exp_f32 v172, v172
  v_exp_f32 v173, v173
  v_exp_f32 v174, v174
  v_exp_f32 v175, v175
  v_pk_fma_f32 v[168:169], v[168:169], v[196:197], v[196:197] op_sel_hi:[1,0,0]
  v_pk_fma_f32 v[170:171], v[170:171], v[196:197], v[196:197] op_sel_hi:[1,0,0]
  v_pk_fma_f32 v[172:173], v[172:173], v[196:197], v[196:197] op_sel_hi:[1,0,0]
  v_pk_fma_f32 v[174:175], v[174:175], v[196:197], v[196:197] op_sel_hi:[1,0,0]
  v_rcp_f32 v168, v168
  v_rcp_f32 v169, v169
  v_rcp_f32 v170, v170
  v_rcp_f32 v171, v171
  v_rcp_f32 v172, v172
  v_rcp_f32 v173, v173
  v_rcp_f32 v174, v174
  v_rcp_f32 v175, v175
  v_pk_mul_f32 v[148:149], v[148:149], v[168:169]
  v_pk_mul_f32 v[150:151], v[150:151], v[170:171]
  v_pk_mul_f32 v[152:153], v[152:153], v[172:173]
  v_pk_mul_f32 v[154:155], v[154:155], v[174:175]
  v_mov_b32 v244, v240
  v_mov_b32 v245, v241
  v_mov_b32 v246, v242
  v_mov_b32 v247, v243
  v_mov_b32 v14, v194
  v_mov_b32 v208, v196
  v_mov_b32 v210, v252
  v_mov_b32 v211, v253
  v_mov_b32 v212, v254
  v_mov_b32 v213, v255
  s_waitcnt vmcnt(14)
  v_lshlrev_b32 v249, 16, v249
  v_lshlrev_b32 v250, 16, v250
  v_mov_b32 v216, v249
  v_mov_b32 v217, v249
  v_mov_b32 v218, v249
  v_mov_b32 v219, v249
  v_mov_b32 v220, v250
  v_mov_b32 v221, v250
  v_mov_b32 v222, v250
  v_mov_b32 v223, v250
kt_tail_kernel_join:
  s_cmp_lg_u32 s3, 0
  s_cbranch_scc1 kt_tail_kernel_wf5d
  v_and_b32 v248, 31, v1
  v_lshrrev_b32 v249, 0, v248
  v_and_b32 v248, 0, v248
  v_lshlrev_b32 v248, 2, v248
  v_lshl_add_u32 v248, v249, 7, v248
  s_mov_b32 s9, 200000
kt_tail_kernel_wf5:
  buffer_load_dword v249, v248, s[72:75], s19 offen sc1
  s_waitcnt vmcnt(0)
  v_cmp_eq_u32 vcc, 0, v249
  s_nop 4
  s_cbranch_vccz kt_tail_kernel_wf5d
  s_sleep 2
  s_sub_u32 s9, s9, 1
  s_cmp_lg_u32 s9, 0
  s_cbranch_scc1 kt_tail_kernel_wf5
kt_tail_kernel_wf5d:
  s_barrier
  s_mul_i32 s10, s77, 589824
  s_add_u32 s10, s10, s17
  s_add_u32 m0, s17, 0
  s_add_u32 s10, s10, 0
  buffer_load_dwordx4 v2, s[56:59], s10 offen sc1 lds
  s_add_u32 m0, s17, 4096
  s_add_u32 s10, s10, 4096
  buffer_load_dwordx4 v2, s[56:59], s10 offen sc1 lds
  s_add_u32 m0, s17, 8192
  s_add_u32 s10, s10, 4096
  buffer_load_dwordx4 v2, s[56:59], s10 offen sc1 lds
  s_add_u32 m0, s17, 12288
  s_add_u32 s10, s10, 4096
  buffer_load_dwordx4 v2, s[56:59], s10 offen sc1 lds
  s_add_u32 m0, s17, 16384
  s_add_u32 s10, s10, 4096
  buffer_load_dwordx4 v2, s[56:59], s10 offen sc1 lds
  s_add_u32 m0, s17, 20480
  s_add_u32 s10, s10, 4096
  buffer_load_dwordx4 v2, s[56:59], s10 offen sc1 lds
  s_add_u32 m0, s17, 24576
  s_add_u32 s10, s10, 4096
  buffer_load_dwordx4 v2, s[56:59], s10 offen sc1 lds
  s_bitcmp1_b32 s77, 0
  s_cbranch_scc1 kt_tail_kernel_zs
  buffer_load_dwordx4 v[244:247], v2, s[60:63], s55 offen sc1
kt_tail_kernel_zs:
  s_add_u32 m0, s17, 28672
  s_add_u32 s10, s10, 4096
  buffer_load_dwordx4 v2, s[56:59], s10 offen sc1 lds
  s_add_u32 m0, s17, 32768
  s_add_u32 s10, s10, 4096
  buffer_load_dwordx4 v2, s[56:59], s10 offen sc1 lds
  s_add_u32 m0, s17, 36864
  s_add_u32 s10, s10, 4096
  buffer_load_dwordx4 v2, s[56:59], s10 offen sc1 lds
  s_add_u32 m0, s17, 40960
  s_add_u32 s10, s10, 4096
  buffer_load_dwordx4 v2, s[56:59], s10 offen sc1 lds
  s_add_u32 m0, s17, 45056
  s_add_u32 s10, s10, 4096
  buffer_load_dwordx4 v2, s[56:59], s10 offen sc1 lds
  s_add_u32 m0, s17, 49152
  s_add_u32 s10, s10, 4096
  buffer_load_dwordx4 v2, s[56:59], s10 offen sc1 lds
  s_add_u32 m0, s17, 53248
  s_add_u32 s10, s10, 4096
  buffer_load_dwordx4 v2, s[56:59], s10 offen sc1 lds
  v_add_u32 v3, 55296, v2
  v_and_b32 v248, 15, v1
  v_lshrrev_b32 v249, 4, v1
  v_lshrrev_b32 v250, 3, v248
  v_lshlrev_b32 v250, 10, v250
  v_and_b32 v251, 7, v248
  v_lshl_add_u32 v250, v251, 7, v250
  v_and_b32 v251, 6, v248
  v_xor_b32 v251, v251, v249
  v_lshl_add_u32 v250, v251, 4, v250
  v_add_u32 v4, s13, v250
  v_xor_b32 v5, 64, v4
  s_waitcnt vmcnt(11)
  s_barrier
  ds_read_b128 v[196:199], v4 offset:0
  ds_read_b128 v[200:203], v4 offset:2048
  ds_read_b128 v[160:163], v2 offset:0
  ds_read_b128 v[164:167], v2 offset:1024
  ds_read_b128 v[168:171], v2 offset:2048
  ds_read_b128 v[172:175], v2 offset:3072
  ds_read_b128 v[176:179], v2 offset:4096
  ds_read_b128 v[180:183], v2 offset:5120
  s_waitcnt vmcnt(7) lgkmcnt(5)
  s_barrier
  s_waitcnt lgkmcnt(3)
  v_mfma_f32_16x16x32_bf16 v[16:19], v[160:163], v[196:199], v[216:219]
  ds_read_b128 v[184:187], v2 offset:6144
  s_add_u32 m0, s17, 57344
  s_add_u32 s10, s10, 4096
  v_mfma_f32_16x16x32_bf16 v[52:55], v[160:163], v[200:203], v[220:223]
  buffer_load_dwordx4 v2, s[56:59], s10 offen sc1 lds
  v_mfma_f32_16x16x32_bf16 v[20:23], v[164:167], v[196:199], v[216:219]
  ds_read_b128 v[188:191], v2 offset:7168
  v_mfma_f32_16x16x32_bf16 v[56:59], v[164:167], v[200:203], v[220:223]
  ds_read_b128 v[224:227], v5 offset:0
  v_mfma_f32_16x16x32_bf16 v[24:27], v[168:171], v[196:199], v[216:219]
  ds_read_b128 v[192:195], v2 offset:8192
  v_mfma_f32_16x16x32_bf16 v[60:63], v[168:171], v[200:203], v[220:223]
  ds_read_b128 v[228:231], v5 offset:2048
  s_waitcnt lgkmcnt(5)
  v_mfma_f32_16x16x32_bf16 v[28:31], v[172:175], v[196:199], v[216:219]
  ds_read_b128 v[160:163], v2 offset:9216
  s_add_u32 m0, s17, 61440
  s_add_u32 s10, s10, 4096
  v_mfma_f32_16x16x32_bf16 v[64:67], v[172:175], v[200:203], v[220:223]
  buffer_load_dwordx4 v2, s[56:59], s10 offen sc1 lds
  v_mfma_f32_16x16x32_bf16 v[32:35], v[176:179], v[196:199], v[216:219]
  ds_read_b128 v[164:167], v2 offset:10240
  v_mfma_f32_16x16x32_bf16 v[68:71], v[176:179], v[200:203], v[220:223]
  v_mfma_f32_16x16x32_bf16 v[36:39], v[180:183], v[196:199], v[216:219]
  ds_read_b128 v[168:171], v2 offset:11264
  s_add_u32 m0, s17, 65536
  s_add_u32 s10, s10, 4096
  v_mfma_f32_16x16x32_bf16 v[72:75], v[180:183], v[200:203], v[220:223]
  buffer_load_dwordx4 v2, s[56:59], s10 offen sc1 lds
  s_waitcnt lgkmcnt(4)
  v_mfma_f32_16x16x32_bf16 v[40:43], v[184:187], v[196:199], v[216:219]
  ds_read_b128 v[172:175], v2 offset:12288
  v_mfma_f32_16x16x32_bf16 v[76:79], v[184:187], v[200:203], v[220:223]
  v_mfma_f32_16x16x32_bf16 v[44:47], v[188:191], v[196:199], v[216:219]
  ds_read_b128 v[176:179], v2 offset:13312
  s_add_u32 m0, s17, 69632
  s_add_u32 s10, s10, 4096
  v_mfma_f32_16x16x32_bf16 v[80:83], v[188:191], v[200:203], v[220:223]
  buffer_load_dwordx4 v2, s[56:59], s10 offen sc1 lds
  v_mfma_f32_16x16x32_bf16 v[48:51], v[192:195], v[196:199], v[216:219]
  ds_read_b128 v[180:183], v2 offset:14336
  v_mfma_f32_16x16x32_bf16 v[84:87], v[192:195], v[200:203], v[220:223]
  s_waitcnt lgkmcnt(3)
  v_mfma_f32_16x16x32_bf16 v[16:19], v[160:163], v[224:227], v[16:19]
  ds_read_b128 v[184:187], v2 offset:15360
  s_add_u32 m0, s13, 0
  s_add_u32 s11, s11, 128
  v_mfma_f32_16x16x32_bf16 v[52:55], v[160:163], v[228:231], v[52:55]
  buffer_load_dwordx4 v210, s[28:31], s11 offen  lds
  v_mfma_f32_16x16x32_bf16 v[20:23], v[164:167], v[224:227], v[20:23]
  ds_read_b128 v[188:191], v2 offset:16384
  v_mfma_f32_16x16x32_bf16 v[56:59], v[164:167], v[228:231], v[56:59]
  ds_read_b128 v[196:199], v4 offset:16384
  v_mfma_f32_16x16x32_bf16 v[24:27], v[168:171], v[224:227], v[24:27]
  ds_read_b128 v[192:195], v2 offset:17408
  v_mfma_f32_16x16x32_bf16 v[60:63], v[168:171], v[228:231], v[60:63]
  ds_read_b128 v[200:203], v4 offset:18432
  s_waitcnt lgkmcnt(5)
  v_mfma_f32_16x16x32_bf16 v[28:31], v[172:175], v[224:227], v[28:31]
  ds_read_b128 v[160:163], v2 offset:18432
  s_add_u32 m0, s13, 1024
  v_mfma_f32_16x16x32_bf16 v[64:67], v[172:175], v[228:231], v[64:67]
  buffer_load_dwordx4 v211, s[28:31], s11 offen  lds
  v_mfma_f32_16x16x32_bf16 v[32:35], v[176:179], v[224:227], v[32:35]
  ds_read_b128 v[164:167], v2 offset:19456
  v_mfma_f32_16x16x32_bf16 v[68:71], v[176:179], v[228:231], v[68:71]
  v_mfma_f32_16x16x32_bf16 v[36:39], v[180:183], v[224:227], v[36:39]
  ds_read_b128 v[168:171], v2 offset:20480
  s_add_u32 m0, s13, 2048
  v_mfma_f32_16x16x32_bf16 v[72:75], v[180:183], v[228:231], v[72:75]
  buffer_load_dwordx4 v212, s[28:31], s11 offen  lds
  s_waitcnt lgkmcnt(4)
  v_mfma_f32_16x16x32_bf16 v[40:43], v[184:187], v[224:227], v[40:43]
  ds_read_b128 v[172:175], v2 offset:21504
  v_mfma_f32_16x16x32_bf16 v[76:79], v[184:187], v[228:231], v[76:79]
  v_mfma_f32_16x16x32_bf16 v[44:47], v[188:191], v[224:227], v[44:47]
  ds_read_b128 v[176:179], v2 offset:22528
  s_add_u32 m0, s13, 3072
  v_mfma_f32_16x16x32_bf16 v[80:83], v[188:191], v[228:231], v[80:83]
  buffer_load_dwordx4 v213, s[28:31], s11 offen  lds
  v_mfma_f32_16x16x32_bf16 v[48:51], v[192:195], v[224:227], v[48:51]
  ds_read_b128 v[180:183], v2 offset:23552
  v_mfma_f32_16x16x32_bf16 v[84:87], v[192:195], v[228:231], v[84:87]
  s_waitcnt vmcnt(10) lgkmcnt(5)
  s_barrier
  s_waitcnt lgkmcnt(3)
  v_mfma_f32_16x16x32_bf16 v[16:19], v[160:163], v[196:199], v[16:19]
  ds_read_b128 v[184:187], v2 offset:24576
  s_add_u32 m0, s17, 0
  s_add_u32 s10, s10, 4096
  v_mfma_f32_16x16x32_bf16 v[52:55], v[160:163], v[200:203], v[52:55]
  buffer_load_dwordx4 v2, s[56:59], s10 offen sc1 lds
  v_mfma_f32_16x16x32_bf16 v[20:23], v[164:167], v[196:199], v[20:23]
  ds_read_b128 v[188:191], v2 offset:25600
  v_mfma_f32_16x16x32_bf16 v[56:59], v[164:167], v[200:203], v[56:59]
  ds_read_b128 v[224:227], v5 offset:16384
  v_mfma_f32_16x16x32_bf16 v[24:27], v[168:171], v[196:199], v[24:27]
  ds_read_b128 v[192:195], v2 offset:26624
  v_mfma_f32_16x16x32_bf16 v[60:63], v[168:171], v[200:203], v[60:63]
  ds_read_b128 v[228:231], v5 offset:18432
  s_waitcnt lgkmcnt(5)
  v_mfma_f32_16x16x32_bf16 v[28:31], v[172:175], v[196:199], v[28:31]
  ds_read_b128 v[160:163], v2 offset:27648
  s_add_u32 m0, s17, 4096
  s_add_u32 s10, s10, 4096
  v_mfma_f32_16x16x32_bf16 v[64:67], v[172:175], v[200:203], v[64:67]
  buffer_load_dwordx4 v2, s[56:59], s10 offen sc1 lds
  v_mfma_f32_16x16x32_bf16 v[32:35], v[176:179], v[196:199], v[32:35]
  ds_read_b128 v[164:167], v2 offset:28672
  v_mfma_f32_16x16x32_bf16 v[68:71], v[176:179], v[200:203], v[68:71]
  v_mfma_f32_16x16x32_bf16 v[36:39], v[180:183], v[196:199], v[36:39]
  ds_read_b128 v[168:171], v2 offset:29696
  s_add_u32 m0, s17, 8192
  s_add_u32 s10, s10, 4096
  v_mfma_f32_16x16x32_bf16 v[72:75], v[180:183], v[200:203], v[72:75]
  buffer_load_dwordx4 v2, s[56:59], s10 offen sc1 lds
  s_waitcnt lgkmcnt(4)
  v_mfma_f32_16x16x32_bf16 v[40:43], v[184:187], v[196:199], v[40:43]
  ds_read_b128 v[172:175], v2 offset:30720
  v_mfma_f32_16x16x32_bf16 v[76:79], v[184:187], v[200:203], v[76:79]
  v_mfma_f32_16x16x32_bf16 v[44:47], v[188:191], v[196:199], v[44:47]
  ds_read_b128 v[176:179], v2 offset:31744
  s_add_u32 m0, s17, 12288
  s_add_u32 s10, s10, 4096
  v_mfma_f32_16x16x32_bf16 v[80:83], v[188:191], v[200:203], v[80:83]
  buffer_load_dwordx4 v2, s[56:59], s10 offen sc1 lds
  v_mfma_f32_16x16x32_bf16 v[48:51], v[192:195], v[196:199], v[48:51]
  ds_read_b128 v[180:183], v2 offset:32768
  v_mfma_f32_16x16x32_bf16 v[84:87], v[192:195], v[200:203], v[84:87]
  s_waitcnt lgkmcnt(3)
  v_mfma_f32_16x16x32_bf16 v[16:19], v[160:163], v[224:227], v[16:19]
  ds_read_b128 v[184:187], v2 offset:33792
  s_add_u32 m0, s13, 16384
  s_add_u32 s11, s11, 128
  v_mfma_f32_16x16x32_bf16 v[52:55], v[160:163], v[228:231], v[52:55]
  buffer_load_dwordx4 v210, s[28:31], s11 offen  lds
  v_mfma_f32_16x16x32_bf16 v[20:23], v[164:167], v[224:227], v[20:23]
  ds_read_b128 v[188:191], v2 offset:34816
  v_mfma_f32_16x16x32_bf16 v[56:59], v[164:167], v[228:231], v[56:59]
  ds_read_b128 v[196:199], v4 offset:32768
  v_mfma_f32_16x16x32_bf16 v[24:27], v[168:171], v[224:227], v[24:27]
  ds_read_b128 v[192:195], v2 offset:35840
  v_mfma_f32_16x16x32_bf16 v[60:63], v[168:171], v[228:231], v[60:63]
  ds_read_b128 v[200:203], v4 offset:34816
  s_waitcnt lgkmcnt(5)
  v_mfma_f32_16x16x32_bf16 v[28:31], v[172:175], v[224:227], v[28:31]
  ds_read_b128 v[160:163], v2 offset:36864
  s_add_u32 m0, s13, 17408
  v_mfma_f32_16x16x32_bf16 v[64:67], v[172:175], v[228:231], v[64:67]
  buffer_load_dwordx4 v211, s[28:31], s11 offen  lds
  v_mfma_f32_16x16x32_bf16 v[32:35], v[176:179], v[224:227], v[32:35]
  ds_read_b128 v[164:167], v2 offset:37888
  v_mfma_f32_16x16x32_bf16 v[68:71], v[176:179], v[228:231], v[68:71]
  v_mfma_f32_16x16x32_bf16 v[36:39], v[180:183], v[224:227], v[36:39]
  ds_read_b128 v[168:171], v2 offset:38912
  s_add_u32 m0, s13, 18432
  v_mfma_f32_16x16x32_bf16 v[72:75], v[180:183], v[228:231], v[72:75]
  buffer_load_dwordx4 v212, s[28:31], s11 offen  lds
  s_waitcnt lgkmcnt(4)
  v_mfma_f32_16x16x32_bf16 v[40:43], v[184:187], v[224:227], v[40:43]
  ds_read_b128 v[172:175], v2 offset:39936
  v_mfma_f32_16x16x32_bf16 v[76:79], v[184:187], v[228:231], v[76:79]
  v_mfma_f32_16x16x32_bf16 v[44:47], v[188:191], v[224:227], v[44:47]
  ds_read_b128 v[176:179], v2 offset:40960
  s_add_u32 m0, s13, 19456
  v_mfma_f32_16x16x32_bf16 v[80:83], v[188:191], v[228:231], v[80:83]
  buffer_load_dwordx4 v213, s[28:31], s11 offen  lds
  v_mfma_f32_16x16x32_bf16 v[48:51], v[192:195], v[224:227], v[48:51]
  ds_read_b128 v[180:183], v2 offset:41984
  v_mfma_f32_16x16x32_bf16 v[84:87], v[192:195], v[228:231], v[84:87]
  s_waitcnt vmcnt(14) lgkmcnt(5)
  s_barrier
  s_waitcnt lgkmcnt(3)
  v_mfma_f32_16x16x32_bf16 v[16:19], v[160:163], v[196:199], v[16:19]
  ds_read_b128 v[184:187], v2 offset:43008
  v_lshlrev_b32 v120, 16, v244
  s_add_u32 m0, s17, 16384
  s_add_u32 s10, s10, 4096
  v_mfma_f32_16x16x32_bf16 v[52:55], v[160:163], v[200:203], v[52:55]
  buffer_load_dwordx4 v2, s[56:59], s10 offen sc1 lds
  v_mfma_f32_16x16x32_bf16 v[20:23], v[164:167], v[196:199], v[20:23]
  ds_read_b128 v[188:191], v2 offset:44032
  v_and_b32 v121, 0xffff0000, v244
  v_mfma_f32_16x16x32_bf16 v[56:59], v[164:167], v[200:203], v[56:59]
  ds_read_b128 v[224:227], v5 offset:32768
  v_mul_f32 v248, v120, v120
  v_mfma_f32_16x16x32_bf16 v[24:27], v[168:171], v[196:199], v[24:27]
  ds_read_b128 v[192:195], v2 offset:45056
  v_lshlrev_b32 v122, 16, v245
  v_mfma_f32_16x16x32_bf16 v[60:63], v[168:171], v[200:203], v[60:63]
  ds_read_b128 v[228:231], v5 offset:34816
  v_mul_f32 v249, v121, v121
  s_waitcnt lgkmcnt(5)
  v_mfma_f32_16x16x32_bf16 v[28:31], v[172:175], v[196:199], v[28:31]
  ds_read_b128 v[160:163], v2 offset:46080
  v_fma_f32 v248, v248, v10, v6
  s_add_u32 m0, s17, 20480
  s_add_u32 s10, s10, 4096
  v_mfma_f32_16x16x32_bf16 v[64:67], v[172:175], v[200:203], v[64:67]
  buffer_load_dwordx4 v2, s[56:59], s10 offen sc1 lds
  v_mfma_f32_16x16x32_bf16 v[32:35], v[176:179], v[196:199], v[32:35]
  ds_read_b128 v[164:167], v2 offset:47104
  v_and_b32 v123, 0xffff0000, v245
  s_add_u32 m0, s17, 24576
  s_add_u32 s10, s10, 4096
  v_mfma_f32_16x16x32_bf16 v[68:71], v[176:179], v[200:203], v[68:71]
  buffer_load_dwordx4 v2, s[56:59], s10 offen sc1 lds
  v_mfma_f32_16x16x32_bf16 v[36:39], v[180:183], v[196:199], v[36:39]
  ds_read_b128 v[168:171], v2 offset:48128
  v_mul_f32 v250, v122, v122
  v_mfma_f32_16x16x32_bf16 v[72:75], v[180:183], v[200:203], v[72:75]
  v_fma_f32 v249, v249, v10, v6
  v_mul_f32 v248, v248, v120
  s_waitcnt lgkmcnt(4)
  v_mfma_f32_16x16x32_bf16 v[40:43], v[184:187], v[196:199], v[40:43]
  ds_read_b128 v[172:175], v2 offset:49152
  v_lshlrev_b32 v156, 16, v246
  s_add_u32 m0, s17, 28672
  s_add_u32 s10, s10, 4096
  v_mfma_f32_16x16x32_bf16 v[76:79], v[184:187], v[200:203], v[76:79]
  buffer_load_dwordx4 v2, s[56:59], s10 offen sc1 lds
  v_mfma_f32_16x16x32_bf16 v[44:47], v[188:191], v[196:199], v[44:47]
  ds_read_b128 v[176:179], v2 offset:50176
  v_mul_f32 v251, v123, v123
  s_add_u32 m0, s17, 32768
  s_add_u32 s10, s10, 4096
  v_mfma_f32_16x16x32_bf16 v[80:83], v[188:191], v[200:203], v[80:83]
  buffer_load_dwordx4 v2, s[56:59], s10 offen sc1 lds
  v_mfma_f32_16x16x32_bf16 v[48:51], v[192:195], v[196:199], v[48:51]
  ds_read_b128 v[180:183], v2 offset:51200
  v_fma_f32 v250, v250, v10, v6
  v_mfma_f32_16x16x32_bf16 v[84:87], v[192:195], v[200:203], v[84:87]
  v_mul_f32 v249, v249, v121
  s_waitcnt lgkmcnt(3)
  v_mfma_f32_16x16x32_bf16 v[16:19], v[160:163], v[224:227], v[16:19]
  ds_read_b128 v[184:187], v2 offset:52224
  s_add_u32 m0, s13, 32768
  s_add_u32 s11, s11, 128
  v_mfma_f32_16x16x32_bf16 v[52:55], v[160:163], v[228:231], v[52:55]
  buffer_load_dwordx4 v210, s[28:31], s11 offen  lds
  v_mfma_f32_16x16x32_bf16 v[20:23], v[164:167], v[224:227], v[20:23]
  ds_read_b128 v[188:191], v2 offset:53248
  v_mfma_f32_16x16x32_bf16 v[56:59], v[164:167], v[228:231], v[56:59]
  ds_read_b128 v[196:199], v4 offset:49152
  v_mfma_f32_16x16x32_bf16 v[24:27], v[168:171], v[224:227], v[24:27]
  ds_read_b128 v[192:195], v2 offset:54272
  v_mfma_f32_16x16x32_bf16 v[60:63], v[168:171], v[228:231], v[60:63]
  ds_read_b128 v[200:203], v4 offset:51200
  s_waitcnt lgkmcnt(5)
  v_mfma_f32_16x16x32_bf16 v[28:31], v[172:175], v[224:227], v[28:31]
  ds_read_b128 v[160:163], v3 offset:0
  s_add_u32 m0, s13, 33792
  v_mfma_f32_16x16x32_bf16 v[64:67], v[172:175], v[228:231], v[64:67]
  buffer_load_dwordx4 v211, s[28:31], s11 offen  lds
  v_mfma_f32_16x16x32_bf16 v[32:35], v[176:179], v[224:227], v[32:35]
  ds_read_b128 v[164:167], v3 offset:1024
  v_mfma_f32_16x16x32_bf16 v[68:71], v[176:179], v[228:231], v[68:71]
  v_exp_f32 v248, v248
  v_mfma_f32_16x16x32_bf16 v[36:39], v[180:183], v[224:227], v[36:39]
  ds_read_b128 v[168:171], v3 offset:2048
  v_and_b32 v157, 0xffff0000, v246
  s_add_u32 m0, s13, 34816
  v_mfma_f32_16x16x32_bf16 v[72:75], v[180:183], v[228:231], v[72:75]
  buffer_load_dwordx4 v212, s[28:31], s11 offen  lds
  s_waitcnt lgkmcnt(4)
  v_mfma_f32_16x16x32_bf16 v[40:43], v[184:187], v[224:227], v[40:43]
  ds_read_b128 v[172:175], v3 offset:3072
  v_mul_f32 v252, v156, v156
  v_mfma_f32_16x16x32_bf16 v[76:79], v[184:187], v[228:231], v[76:79]
  v_fma_f32 v251, v251, v10, v6
  v_mul_f32 v250, v250, v122
  v_mfma_f32_16x16x32_bf16 v[44:47], v[188:191], v[224:227], v[44:47]
  ds_read_b128 v[176:179], v3 offset:4096
  s_add_u32 m0, s13, 35840
  v_mfma_f32_16x16x32_bf16 v[80:83], v[188:191], v[228:231], v[80:83]
  buffer_load_dwordx4 v213, s[28:31], s11 offen  lds
  v_mfma_f32_16x16x32_bf16 v[48:51], v[192:195], v[224:227], v[48:51]
  ds_read_b128 v[180:183], v3 offset:5120
  v_mfma_f32_16x16x32_bf16 v[84:87], v[192:195], v[228:231], v[84:87]
  v_exp_f32 v249, v249
  s_waitcnt vmcnt(14) lgkmcnt(5)
  s_barrier
  s_waitcnt lgkmcnt(3)
  v_mfma_f32_16x16x32_bf16 v[16:19], v[160:163], v[196:199], v[16:19]
  ds_read_b128 v[184:187], v3 offset:6144
  v_fma_f32 v248, v248, v14, v14
  s_add_u32 m0, s17, 36864
  s_add_u32 s10, s10, 4096
  v_mfma_f32_16x16x32_bf16 v[52:55], v[160:163], v[200:203], v[52:55]
  buffer_load_dwordx4 v2, s[56:59], s10 offen sc1 lds
  v_mfma_f32_16x16x32_bf16 v[20:23], v[164:167], v[196:199], v[20:23]
  ds_read_b128 v[188:191], v3 offset:7168
  v_lshlrev_b32 v158, 16, v247
  v_mfma_f32_16x16x32_bf16 v[56:59], v[164:167], v[200:203], v[56:59]
  ds_read_b128 v[224:227], v5 offset:49152
  v_mul_f32 v253, v157, v157
  v_mfma_f32_16x16x32_bf16 v[24:27], v[168:171], v[196:199], v[24:27]
  ds_read_b128 v[192:195], v3 offset:8192
  v_fma_f32 v252, v252, v12, v8
  v_mfma_f32_16x16x32_bf16 v[60:63], v[168:171], v[200:203], v[60:63]
  ds_read_b128 v[228:231], v5 offset:51200
  v_mul_f32 v251, v251, v123
  s_waitcnt lgkmcnt(5)
  v_mfma_f32_16x16x32_bf16 v[28:31], v[172:175], v[196:199], v[28:31]
  ds_read_b128 v[160:163], v3 offset:9216
  s_add_u32 m0, s17, 40960
  s_add_u32 s10, s10, 4096
  v_mfma_f32_16x16x32_bf16 v[64:67], v[172:175], v[200:203], v[64:67]
  buffer_load_dwordx4 v2, s[56:59], s10 offen sc1 lds
  v_mfma_f32_16x16x32_bf16 v[32:35], v[176:179], v[196:199], v[32:35]
  ds_read_b128 v[164:167], v3 offset:10240
  v_mfma_f32_16x16x32_bf16 v[68:71], v[176:179], v[200:203], v[68:71]
  v_exp_f32 v250, v250
  v_mfma_f32_16x16x32_bf16 v[36:39], v[180:183], v[196:199], v[36:39]
  ds_read_b128 v[168:171], v3 offset:11264
  v_fma_f32 v249, v249, v14, v14
  s_add_u32 m0, s17, 45056
  s_add_u32 s10, s10, 4096
  v_mfma_f32_16x16x32_bf16 v[72:75], v[180:183], v[200:203], v[72:75]
  buffer_load_dwordx4 v2, s[56:59], s10 offen sc1 lds
  s_waitcnt lgkmcnt(4)
  v_mfma_f32_16x16x32_bf16 v[40:43], v[184:187], v[196:199], v[40:43]
  ds_read_b128 v[172:175], v3 offset:12288
  v_mfma_f32_16x16x32_bf16 v[76:79], v[184:187], v[200:203], v[76:79]
  v_rcp_f32 v248, v248
  v_mfma_f32_16x16x32_bf16 v[44:47], v[188:191], v[196:199], v[44:47]
  ds_read_b128 v[176:179], v3 offset:13312
  v_and_b32 v159, 0xffff0000, v247
  s_add_u32 m0, s17, 49152
  s_add_u32 s10, s10, 4096
  v_mfma_f32_16x16x32_bf16 v[80:83], v[188:191], v[200:203], v[80:83]
  buffer_load_dwordx4 v2, s[56:59], s10 offen sc1 lds
  v_mfma_f32_16x16x32_bf16 v[48:51], v[192:195], v[196:199], v[48:51]
  ds_read_b128 v[180:183], v3 offset:14336
  v_mul_f32 v254, v158, v158
  v_mfma_f32_16x16x32_bf16 v[84:87], v[192:195], v[200:203], v[84:87]
  v_fma_f32 v253, v253, v12, v8
  v_mul_f32 v252, v252, v156
  s_waitcnt lgkmcnt(3)
  v_mfma_f32_16x16x32_bf16 v[16:19], v[160:163], v[224:227], v[16:19]
  ds_read_b128 v[184:187], v3 offset:15360
  s_add_u32 m0, s13, 49152
  s_add_u32 s11, s11, 128
  v_mfma_f32_16x16x32_bf16 v[52:55], v[160:163], v[228:231], v[52:55]
  buffer_load_dwordx4 v210, s[28:31], s11 offen  lds
  v_mfma_f32_16x16x32_bf16 v[20:23], v[164:167], v[224:227], v[20:23]
  ds_read_b128 v[188:191], v3 offset:16384
  v_mfma_f32_16x16x32_bf16 v[56:59], v[164:167], v[228:231], v[56:59]
  ds_read_b128 v[196:199], v4 offset:0
  v_mfma_f32_16x16x32_bf16 v[24:27], v[168:171], v[224:227], v[24:27]
  ds_read_b128 v[192:195], v3 offset:17408
  v_mfma_f32_16x16x32_bf16 v[60:63], v[168:171], v[228:231], v[60:63]
  ds_read_b128 v[200:203], v4 offset:2048
  s_waitcnt lgkmcnt(5)
  v_mfma_f32_16x16x32_bf16 v[28:31], v[172:175], v[224:227], v[28:31]
  ds_read_b128 v[160:163], v2 offset:0
  s_add_u32 m0, s13, 50176
  v_mfma_f32_16x16x32_bf16 v[64:67], v[172:175], v[228:231], v[64:67]
  buffer_load_dwordx4 v211, s[28:31], s11 offen  lds
  v_mfma_f32_16x16x32_bf16 v[32:35], v[176:179], v[224:227], v[32:35]
  ds_read_b128 v[164:167], v2 offset:1024
  v_mfma_f32_16x16x32_bf16 v[68:71], v[176:179], v[228:231], v[68:71]
  v_exp_f32 v251, v251
  v_mfma_f32_16x16x32_bf16 v[36:39], v[180:183], v[224:227], v[36:39]
  ds_read_b128 v[168:171], v2 offset:2048
  v_fma_f32 v250, v250, v14, v14
  s_add_u32 m0, s13, 51200
  v_mfma_f32_16x16x32_bf16 v[72:75], v[180:183], v[228:231], v[72:75]
  buffer_load_dwordx4 v212, s[28:31], s11 offen  lds
  s_waitcnt lgkmcnt(4)
  v_mfma_f32_16x16x32_bf16 v[40:43], v[184:187], v[224:227], v[40:43]
  ds_read_b128 v[172:175], v2 offset:3072
  v_mfma_f32_16x16x32_bf16 v[76:79], v[184:187], v[228:231], v[76:79]
  v_rcp_f32 v249, v249
  v_mfma_f32_16x16x32_bf16 v[44:47], v[188:191], v[224:227], v[44:47]
  ds_read_b128 v[176:179], v2 offset:4096
  v_mul_f32 v120, v120, v248
  s_add_u32 m0, s13, 52224
  v_mfma_f32_16x16x32_bf16 v[80:83], v[188:191], v[228:231], v[80:83]
  buffer_load_dwordx4 v213, s[28:31], s11 offen  lds
  v_mfma_f32_16x16x32_bf16 v[48:51], v[192:195], v[224:227], v[48:51]
  ds_read_b128 v[180:183], v2 offset:5120
  v_mul_f32 v255, v159, v159
  v_mfma_f32_16x16x32_bf16 v[84:87], v[192:195], v[228:231], v[84:87]
  v_fma_f32 v254, v254, v12, v8
  v_mul_f32 v253, v253, v157
  s_waitcnt vmcnt(14) lgkmcnt(5)
  s_barrier
  s_waitcnt lgkmcnt(3)
  v_mfma_f32_16x16x32_bf16 v[16:19], v[160:163], v[196:199], v[16:19]
  ds_read_b128 v[184:187], v2 offset:6144
  s_add_u32 m0, s17, 53248
  s_add_u32 s10, s10, 4096
  v_mfma_f32_16x16x32_bf16 v[52:55], v[160:163], v[200:203], v[52:55]
  buffer_load_dwordx4 v2, s[56:59], s10 offen sc1 lds
  v_mfma_f32_16x16x32_bf16 v[20:23], v[164:167], v[196:199], v[20:23]
  ds_read_b128 v[188:191], v2 offset:7168
  v_mfma_f32_16x16x32_bf16 v[56:59], v[164:167], v[200:203], v[56:59]
  ds_read_b128 v[224:227], v5 offset:0
  v_mfma_f32_16x16x32_bf16 v[24:27], v[168:171], v[196:199], v[24:27]
  ds_read_b128 v[192:195], v2 offset:8192
  v_mfma_f32_16x16x32_bf16 v[60:63], v[168:171], v[200:203], v[60:63]
  ds_read_b128 v[228:231], v5 offset:2048
  s_waitcnt lgkmcnt(5)
  v_mfma_f32_16x16x32_bf16 v[28:31], v[172:175], v[196:199], v[28:31]
  ds_read_b128 v[160:163], v2 offset:9216
  s_add_u32 m0, s17, 57344
  s_add_u32 s10, s10, 4096
  v_mfma_f32_16x16x32_bf16 v[64:67], v[172:175], v[200:203], v[64:67]
  buffer_load_dwordx4 v2, s[56:59], s10 offen sc1 lds
  v_mfma_f32_16x16x32_bf16 v[32:35], v[176:179], v[196:199], v[32:35]
  ds_read_b128 v[164:167], v2 offset:10240
  s_add_u32 m0, s17, 61440
  s_add_u32 s10, s10, 4096
  v_mfma_f32_16x16x32_bf16 v[68:71], v[176:179], v[200:203], v[68:71]
  buffer_load_dwordx4 v2, s[56:59], s10 offen sc1 lds
  v_mfma_f32_16x16x32_bf16 v[36:39], v[180:183], v[196:199], v[36:39]
  ds_read_b128 v[168:171], v2 offset:11264
  v_mfma_f32_16x16x32_bf16 v[72:75], v[180:183], v[200:203], v[72:75]
  v_exp_f32 v252, v252
  s_waitcnt lgkmcnt(4)
  v_mfma_f32_16x16x32_bf16 v[40:43], v[184:187], v[196:199], v[40:43]
  ds_read_b128 v[172:175], v2 offset:12288
  v_fma_f32 v251, v251, v14, v14
  s_add_u32 m0, s17, 65536
  s_add_u32 s10, s10, 4096
  v_mfma_f32_16x16x32_bf16 v[76:79], v[184:187], v[200:203], v[76:79]
  buffer_load_dwordx4 v2, s[56:59], s10 offen sc1 lds
  v_mfma_f32_16x16x32_bf16 v[44:47], v[188:191], v[196:199], v[44:47]
  ds_read_b128 v[176:179], v2 offset:13312
  s_add_u32 m0, s17, 69632
  s_add_u32 s10, s10, 4096
  v_mfma_f32_16x16x32_bf16 v[80:83], v[188:191], v[200:203], v[80:83]
  buffer_load_dwordx4 v2, s[56:59], s10 offen sc1 lds
  v_mfma_f32_16x16x32_bf16 v[48:51], v[192:195], v[196:199], v[48:51]
  ds_read_b128 v[180:183], v2 offset:14336
  v_mfma_f32_16x16x32_bf16 v[84:87], v[192:195], v[200:203], v[84:87]
  v_rcp_f32 v250, v250
  s_waitcnt lgkmcnt(3)
  v_mfma_f32_16x16x32_bf16 v[16:19], v[160:163], v[224:227], v[16:19]
  ds_read_b128 v[184:187], v2 offset:15360
  v_mul_f32 v121, v121, v249
  s_add_u32 m0, s13, 0
  s_add_u32 s11, s11, 128
  v_mfma_f32_16x16x32_bf16 v[52:55], v[160:163], v[228:231], v[52:55]
  buffer_load_dwordx4 v210, s[28:31], s11 offen  lds
  v_mfma_f32_16x16x32_bf16 v[20:23], v[164:167], v[224:227], v[20:23]
  ds_read_b128 v[188:191], v2 offset:16384
  v_fma_f32 v255, v255, v12, v8
  v_mfma_f32_16x16x32_bf16 v[56:59], v[164:167], v[228:231], v[56:59]
  ds_read_b128 v[196:199], v4 offset:16384
  v_mul_f32 v254, v254, v158
  v_mfma_f32_16x16x32_bf16 v[24:27], v[168:171], v[224:227], v[24:27]
  ds_read_b128 v[192:195], v2 offset:17408
  v_mfma_f32_16x16x32_bf16 v[60:63], v[168:171], v[228:231], v[60:63]
  ds_read_b128 v[200:203], v4 offset:18432
  s_waitcnt lgkmcnt(5)
  v_mfma_f32_16x16x32_bf16 v[28:31], v[172:175], v[224:227], v[28:31]
  ds_read_b128 v[160:163], v2 offset:18432
  s_add_u32 m0, s13, 1024
  v_mfma_f32_16x16x32_bf16 v[64:67], v[172:175], v[228:231], v[64:67]
  buffer_load_dwordx4 v211, s[28:31], s11 offen  lds
  v_mfma_f32_16x16x32_bf16 v[32:35], v[176:179], v[224:227], v[32:35]
  ds_read_b128 v[164:167], v2 offset:19456
  v_mfma_f32_16x16x32_bf16 v[68:71], v[176:179], v[228:231], v[68:71]
  v_exp_f32 v253, v253
  v_mfma_f32_16x16x32_bf16 v[36:39], v[180:183], v[224:227], v[36:39]
  ds_read_b128 v[168:171], v2 offset:20480
  v_fma_f32 v252, v252, v208, v208
  s_add_u32 m0, s13, 2048
  v_mfma_f32_16x16x32_bf16 v[72:75], v[180:183], v[228:231], v[72:75]
  buffer_load_dwordx4 v212, s[28:31], s11 offen  lds
  s_waitcnt lgkmcnt(4)
  v_mfma_f32_16x16x32_bf16 v[40:43], v[184:187], v[224:227], v[40:43]
  ds_read_b128 v[172:175], v2 offset:21504
  v_mfma_f32_16x16x32_bf16 v[76:79], v[184:187], v[228:231], v[76:79]
  v_rcp_f32 v251, v251
  v_mfma_f32_16x16x32_bf16 v[44:47], v[188:191], v[224:227], v[44:47]
  ds_read_b128 v[176:179], v2 offset:22528
  v_mul_f32 v122, v122, v250
  s_add_u32 m0, s13, 3072
  v_mfma_f32_16x16x32_bf16 v[80:83], v[188:191], v[228:231], v[80:83]
  buffer_load_dwordx4 v213, s[28:31], s11 offen  lds
  v_mfma_f32_16x16x32_bf16 v[48:51], v[192:195], v[224:227], v[48:51]
  ds_read_b128 v[180:183], v2 offset:23552
  v_mul_f32 v255, v255, v159
  v_mfma_f32_16x16x32_bf16 v[84:87], v[192:195], v[228:231], v[84:87]
  v_exp_f32 v254, v254
  s_waitcnt vmcnt(14) lgkmcnt(5)
  s_barrier
  s_waitcnt lgkmcnt(3)
  v_mfma_f32_16x16x32_bf16 v[16:19], v[160:163], v[196:199], v[16:19]
  ds_read_b128 v[184:187], v2 offset:24576
  v_fma_f32 v253, v253, v208, v208
  s_add_u32 m0, s17, 0
  s_add_u32 s10, s10, 4096
  v_mfma_f32_16x16x32_bf16 v[52:55], v[160:163], v[200:203], v[52:55]
  buffer_load_dwordx4 v2, s[56:59], s10 offen sc1 lds
  v_mfma_f32_16x16x32_bf16 v[20:23], v[164:167], v[196:199], v[20:23]
  ds_read_b128 v[188:191], v2 offset:25600
  v_mfma_f32_16x16x32_bf16 v[56:59], v[164:167], v[200:203], v[56:59]
  ds_read_b128 v[224:227], v5 offset:16384
  v_mfma_f32_16x16x32_bf16 v[24:27], v[168:171], v[196:199], v[24:27]
  ds_read_b128 v[192:195], v2 offset:26624
  v_mfma_f32_16x16x32_bf16 v[60:63], v[168:171], v[200:203], v[60:63]
  ds_read_b128 v[228:231], v5 offset:18432
  s_waitcnt lgkmcnt(5)
  v_mfma_f32_16x16x32_bf16 v[28:31], v[172:175], v[196:199], v[28:31]
  ds_read_b128 v[160:163], v2 offset:27648
  s_add_u32 m0, s17, 4096
  s_add_u32 s10, s10, 4096
  v_mfma_f32_16x16x32_bf16 v[64:67], v[172:175], v[200:203], v[64:67]
  buffer_load_dwordx4 v2, s[56:59], s10 offen sc1 lds
  v_mfma_f32_16x16x32_bf16 v[32:35], v[176:179], v[196:199], v[32:35]
  ds_read_b128 v[164:167], v2 offset:28672
  v_mfma_f32_16x16x32_bf16 v[68:71], v[176:179], v[200:203], v[68:71]
  v_rcp_f32 v252, v252
  v_mfma_f32_16x16x32_bf16 v[36:39], v[180:183], v[196:199], v[36:39]
  ds_read_b128 v[168:171], v2 offset:29696
  v_mul_f32 v123, v123, v251
  s_add_u32 m0, s17, 8192
  s_add_u32 s10, s10, 4096
  v_mfma_f32_16x16x32_bf16 v[72:75], v[180:183], v[200:203], v[72:75]
  buffer_load_dwordx4 v2, s[56:59], s10 offen sc1 lds
  s_waitcnt lgkmcnt(4)
  v_mfma_f32_16x16x32_bf16 v[40:43], v[184:187], v[196:199], v[40:43]
  ds_read_b128 v[172:175], v2 offset:30720
  v_mfma_f32_16x16x32_bf16 v[76:79], v[184:187], v[200:203], v[76:79]
  v_exp_f32 v255, v255
  v_mfma_f32_16x16x32_bf16 v[44:47], v[188:191], v[196:199], v[44:47]
  ds_read_b128 v[176:179], v2 offset:31744
  v_fma_f32 v254, v254, v208, v208
  s_add_u32 m0, s17, 12288
  s_add_u32 s10, s10, 4096
  v_mfma_f32_16x16x32_bf16 v[80:83], v[188:191], v[200:203], v[80:83]
  buffer_load_dwordx4 v2, s[56:59], s10 offen sc1 lds
  v_mfma_f32_16x16x32_bf16 v[48:51], v[192:195], v[196:199], v[48:51]
  ds_read_b128 v[180:183], v2 offset:32768
  v_mfma_f32_16x16x32_bf16 v[84:87], v[192:195], v[200:203], v[84:87]
  v_rcp_f32 v253, v253
  s_waitcnt lgkmcnt(3)
  v_mfma_f32_16x16x32_bf16 v[16:19], v[160:163], v[224:227], v[16:19]
  ds_read_b128 v[184:187], v2 offset:33792
  v_mul_f32 v156, v156, v252
  s_add_u32 m0, s13, 16384
  s_add_u32 s11, s11, 128
  v_mfma_f32_16x16x32_bf16 v[52:55], v[160:163], v[228:231], v[52:55]
  buffer_load_dwordx4 v210, s[28:31], s11 offen  lds
  v_mfma_f32_16x16x32_bf16 v[20:23], v[164:167], v[224:227], v[20:23]
  ds_read_b128 v[188:191], v2 offset:34816
  v_fma_f32 v255, v255, v208, v208
  v_mfma_f32_16x16x32_bf16 v[56:59], v[164:167], v[228:231], v[56:59]
  ds_read_b128 v[196:199], v4 offset:32768
  v_mfma_f32_16x16x32_bf16 v[24:27], v[168:171], v[224:227], v[24:27]
  ds_read_b128 v[192:195], v2 offset:35840
  v_mfma_f32_16x16x32_bf16 v[60:63], v[168:171], v[228:231], v[60:63]
  ds_read_b128 v[200:203], v4 offset:34816
  s_waitcnt lgkmcnt(5)
  v_mfma_f32_16x16x32_bf16 v[28:31], v[172:175], v[224:227], v[28:31]
  ds_read_b128 v[160:163], v2 offset:36864
  s_add_u32 m0, s13, 17408
  v_mfma_f32_16x16x32_bf16 v[64:67], v[172:175], v[228:231], v[64:67]
  buffer_load_dwordx4 v211, s[28:31], s11 offen  lds
  v_mfma_f32_16x16x32_bf16 v[32:35], v[176:179], v[224:227], v[32:35]
  ds_read_b128 v[164:167], v2 offset:37888
  v_mfma_f32_16x16x32_bf16 v[68:71], v[176:179], v[228:231], v[68:71]
  v_rcp_f32 v254, v254
  v_mfma_f32_16x16x32_bf16 v[36:39], v[180:183], v[224:227], v[36:39]
  ds_read_b128 v[168:171], v2 offset:38912
  v_mul_f32 v157, v157, v253
  s_add_u32 m0, s13, 18432
  v_mfma_f32_16x16x32_bf16 v[72:75], v[180:183], v[228:231], v[72:75]
  buffer_load_dwordx4 v212, s[28:31], s11 offen  lds
  s_waitcnt lgkmcnt(4)
  v_mfma_f32_16x16x32_bf16 v[40:43], v[184:187], v[224:227], v[40:43]
  ds_read_b128 v[172:175], v2 offset:39936
  v_mfma_f32_16x16x32_bf16 v[76:79], v[184:187], v[228:231], v[76:79]
  v_rcp_f32 v255, v255
  v_mfma_f32_16x16x32_bf16 v[44:47], v[188:191], v[224:227], v[44:47]
  ds_read_b128 v[176:179], v2 offset:40960
  v_mul_f32 v158, v158, v254
  s_add_u32 m0, s13, 19456
  v_mfma_f32_16x16x32_bf16 v[80:83], v[188:191], v[228:231], v[80:83]
  buffer_load_dwordx4 v213, s[28:31], s11 offen  lds
  v_mfma_f32_16x16x32_bf16 v[48:51], v[192:195], v[224:227], v[48:51]
  ds_read_b128 v[180:183], v2 offset:41984
  v_mul_f32 v159, v159, v255
  v_mfma_f32_16x16x32_bf16 v[84:87], v[192:195], v[228:231], v[84:87]
  s_waitcnt vmcnt(14) lgkmcnt(5)
  s_barrier
  s_waitcnt lgkmcnt(3)
  v_mfma_f32_16x16x32_bf16 v[16:19], v[160:163], v[196:199], v[16:19]
  ds_read_b128 v[184:187], v2 offset:43008
  s_add_u32 m0, s17, 16384
  s_add_u32 s10, s10, 4096
  v_mfma_f32_16x16x32_bf16 v[52:55], v[160:163], v[200:203], v[52:55]
  buffer_load_dwordx4 v2, s[56:59], s10 offen sc1 lds
  v_mfma_f32_16x16x32_bf16 v[20:23], v[164:167], v[196:199], v[20:23]
  ds_read_b128 v[188:191], v2 offset:44032
  v_mfma_f32_16x16x32_bf16 v[56:59], v[164:167], v[200:203], v[56:59]
  ds_read_b128 v[224:227], v5 offset:32768
  v_mfma_f32_16x16x32_bf16 v[24:27], v[168:171], v[196:199], v[24:27]
  ds_read_b128 v[192:195], v2 offset:45056
  v_mfma_f32_16x16x32_bf16 v[60:63], v[168:171], v[200:203], v[60:63]
  ds_read_b128 v[228:231], v5 offset:34816
  s_waitcnt lgkmcnt(5)
  v_mfma_f32_16x16x32_bf16 v[28:31], v[172:175], v[196:199], v[28:31]
  ds_read_b128 v[160:163], v2 offset:46080
  s_add_u32 m0, s17, 20480
  s_add_u32 s10, s10, 4096
  v_mfma_f32_16x16x32_bf16 v[64:67], v[172:175], v[200:203], v[64:67]
  buffer_load_dwordx4 v2, s[56:59], s10 offen sc1 lds
  v_mfma_f32_16x16x32_bf16 v[32:35], v[176:179], v[196:199], v[32:35]
  ds_read_b128 v[164:167], v2 offset:47104
  s_add_u32 m0, s17, 24576
  s_add_u32 s10, s10, 4096
  v_mfma_f32_16x16x32_bf16 v[68:71], v[176:179], v[200:203], v[68:71]
  buffer_load_dwordx4 v2, s[56:59], s10 offen sc1 lds
  v_mfma_f32_16x16x32_bf16 v[36:39], v[180:183], v[196:199], v[36:39]
  ds_read_b128 v[168:171], v2 offset:48128
  v_mfma_f32_16x16x32_bf16 v[72:75], v[180:183], v[200:203], v[72:75]
  s_waitcnt lgkmcnt(4)
  v_mfma_f32_16x16x32_bf16 v[40:43], v[184:187], v[196:199], v[40:43]
  ds_read_b128 v[172:175], v2 offset:49152
  s_add_u32 m0, s17, 28672
  s_add_u32 s10, s10, 4096
  v_mfma_f32_16x16x32_bf16 v[76:79], v[184:187], v[200:203], v[76:79]
  buffer_load_dwordx4 v2, s[56:59], s10 offen sc1 lds
  v_mfma_f32_16x16x32_bf16 v[44:47], v[188:191], v[196:199], v[44:47]
  ds_read_b128 v[176:179], v2 offset:50176
  s_add_u32 m0, s17, 32768
  s_add_u32 s10, s10, 4096
  v_mfma_f32_16x16x32_bf16 v[80:83], v[188:191], v[200:203], v[80:83]
  buffer_load_dwordx4 v2, s[56:59], s10 offen sc1 lds
  v_mfma_f32_16x16x32_bf16 v[48:51], v[192:195], v[196:199], v[48:51]
  ds_read_b128 v[180:183], v2 offset:51200
  v_mfma_f32_16x16x32_bf16 v[84:87], v[192:195], v[200:203], v[84:87]
  s_waitcnt lgkmcnt(3)
  v_mfma_f32_16x16x32_bf16 v[16:19], v[160:163], v[224:227], v[16:19]
  ds_read_b128 v[184:187], v2 offset:52224
  s_add_u32 m0, s13, 32768
  s_add_u32 s11, s11, 128
  v_mfma_f32_16x16x32_bf16 v[52:55], v[160:163], v[228:231], v[52:55]
  buffer_load_dwordx4 v210, s[28:31], s11 offen  lds
  v_mfma_f32_16x16x32_bf16 v[20:23], v[164:167], v[224:227], v[20:23]
  ds_read_b128 v[188:191], v2 offset:53248
  v_mfma_f32_16x16x32_bf16 v[56:59], v[164:167], v[228:231], v[56:59]
  ds_read_b128 v[196:199], v4 offset:49152
  v_mfma_f32_16x16x32_bf16 v[24:27], v[168:171], v[224:227], v[24:27]
  ds_read_b128 v[192:195], v2 offset:54272
  v_mfma_f32_16x16x32_bf16 v[60:63], v[168:171], v[228:231], v[60:63]
  ds_read_b128 v[200:203], v4 offset:51200
  s_waitcnt lgkmcnt(5)
  v_mfma_f32_16x16x32_bf16 v[28:31], v[172:175], v[224:227], v[28:31]
  ds_read_b128 v[160:163], v3 offset:0
  s_add_u32 m0, s13, 33792
  v_mfma_f32_16x16x32_bf16 v[64:67], v[172:175], v[228:231], v[64:67]
  buffer_load_dwordx4 v211, s[28:31], s11 offen  lds
  v_mfma_f32_16x16x32_bf16 v[32:35], v[176:179], v[224:227], v[32:35]
  ds_read_b128 v[164:167], v3 offset:1024
  v_mfma_f32_16x16x32_bf16 v[68:71], v[176:179], v[228:231], v[68:71]
  v_mfma_f32_16x16x32_bf16 v[36:39], v[180:183], v[224:227], v[36:39]
  ds_read_b128 v[168:171], v3 offset:2048
  s_add_u32 m0, s13, 34816
  v_mfma_f32_16x16x32_bf16 v[72:75], v[180:183], v[228:231], v[72:75]
  buffer_load_dwordx4 v212, s[28:31], s11 offen  lds
  s_waitcnt lgkmcnt(4)
  v_mfma_f32_16x16x32_bf16 v[40:43], v[184:187], v[224:227], v[40:43]
  ds_read_b128 v[172:175], v3 offset:3072
  v_mfma_f32_16x16x32_bf16 v[76:79], v[184:187], v[228:231], v[76:79]
  v_mfma_f32_16x16x32_bf16 v[44:47], v[188:191], v[224:227], v[44:47]
  ds_read_b128 v[176:179], v3 offset:4096
  s_add_u32 m0, s13, 35840
  v_mfma_f32_16x16x32_bf16 v[80:83], v[188:191], v[228:231], v[80:83]
  buffer_load_dwordx4 v213, s[28:31], s11 offen  lds
  v_mfma_f32_16x16x32_bf16 v[48:51], v[192:195], v[224:227], v[48:51]
  ds_read_b128 v[180:183], v3 offset:5120
  v_mfma_f32_16x16x32_bf16 v[84:87], v[192:195], v[228:231], v[84:87]
  s_waitcnt vmcnt(14) lgkmcnt(5)
  s_barrier
  s_waitcnt lgkmcnt(3)
  v_mfma_f32_16x16x32_bf16 v[16:19], v[160:163], v[196:199], v[16:19]
  ds_read_b128 v[184:187], v3 offset:6144
  s_add_u32 m0, s17, 36864
  s_add_u32 s10, s10, 4096
  v_mfma_f32_16x16x32_bf16 v[52:55], v[160:163], v[200:203], v[52:55]
  buffer_load_dwordx4 v2, s[56:59], s10 offen sc1 lds
  v_mfma_f32_16x16x32_bf16 v[20:23], v[164:167], v[196:199], v[20:23]
  ds_read_b128 v[188:191], v3 offset:7168
  v_mfma_f32_16x16x32_bf16 v[56:59], v[164:167], v[200:203], v[56:59]
  ds_read_b128 v[224:227], v5 offset:49152
  v_mfma_f32_16x16x32_bf16 v[24:27], v[168:171], v[196:199], v[24:27]
  ds_read_b128 v[192:195], v3 offset:8192
  v_mfma_f32_16x16x32_bf16 v[60:63], v[168:171], v[200:203], v[60:63]
  ds_read_b128 v[228:231], v5 offset:51200
  s_waitcnt lgkmcnt(5)
  v_mfma_f32_16x16x32_bf16 v[28:31], v[172:175], v[196:199], v[28:31]
  ds_read_b128 v[160:163], v3 offset:9216
  s_add_u32 m0, s17, 40960
  s_add_u32 s10, s10, 4096
  v_mfma_f32_16x16x32_bf16 v[64:67], v[172:175], v[200:203], v[64:67]
  buffer_load_dwordx4 v2, s[56:59], s10 offen sc1 lds
  v_mfma_f32_16x16x32_bf16 v[32:35], v[176:179], v[196:199], v[32:35]
  ds_read_b128 v[164:167], v3 offset:10240
  v_mfma_f32_16x16x32_bf16 v[68:71], v[176:179], v[200:203], v[68:71]
  v_mfma_f32_16x16x32_bf16 v[36:39], v[180:183], v[196:199], v[36:39]
  ds_read_b128 v[168:171], v3 offset:11264
  s_add_u32 m0, s17, 45056
  s_add_u32 s10, s10, 4096
  v_mfma_f32_16x16x32_bf16 v[72:75], v[180:183], v[200:203], v[72:75]
  buffer_load_dwordx4 v2, s[56:59], s10 offen sc1 lds
  s_waitcnt lgkmcnt(4)
  v_mfma_f32_16x16x32_bf16 v[40:43], v[184:187], v[196:199], v[40:43]
  ds_read_b128 v[172:175], v3 offset:12288
  v_mfma_f32_16x16x32_bf16 v[76:79], v[184:187], v[200:203], v[76:79]
  v_mfma_f32_16x16x32_bf16 v[44:47], v[188:191], v[196:199], v[44:47]
  ds_read_b128 v[176:179], v3 offset:13312
  s_add_u32 m0, s17, 49152
  s_add_u32 s10, s10, 4096
  v_mfma_f32_16x16x32_bf16 v[80:83], v[188:191], v[200:203], v[80:83]
  buffer_load_dwordx4 v2, s[56:59], s10 offen sc1 lds
  v_mfma_f32_16x16x32_bf16 v[48:51], v[192:195], v[196:199], v[48:51]
  ds_read_b128 v[180:183], v3 offset:14336
  v_mfma_f32_16x16x32_bf16 v[84:87], v[192:195], v[200:203], v[84:87]
  s_waitcnt lgkmcnt(3)
  v_mfma_f32_16x16x32_bf16 v[16:19], v[160:163], v[224:227], v[16:19]
  ds_read_b128 v[184:187], v3 offset:15360
  s_add_u32 m0, s13, 49152
  s_add_u32 s11, s11, 128
  v_mfma_f32_16x16x32_bf16 v[52:55], v[160:163], v[228:231], v[52:55]
  buffer_load_dwordx4 v210, s[28:31], s11 offen  lds
  v_mfma_f32_16x16x32_bf16 v[20:23], v[164:167], v[224:227], v[20:23]
  ds_read_b128 v[188:191], v3 offset:16384
  v_mfma_f32_16x16x32_bf16 v[56:59], v[164:167], v[228:231], v[56:59]
  ds_read_b128 v[196:199], v4 offset:0
  v_mfma_f32_16x16x32_bf16 v[24:27], v[168:171], v[224:227], v[24:27]
  ds_read_b128 v[192:195], v3 offset:17408
  v_mfma_f32_16x16x32_bf16 v[60:63], v[168:171], v[228:231], v[60:63]
  ds_read_b128 v[200:203], v4 offset:2048
  s_waitcnt lgkmcnt(5)
  v_mfma_f32_16x16x32_bf16 v[28:31], v[172:175], v[224:227], v[28:31]
  ds_read_b128 v[160:163], v2 offset:0
  s_add_u32 m0, s13, 50176
  v_mfma_f32_16x16x32_bf16 v[64:67], v[172:175], v[228:231], v[64:67]
  buffer_load_dwordx4 v211, s[28:31], s11 offen  lds
  v_mfma_f32_16x16x32_bf16 v[32:35], v[176:179], v[224:227], v[32:35]
  ds_read_b128 v[164:167], v2 offset:1024
  v_mfma_f32_16x16x32_bf16 v[68:71], v[176:179], v[228:231], v[68:71]
  v_mfma_f32_16x16x32_bf16 v[36:39], v[180:183], v[224:227], v[36:39]
  ds_read_b128 v[168:171], v2 offset:2048
  s_add_u32 m0, s13, 51200
  v_mfma_f32_16x16x32_bf16 v[72:75], v[180:183], v[228:231], v[72:75]
  buffer_load_dwordx4 v212, s[28:31], s11 offen  lds
  s_waitcnt lgkmcnt(4)
  v_mfma_f32_16x16x32_bf16 v[40:43], v[184:187], v[224:227], v[40:43]
  ds_read_b128 v[172:175], v2 offset:3072
  v_mfma_f32_16x16x32_bf16 v[76:79], v[184:187], v[228:231], v[76:79]
  v_mfma_f32_16x16x32_bf16 v[44:47], v[188:191], v[224:227], v[44:47]
  ds_read_b128 v[176:179], v2 offset:4096
  s_add_u32 m0, s13, 52224
  v_mfma_f32_16x16x32_bf16 v[80:83], v[188:191], v[228:231], v[80:83]
  buffer_load_dwordx4 v213, s[28:31], s11 offen  lds
  v_mfma_f32_16x16x32_bf16 v[48:51], v[192:195], v[224:227], v[48:51]
  ds_read_b128 v[180:183], v2 offset:5120
  v_mfma_f32_16x16x32_bf16 v[84:87], v[192:195], v[228:231], v[84:87]
  s_mov_b32 s23, 5
kt_tail_kernel_floop:
  s_waitcnt vmcnt(14) lgkmcnt(5)
  s_barrier
  s_waitcnt lgkmcnt(3)
  v_mfma_f32_16x16x32_bf16 v[16:19], v[160:163], v[196:199], v[16:19]
  ds_read_b128 v[184:187], v2 offset:6144
  s_add_u32 m0, s17, 53248
  s_add_u32 s10, s10, 4096
  v_mfma_f32_16x16x32_bf16 v[52:55], v[160:163], v[200:203], v[52:55]
  buffer_load_dwordx4 v2, s[56:59], s10 offen sc1 lds
  v_mfma_f32_16x16x32_bf16 v[20:23], v[164:167], v[196:199], v[20:23]
  ds_read_b128 v[188:191], v2 offset:7168
  v_mfma_f32_16x16x32_bf16 v[56:59], v[164:167], v[200:203], v[56:59]
  ds_read_b128 v[224:227], v5 offset:0
  v_mfma_f32_16x16x32_bf16 v[24:27], v[168:171], v[196:199], v[24:27]
  ds_read_b128 v[192:195], v2 offset:8192
  v_mfma_f32_16x16x32_bf16 v[60:63], v[168:171], v[200:203], v[60:63]
  ds_read_b128 v[228:231], v5 offset:2048
  s_waitcnt lgkmcnt(5)
  v_mfma_f32_16x16x32_bf16 v[28:31], v[172:175], v[196:199], v[28:31]
  ds_read_b128 v[160:163], v2 offset:9216
  s_add_u32 m0, s17, 57344
  s_add_u32 s10, s10, 4096
  v_mfma_f32_16x16x32_bf16 v[64:67], v[172:175], v[200:203], v[64:67]
  buffer_load_dwordx4 v2, s[56:59], s10 offen sc1 lds
  v_mfma_f32_16x16x32_bf16 v[32:35], v[176:179], v[196:199], v[32:35]
  ds_read_b128 v[164:167], v2 offset:10240
  s_add_u32 m0, s17, 61440
  s_add_u32 s10, s10, 4096
  v_mfma_f32_16x16x32_bf16 v[68:71], v[176:179], v[200:203], v[68:71]
  buffer_load_dwordx4 v2, s[56:59], s10 offen sc1 lds
  v_mfma_f32_16x16x32_bf16 v[36:39], v[180:183], v[196:199], v[36:39]
  ds_read_b128 v[168:171], v2 offset:11264
  v_mfma_f32_16x16x32_bf16 v[72:75], v[180:183], v[200:203], v[72:75]
  s_waitcnt lgkmcnt(4)
  v_mfma_f32_16x16x32_bf16 v[40:43], v[184:187], v[196:199], v[40:43]
  ds_read_b128 v[172:175], v2 offset:12288
  s_add_u32 m0, s17, 65536
  s_add_u32 s10, s10, 4096
  v_mfma_f32_16x16x32_bf16 v[76:79], v[184:187], v[200:203], v[76:79]
  buffer_load_dwordx4 v2, s[56:59], s10 offen sc1 lds
  v_mfma_f32_16x16x32_bf16 v[44:47], v[188:191], v[196:199], v[44:47]
  ds_read_b128 v[176:179], v2 offset:13312
  s_add_u32 m0, s17, 69632
  s_add_u32 s10, s10, 4096
  v_mfma_f32_16x16x32_bf16 v[80:83], v[188:191], v[200:203], v[80:83]
  buffer_load_dwordx4 v2, s[56:59], s10 offen sc1 lds
  v_mfma_f32_16x16x32_bf16 v[48:51], v[192:195], v[196:199], v[48:51]
  ds_read_b128 v[180:183], v2 offset:14336
  v_mfma_f32_16x16x32_bf16 v[84:87], v[192:195], v[200:203], v[84:87]
  s_waitcnt lgkmcnt(3)
  v_mfma_f32_16x16x32_bf16 v[16:19], v[160:163], v[224:227], v[16:19]
  ds_read_b128 v[184:187], v2 offset:15360
  s_add_u32 m0, s13, 0
  s_add_u32 s11, s11, 128
  v_mfma_f32_16x16x32_bf16 v[52:55], v[160:163], v[228:231], v[52:55]
  buffer_load_dwordx4 v210, s[28:31], s11 offen  lds
  v_mfma_f32_16x16x32_bf16 v[20:23], v[164:167], v[224:227], v[20:23]
  ds_read_b128 v[188:191], v2 offset:16384
  v_mfma_f32_16x16x32_bf16 v[56:59], v[164:167], v[228:231], v[56:59]
  ds_read_b128 v[196:199], v4 offset:16384
  v_mfma_f32_16x16x32_bf16 v[24:27], v[168:171], v[224:227], v[24:27]
  ds_read_b128 v[192:195], v2 offset:17408
  v_mfma_f32_16x16x32_bf16 v[60:63], v[168:171], v[228:231], v[60:63]
  ds_read_b128 v[200:203], v4 offset:18432
  s_waitcnt lgkmcnt(5)
  v_mfma_f32_16x16x32_bf16 v[28:31], v[172:175], v[224:227], v[28:31]
  ds_read_b128 v[160:163], v2 offset:18432
  s_add_u32 m0, s13, 1024
  v_mfma_f32_16x16x32_bf16 v[64:67], v[172:175], v[228:231], v[64:67]
  buffer_load_dwordx4 v211, s[28:31], s11 offen  lds
  v_mfma_f32_16x16x32_bf16 v[32:35], v[176:179], v[224:227], v[32:35]
  ds_read_b128 v[164:167], v2 offset:19456
  v_mfma_f32_16x16x32_bf16 v[68:71], v[176:179], v[228:231], v[68:71]
  v_mfma_f32_16x16x32_bf16 v[36:39], v[180:183], v[224:227], v[36:39]
  ds_read_b128 v[168:171], v2 offset:20480
  s_add_u32 m0, s13, 2048
  v_mfma_f32_16x16x32_bf16 v[72:75], v[180:183], v[228:231], v[72:75]
  buffer_load_dwordx4 v212, s[28:31], s11 offen  lds
  s_waitcnt lgkmcnt(4)
  v_mfma_f32_16x16x32_bf16 v[40:43], v[184:187], v[224:227], v[40:43]
  ds_read_b128 v[172:175], v2 offset:21504
  v_mfma_f32_16x16x32_bf16 v[76:79], v[184:187], v[228:231], v[76:79]
  v_mfma_f32_16x16x32_bf16 v[44:47], v[188:191], v[224:227], v[44:47]
  ds_read_b128 v[176:179], v2 offset:22528
  s_add_u32 m0, s13, 3072
  v_mfma_f32_16x16x32_bf16 v[80:83], v[188:191], v[228:231], v[80:83]
  buffer_load_dwordx4 v213, s[28:31], s11 offen  lds
  v_mfma_f32_16x16x32_bf16 v[48:51], v[192:195], v[224:227], v[48:51]
  ds_read_b128 v[180:183], v2 offset:23552
  v_mfma_f32_16x16x32_bf16 v[84:87], v[192:195], v[228:231], v[84:87]
  s_waitcnt vmcnt(14) lgkmcnt(5)
  s_barrier
  s_waitcnt lgkmcnt(3)
  v_mfma_f32_16x16x32_bf16 v[16:19], v[160:163], v[196:199], v[16:19]
  ds_read_b128 v[184:187], v2 offset:24576
  s_add_u32 m0, s17, 0
  s_add_u32 s10, s10, 4096
  v_mfma_f32_16x16x32_bf16 v[52:55], v[160:163], v[200:203], v[52:55]
  buffer_load_dwordx4 v2, s[56:59], s10 offen sc1 lds
  v_mfma_f32_16x16x32_bf16 v[20:23], v[164:167], v[196:199], v[20:23]
  ds_read_b128 v[188:191], v2 offset:25600
  v_mfma_f32_16x16x32_bf16 v[56:59], v[164:167], v[200:203], v[56:59]
  ds_read_b128 v[224:227], v5 offset:16384
  v_mfma_f32_16x16x32_bf16 v[24:27], v[168:171], v[196:199], v[24:27]
  ds_read_b128 v[192:195], v2 offset:26624
  v_mfma_f32_16x16x32_bf16 v[60:63], v[168:171], v[200:203], v[60:63]
  ds_read_b128 v[228:231], v5 offset:18432
  s_waitcnt lgkmcnt(5)
  v_mfma_f32_16x16x32_bf16 v[28:31], v[172:175], v[196:199], v[28:31]
  ds_read_b128 v[160:163], v2 offset:27648
  s_add_u32 m0, s17, 4096
  s_add_u32 s10, s10, 4096
  v_mfma_f32_16x16x32_bf16 v[64:67], v[172:175], v[200:203], v[64:67]
  buffer_load_dwordx4 v2, s[56:59], s10 offen sc1 lds
  v_mfma_f32_16x16x32_bf16 v[32:35], v[176:179], v[196:199], v[32:35]
  ds_read_b128 v[164:167], v2 offset:28672
  v_mfma_f32_16x16x32_bf16 v[68:71], v[176:179], v[200:203], v[68:71]
  v_mfma_f32_16x16x32_bf16 v[36:39], v[180:183], v[196:199], v[36:39]
  ds_read_b128 v[168:171], v2 offset:29696
  s_add_u32 m0, s17, 8192
  s_add_u32 s10, s10, 4096
  v_mfma_f32_16x16x32_bf16 v[72:75], v[180:183], v[200:203], v[72:75]
  buffer_load_dwordx4 v2, s[56:59], s10 offen sc1 lds
  s_waitcnt lgkmcnt(4)
  v_mfma_f32_16x16x32_bf16 v[40:43], v[184:187], v[196:199], v[40:43]
  ds_read_b128 v[172:175], v2 offset:30720
  v_mfma_f32_16x16x32_bf16 v[76:79], v[184:187], v[200:203], v[76:79]
  v_mfma_f32_16x16x32_bf16 v[44:47], v[188:191], v[196:199], v[44:47]
  ds_read_b128 v[176:179], v2 offset:31744
  s_add_u32 m0, s17, 12288
  s_add_u32 s10, s10, 4096
  v_mfma_f32_16x16x32_bf16 v[80:83], v[188:191], v[200:203], v[80:83]
  buffer_load_dwordx4 v2, s[56:59], s10 offen sc1 lds
  v_mfma_f32_16x16x32_bf16 v[48:51], v[192:195], v[196:199], v[48:51]
  ds_read_b128 v[180:183], v2 offset:32768
  v_mfma_f32_16x16x32_bf16 v[84:87], v[192:195], v[200:203], v[84:87]
  s_waitcnt lgkmcnt(3)
  v_mfma_f32_16x16x32_bf16 v[16:19], v[160:163], v[224:227], v[16:19]
  ds_read_b128 v[184:187], v2 offset:33792
  s_add_u32 m0, s13, 16384
  s_add_u32 s11, s11, 128
  v_mfma_f32_16x16x32_bf16 v[52:55], v[160:163], v[228:231], v[52:55]
  buffer_load_dwordx4 v210, s[28:31], s11 offen  lds
  v_mfma_f32_16x16x32_bf16 v[20:23], v[164:167], v[224:227], v[20:23]
  ds_read_b128 v[188:191], v2 offset:34816
  v_mfma_f32_16x16x32_bf16 v[56:59], v[164:167], v[228:231], v[56:59]
  ds_read_b128 v[196:199], v4 offset:32768
  v_mfma_f32_16x16x32_bf16 v[24:27], v[168:171], v[224:227], v[24:27]
  ds_read_b128 v[192:195], v2 offset:35840
  v_mfma_f32_16x16x32_bf16 v[60:63], v[168:171], v[228:231], v[60:63]
  ds_read_b128 v[200:203], v4 offset:34816
  s_waitcnt lgkmcnt(5)
  v_mfma_f32_16x16x32_bf16 v[28:31], v[172:175], v[224:227], v[28:31]
  ds_read_b128 v[160:163], v2 offset:36864
  s_add_u32 m0, s13, 17408
  v_mfma_f32_16x16x32_bf16 v[64:67], v[172:175], v[228:231], v[64:67]
  buffer_load_dwordx4 v211, s[28:31], s11 offen  lds
  v_mfma_f32_16x16x32_bf16 v[32:35], v[176:179], v[224:227], v[32:35]
  ds_read_b128 v[164:167], v2 offset:37888
  v_mfma_f32_16x16x32_bf16 v[68:71], v[176:179], v[228:231], v[68:71]
  v_mfma_f32_16x16x32_bf16 v[36:39], v[180:183], v[224:227], v[36:39]
  ds_read_b128 v[168:171], v2 offset:38912
  s_add_u32 m0, s13, 18432
  v_mfma_f32_16x16x32_bf16 v[72:75], v[180:183], v[228:231], v[72:75]
  buffer_load_dwordx4 v212, s[28:31], s11 offen  lds
  s_waitcnt lgkmcnt(4)
  v_mfma_f32_16x16x32_bf16 v[40:43], v[184:187], v[224:227], v[40:43]
  ds_read_b128 v[172:175], v2 offset:39936
  v_mfma_f32_16x16x32_bf16 v[76:79], v[184:187], v[228:231], v[76:79]
  v_mfma_f32_16x16x32_bf16 v[44:47], v[188:191], v[224:227], v[44:47]
  ds_read_b128 v[176:179], v2 offset:40960
  s_add_u32 m0, s13, 19456
  v_mfma_f32_16x16x32_bf16 v[80:83], v[188:191], v[228:231], v[80:83]
  buffer_load_dwordx4 v213, s[28:31], s11 offen  lds
  v_mfma_f32_16x16x32_bf16 v[48:51], v[192:195], v[224:227], v[48:51]
  ds_read_b128 v[180:183], v2 offset:41984
  v_mfma_f32_16x16x32_bf16 v[84:87], v[192:195], v[228:231], v[84:87]
  s_waitcnt vmcnt(14) lgkmcnt(5)
  s_barrier
  s_waitcnt lgkmcnt(3)
  v_mfma_f32_16x16x32_bf16 v[16:19], v[160:163], v[196:199], v[16:19]
  ds_read_b128 v[184:187], v2 offset:43008
  s_add_u32 m0, s17, 16384
  s_add_u32 s10, s10, 4096
  v_mfma_f32_16x16x32_bf16 v[52:55], v[160:163], v[200:203], v[52:55]
  buffer_load_dwordx4 v2, s[56:59], s10 offen sc1 lds
  v_mfma_f32_16x16x32_bf16 v[20:23], v[164:167], v[196:199], v[20:23]
  ds_read_b128 v[188:191], v2 offset:44032
  v_mfma_f32_16x16x32_bf16 v[56:59], v[164:167], v[200:203], v[56:59]
  ds_read_b128 v[224:227], v5 offset:32768
  v_mfma_f32_16x16x32_bf16 v[24:27], v[168:171], v[196:199], v[24:27]
  ds_read_b128 v[192:195], v2 offset:45056
  v_mfma_f32_16x16x32_bf16 v[60:63], v[168:171], v[200:203], v[60:63]
  ds_read_b128 v[228:231], v5 offset:34816
  s_waitcnt lgkmcnt(5)
  v_mfma_f32_16x16x32_bf16 v[28:31], v[172:175], v[196:199], v[28:31]
  ds_read_b128 v[160:163], v2 offset:46080
  s_add_u32 m0, s17, 20480
  s_add_u32 s10, s10, 4096
  v_mfma_f32_16x16x32_bf16 v[64:67], v[172:175], v[200:203], v[64:67]
  buffer_load_dwordx4 v2, s[56:59], s10 offen sc1 lds
  v_mfma_f32_16x16x32_bf16 v[32:35], v[176:179], v[196:199], v[32:35]
  ds_read_b128 v[164:167], v2 offset:47104
  s_add_u32 m0, s17, 24576
  s_add_u32 s10, s10, 4096
  v_mfma_f32_16x16x32_bf16 v[68:71], v[176:179], v[200:203], v[68:71]
  buffer_load_dwordx4 v2, s[56:59], s10 offen sc1 lds
  v_mfma_f32_16x16x32_bf16 v[36:39], v[180:183], v[196:199], v[36:39]
  ds_read_b128 v[168:171], v2 offset:48128
  v_mfma_f32_16x16x32_bf16 v[72:75], v[180:183], v[200:203], v[72:75]
  s_waitcnt lgkmcnt(4)
  v_mfma_f32_16x16x32_bf16 v[40:43], v[184:187], v[196:199], v[40:43]
  ds_read_b128 v[172:175], v2 offset:49152
  s_add_u32 m0, s17, 28672
  s_add_u32 s10, s10, 4096
  v_mfma_f32_16x16x32_bf16 v[76:79], v[184:187], v[200:203], v[76:79]
  buffer_load_dwordx4 v2, s[56:59], s10 offen sc1 lds
  v_mfma_f32_16x16x32_bf16 v[44:47], v[188:191], v[196:199], v[44:47]
  ds_read_b128 v[176:179], v2 offset:50176
  s_add_u32 m0, s17, 32768
  s_add_u32 s10, s10, 4096
  v_mfma_f32_16x16x32_bf16 v[80:83], v[188:191], v[200:203], v[80:83]
  buffer_load_dwordx4 v2, s[56:59], s10 offen sc1 lds
  v_mfma_f32_16x16x32_bf16 v[48:51], v[192:195], v[196:199], v[48:51]
  ds_read_b128 v[180:183], v2 offset:51200
  v_mfma_f32_16x16x32_bf16 v[84:87], v[192:195], v[200:203], v[84:87]
  s_waitcnt lgkmcnt(3)
  v_mfma_f32_16x16x32_bf16 v[16:19], v[160:163], v[224:227], v[16:19]
  ds_read_b128 v[184:187], v2 offset:52224
  s_add_u32 m0, s13, 32768
  s_add_u32 s11, s11, 128
  v_mfma_f32_16x16x32_bf16 v[52:55], v[160:163], v[228:231], v[52:55]
  buffer_load_dwordx4 v210, s[28:31], s11 offen  lds
  v_mfma_f32_16x16x32_bf16 v[20:23], v[164:167], v[224:227], v[20:23]
  ds_read_b128 v[188:191], v2 offset:53248
  v_mfma_f32_16x16x32_bf16 v[56:59], v[164:167], v[228:231], v[56:59]
  ds_read_b128 v[196:199], v4 offset:49152
  v_mfma_f32_16x16x32_bf16 v[24:27], v[168:171], v[224:227], v[24:27]
  ds_read_b128 v[192:195], v2 offset:54272
  v_mfma_f32_16x16x32_bf16 v[60:63], v[168:171], v[228:231], v[60:63]
  ds_read_b128 v[200:203], v4 offset:51200
  s_waitcnt lgkmcnt(5)
  v_mfma_f32_16x16x32_bf16 v[28:31], v[172:175], v[224:227], v[28:31]
  ds_read_b128 v[160:163], v3 offset:0
  s_add_u32 m0, s13, 33792
  v_mfma_f32_16x16x32_bf16 v[64:67], v[172:175], v[228:231], v[64:67]
  buffer_load_dwordx4 v211, s[28:31], s11 offen  lds
  v_mfma_f32_16x16x32_bf16 v[32:35], v[176:179], v[224:227], v[32:35]
  ds_read_b128 v[164:167], v3 offset:1024
  v_mfma_f32_16x16x32_bf16 v[68:71], v[176:179], v[228:231], v[68:71]
  v_mfma_f32_16x16x32_bf16 v[36:39], v[180:183], v[224:227], v[36:39]
  ds_read_b128 v[168:171], v3 offset:2048
  s_add_u32 m0, s13, 34816
  v_mfma_f32_16x16x32_bf16 v[72:75], v[180:183], v[228:231], v[72:75]
  buffer_load_dwordx4 v212, s[28:31], s11 offen  lds
  s_waitcnt lgkmcnt(4)
  v_mfma_f32_16x16x32_bf16 v[40:43], v[184:187], v[224:227], v[40:43]
  ds_read_b128 v[172:175], v3 offset:3072
  v_mfma_f32_16x16x32_bf16 v[76:79], v[184:187], v[228:231], v[76:79]
  v_mfma_f32_16x16x32_bf16 v[44:47], v[188:191], v[224:227], v[44:47]
  ds_read_b128 v[176:179], v3 offset:4096
  s_add_u32 m0, s13, 35840
  v_mfma_f32_16x16x32_bf16 v[80:83], v[188:191], v[228:231], v[80:83]
  buffer_load_dwordx4 v213, s[28:31], s11 offen  lds
  v_mfma_f32_16x16x32_bf16 v[48:51], v[192:195], v[224:227], v[48:51]
  ds_read_b128 v[180:183], v3 offset:5120
  v_mfma_f32_16x16x32_bf16 v[84:87], v[192:195], v[228:231], v[84:87]
  s_waitcnt vmcnt(14) lgkmcnt(5)
  s_barrier
  s_waitcnt lgkmcnt(3)
  v_mfma_f32_16x16x32_bf16 v[16:19], v[160:163], v[196:199], v[16:19]
  ds_read_b128 v[184:187], v3 offset:6144
  s_add_u32 m0, s17, 36864
  s_add_u32 s10, s10, 4096
  v_mfma_f32_16x16x32_bf16 v[52:55], v[160:163], v[200:203], v[52:55]
  buffer_load_dwordx4 v2, s[56:59], s10 offen sc1 lds
  v_mfma_f32_16x16x32_bf16 v[20:23], v[164:167], v[196:199], v[20:23]
  ds_read_b128 v[188:191], v3 offset:7168
  v_mfma_f32_16x16x32_bf16 v[56:59], v[164:167], v[200:203], v[56:59]
  ds_read_b128 v[224:227], v5 offset:49152
  v_mfma_f32_16x16x32_bf16 v[24:27], v[168:171], v[196:199], v[24:27]
  ds_read_b128 v[192:195], v3 offset:8192
  v_mfma_f32_16x16x32_bf16 v[60:63], v[168:171], v[200:203], v[60:63]
  ds_read_b128 v[228:231], v5 offset:51200
  s_waitcnt lgkmcnt(5)
  v_mfma_f32_16x16x32_bf16 v[28:31], v[172:175], v[196:199], v[28:31]
  ds_read_b128 v[160:163], v3 offset:9216
  s_add_u32 m0, s17, 40960
  s_add_u32 s10, s10, 4096
  v_mfma_f32_16x16x32_bf16 v[64:67], v[172:175], v[200:203], v[64:67]
  buffer_load_dwordx4 v2, s[56:59], s10 offen sc1 lds
  v_mfma_f32_16x16x32_bf16 v[32:35], v[176:179], v[196:199], v[32:35]
  ds_read_b128 v[164:167], v3 offset:10240
  v_mfma_f32_16x16x32_bf16 v[68:71], v[176:179], v[200:203], v[68:71]
  v_mfma_f32_16x16x32_bf16 v[36:39], v[180:183], v[196:199], v[36:39]
  ds_read_b128 v[168:171], v3 offset:11264
  s_add_u32 m0, s17, 45056
  s_add_u32 s10, s10, 4096
  v_mfma_f32_16x16x32_bf16 v[72:75], v[180:183], v[200:203], v[72:75]
  buffer_load_dwordx4 v2, s[56:59], s10 offen sc1 lds
  s_waitcnt lgkmcnt(4)
  v_mfma_f32_16x16x32_bf16 v[40:43], v[184:187], v[196:199], v[40:43]
  ds_read_b128 v[172:175], v3 offset:12288
  v_mfma_f32_16x16x32_bf16 v[76:79], v[184:187], v[200:203], v[76:79]
  v_mfma_f32_16x16x32_bf16 v[44:47], v[188:191], v[196:199], v[44:47]
  ds_read_b128 v[176:179], v3 offset:13312
  s_add_u32 m0, s17, 49152
  s_add_u32 s10, s10, 4096
  v_mfma_f32_16x16x32_bf16 v[80:83], v[188:191], v[200:203], v[80:83]
  buffer_load_dwordx4 v2, s[56:59], s10 offen sc1 lds
  v_mfma_f32_16x16x32_bf16 v[48:51], v[192:195], v[196:199], v[48:51]
  ds_read_b128 v[180:183], v3 offset:14336
  v_mfma_f32_16x16x32_bf16 v[84:87], v[192:195], v[200:203], v[84:87]
  s_waitcnt lgkmcnt(3)
  v_mfma_f32_16x16x32_bf16 v[16:19], v[160:163], v[224:227], v[16:19]
  ds_read_b128 v[184:187], v3 offset:15360
  s_add_u32 m0, s13, 49152
  s_add_u32 s11, s11, 128
  v_mfma_f32_16x16x32_bf16 v[52:55], v[160:163], v[228:231], v[52:55]
  buffer_load_dwordx4 v210, s[28:31], s11 offen  lds
  v_mfma_f32_16x16x32_bf16 v[20:23], v[164:167], v[224:227], v[20:23]
  ds_read_b128 v[188:191], v3 offset:16384
  v_mfma_f32_16x16x32_bf16 v[56:59], v[164:167], v[228:231], v[56:59]
  ds_read_b128 v[196:199], v4 offset:0
  v_mfma_f32_16x16x32_bf16 v[24:27], v[168:171], v[224:227], v[24:27]
  ds_read_b128 v[192:195], v3 offset:17408
  v_mfma_f32_16x16x32_bf16 v[60:63], v[168:171], v[228:231], v[60:63]
  ds_read_b128 v[200:203], v4 offset:2048
  s_waitcnt lgkmcnt(5)
  v_mfma_f32_16x16x32_bf16 v[28:31], v[172:175], v[224:227], v[28:31]
  ds_read_b128 v[160:163], v2 offset:0
  s_add_u32 m0, s13, 50176
  v_mfma_f32_16x16x32_bf16 v[64:67], v[172:175], v[228:231], v[64:67]
  buffer_load_dwordx4 v211, s[28:31], s11 offen  lds
  v_mfma_f32_16x16x32_bf16 v[32:35], v[176:179], v[224:227], v[32:35]
  ds_read_b128 v[164:167], v2 offset:1024
  v_mfma_f32_16x16x32_bf16 v[68:71], v[176:179], v[228:231], v[68:71]
  v_mfma_f32_16x16x32_bf16 v[36:39], v[180:183], v[224:227], v[36:39]
  ds_read_b128 v[168:171], v2 offset:2048
  s_add_u32 m0, s13, 51200
  v_mfma_f32_16x16x32_bf16 v[72:75], v[180:183], v[228:231], v[72:75]
  buffer_load_dwordx4 v212, s[28:31], s11 offen  lds
  s_waitcnt lgkmcnt(4)
  v_mfma_f32_16x16x32_bf16 v[40:43], v[184:187], v[224:227], v[40:43]
  ds_read_b128 v[172:175], v2 offset:3072
  v_mfma_f32_16x16x32_bf16 v[76:79], v[184:187], v[228:231], v[76:79]
  v_mfma_f32_16x16x32_bf16 v[44:47], v[188:191], v[224:227], v[44:47]
  ds_read_b128 v[176:179], v2 offset:4096
  s_add_u32 m0, s13, 52224
  v_mfma_f32_16x16x32_bf16 v[80:83], v[188:191], v[228:231], v[80:83]
  buffer_load_dwordx4 v213, s[28:31], s11 offen  lds
  v_mfma_f32_16x16x32_bf16 v[48:51], v[192:195], v[224:227], v[48:51]
  ds_read_b128 v[180:183], v2 offset:5120
  v_mfma_f32_16x16x32_bf16 v[84:87], v[192:195], v[228:231], v[84:87]
  s_sub_u32 s23, s23, 1
  s_cmp_lg_u32 s23, 0
  s_cbranch_scc1 kt_tail_kernel_floop
  s_waitcnt vmcnt(14) lgkmcnt(5)
  s_barrier
  s_add_u32 s48, s20, 26439680
  s_addc_u32 s49, s21, 0
  s_and_b32 s49, s49, 0xffff
  s_mov_b32 s50, 9437184
  s_mov_b32 s51, 0x20000
  s_mul_i32 s15, s78, 144
  s_add_u32 s22, s15, s77
  s_lshl_b32 s22, s22, 10
  s_add_u32 s14, s15, s79
  s_add_u32 s14, s14, 64
  s_lshl_b32 s14, s14, 10
  s_and_b32 s15, s77, 1
  s_lshl_b32 s15, s15, 3
  v_add_u32 v14, s15, v2
  s_add_u32 s23, s22, 73728
  s_add_u32 s15, s14, 73728
  s_waitcnt lgkmcnt(3)
  v_mfma_f32_16x16x32_bf16 v[16:19], v[160:163], v[196:199], v[16:19]
  ds_read_b128 v[184:187], v2 offset:6144
  ds_read_b128 v[224:227], v5 offset:0
  s_add_u32 m0, s17, 53248
  s_add_u32 s10, s10, 4096
  v_mfma_f32_16x16x32_bf16 v[20:23], v[164:167], v[196:199], v[20:23]
  buffer_load_dwordx4 v2, s[56:59], s10 offen sc1 lds
  ds_read_b128 v[188:191], v2 offset:7168
  v_mfma_f32_16x16x32_bf16 v[24:27], v[168:171], v[196:199], v[24:27]
  ds_read_b128 v[192:195], v2 offset:8192
  s_waitcnt lgkmcnt(4)
  v_mfma_f32_16x16x32_bf16 v[28:31], v[172:175], v[196:199], v[28:31]
  ds_read_b128 v[160:163], v2 offset:9216
  s_add_u32 m0, s17, 57344
  s_add_u32 s10, s10, 4096
  v_mfma_f32_16x16x32_bf16 v[32:35], v[176:179], v[196:199], v[32:35]
  buffer_load_dwordx4 v2, s[56:59], s10 offen sc1 lds
  ds_read_b128 v[164:167], v2 offset:10240
  v_mfma_f32_16x16x32_bf16 v[36:39], v[180:183], v[196:199], v[36:39]
  ds_read_b128 v[168:171], v2 offset:11264
  s_waitcnt lgkmcnt(3)
  v_mfma_f32_16x16x32_bf16 v[40:43], v[184:187], v[196:199], v[40:43]
  ds_read_b128 v[172:175], v2 offset:12288
  s_add_u32 m0, s17, 61440
  s_add_u32 s10, s10, 4096
  v_mfma_f32_16x16x32_bf16 v[44:47], v[188:191], v[196:199], v[44:47]
  buffer_load_dwordx4 v2, s[56:59], s10 offen sc1 lds
  ds_read_b128 v[176:179], v2 offset:13312
  v_mfma_f32_16x16x32_bf16 v[48:51], v[192:195], v[196:199], v[48:51]
  ds_read_b128 v[180:183], v2 offset:14336
  s_waitcnt lgkmcnt(3)
  v_mfma_f32_16x16x32_bf16 v[16:19], v[160:163], v[224:227], v[16:19]
  ds_read_b128 v[184:187], v2 offset:15360
  ds_read_b128 v[196:199], v4 offset:16384
  s_add_u32 m0, s17, 65536
  s_add_u32 s10, s10, 4096
  v_mfma_f32_16x16x32_bf16 v[20:23], v[164:167], v[224:227], v[20:23]
  buffer_load_dwordx4 v2, s[56:59], s10 offen sc1 lds
  ds_read_b128 v[188:191], v2 offset:16384
  v_mfma_f32_16x16x32_bf16 v[24:27], v[168:171], v[224:227], v[24:27]
  ds_read_b128 v[192:195], v2 offset:17408
  s_waitcnt lgkmcnt(4)
  v_mfma_f32_16x16x32_bf16 v[28:31], v[172:175], v[224:227], v[28:31]
  ds_read_b128 v[160:163], v2 offset:18432
  s_add_u32 m0, s17, 69632
  s_add_u32 s10, s10, 4096
  v_mfma_f32_16x16x32_bf16 v[32:35], v[176:179], v[224:227], v[32:35]
  buffer_load_dwordx4 v2, s[56:59], s10 offen sc1 lds
  ds_read_b128 v[164:167], v2 offset:19456
  v_mfma_f32_16x16x32_bf16 v[36:39], v[180:183], v[224:227], v[36:39]
  ds_read_b128 v[168:171], v2 offset:20480
  s_waitcnt lgkmcnt(3)
  v_mfma_f32_16x16x32_bf16 v[40:43], v[184:187], v[224:227], v[40:43]
  ds_read_b128 v[172:175], v2 offset:21504
  v_mfma_f32_16x16x32_bf16 v[44:47], v[188:191], v[224:227], v[44:47]
  ds_read_b128 v[176:179], v2 offset:22528
  buffer_load_dwordx4 a[24:27], v2, s[36:39], s7 offen
  s_add_u32 s7, s7, 4096
  v_mfma_f32_16x16x32_bf16 v[48:51], v[192:195], v[224:227], v[48:51]
  ds_read_b128 v[180:183], v2 offset:23552
  s_waitcnt lgkmcnt(3)
  v_mfma_f32_16x16x32_bf16 v[16:19], v[160:163], v[196:199], v[16:19]
  ds_read_b128 v[184:187], v2 offset:24576
  ds_read_b128 v[224:227], v5 offset:16384
  v_mfma_f32_16x16x32_bf16 v[20:23], v[164:167], v[196:199], v[20:23]
  ds_read_b128 v[188:191], v2 offset:25600
  buffer_load_dwordx4 a[28:31], v2, s[36:39], s7 offen
  s_add_u32 s7, s7, 4096
  v_mfma_f32_16x16x32_bf16 v[24:27], v[168:171], v[196:199], v[24:27]
  ds_read_b128 v[192:195], v2 offset:26624
  s_waitcnt lgkmcnt(4)
  v_mfma_f32_16x16x32_bf16 v[28:31], v[172:175], v[196:199], v[28:31]
  s_waitcnt vmcnt(6)
  s_barrier
  ds_read_b128 v[160:163], v2 offset:27648
  v_mfma_f32_16x16x32_bf16 v[32:35], v[176:179], v[196:199], v[32:35]
  ds_read_b128 v[164:167], v2 offset:28672
  buffer_load_dwordx4 a[32:35], v2, s[36:39], s7 offen
  s_add_u32 s7, s7, 4096
  v_mfma_f32_16x16x32_bf16 v[36:39], v[180:183], v[196:199], v[36:39]
  ds_read_b128 v[168:171], v2 offset:29696
  s_waitcnt lgkmcnt(3)
  v_mfma_f32_16x16x32_bf16 v[40:43], v[184:187], v[196:199], v[40:43]
  ds_read_b128 v[172:175], v2 offset:30720
  v_mfma_f32_16x16x32_bf16 v[44:47], v[188:191], v[196:199], v[44:47]
  ds_read_b128 v[176:179], v2 offset:31744
  buffer_load_dwordx4 a[36:39], v2, s[36:39], s7 offen
  s_add_u32 s7, s7, 4096
  v_mfma_f32_16x16x32_bf16 v[48:51], v[192:195], v[196:199], v[48:51]
  ds_read_b128 v[180:183], v2 offset:32768
  s_waitcnt lgkmcnt(3)
  v_mfma_f32_16x16x32_bf16 v[16:19], v[160:163], v[224:227], v[16:19]
  ds_read_b128 v[184:187], v2 offset:33792
  ds_read_b128 v[196:199], v4 offset:32768
  v_mfma_f32_16x16x32_bf16 v[20:23], v[164:167], v[224:227], v[20:23]
  ds_read_b128 v[188:191], v2 offset:34816
  buffer_load_dwordx4 a[40:43], v2, s[36:39], s7 offen
  s_add_u32 s7, s7, 4096
  v_mfma_f32_16x16x32_bf16 v[24:27], v[168:171], v[224:227], v[24:27]
  ds_read_b128 v[192:195], v2 offset:35840
  s_waitcnt lgkmcnt(4)
  v_mfma_f32_16x16x32_bf16 v[28:31], v[172:175], v[224:227], v[28:31]
  ds_read_b128 v[160:163], v2 offset:36864
  v_mfma_f32_16x16x32_bf16 v[32:35], v[176:179], v[224:227], v[32:35]
  ds_read_b128 v[164:167], v2 offset:37888
  buffer_load_dwordx4 a[44:47], v2, s[36:39], s7 offen
  s_add_u32 s7, s7, 4096
  v_mfma_f32_16x16x32_bf16 v[36:39], v[180:183], v[224:227], v[36:39]
  ds_read_b128 v[168:171], v2 offset:38912
  s_waitcnt lgkmcnt(3)
  v_mfma_f32_16x16x32_bf16 v[40:43], v[184:187], v[224:227], v[40:43]
  ds_read_b128 v[172:175], v2 offset:39936
  v_mfma_f32_16x16x32_bf16 v[44:47], v[188:191], v[224:227], v[44:47]
  ds_read_b128 v[176:179], v2 offset:40960
  buffer_load_dwordx4 a[48:51], v2, s[36:39], s7 offen
  s_add_u32 s7, s7, 4096
  v_mfma_f32_16x16x32_bf16 v[48:51], v[192:195], v[224:227], v[48:51]
  ds_read_b128 v[180:183], v2 offset:41984
  s_waitcnt lgkmcnt(3)
  v_mfma_f32_16x16x32_bf16 v[16:19], v[160:163], v[196:199], v[16:19]
  ds_read_b128 v[184:187], v2 offset:43008
  ds_read_b128 v[224:227], v5 offset:32768
  v_mfma_f32_16x16x32_bf16 v[20:23], v[164:167], v[196:199], v[20:23]
  ds_read_b128 v[188:191], v2 offset:44032
  buffer_load_dwordx4 a[52:55], v2, s[36:39], s7 offen
  s_add_u32 s7, s7, 4096
  v_mfma_f32_16x16x32_bf16 v[24:27], v[168:171], v[196:199], v[24:27]
  ds_read_b128 v[192:195], v2 offset:45056
  s_waitcnt lgkmcnt(4)
  v_mfma_f32_16x16x32_bf16 v[28:31], v[172:175], v[196:199], v[28:31]
  ds_read_b128 v[160:163], v2 offset:46080
  v_mfma_f32_16x16x32_bf16 v[32:35], v[176:179], v[196:199], v[32:35]
  ds_read_b128 v[164:167], v2 offset:47104
  buffer_load_dwordx4 a[56:59], v2, s[36:39], s7 offen
  s_add_u32 s7, s7, 4096
  v_mfma_f32_16x16x32_bf16 v[36:39], v[180:183], v[196:199], v[36:39]
  ds_read_b128 v[168:171], v2 offset:48128
  s_waitcnt lgkmcnt(3)
  v_mfma_f32_16x16x32_bf16 v[40:43], v[184:187], v[196:199], v[40:43]
  ds_read_b128 v[172:175], v2 offset:49152
  v_mfma_f32_16x16x32_bf16 v[44:47], v[188:191], v[196:199], v[44:47]
  ds_read_b128 v[176:179], v2 offset:50176
  buffer_load_dwordx4 a[60:63], v2, s[36:39], s7 offen
  s_add_u32 s7, s7, 4096
  v_mfma_f32_16x16x32_bf16 v[48:51], v[192:195], v[196:199], v[48:51]
  ds_read_b128 v[180:183], v2 offset:51200
  s_waitcnt lgkmcnt(3)
  v_mfma_f32_16x16x32_bf16 v[16:19], v[160:163], v[224:227], v[16:19]
  s_waitcnt vmcnt(10)
  s_barrier
  ds_read_b128 v[184:187], v2 offset:52224
  ds_read_b128 v[196:199], v4 offset:49152
  v_mfma_f32_16x16x32_bf16 v[20:23], v[164:167], v[224:227], v[20:23]
  ds_read_b128 v[188:191], v2 offset:53248
  buffer_load_dwordx4 a[64:67], v2, s[36:39], s7 offen
  s_add_u32 s7, s7, 4096
  v_mfma_f32_16x16x32_bf16 v[24:27], v[168:171], v[224:227], v[24:27]
  ds_read_b128 v[192:195], v2 offset:54272
  s_waitcnt lgkmcnt(4)
  v_mfma_f32_16x16x32_bf16 v[28:31], v[172:175], v[224:227], v[28:31]
  ds_read_b128 v[160:163], v3 offset:0
  v_mfma_f32_16x16x32_bf16 v[32:35], v[176:179], v[224:227], v[32:35]
  ds_read_b128 v[164:167], v3 offset:1024
  buffer_load_dwordx4 a[68:71], v2, s[36:39], s7 offen
  s_add_u32 s7, s7, 4096
  v_mfma_f32_16x16x32_bf16 v[36:39], v[180:183], v[224:227], v[36:39]
  ds_read_b128 v[168:171], v3 offset:2048
  s_waitcnt lgkmcnt(3)
  v_mfma_f32_16x16x32_bf16 v[40:43], v[184:187], v[224:227], v[40:43]
  ds_read_b128 v[172:175], v3 offset:3072
  v_mfma_f32_16x16x32_bf16 v[44:47], v[188:191], v[224:227], v[44:47]
  ds_read_b128 v[176:179], v3 offset:4096
  buffer_load_dwordx4 a[72:75], v2, s[36:39], s7 offen
  s_add_u32 s7, s7, 4096
  v_mfma_f32_16x16x32_bf16 v[48:51], v[192:195], v[224:227], v[48:51]
  ds_read_b128 v[180:183], v3 offset:5120
  s_waitcnt lgkmcnt(3)
  v_mfma_f32_16x16x32_bf16 v[16:19], v[160:163], v[196:199], v[16:19]
  ds_read_b128 v[184:187], v3 offset:6144
  ds_read_b128 v[224:227], v5 offset:49152
  v_mfma_f32_16x16x32_bf16 v[20:23], v[164:167], v[196:199], v[20:23]
  ds_read_b128 v[188:191], v3 offset:7168
  buffer_load_dwordx4 a[76:79], v2, s[36:39], s7 offen
  s_add_u32 s7, s7, 4096
  v_mfma_f32_16x16x32_bf16 v[24:27], v[168:171], v[196:199], v[24:27]
  ds_read_b128 v[192:195], v3 offset:8192
  s_waitcnt lgkmcnt(4)
  v_mfma_f32_16x16x32_bf16 v[28:31], v[172:175], v[196:199], v[28:31]
  ds_read_b128 v[160:163], v3 offset:9216
  v_mfma_f32_16x16x32_bf16 v[32:35], v[176:179], v[196:199], v[32:35]
  ds_read_b128 v[164:167], v3 offset:10240
  buffer_load_dwordx4 a[80:83], v2, s[36:39], s7 offen
  s_add_u32 s7, s7, 4096
  v_mfma_f32_16x16x32_bf16 v[36:39], v[180:183], v[196:199], v[36:39]
  ds_read_b128 v[168:171], v3 offset:11264
  s_waitcnt lgkmcnt(3)
  v_mfma_f32_16x16x32_bf16 v[40:43], v[184:187], v[196:199], v[40:43]
  ds_read_b128 v[172:175], v3 offset:12288
  v_mfma_f32_16x16x32_bf16 v[44:47], v[188:191], v[196:199], v[44:47]
  ds_read_b128 v[176:179], v3 offset:13312
  buffer_load_dwordx4 a[84:87], v2, s[36:39], s7 offen
  s_add_u32 s7, s7, 4096
  v_mfma_f32_16x16x32_bf16 v[48:51], v[192:195], v[196:199], v[48:51]
  ds_read_b128 v[180:183], v3 offset:14336
  s_waitcnt lgkmcnt(3)
  v_mfma_f32_16x16x32_bf16 v[16:19], v[160:163], v[224:227], v[16:19]
  ds_read_b128 v[184:187], v3 offset:15360
  ds_read_b128 v[200:203], v4 offset:2048
  v_mfma_f32_16x16x32_bf16 v[20:23], v[164:167], v[224:227], v[20:23]
  ds_read_b128 v[188:191], v3 offset:16384
  buffer_load_dwordx4 a[88:91], v2, s[36:39], s7 offen
  s_add_u32 s7, s7, 4096
  v_mfma_f32_16x16x32_bf16 v[24:27], v[168:171], v[224:227], v[24:27]
  ds_read_b128 v[192:195], v3 offset:17408
  s_waitcnt lgkmcnt(4)
  v_mfma_f32_16x16x32_bf16 v[28:31], v[172:175], v[224:227], v[28:31]
  ds_read_b128 v[160:163], v2 offset:0
  v_mfma_f32_16x16x32_bf16 v[32:35], v[176:179], v[224:227], v[32:35]
  ds_read_b128 v[164:167], v2 offset:1024
  buffer_load_dwordx4 a[92:95], v2, s[36:39], s7 offen
  s_add_u32 s7, s7, 4096
  v_mfma_f32_16x16x32_bf16 v[36:39], v[180:183], v[224:227], v[36:39]
  ds_read_b128 v[168:171], v2 offset:2048
  s_waitcnt lgkmcnt(3)
  v_mfma_f32_16x16x32_bf16 v[40:43], v[184:187], v[224:227], v[40:43]
  ds_read_b128 v[172:175], v2 offset:3072
  v_mfma_f32_16x16x32_bf16 v[44:47], v[188:191], v[224:227], v[44:47]
  ds_read_b128 v[176:179], v2 offset:4096
  buffer_load_dwordx4 a[96:99], v2, s[36:39], s7 offen
  s_add_u32 s7, s7, 4096
  v_mfma_f32_16x16x32_bf16 v[48:51], v[192:195], v[224:227], v[48:51]
  ds_read_b128 v[180:183], v2 offset:5120
  s_waitcnt lgkmcnt(3)
  v_mfma_f32_16x16x32_bf16 v[52:55], v[160:163], v[200:203], v[52:55]
  ds_read_b128 v[184:187], v2 offset:6144
  ds_read_b128 v[228:231], v5 offset:2048
  v_mfma_f32_16x16x32_bf16 v[56:59], v[164:167], v[200:203], v[56:59]
  ds_read_b128 v[188:191], v2 offset:7168
  v_mfma_f32_16x16x32_bf16 v[60:63], v[168:171], v[200:203], v[60:63]
  ds_read_b128 v[192:195], v2 offset:8192
  s_waitcnt lgkmcnt(4)
  v_mfma_f32_16x16x32_bf16 v[64:67], v[172:175], v[200:203], v[64:67]
  ds_read_b128 v[160:163], v2 offset:9216
  v_mfma_f32_16x16x32_bf16 v[68:71], v[176:179], v[200:203], v[68:71]
  ds_read_b128 v[164:167], v2 offset:10240
  v_mul_f32 v16, v16, v88
  v_mfma_f32_16x16x32_bf16 v[72:75], v[180:183], v[200:203], v[72:75]
  ds_read_b128 v[168:171], v2 offset:11264
  v_mul_f32 v17, v17, v89
  s_waitcnt lgkmcnt(3)
  v_mfma_f32_16x16x32_bf16 v[76:79], v[184:187], v[200:203], v[76:79]
  ds_read_b128 v[172:175], v2 offset:12288
  v_mul_f32 v18, v18, v90
  v_mul_f32 v19, v19, v91
  v_mfma_f32_16x16x32_bf16 v[80:83], v[188:191], v[200:203], v[80:83]
  ds_read_b128 v[176:179], v2 offset:13312
  v_cvt_pk_bf16_f32 v88, v16, v17
  v_mfma_f32_16x16x32_bf16 v[84:87], v[192:195], v[200:203], v[84:87]
  ds_read_b128 v[180:183], v2 offset:14336
  v_cvt_pk_bf16_f32 v89, v18, v19
  s_waitcnt lgkmcnt(3)
  v_mfma_f32_16x16x32_bf16 v[52:55], v[160:163], v[228:231], v[52:55]
  ds_read_b128 v[184:187], v2 offset:15360
  ds_read_b128 v[200:203], v4 offset:18432
  v_min_u32 v88, -2, v88
  v_min_u32 v89, -2, v89
  v_mfma_f32_16x16x32_bf16 v[56:59], v[164:167], v[228:231], v[56:59]
  ds_read_b128 v[188:191], v2 offset:16384
  v_mul_f32 v20, v20, v92
  v_mfma_f32_16x16x32_bf16 v[60:63], v[168:171], v[228:231], v[60:63]
  ds_read_b128 v[192:195], v2 offset:17408
  v_mul_f32 v21, v21, v93
  s_waitcnt lgkmcnt(4)
  v_mfma_f32_16x16x32_bf16 v[64:67], v[172:175], v[228:231], v[64:67]
  ds_read_b128 v[160:163], v2 offset:18432
  v_mul_f32 v22, v22, v94
  v_mul_f32 v23, v23, v95
  v_mfma_f32_16x16x32_bf16 v[68:71], v[176:179], v[228:231], v[68:71]
  ds_read_b128 v[164:167], v2 offset:19456
  v_cvt_pk_bf16_f32 v90, v20, v21
  v_mfma_f32_16x16x32_bf16 v[72:75], v[180:183], v[228:231], v[72:75]
  ds_read_b128 v[168:171], v2 offset:20480
  v_cvt_pk_bf16_f32 v91, v22, v23
  s_waitcnt lgkmcnt(3)
  v_mfma_f32_16x16x32_bf16 v[76:79], v[184:187], v[228:231], v[76:79]
  ds_read_b128 v[172:175], v2 offset:21504
  v_min_u32 v90, -2, v90
  v_min_u32 v91, -2, v91
  v_mfma_f32_16x16x32_bf16 v[80:83], v[188:191], v[228:231], v[80:83]
  ds_read_b128 v[176:179], v2 offset:22528
  buffer_store_dwordx4 v[88:91], v2, s[48:51], s22 offen sc1
  v_mfma_f32_16x16x32_bf16 v[84:87], v[192:195], v[228:231], v[84:87]
  ds_read_b128 v[180:183], v2 offset:23552
  s_add_u32 s22, s22, 16384
  s_waitcnt lgkmcnt(3)
  v_mfma_f32_16x16x32_bf16 v[52:55], v[160:163], v[200:203], v[52:55]
  ds_read_b128 v[184:187], v2 offset:24576
  ds_read_b128 v[228:231], v5 offset:18432
  v_mul_f32 v24, v24, v96
  v_mul_f32 v25, v25, v97
  v_mfma_f32_16x16x32_bf16 v[56:59], v[164:167], v[200:203], v[56:59]
  ds_read_b128 v[188:191], v2 offset:25600
  v_mul_f32 v26, v26, v98
  v_mfma_f32_16x16x32_bf16 v[60:63], v[168:171], v[200:203], v[60:63]
  ds_read_b128 v[192:195], v2 offset:26624
  v_mul_f32 v27, v27, v99
  s_waitcnt lgkmcnt(4)
  v_mfma_f32_16x16x32_bf16 v[64:67], v[172:175], v[200:203], v[64:67]
  ds_read_b128 v[160:163], v2 offset:27648
  v_cvt_pk_bf16_f32 v96, v24, v25
  v_cvt_pk_bf16_f32 v97, v26, v27
  v_mfma_f32_16x16x32_bf16 v[68:71], v[176:179], v[200:203], v[68:71]
  ds_read_b128 v[164:167], v2 offset:28672
  v_min_u32 v96, -2, v96
  v_mfma_f32_16x16x32_bf16 v[72:75], v[180:183], v[200:203], v[72:75]
  ds_read_b128 v[168:171], v2 offset:29696
  v_min_u32 v97, -2, v97
  v_mul_f32 v28, v28, v100
  s_waitcnt lgkmcnt(3)
  v_mfma_f32_16x16x32_bf16 v[76:79], v[184:187], v[200:203], v[76:79]
  ds_read_b128 v[172:175], v2 offset:30720
  v_mul_f32 v29, v29, v101
  v_mfma_f32_16x16x32_bf16 v[80:83], v[188:191], v[200:203], v[80:83]
  ds_read_b128 v[176:179], v2 offset:31744
  v_mul_f32 v30, v30, v102
  v_mfma_f32_16x16x32_bf16 v[84:87], v[192:195], v[200:203], v[84:87]
  ds_read_b128 v[180:183], v2 offset:32768
  v_mul_f32 v31, v31, v103
  v_cvt_pk_bf16_f32 v98, v28, v29
  s_waitcnt lgkmcnt(3)
  v_mfma_f32_16x16x32_bf16 v[52:55], v[160:163], v[228:231], v[52:55]
  ds_read_b128 v[184:187], v2 offset:33792
  ds_read_b128 v[200:203], v4 offset:34816
  v_cvt_pk_bf16_f32 v99, v30, v31
  v_mfma_f32_16x16x32_bf16 v[56:59], v[164:167], v[228:231], v[56:59]
  ds_read_b128 v[188:191], v2 offset:34816
  v_min_u32 v98, -2, v98
  v_mfma_f32_16x16x32_bf16 v[60:63], v[168:171], v[228:231], v[60:63]
  ds_read_b128 v[192:195], v2 offset:35840
  v_min_u32 v99, -2, v99
  buffer_store_dwordx4 v[96:99], v2, s[48:51], s22 offen sc1
  s_waitcnt lgkmcnt(4)
  v_mfma_f32_16x16x32_bf16 v[64:67], v[172:175], v[228:231], v[64:67]
  ds_read_b128 v[160:163], v2 offset:36864
  s_add_u32 s22, s22, 16384
  v_mfma_f32_16x16x32_bf16 v[68:71], v[176:179], v[228:231], v[68:71]
  ds_read_b128 v[164:167], v2 offset:37888
  v_mul_f32 v32, v32, v104
  v_mfma_f32_16x16x32_bf16 v[72:75], v[180:183], v[228:231], v[72:75]
  ds_read_b128 v[168:171], v2 offset:38912
  v_mul_f32 v33, v33, v105
  v_mul_f32 v34, v34, v106
  s_waitcnt lgkmcnt(3)
  v_mfma_f32_16x16x32_bf16 v[76:79], v[184:187], v[228:231], v[76:79]
  ds_read_b128 v[172:175], v2 offset:39936
  v_mul_f32 v35, v35, v107
  v_mfma_f32_16x16x32_bf16 v[80:83], v[188:191], v[228:231], v[80:83]
  ds_read_b128 v[176:179], v2 offset:40960
  v_cvt_pk_bf16_f32 v104, v32, v33
  v_mfma_f32_16x16x32_bf16 v[84:87], v[192:195], v[228:231], v[84:87]
  ds_read_b128 v[180:183], v2 offset:41984
  v_cvt_pk_bf16_f32 v105, v34, v35
  v_min_u32 v104, -2, v104
  s_waitcnt lgkmcnt(3)
  v_mfma_f32_16x16x32_bf16 v[52:55], v[160:163], v[200:203], v[52:55]
  ds_read_b128 v[184:187], v2 offset:43008
  ds_read_b128 v[228:231], v5 offset:34816
  v_min_u32 v105, -2, v105
  v_mfma_f32_16x16x32_bf16 v[56:59], v[164:167], v[200:203], v[56:59]
  ds_read_b128 v[188:191], v2 offset:44032
  v_mul_f32 v36, v36, v108
  v_mfma_f32_16x16x32_bf16 v[60:63], v[168:171], v[200:203], v[60:63]
  ds_read_b128 v[192:195], v2 offset:45056
  v_mul_f32 v37, v37, v109
  v_mul_f32 v38, v38, v110
  s_waitcnt lgkmcnt(4)
  v_mfma_f32_16x16x32_bf16 v[64:67], v[172:175], v[200:203], v[64:67]
  ds_read_b128 v[160:163], v2 offset:46080
  v_mul_f32 v39, v39, v111
  v_mfma_f32_16x16x32_bf16 v[68:71], v[176:179], v[200:203], v[68:71]
  ds_read_b128 v[164:167], v2 offset:47104
  v_cvt_pk_bf16_f32 v106, v36, v37
  v_mfma_f32_16x16x32_bf16 v[72:75], v[180:183], v[200:203], v[72:75]
  ds_read_b128 v[168:171], v2 offset:48128
  v_cvt_pk_bf16_f32 v107, v38, v39
  v_min_u32 v106, -2, v106
  s_waitcnt lgkmcnt(3)
  v_mfma_f32_16x16x32_bf16 v[76:79], v[184:187], v[200:203], v[76:79]
  ds_read_b128 v[172:175], v2 offset:49152
  v_min_u32 v107, -2, v107
  v_mfma_f32_16x16x32_bf16 v[80:83], v[188:191], v[200:203], v[80:83]
  ds_read_b128 v[176:179], v2 offset:50176
  buffer_store_dwordx4 v[104:107], v2, s[48:51], s22 offen sc1
  s_add_u32 s22, s22, 16384
  v_mfma_f32_16x16x32_bf16 v[84:87], v[192:195], v[200:203], v[84:87]
  ds_read_b128 v[180:183], v2 offset:51200
  v_mul_f32 v40, v40, v112
  s_waitcnt lgkmcnt(3)
  v_mfma_f32_16x16x32_bf16 v[52:55], v[160:163], v[228:231], v[52:55]
  ds_read_b128 v[184:187], v2 offset:52224
  ds_read_b128 v[200:203], v4 offset:51200
  v_mul_f32 v41, v41, v113
  v_mfma_f32_16x16x32_bf16 v[56:59], v[164:167], v[228:231], v[56:59]
  ds_read_b128 v[188:191], v2 offset:53248
  v_mul_f32 v42, v42, v114
  v_mul_f32 v43, v43, v115
  v_mfma_f32_16x16x32_bf16 v[60:63], v[168:171], v[228:231], v[60:63]
  ds_read_b128 v[192:195], v2 offset:54272
  v_cvt_pk_bf16_f32 v112, v40, v41
  s_waitcnt lgkmcnt(4)
  v_mfma_f32_16x16x32_bf16 v[64:67], v[172:175], v[228:231], v[64:67]
  ds_read_b128 v[160:163], v3 offset:0
  v_cvt_pk_bf16_f32 v113, v42, v43
  v_mfma_f32_16x16x32_bf16 v[68:71], v[176:179], v[228:231], v[68:71]
  ds_read_b128 v[164:167], v3 offset:1024
  v_min_u32 v112, -2, v112
  v_min_u32 v113, -2, v113
  v_mfma_f32_16x16x32_bf16 v[72:75], v[180:183], v[228:231], v[72:75]
  ds_read_b128 v[168:171], v3 offset:2048
  v_mul_f32 v44, v44, v116
  s_waitcnt lgkmcnt(3)
  v_mfma_f32_16x16x32_bf16 v[76:79], v[184:187], v[228:231], v[76:79]
  ds_read_b128 v[172:175], v3 offset:3072
  v_mul_f32 v45, v45, v117
  v_mfma_f32_16x16x32_bf16 v[80:83], v[188:191], v[228:231], v[80:83]
  ds_read_b128 v[176:179], v3 offset:4096
  v_mul_f32 v46, v46, v118
  v_mul_f32 v47, v47, v119
  v_mfma_f32_16x16x32_bf16 v[84:87], v[192:195], v[228:231], v[84:87]
  ds_read_b128 v[180:183], v3 offset:5120
  v_cvt_pk_bf16_f32 v114, v44, v45
  s_waitcnt lgkmcnt(3)
  v_mfma_f32_16x16x32_bf16 v[52:55], v[160:163], v[200:203], v[52:55]
  ds_read_b128 v[184:187], v3 offset:6144
  ds_read_b128 v[228:231], v5 offset:51200
  v_cvt_pk_bf16_f32 v115, v46, v47
  v_mfma_f32_16x16x32_bf16 v[56:59], v[164:167], v[200:203], v[56:59]
  ds_read_b128 v[188:191], v3 offset:7168
  v_min_u32 v114, -2, v114
  v_min_u32 v115, -2, v115
  v_mfma_f32_16x16x32_bf16 v[60:63], v[168:171], v[200:203], v[60:63]
  ds_read_b128 v[192:195], v3 offset:8192
  buffer_store_dwordx4 v[112:115], v2, s[48:51], s22 offen sc1
  s_waitcnt lgkmcnt(4)
  v_mfma_f32_16x16x32_bf16 v[64:67], v[172:175], v[200:203], v[64:67]
  ds_read_b128 v[160:163], v3 offset:9216
  s_add_u32 s22, s22, 16384
  v_mfma_f32_16x16x32_bf16 v[68:71], v[176:179], v[200:203], v[68:71]
  ds_read_b128 v[164:167], v3 offset:10240
  v_mul_f32 v48, v48, v120
  v_mul_f32 v49, v49, v121
  v_mfma_f32_16x16x32_bf16 v[72:75], v[180:183], v[200:203], v[72:75]
  ds_read_b128 v[168:171], v3 offset:11264
  v_mul_f32 v50, v50, v122
  s_waitcnt lgkmcnt(3)
  v_mfma_f32_16x16x32_bf16 v[76:79], v[184:187], v[200:203], v[76:79]
  ds_read_b128 v[172:175], v3 offset:12288
  v_mul_f32 v51, v51, v123
  v_mfma_f32_16x16x32_bf16 v[80:83], v[188:191], v[200:203], v[80:83]
  ds_read_b128 v[176:179], v3 offset:13312
  v_cvt_pk_bf16_f32 v120, v48, v49
  v_cvt_pk_bf16_f32 v121, v50, v51
  v_mfma_f32_16x16x32_bf16 v[84:87], v[192:195], v[200:203], v[84:87]
  ds_read_b128 v[180:183], v3 offset:14336
  v_min_u32 v120, -2, v120
  s_waitcnt lgkmcnt(3)
  v_mfma_f32_16x16x32_bf16 v[52:55], v[160:163], v[228:231], v[52:55]
  ds_read_b128 v[184:187], v3 offset:15360
  v_min_u32 v121, -2, v121
  buffer_store_dwordx2 v[120:121], v14, s[48:51], s14 offen sc1
  v_mfma_f32_16x16x32_bf16 v[56:59], v[164:167], v[228:231], v[56:59]
  ds_read_b128 v[188:191], v3 offset:16384
  v_mfma_f32_16x16x32_bf16 v[60:63], v[168:171], v[228:231], v[60:63]
  ds_read_b128 v[192:195], v3 offset:17408
  s_waitcnt lgkmcnt(3)
  v_mfma_f32_16x16x32_bf16 v[64:67], v[172:175], v[228:231], v[64:67]
  v_mfma_f32_16x16x32_bf16 v[68:71], v[176:179], v[228:231], v[68:71]
  v_mfma_f32_16x16x32_bf16 v[72:75], v[180:183], v[228:231], v[72:75]
  s_waitcnt lgkmcnt(0)
  v_mfma_f32_16x16x32_bf16 v[76:79], v[184:187], v[228:231], v[76:79]
  v_mfma_f32_16x16x32_bf16 v[80:83], v[188:191], v[228:231], v[80:83]
  v_mfma_f32_16x16x32_bf16 v[84:87], v[192:195], v[228:231], v[84:87]
  s_add_u32 s32, s20, 14086144
  s_addc_u32 s33, s21, 0
  s_and_b32 s33, s33, 0xffff
  s_mov_b32 s34, 2654208
  s_mov_b32 s35, 0x20000
  s_mul_i32 s11, s5, 331776
  s_add_u32 s11, s11, s17
  s_add_u32 s11, s11, 143360
  v_add_u32 v3, s17, v2
  v_add_u32 v4, 65536, v3
  v_add_u32 v5, 131072, v3
  s_barrier
  v_pk_mul_f32 v[52:53], v[52:53], v[124:125]
  v_pk_mul_f32 v[54:55], v[54:55], v[126:127]
  v_cvt_pk_bf16_f32 v124, v52, v53
  v_cvt_pk_bf16_f32 v125, v54, v55
  v_min_u32 v124, -2, v124
  v_min_u32 v125, -2, v125
  v_pk_mul_f32 v[56:57], v[56:57], v[128:129]
  v_pk_mul_f32 v[58:59], v[58:59], v[130:131]
  v_cvt_pk_bf16_f32 v126, v56, v57
  v_cvt_pk_bf16_f32 v127, v58, v59
  v_min_u32 v126, -2, v126
  v_min_u32 v127, -2, v127
  buffer_store_dwordx4 v[124:127], v2, s[48:51], s23 offen sc1
  s_add_u32 s23, s23, 16384
  v_pk_mul_f32 v[60:61], v[60:61], v[132:133]
  v_pk_mul_f32 v[62:63], v[62:63], v[134:135]
  v_cvt_pk_bf16_f32 v132, v60, v61
  v_cvt_pk_bf16_f32 v133, v62, v63
  v_min_u32 v132, -2, v132
  v_min_u32 v133, -2, v133
  v_pk_mul_f32 v[64:65], v[64:65], v[136:137]
  v_pk_mul_f32 v[66:67], v[66:67], v[138:139]
  v_cvt_pk_bf16_f32 v134, v64, v65
  v_cvt_pk_bf16_f32 v135, v66, v67
  v_min_u32 v134, -2, v134
  v_min_u32 v135, -2, v135
  buffer_store_dwordx4 v[132:135], v2, s[48:51], s23 offen sc1
  s_add_u32 s23, s23, 16384
  v_pk_mul_f32 v[68:69], v[68:69], v[140:141]
  v_pk_mul_f32 v[70:71], v[70:71], v[142:143]
  v_cvt_pk_bf16_f32 v140, v68, v69
  v_cvt_pk_bf16_f32 v141, v70, v71
  v_min_u32 v140, -2, v140
  v_min_u32 v141, -2, v141
  v_pk_mul_f32 v[72:73], v[72:73], v[144:145]
  v_pk_mul_f32 v[74:75], v[74:75], v[146:147]
  v_cvt_pk_bf16_f32 v142, v72, v73
  v_cvt_pk_bf16_f32 v143, v74, v75
  v_min_u32 v142, -2, v142
  v_min_u32 v143, -2, v143
  buffer_store_dwordx4 v[140:143], v2, s[48:51], s23 offen sc1
  s_add_u32 s23, s23, 16384
  v_pk_mul_f32 v[76:77], v[76:77], v[148:149]
  v_pk_mul_f32 v[78:79], v[78:79], v[150:151]
  v_cvt_pk_bf16_f32 v148, v76, v77
  v_cvt_pk_bf16_f32 v149, v78, v79
  v_min_u32 v148, -2, v148
  v_min_u32 v149, -2, v149
  v_pk_mul_f32 v[80:81], v[80:81], v[152:153]
  v_pk_mul_f32 v[82:83], v[82:83], v[154:155]
  v_cvt_pk_bf16_f32 v150, v80, v81
  v_cvt_pk_bf16_f32 v151, v82, v83
  v_min_u32 v150, -2, v150
  v_min_u32 v151, -2, v151
  buffer_store_dwordx4 v[148:151], v2, s[48:51], s23 offen sc1
  s_add_u32 s23, s23, 16384
  v_pk_mul_f32 v[84:85], v[84:85], v[156:157]
  v_pk_mul_f32 v[86:87], v[86:87], v[158:159]
  v_cvt_pk_bf16_f32 v156, v84, v85
  v_cvt_pk_bf16_f32 v157, v86, v87
  v_min_u32 v156, -2, v156
  v_min_u32 v157, -2, v157
  buffer_store_dwordx2 v[156:157], v14, s[48:51], s15 offen sc1
  s_add_u32 s28, s20, 26439680
  s_addc_u32 s29, s21, 0
  s_and_b32 s29, s29, 0xffff
  s_mov_b32 s30, 9437184
  s_mov_b32 s31, 0x20000
  s_add_u32 s36, s20, 0
  s_addc_u32 s37, s21, 0
  s_and_b32 s37, s37, 0xffff
  s_mov_b32 s38, 13824
  s_mov_b32 s39, 0x20000
  s_mov_b32 s24, s64
  s_and_b32 s25, s65, 0xffff
  s_mov_b32 s26, 2359296
  s_mov_b32 s27, 0x20000
  v_and_b32 v8, 15, v1
  v_lshrrev_b32 v9, 4, v1
  s_mul_i32 s10, s6, 73728
  s_mov_b32 s18, s10
  s_mul_i32 s13, s5, 288
  s_add_u32 s13, s13, 11520
  s_add_u32 s16, s17, 147456
  s_mov_b32 s9, 200000
  buffer_load_dwordx4 v[48:51], v2, s[28:31], s10 offen offset:0 sc1
  buffer_load_dwordx4 v[52:55], v2, s[28:31], s10 offen offset:1024 sc1
  buffer_load_dwordx4 v[56:59], v2, s[28:31], s10 offen offset:2048 sc1
  buffer_load_dwordx4 v[60:63], v2, s[28:31], s10 offen offset:3072 sc1
  s_add_u32 s10, s10, 4096
  buffer_load_dwordx4 v[64:67], v2, s[28:31], s10 offen offset:0 sc1
  buffer_load_dwordx4 v[68:71], v2, s[28:31], s10 offen offset:1024 sc1
  buffer_load_dwordx4 v[72:75], v2, s[28:31], s10 offen offset:2048 sc1
  buffer_load_dwordx4 v[76:79], v2, s[28:31], s10 offen offset:3072 sc1
  s_add_u32 s10, s10, 4096
  v_add_u32 v10, 0, v2
  v_add_u32 v11, 64512, v2
  v_add_u32 v12, 129024, v2
  v_lshrrev_b32 v13, 4, v1
  v_lshlrev_b32 v13, 7, v13
  v_and_b32 v14, 7, v1
  v_lshl_add_u32 v13, v14, 4, v13
  v_add_u32 v15, 133120, v13
  v_add_u32 v14, 68608, v13
  v_add_u32 v13, 4096, v13
  s_waitcnt vmcnt(18)
  ds_write_b128 v3, a[212:215] offset:0
  ds_write_b128 v3, a[216:219] offset:4096
  ds_write_b128 v3, a[220:223] offset:8192
  ds_write_b128 v3, a[224:227] offset:12288
  ds_write_b128 v3, a[228:231] offset:16384
  ds_write_b128 v3, a[232:235] offset:20480
  ds_write_b128 v3, a[236:239] offset:24576
  ds_write_b128 v3, a[240:243] offset:28672
  ds_write_b128 v3, a[244:247] offset:32768
  ds_write_b128 v3, a[248:251] offset:36864
  ds_write_b128 v3, a[252:255] offset:40960
  ds_write_b128 v3, a[0:3] offset:45056
  ds_write_b128 v3, a[4:7] offset:49152
  ds_write_b128 v3, a[8:11] offset:53248
  ds_write_b128 v3, a[12:15] offset:57344
  ds_write_b128 v3, a[16:19] offset:61440
  ds_write_b128 v4, a[20:23] offset:0
  ds_write_b128 v4, a[24:27] offset:4096
  ds_write_b128 v4, a[28:31] offset:8192
  ds_write_b128 v4, a[32:35] offset:12288
  ds_write_b128 v4, a[36:39] offset:16384
  ds_write_b128 v4, a[40:43] offset:20480
  ds_write_b128 v4, a[44:47] offset:24576
  ds_write_b128 v4, a[48:51] offset:28672
  ds_write_b128 v4, a[52:55] offset:32768
  ds_write_b128 v4, a[56:59] offset:36864
  ds_write_b128 v4, a[60:63] offset:40960
  ds_write_b128 v4, a[64:67] offset:45056
  ds_write_b128 v4, a[68:71] offset:49152
  ds_write_b128 v4, a[72:75] offset:53248
  ds_write_b128 v4, a[76:79] offset:57344
  ds_write_b128 v4, a[80:83] offset:61440
  ds_write_b128 v5, a[84:87] offset:0
  ds_write_b128 v5, a[88:91] offset:4096
  ds_write_b128 v5, a[92:95] offset:8192
  ds_write_b128 v5, a[96:99] offset:12288
  v_accvgpr_read_b32 v16, a200
  v_accvgpr_read_b32 v17, a201
  v_accvgpr_read_b32 v18, a202
  v_accvgpr_read_b32 v19, a203
  v_accvgpr_read_b32 v20, a204
  v_accvgpr_read_b32 v21, a205
  v_accvgpr_read_b32 v22, a206
  v_accvgpr_read_b32 v23, a207
  v_accvgpr_read_b32 v24, a208
  v_accvgpr_read_b32 v25, a209
  v_mov_b32 v176, 0
  v_mov_b32 v177, 0
  v_mov_b32 v178, 0
  v_mov_b32 v179, 0
  v_mov_b32 v180, 0
  v_mov_b32 v181, 0
  v_mov_b32 v182, 0
  v_mov_b32 v183, 0
  v_mov_b32 v184, 0
  v_mov_b32 v185, 0
  v_mov_b32 v186, 0
  v_mov_b32 v187, 0
  v_mov_b32 v188, 0
  v_mov_b32 v189, 0
  v_mov_b32 v190, 0
  v_mov_b32 v191, 0
  v_mov_b32 v192, 0
  v_mov_b32 v193, 0
  v_mov_b32 v194, 0
  v_mov_b32 v195, 0
  v_lshlrev_b32 v144, 16, v16
  v_and_b32 v145, 0xffff0000, v16
  v_lshlrev_b32 v146, 16, v17
  v_and_b32 v147, 0xffff0000, v17
  v_lshlrev_b32 v148, 16, v18
  v_and_b32 v149, 0xffff0000, v18
  v_lshlrev_b32 v150, 16, v19
  v_and_b32 v151, 0xffff0000, v19
  v_lshlrev_b32 v152, 16, v20
  v_and_b32 v153, 0xffff0000, v20
  v_lshlrev_b32 v154, 16, v21
  v_and_b32 v155, 0xffff0000, v21
  v_lshlrev_b32 v156, 16, v22
  v_and_b32 v157, 0xffff0000, v22
  v_lshlrev_b32 v158, 16, v23
  v_and_b32 v159, 0xffff0000, v23
  v_lshlrev_b32 v160, 16, v24
  v_and_b32 v161, 0xffff0000, v24
  v_lshlrev_b32 v162, 16, v25
  v_and_b32 v163, 0xffff0000, v25
  v_mul_u32_u24 v26, 1152, v8
  v_lshl_add_u32 v27, v9, 3, v26
  v_and_b32 v7, 1, v9
  v_lshl_add_u32 v26, v7, 5, v26
  v_lshrrev_b32 v7, 1, v9
  v_lshl_add_u32 v26, v7, 4, v26
  s_mul_i32 s22, s6, 18432
  s_mul_i32 s23, s5, 144
  s_add_u32 s22, s22, s23
  v_lshl_add_u32 v7, v9, 4, s16
  s_waitcnt vmcnt(7) lgkmcnt(0)
  v_max_u32 v4, v48, v49
  v_max3_u32 v4, v50, v51, v4
  v_cmp_eq_u32 vcc, -1, v4
  s_nop 4
  s_cbranch_vccnz kt_tail_kernel_fx0
kt_tail_kernel_fx0r:
  s_barrier
  ds_read_b128 v[196:199], v10 offset:0
  ds_read_b128 v[200:203], v10 offset:1024
  ds_read_b128 v[204:207], v10 offset:2048
  ds_read_b128 v[208:211], v10 offset:3072
  ds_read_b128 v[212:215], v13 offset:0
  ds_read_b128 v[216:219], v10 offset:4608
  ds_read_b128 v[220:223], v10 offset:5632
  ds_read_b128 v[224:227], v10 offset:6656
  ds_read_b128 v[228:231], v10 offset:7680
  ds_read_b128 v[232:235], v13 offset:4608
  s_waitcnt lgkmcnt(5)
  v_mfma_f32_16x16x32_bf16 v[176:179], v[196:199], v[48:51], v[176:179]
  ds_read_b128 v[236:239], v10 offset:9216
  buffer_load_dwordx4 v[80:83], v2, s[28:31], s10 offen offset:0 sc1
  v_mfma_f32_16x16x32_bf16 v[180:183], v[200:203], v[48:51], v[180:183]
  ds_read_b128 v[240:243], v10 offset:10240
  buffer_load_dwordx4 v[84:87], v2, s[28:31], s10 offen offset:1024 sc1
  v_mfma_f32_16x16x32_bf16 v[184:187], v[204:207], v[48:51], v[184:187]
  ds_read_b128 v[244:247], v10 offset:11264
  buffer_load_dwordx4 v[88:91], v2, s[28:31], s10 offen offset:2048 sc1
  v_mfma_f32_16x16x32_bf16 v[188:191], v[208:211], v[48:51], v[188:191]
  ds_read_b128 v[248:251], v10 offset:12288
  buffer_load_dwordx4 v[92:95], v2, s[28:31], s10 offen offset:3072 sc1
  s_add_u32 s10, s10, 4096
  v_mfma_f32_16x16x32_bf16 v[192:195], v[212:215], v[48:51], v[192:195]
  ds_read_b128 v[252:255], v13 offset:9216
  buffer_load_dwordx4 v[96:99], v2, s[28:31], s10 offen offset:0 sc1
  s_waitcnt vmcnt(10) lgkmcnt(5)
  v_max_u32 v4, v52, v53
  v_max3_u32 v4, v54, v55, v4
  v_max3_u32 v4, v56, v57, v4
  v_max3_u32 v4, v58, v59, v4
  v_cmp_eq_u32 vcc, -1, v4
  s_nop 4
  s_cbranch_vccnz kt_tail_kernel_fx1
kt_tail_kernel_fx1r:
  s_barrier
  v_mfma_f32_16x16x32_bf16 v[176:179], v[216:219], v[52:55], v[176:179]
  ds_read_b128 v[196:199], v10 offset:13824
  v_mfma_f32_16x16x32_bf16 v[180:183], v[220:223], v[52:55], v[180:183]
  ds_read_b128 v[200:203], v10 offset:14848
  v_mfma_f32_16x16x32_bf16 v[184:187], v[224:227], v[52:55], v[184:187]
  ds_read_b128 v[204:207], v10 offset:15872
  v_mfma_f32_16x16x32_bf16 v[188:191], v[228:231], v[52:55], v[188:191]
  ds_read_b128 v[208:211], v10 offset:16896
  v_mfma_f32_16x16x32_bf16 v[192:195], v[232:235], v[52:55], v[192:195]
  ds_read_b128 v[212:215], v13 offset:13824
  buffer_load_dwordx4 v[100:103], v2, s[28:31], s10 offen offset:1024 sc1
  s_waitcnt lgkmcnt(5)
  v_mfma_f32_16x16x32_bf16 v[176:179], v[236:239], v[56:59], v[176:179]
  ds_read_b128 v[216:219], v10 offset:18432
  v_mfma_f32_16x16x32_bf16 v[180:183], v[240:243], v[56:59], v[180:183]
  ds_read_b128 v[220:223], v10 offset:19456
  v_mfma_f32_16x16x32_bf16 v[184:187], v[244:247], v[56:59], v[184:187]
  ds_read_b128 v[224:227], v10 offset:20480
  v_mfma_f32_16x16x32_bf16 v[188:191], v[248:251], v[56:59], v[188:191]
  ds_read_b128 v[228:231], v10 offset:21504
  v_mfma_f32_16x16x32_bf16 v[192:195], v[252:255], v[56:59], v[192:195]
  ds_read_b128 v[232:235], v13 offset:18432
  buffer_load_dwordx4 v[104:107], v2, s[28:31], s10 offen offset:2048 sc1
  s_waitcnt vmcnt(9) lgkmcnt(5)
  v_max_u32 v4, v60, v61
  v_max3_u32 v4, v62, v63, v4
  v_max3_u32 v4, v64, v65, v4
  v_max3_u32 v4, v66, v67, v4
  v_max3_u32 v4, v68, v69, v4
  v_max3_u32 v4, v70, v71, v4
  v_cmp_eq_u32 vcc, -1, v4
  s_nop 4
  s_cbranch_vccnz kt_tail_kernel_fx3
kt_tail_kernel_fx3r:
  s_barrier
  v_mfma_f32_16x16x32_bf16 v[176:179], v[196:199], v[60:63], v[176:179]
  ds_read_b128 v[236:239], v10 offset:23040
  v_mfma_f32_16x16x32_bf16 v[180:183], v[200:203], v[60:63], v[180:183]
  ds_read_b128 v[240:243], v10 offset:24064
  v_mfma_f32_16x16x32_bf16 v[184:187], v[204:207], v[60:63], v[184:187]
  ds_read_b128 v[244:247], v10 offset:25088
  v_mfma_f32_16x16x32_bf16 v[188:191], v[208:211], v[60:63], v[188:191]
  ds_read_b128 v[248:251], v10 offset:26112
  v_mfma_f32_16x16x32_bf16 v[192:195], v[212:215], v[60:63], v[192:195]
  ds_read_b128 v[252:255], v13 offset:23040
  buffer_load_dwordx4 v[108:111], v2, s[28:31], s10 offen offset:3072 sc1
  s_add_u32 s10, s10, 4096
  s_waitcnt lgkmcnt(5)
  v_mfma_f32_16x16x32_bf16 v[176:179], v[216:219], v[64:67], v[176:179]
  ds_read_b128 v[196:199], v10 offset:27648
  v_mfma_f32_16x16x32_bf16 v[180:183], v[220:223], v[64:67], v[180:183]
  ds_read_b128 v[200:203], v10 offset:28672
  v_mfma_f32_16x16x32_bf16 v[184:187], v[224:227], v[64:67], v[184:187]
  ds_read_b128 v[204:207], v10 offset:29696
  v_mfma_f32_16x16x32_bf16 v[188:191], v[228:231], v[64:67], v[188:191]
  ds_read_b128 v[208:211], v10 offset:30720
  v_mfma_f32_16x16x32_bf16 v[192:195], v[232:235], v[64:67], v[192:195]
  ds_read_b128 v[212:215], v13 offset:27648
  buffer_load_dwordx4 v[112:115], v2, s[28:31], s10 offen offset:0 sc1
  s_waitcnt lgkmcnt(5)
  v_mfma_f32_16x16x32_bf16 v[176:179], v[236:239], v[68:71], v[176:179]
  ds_read_b128 v[216:219], v10 offset:32256
  v_mfma_f32_16x16x32_bf16 v[180:183], v[240:243], v[68:71], v[180:183]
  ds_read_b128 v[220:223], v10 offset:33280
  v_mfma_f32_16x16x32_bf16 v[184:187], v[244:247], v[68:71], v[184:187]
  ds_read_b128 v[224:227], v10 offset:34304
  v_mfma_f32_16x16x32_bf16 v[188:191], v[248:251], v[68:71], v[188:191]
  ds_read_b128 v[228:231], v10 offset:35328
  v_mfma_f32_16x16x32_bf16 v[192:195], v[252:255], v[68:71], v[192:195]
  ds_read_b128 v[232:235], v13 offset:32256
  buffer_load_dwordx4 v[116:119], v2, s[28:31], s10 offen offset:1024 sc1
  s_waitcnt vmcnt(8) lgkmcnt(5)
  v_max_u32 v4, v72, v73
  v_max3_u32 v4, v74, v75, v4
  v_max3_u32 v4, v76, v77, v4
  v_max3_u32 v4, v78, v79, v4
  v_max3_u32 v4, v80, v81, v4
  v_max3_u32 v4, v82, v83, v4
  v_max3_u32 v4, v84, v85, v4
  v_max3_u32 v4, v86, v87, v4
  v_cmp_eq_u32 vcc, -1, v4
  s_nop 4
  s_cbranch_vccnz kt_tail_kernel_fx6
kt_tail_kernel_fx6r:
  s_barrier
  v_mfma_f32_16x16x32_bf16 v[176:179], v[196:199], v[72:75], v[176:179]
  ds_read_b128 v[236:239], v10 offset:36864
  v_mfma_f32_16x16x32_bf16 v[180:183], v[200:203], v[72:75], v[180:183]
  ds_read_b128 v[240:243], v10 offset:37888
  v_mfma_f32_16x16x32_bf16 v[184:187], v[204:207], v[72:75], v[184:187]
  ds_read_b128 v[244:247], v10 offset:38912
  v_mfma_f32_16x16x32_bf16 v[188:191], v[208:211], v[72:75], v[188:191]
  ds_read_b128 v[248:251], v10 offset:39936
  v_mfma_f32_16x16x32_bf16 v[192:195], v[212:215], v[72:75], v[192:195]
  ds_read_b128 v[252:255], v13 offset:36864
  buffer_load_dwordx4 v[120:123], v2, s[28:31], s10 offen offset:2048 sc1
  s_waitcnt lgkmcnt(5)
  v_mfma_f32_16x16x32_bf16 v[176:179], v[216:219], v[76:79], v[176:179]
  ds_read_b128 v[196:199], v10 offset:41472
  v_mfma_f32_16x16x32_bf16 v[180:183], v[220:223], v[76:79], v[180:183]
  ds_read_b128 v[200:203], v10 offset:42496
  v_mfma_f32_16x16x32_bf16 v[184:187], v[224:227], v[76:79], v[184:187]
  ds_read_b128 v[204:207], v10 offset:43520
  v_mfma_f32_16x16x32_bf16 v[188:191], v[228:231], v[76:79], v[188:191]
  ds_read_b128 v[208:211], v10 offset:44544
  v_mfma_f32_16x16x32_bf16 v[192:195], v[232:235], v[76:79], v[192:195]
  ds_read_b128 v[212:215], v13 offset:41472
  buffer_load_dwordx4 v[124:127], v2, s[28:31], s10 offen offset:3072 sc1
  s_add_u32 s10, s10, 4096
  s_waitcnt lgkmcnt(5)
  v_mfma_f32_16x16x32_bf16 v[176:179], v[236:239], v[80:83], v[176:179]
  ds_read_b128 v[216:219], v10 offset:46080
  v_mfma_f32_16x16x32_bf16 v[180:183], v[240:243], v[80:83], v[180:183]
  ds_read_b128 v[220:223], v10 offset:47104
  v_mfma_f32_16x16x32_bf16 v[184:187], v[244:247], v[80:83], v[184:187]
  ds_read_b128 v[224:227], v10 offset:48128
  v_mfma_f32_16x16x32_bf16 v[188:191], v[248:251], v[80:83], v[188:191]
  ds_read_b128 v[228:231], v10 offset:49152
  v_mfma_f32_16x16x32_bf16 v[192:195], v[252:255], v[80:83], v[192:195]
  ds_read_b128 v[232:235], v13 offset:46080
  buffer_load_dwordx4 v[128:131], v2, s[28:31], s10 offen offset:0 sc1
  s_waitcnt lgkmcnt(5)
  v_mfma_f32_16x16x32_bf16 v[176:179], v[196:199], v[84:87], v[176:179]
  ds_read_b128 v[236:239], v10 offset:50688
  v_mfma_f32_16x16x32_bf16 v[180:183], v[200:203], v[84:87], v[180:183]
  ds_read_b128 v[240:243], v10 offset:51712
  v_mfma_f32_16x16x32_bf16 v[184:187], v[204:207], v[84:87], v[184:187]
  ds_read_b128 v[244:247], v10 offset:52736
  v_mfma_f32_16x16x32_bf16 v[188:191], v[208:211], v[84:87], v[188:191]
  ds_read_b128 v[248:251], v10 offset:53760
  v_mfma_f32_16x16x32_bf16 v[192:195], v[212:215], v[84:87], v[192:195]
  ds_read_b128 v[252:255], v13 offset:50688
  buffer_load_dwordx4 v[132:135], v2, s[28:31], s10 offen offset:1024 sc1
  s_waitcnt vmcnt(8) lgkmcnt(5)
  v_max_u32 v4, v88, v89
  v_max3_u32 v4, v90, v91, v4
  v_max3_u32 v4, v92, v93, v4
  v_max3_u32 v4, v94, v95, v4
  v_max3_u32 v4, v96, v97, v4
  v_max3_u32 v4, v98, v99, v4
  v_max3_u32 v4, v100, v101, v4
  v_max3_u32 v4, v102, v103, v4
  v_cmp_eq_u32 vcc, -1, v4
  s_nop 4
  s_cbranch_vccnz kt_tail_kernel_fx10
kt_tail_kernel_fx10r:
  s_barrier
  v_mfma_f32_16x16x32_bf16 v[176:179], v[216:219], v[88:91], v[176:179]
  ds_read_b128 v[196:199], v10 offset:55296
  v_mfma_f32_16x16x32_bf16 v[180:183], v[220:223], v[88:91], v[180:183]
  ds_read_b128 v[200:203], v10 offset:56320
  v_mfma_f32_16x16x32_bf16 v[184:187], v[224:227], v[88:91], v[184:187]
  ds_read_b128 v[204:207], v10 offset:57344
  v_mfma_f32_16x16x32_bf16 v[188:191], v[228:231], v[88:91], v[188:191]
  ds_read_b128 v[208:211], v10 offset:58368
  v_mfma_f32_16x16x32_bf16 v[192:195], v[232:235], v[88:91], v[192:195]
  ds_read_b128 v[212:215], v13 offset:55296
  buffer_load_dwordx4 v[136:139], v2, s[28:31], s10 offen offset:2048 sc1
  s_waitcnt lgkmcnt(5)
  v_mfma_f32_16x16x32_bf16 v[176:179], v[236:239], v[92:95], v[176:179]
  ds_read_b128 v[216:219], v10 offset:59904
  v_mfma_f32_16x16x32_bf16 v[180:183], v[240:243], v[92:95], v[180:183]
  ds_read_b128 v[220:223], v10 offset:60928
  v_mfma_f32_16x16x32_bf16 v[184:187], v[244:247], v[92:95], v[184:187]
  ds_read_b128 v[224:227], v10 offset:61952
  v_mfma_f32_16x16x32_bf16 v[188:191], v[248:251], v[92:95], v[188:191]
  ds_read_b128 v[228:231], v10 offset:62976
  v_mfma_f32_16x16x32_bf16 v[192:195], v[252:255], v[92:95], v[192:195]
  ds_read_b128 v[232:235], v13 offset:59904
  buffer_load_dwordx4 v[140:143], v2, s[28:31], s10 offen offset:3072 sc1
  s_add_u32 s10, s10, 4096
  s_waitcnt lgkmcnt(5)
  v_mfma_f32_16x16x32_bf16 v[176:179], v[196:199], v[96:99], v[176:179]
  ds_read_b128 v[236:239], v11 offset:0
  v_mfma_f32_16x16x32_bf16 v[180:183], v[200:203], v[96:99], v[180:183]
  ds_read_b128 v[240:243], v11 offset:1024
  v_mfma_f32_16x16x32_bf16 v[184:187], v[204:207], v[96:99], v[184:187]
  ds_read_b128 v[244:247], v11 offset:2048
  v_mfma_f32_16x16x32_bf16 v[188:191], v[208:211], v[96:99], v[188:191]
  ds_read_b128 v[248:251], v11 offset:3072
  v_mfma_f32_16x16x32_bf16 v[192:195], v[212:215], v[96:99], v[192:195]
  ds_read_b128 v[252:255], v14 offset:0
  buffer_load_dwordx4 v[48:51], v2, s[28:31], s10 offen offset:0 sc1
  s_waitcnt lgkmcnt(5)
  v_mfma_f32_16x16x32_bf16 v[176:179], v[216:219], v[100:103], v[176:179]
  ds_read_b128 v[196:199], v11 offset:4608
  v_mfma_f32_16x16x32_bf16 v[180:183], v[220:223], v[100:103], v[180:183]
  ds_read_b128 v[200:203], v11 offset:5632
  v_mfma_f32_16x16x32_bf16 v[184:187], v[224:227], v[100:103], v[184:187]
  ds_read_b128 v[204:207], v11 offset:6656
  buffer_load_dwordx4 v[52:55], v2, s[28:31], s10 offen offset:1024 sc1
  v_mfma_f32_16x16x32_bf16 v[188:191], v[228:231], v[100:103], v[188:191]
  ds_read_b128 v[208:211], v11 offset:7680
  v_mfma_f32_16x16x32_bf16 v[192:195], v[232:235], v[100:103], v[192:195]
  ds_read_b128 v[212:215], v14 offset:4608
  s_add_u32 m0, s17, 0
  s_add_u32 s11, s11, 4096
  buffer_load_dwordx4 v2, s[32:35], s11 offen lds
  s_waitcnt vmcnt(9) lgkmcnt(5)
  v_max_u32 v4, v104, v105
  v_max3_u32 v4, v106, v107, v4
  v_max3_u32 v4, v108, v109, v4
  v_max3_u32 v4, v110, v111, v4
  v_max3_u32 v4, v112, v113, v4
  v_max3_u32 v4, v114, v115, v4
  v_max3_u32 v4, v116, v117, v4
  v_max3_u32 v4, v118, v119, v4
  v_cmp_eq_u32 vcc, -1, v4
  s_nop 4
  s_cbranch_vccnz kt_tail_kernel_fx14
kt_tail_kernel_fx14r:
  s_barrier
  v_mfma_f32_16x16x32_bf16 v[176:179], v[236:239], v[104:107], v[176:179]
  ds_read_b128 v[216:219], v11 offset:9216
  v_mfma_f32_16x16x32_bf16 v[180:183], v[240:243], v[104:107], v[180:183]
  ds_read_b128 v[220:223], v11 offset:10240
  buffer_load_dwordx4 v[56:59], v2, s[28:31], s10 offen offset:2048 sc1
  v_mfma_f32_16x16x32_bf16 v[184:187], v[244:247], v[104:107], v[184:187]
  ds_read_b128 v[224:227], v11 offset:11264
  v_mfma_f32_16x16x32_bf16 v[188:191], v[248:251], v[104:107], v[188:191]
  ds_read_b128 v[228:231], v11 offset:12288
  s_add_u32 m0, s17, 4096
  s_add_u32 s11, s11, 4096
  buffer_load_dwordx4 v2, s[32:35], s11 offen lds
  v_mfma_f32_16x16x32_bf16 v[192:195], v[252:255], v[104:107], v[192:195]
  ds_read_b128 v[232:235], v14 offset:9216
  s_add_u32 m0, s17, 8192
  s_add_u32 s11, s11, 4096
  buffer_load_dwordx4 v2, s[32:35], s11 offen lds
  s_waitcnt lgkmcnt(5)
  v_mfma_f32_16x16x32_bf16 v[176:179], v[196:199], v[108:111], v[176:179]
  ds_read_b128 v[236:239], v11 offset:13824
  v_mfma_f32_16x16x32_bf16 v[180:183], v[200:203], v[108:111], v[180:183]
  ds_read_b128 v[240:243], v11 offset:14848
  buffer_load_dwordx4 v[60:63], v2, s[28:31], s10 offen offset:3072 sc1
  s_add_u32 s10, s10, 4096
  v_mfma_f32_16x16x32_bf16 v[184:187], v[204:207], v[108:111], v[184:187]
  ds_read_b128 v[244:247], v11 offset:15872
  v_mfma_f32_16x16x32_bf16 v[188:191], v[208:211], v[108:111], v[188:191]
  ds_read_b128 v[248:251], v11 offset:16896
  s_add_u32 m0, s17, 12288
  s_add_u32 s11, s11, 4096
  buffer_load_dwordx4 v2, s[32:35], s11 offen lds
  v_mfma_f32_16x16x32_bf16 v[192:195], v[212:215], v[108:111], v[192:195]
  ds_read_b128 v[252:255], v14 offset:13824
  s_add_u32 m0, s17, 16384
  s_add_u32 s11, s11, 4096
  buffer_load_dwordx4 v2, s[32:35], s11 offen lds
  s_waitcnt lgkmcnt(5)
  v_mfma_f32_16x16x32_bf16 v[176:179], v[216:219], v[112:115], v[176:179]
  ds_read_b128 v[196:199], v11 offset:18432
  v_mfma_f32_16x16x32_bf16 v[180:183], v[220:223], v[112:115], v[180:183]
  ds_read_b128 v[200:203], v11 offset:19456
  v_mfma_f32_16x16x32_bf16 v[184:187], v[224:227], v[112:115], v[184:187]
  ds_read_b128 v[204:207], v11 offset:20480
  buffer_load_dwordx4 v[64:67], v2, s[28:31], s10 offen offset:0 sc1
  v_mfma_f32_16x16x32_bf16 v[188:191], v[228:231], v[112:115], v[188:191]
  ds_read_b128 v[208:211], v11 offset:21504
  v_mfma_f32_16x16x32_bf16 v[192:195], v[232:235], v[112:115], v[192:195]
  ds_read_b128 v[212:215], v14 offset:18432
  s_add_u32 m0, s17, 20480
  s_add_u32 s11, s11, 4096
  buffer_load_dwordx4 v2, s[32:35], s11 offen lds
  s_waitcnt lgkmcnt(5)
  v_mfma_f32_16x16x32_bf16 v[176:179], v[236:239], v[116:119], v[176:179]
  ds_read_b128 v[216:219], v11 offset:23040
  v_mfma_f32_16x16x32_bf16 v[180:183], v[240:243], v[116:119], v[180:183]
  ds_read_b128 v[220:223], v11 offset:24064
  v_mfma_f32_16x16x32_bf16 v[184:187], v[244:247], v[116:119], v[184:187]
  ds_read_b128 v[224:227], v11 offset:25088
  buffer_load_dwordx4 v[68:71], v2, s[28:31], s10 offen offset:1024 sc1
  v_mfma_f32_16x16x32_bf16 v[188:191], v[248:251], v[116:119], v[188:191]
  ds_read_b128 v[228:231], v11 offset:26112
  v_mfma_f32_16x16x32_bf16 v[192:195], v[252:255], v[116:119], v[192:195]
  ds_read_b128 v[232:235], v14 offset:23040
  s_add_u32 m0, s17, 24576
  s_add_u32 s11, s11, 4096
  buffer_load_dwordx4 v2, s[32:35], s11 offen lds
  s_waitcnt vmcnt(15) lgkmcnt(5)
  v_max_u32 v4, v120, v121
  v_max3_u32 v4, v122, v123, v4
  v_max3_u32 v4, v124, v125, v4
  v_max3_u32 v4, v126, v127, v4
  v_max3_u32 v4, v128, v129, v4
  v_max3_u32 v4, v130, v131, v4
  v_max3_u32 v4, v132, v133, v4
  v_max3_u32 v4, v134, v135, v4
  v_cmp_eq_u32 vcc, -1, v4
  s_nop 4
  s_cbranch_vccnz kt_tail_kernel_fx18
kt_tail_kernel_fx18r:
  s_barrier
  v_mfma_f32_16x16x32_bf16 v[176:179], v[196:199], v[120:123], v[176:179]
  ds_read_b128 v[236:239], v11 offset:27648
  v_mfma_f32_16x16x32_bf16 v[180:183], v[200:203], v[120:123], v[180:183]
  ds_read_b128 v[240:243], v11 offset:28672
  v_mfma_f32_16x16x32_bf16 v[184:187], v[204:207], v[120:123], v[184:187]
  ds_read_b128 v[244:247], v11 offset:29696
  buffer_load_dwordx4 v[72:75], v2, s[28:31], s10 offen offset:2048 sc1
  v_mfma_f32_16x16x32_bf16 v[188:191], v[208:211], v[120:123], v[188:191]
  ds_read_b128 v[248:251], v11 offset:30720
  v_mfma_f32_16x16x32_bf16 v[192:195], v[212:215], v[120:123], v[192:195]
  ds_read_b128 v[252:255], v14 offset:27648
  s_add_u32 m0, s17, 28672
  s_add_u32 s11, s11, 4096
  buffer_load_dwordx4 v2, s[32:35], s11 offen lds
  s_waitcnt lgkmcnt(5)
  v_mfma_f32_16x16x32_bf16 v[176:179], v[216:219], v[124:127], v[176:179]
  ds_read_b128 v[196:199], v11 offset:32256
  v_mfma_f32_16x16x32_bf16 v[180:183], v[220:223], v[124:127], v[180:183]
  ds_read_b128 v[200:203], v11 offset:33280
  v_mfma_f32_16x16x32_bf16 v[184:187], v[224:227], v[124:127], v[184:187]
  ds_read_b128 v[204:207], v11 offset:34304
  buffer_load_dwordx4 v[76:79], v2, s[28:31], s10 offen offset:3072 sc1
  s_add_u32 s10, s10, 4096
  v_mfma_f32_16x16x32_bf16 v[188:191], v[228:231], v[124:127], v[188:191]
  ds_read_b128 v[208:211], v11 offset:35328
  v_mfma_f32_16x16x32_bf16 v[192:195], v[232:235], v[124:127], v[192:195]
  ds_read_b128 v[212:215], v14 offset:32256
  s_add_u32 m0, s17, 32768
  s_add_u32 s11, s11, 4096
  buffer_load_dwordx4 v2, s[32:35], s11 offen lds
  s_waitcnt lgkmcnt(5)
  v_mfma_f32_16x16x32_bf16 v[176:179], v[236:239], v[128:131], v[176:179]
  ds_read_b128 v[216:219], v11 offset:36864
  v_mfma_f32_16x16x32_bf16 v[180:183], v[240:243], v[128:131], v[180:183]
  ds_read_b128 v[220:223], v11 offset:37888
  buffer_load_dwordx4 v[80:83], v2, s[28:31], s10 offen offset:0 sc1
  v_mfma_f32_16x16x32_bf16 v[184:187], v[244:247], v[128:131], v[184:187]
  ds_read_b128 v[224:227], v11 offset:38912
  v_mfma_f32_16x16x32_bf16 v[188:191], v[248:251], v[128:131], v[188:191]
  ds_read_b128 v[228:231], v11 offset:39936
  s_add_u32 m0, s17, 36864
  s_add_u32 s11, s11, 4096
  buffer_load_dwordx4 v2, s[32:35], s11 offen lds
  v_mfma_f32_16x16x32_bf16 v[192:195], v[252:255], v[128:131], v[192:195]
  ds_read_b128 v[232:235], v14 offset:36864
  s_add_u32 m0, s17, 40960
  s_add_u32 s11, s11, 4096
  buffer_load_dwordx4 v2, s[32:35], s11 offen lds
  s_waitcnt lgkmcnt(5)
  v_mfma_f32_16x16x32_bf16 v[176:179], v[196:199], v[132:135], v[176:179]
  ds_read_b128 v[236:239], v11 offset:41472
  v_mfma_f32_16x16x32_bf16 v[180:183], v[200:203], v[132:135], v[180:183]
  ds_read_b128 v[240:243], v11 offset:42496
  v_mfma_f32_16x16x32_bf16 v[184:187], v[204:207], v[132:135], v[184:187]
  ds_read_b128 v[244:247], v11 offset:43520
  buffer_load_dwordx4 v[84:87], v2, s[28:31], s10 offen offset:1024 sc1
  v_mfma_f32_16x16x32_bf16 v[188:191], v[208:211], v[132:135], v[188:191]
  ds_read_b128 v[248:251], v11 offset:44544
  v_mfma_f32_16x16x32_bf16 v[192:195], v[212:215], v[132:135], v[192:195]
  ds_read_b128 v[252:255], v14 offset:41472
  s_add_u32 m0, s17, 45056
  s_add_u32 s11, s11, 4096
  buffer_load_dwordx4 v2, s[32:35], s11 offen lds
  s_waitcnt vmcnt(20) lgkmcnt(5)
  v_max_u32 v4, v136, v137
  v_max3_u32 v4, v138, v139, v4
  v_max3_u32 v4, v140, v141, v4
  v_max3_u32 v4, v142, v143, v4
  v_max3_u32 v4, v48, v49, v4
  v_max3_u32 v4, v50, v51, v4
  v_max3_u32 v4, v52, v53, v4
  v_max3_u32 v4, v54, v55, v4
  v_cmp_eq_u32 vcc, -1, v4
  s_nop 4
  s_cbranch_vccnz kt_tail_kernel_fx22
kt_tail_kernel_fx22r:
  s_barrier
  v_mfma_f32_16x16x32_bf16 v[176:179], v[216:219], v[136:139], v[176:179]
  ds_read_b128 v[196:199], v11 offset:46080
  v_mfma_f32_16x16x32_bf16 v[180:183], v[220:223], v[136:139], v[180:183]
  ds_read_b128 v[200:203], v11 offset:47104
  v_mfma_f32_16x16x32_bf16 v[184:187], v[224:227], v[136:139], v[184:187]
  ds_read_b128 v[204:207], v11 offset:48128
  buffer_load_dwordx4 v[88:91], v2, s[28:31], s10 offen offset:2048 sc1
  v_mfma_f32_16x16x32_bf16 v[188:191], v[228:231], v[136:139], v[188:191]
  ds_read_b128 v[208:211], v11 offset:49152
  v_mfma_f32_16x16x32_bf16 v[192:195], v[232:235], v[136:139], v[192:195]
  ds_read_b128 v[212:215], v14 offset:46080
  s_add_u32 m0, s17, 49152
  s_add_u32 s11, s11, 4096
  buffer_load_dwordx4 v2, s[32:35], s11 offen lds
  s_waitcnt lgkmcnt(5)
  v_mfma_f32_16x16x32_bf16 v[176:179], v[236:239], v[140:143], v[176:179]
  ds_read_b128 v[216:219], v11 offset:50688
  v_mfma_f32_16x16x32_bf16 v[180:183], v[240:243], v[140:143], v[180:183]
  ds_read_b128 v[220:223], v11 offset:51712
  v_mfma_f32_16x16x32_bf16 v[184:187], v[244:247], v[140:143], v[184:187]
  ds_read_b128 v[224:227], v11 offset:52736
  buffer_load_dwordx4 v[92:95], v2, s[28:31], s10 offen offset:3072 sc1
  s_add_u32 s10, s10, 4096
  v_mfma_f32_16x16x32_bf16 v[188:191], v[248:251], v[140:143], v[188:191]
  ds_read_b128 v[228:231], v11 offset:53760
  v_mfma_f32_16x16x32_bf16 v[192:195], v[252:255], v[140:143], v[192:195]
  ds_read_b128 v[232:235], v14 offset:50688
  s_add_u32 m0, s17, 53248
  s_add_u32 s11, s11, 4096
  buffer_load_dwordx4 v2, s[32:35], s11 offen lds
  s_waitcnt lgkmcnt(5)
  v_mfma_f32_16x16x32_bf16 v[176:179], v[196:199], v[48:51], v[176:179]
  ds_read_b128 v[236:239], v11 offset:55296
  v_mfma_f32_16x16x32_bf16 v[180:183], v[200:203], v[48:51], v[180:183]
  ds_read_b128 v[240:243], v11 offset:56320
  v_mfma_f32_16x16x32_bf16 v[184:187], v[204:207], v[48:51], v[184:187]
  ds_read_b128 v[244:247], v11 offset:57344
  buffer_load_dwordx4 v[96:99], v2, s[28:31], s10 offen offset:0 sc1
  v_mfma_f32_16x16x32_bf16 v[188:191], v[208:211], v[48:51], v[188:191]
  ds_read_b128 v[248:251], v11 offset:58368
  v_mfma_f32_16x16x32_bf16 v[192:195], v[212:215], v[48:51], v[192:195]
  ds_read_b128 v[252:255], v14 offset:55296
  s_add_u32 m0, s17, 57344
  s_add_u32 s11, s11, 4096
  buffer_load_dwordx4 v2, s[32:35], s11 offen lds
  s_waitcnt lgkmcnt(5)
  v_mfma_f32_16x16x32_bf16 v[176:179], v[216:219], v[52:55], v[176:179]
  ds_read_b128 v[196:199], v11 offset:59904
  v_mfma_f32_16x16x32_bf16 v[180:183], v[220:223], v[52:55], v[180:183]
  ds_read_b128 v[200:203], v11 offset:60928
  v_mfma_f32_16x16x32_bf16 v[184:187], v[224:227], v[52:55], v[184:187]
  ds_read_b128 v[204:207], v11 offset:61952
  buffer_load_dwordx4 v[100:103], v2, s[28:31], s10 offen offset:1024 sc1
  v_mfma_f32_16x16x32_bf16 v[188:191], v[228:231], v[52:55], v[188:191]
  ds_read_b128 v[208:211], v11 offset:62976
  v_mfma_f32_16x16x32_bf16 v[192:195], v[232:235], v[52:55], v[192:195]
  ds_read_b128 v[212:215], v14 offset:59904
  s_add_u32 m0, s17, 61440
  s_add_u32 s11, s11, 4096
  buffer_load_dwordx4 v2, s[32:35], s11 offen lds
  s_waitcnt vmcnt(18) lgkmcnt(5)
  v_max_u32 v4, v56, v57
  v_max3_u32 v4, v58, v59, v4
  v_max3_u32 v4, v60, v61, v4
  v_max3_u32 v4, v62, v63, v4
  v_max3_u32 v4, v64, v65, v4
  v_max3_u32 v4, v66, v67, v4
  v_max3_u32 v4, v68, v69, v4
  v_max3_u32 v4, v70, v71, v4
  v_cmp_eq_u32 vcc, -1, v4
  s_nop 4
  s_cbranch_vccnz kt_tail_kernel_fx26
kt_tail_kernel_fx26r:
  s_barrier
  v_mfma_f32_16x16x32_bf16 v[176:179], v[236:239], v[56:59], v[176:179]
  ds_read_b128 v[216:219], v12 offset:0
  v_mfma_f32_16x16x32_bf16 v[180:183], v[240:243], v[56:59], v[180:183]
  ds_read_b128 v[220:223], v12 offset:1024
  v_mfma_f32_16x16x32_bf16 v[184:187], v[244:247], v[56:59], v[184:187]
  ds_read_b128 v[224:227], v12 offset:2048
  buffer_load_dwordx4 v[104:107], v2, s[28:31], s10 offen offset:2048 sc1
  v_mfma_f32_16x16x32_bf16 v[188:191], v[248:251], v[56:59], v[188:191]
  ds_read_b128 v[228:231], v12 offset:3072
  v_mfma_f32_16x16x32_bf16 v[192:195], v[252:255], v[56:59], v[192:195]
  ds_read_b128 v[232:235], v15 offset:0
  s_add_u32 m0, s17, 65536
  s_add_u32 s11, s11, 4096
  buffer_load_dwordx4 v2, s[32:35], s11 offen lds
  s_waitcnt lgkmcnt(5)
  v_mfma_f32_16x16x32_bf16 v[176:179], v[196:199], v[60:63], v[176:179]
  ds_read_b128 v[236:239], v12 offset:4608
  v_mfma_f32_16x16x32_bf16 v[180:183], v[200:203], v[60:63], v[180:183]
  ds_read_b128 v[240:243], v12 offset:5632
  v_mfma_f32_16x16x32_bf16 v[184:187], v[204:207], v[60:63], v[184:187]
  ds_read_b128 v[244:247], v12 offset:6656
  buffer_load_dwordx4 v[108:111], v2, s[28:31], s10 offen offset:3072 sc1
  s_add_u32 s10, s10, 4096
  v_mfma_f32_16x16x32_bf16 v[188:191], v[208:211], v[60:63], v[188:191]
  ds_read_b128 v[248:251], v12 offset:7680
  v_mfma_f32_16x16x32_bf16 v[192:195], v[212:215], v[60:63], v[192:195]
  ds_read_b128 v[252:255], v15 offset:4608
  s_add_u32 m0, s17, 69632
  s_add_u32 s11, s11, 4096
  buffer_load_dwordx4 v2, s[32:35], s11 offen lds
  s_waitcnt lgkmcnt(5)
  v_mfma_f32_16x16x32_bf16 v[176:179], v[216:219], v[64:67], v[176:179]
  ds_read_b128 v[196:199], v12 offset:9216
  v_mfma_f32_16x16x32_bf16 v[180:183], v[220:223], v[64:67], v[180:183]
  ds_read_b128 v[200:203], v12 offset:10240
  buffer_load_dwordx4 v[112:115], v2, s[28:31], s10 offen offset:0 sc1
  v_mfma_f32_16x16x32_bf16 v[184:187], v[224:227], v[64:67], v[184:187]
  ds_read_b128 v[204:207], v12 offset:11264
  v_mfma_f32_16x16x32_bf16 v[188:191], v[228:231], v[64:67], v[188:191]
  ds_read_b128 v[208:211], v12 offset:12288
  s_add_u32 m0, s17, 73728
  s_add_u32 s11, s11, 4096
  buffer_load_dwordx4 v2, s[32:35], s11 offen lds
  v_mfma_f32_16x16x32_bf16 v[192:195], v[232:235], v[64:67], v[192:195]
  ds_read_b128 v[212:215], v15 offset:9216
  s_add_u32 m0, s17, 77824
  s_add_u32 s11, s11, 4096
  buffer_load_dwordx4 v2, s[32:35], s11 offen lds
  s_waitcnt lgkmcnt(5)
  v_mfma_f32_16x16x32_bf16 v[176:179], v[236:239], v[68:71], v[176:179]
  ds_read_b128 v[216:219], v12 offset:13824
  v_mfma_f32_16x16x32_bf16 v[180:183], v[240:243], v[68:71], v[180:183]
  ds_read_b128 v[220:223], v12 offset:14848
  v_mfma_f32_16x16x32_bf16 v[184:187], v[244:247], v[68:71], v[184:187]
  ds_read_b128 v[224:227], v12 offset:15872
  buffer_load_dwordx4 v[116:119], v2, s[28:31], s10 offen offset:1024 sc1
  v_mfma_f32_16x16x32_bf16 v[188:191], v[248:251], v[68:71], v[188:191]
  ds_read_b128 v[228:231], v12 offset:16896
  v_mfma_f32_16x16x32_bf16 v[192:195], v[252:255], v[68:71], v[192:195]
  ds_read_b128 v[232:235], v15 offset:13824
  s_add_u32 m0, s17, 81920
  s_add_u32 s11, s11, 4096
  buffer_load_dwordx4 v2, s[32:35], s11 offen lds
  s_waitcnt vmcnt(18) lgkmcnt(5)
  v_max_u32 v4, v72, v73
  v_max3_u32 v4, v74, v75, v4
  v_max3_u32 v4, v76, v77, v4
  v_max3_u32 v4, v78, v79, v4
  v_max3_u32 v4, v80, v81, v4
  v_max3_u32 v4, v82, v83, v4
  v_max3_u32 v4, v84, v85, v4
  v_max3_u32 v4, v86, v87, v4
  v_cmp_eq_u32 vcc, -1, v4
  s_nop 4
  s_cbranch_vccnz kt_tail_kernel_fx30
kt_tail_kernel_fx30r:
  s_barrier
  v_mfma_f32_16x16x32_bf16 v[176:179], v[196:199], v[72:75], v[176:179]
  ds_read_b128 v[236:239], v10 offset:0
  v_mfma_f32_16x16x32_bf16 v[180:183], v[200:203], v[72:75], v[180:183]
  ds_read_b128 v[240:243], v10 offset:1024
  buffer_load_dwordx4 v[120:123], v2, s[28:31], s10 offen offset:2048 sc1
  v_mfma_f32_16x16x32_bf16 v[184:187], v[204:207], v[72:75], v[184:187]
  ds_read_b128 v[244:247], v10 offset:2048
  v_mfma_f32_16x16x32_bf16 v[188:191], v[208:211], v[72:75], v[188:191]
  ds_read_b128 v[248:251], v10 offset:3072
  s_add_u32 m0, s17, 86016
  s_add_u32 s11, s11, 4096
  buffer_load_dwordx4 v2, s[32:35], s11 offen lds
  v_mfma_f32_16x16x32_bf16 v[192:195], v[212:215], v[72:75], v[192:195]
  ds_read_b128 v[252:255], v13 offset:0
  s_mov_b32 m0, s16
  s_nop 0
  buffer_load_dwordx4 v2, s[36:39], s13 offen lds
  s_waitcnt lgkmcnt(5)
  v_mfma_f32_16x16x32_bf16 v[176:179], v[216:219], v[76:79], v[176:179]
  ds_read_b128 v[196:199], v10 offset:4608
  v_mfma_f32_16x16x32_bf16 v[180:183], v[220:223], v[76:79], v[180:183]
  ds_read_b128 v[200:203], v10 offset:5632
  buffer_load_dwordx4 v[124:127], v2, s[28:31], s10 offen offset:3072 sc1
  s_add_u32 s10, s10, 4096
  v_mfma_f32_16x16x32_bf16 v[184:187], v[224:227], v[76:79], v[184:187]
  ds_read_b128 v[204:207], v10 offset:6656
  v_mfma_f32_16x16x32_bf16 v[188:191], v[228:231], v[76:79], v[188:191]
  ds_read_b128 v[208:211], v10 offset:7680
  s_add_u32 m0, s17, 90112
  s_add_u32 s11, s11, 4096
  buffer_load_dwordx4 v2, s[32:35], s11 offen lds
  v_mfma_f32_16x16x32_bf16 v[192:195], v[232:235], v[76:79], v[192:195]
  ds_read_b128 v[212:215], v13 offset:4608
  s_waitcnt lgkmcnt(5)
  v_mfma_f32_16x16x32_bf16 v[176:179], v[236:239], v[80:83], v[176:179]
  ds_read_b128 v[216:219], v10 offset:9216
  v_mfma_f32_16x16x32_bf16 v[180:183], v[240:243], v[80:83], v[180:183]
  ds_read_b128 v[220:223], v10 offset:10240
  buffer_load_dwordx4 v[128:131], v2, s[28:31], s10 offen offset:0 sc1
  v_mfma_f32_16x16x32_bf16 v[184:187], v[244:247], v[80:83], v[184:187]
  ds_read_b128 v[224:227], v10 offset:11264
  v_mfma_f32_16x16x32_bf16 v[188:191], v[248:251], v[80:83], v[188:191]
  ds_read_b128 v[228:231], v10 offset:12288
  s_add_u32 m0, s17, 94208
  s_add_u32 s11, s11, 4096
  buffer_load_dwordx4 v2, s[32:35], s11 offen lds
  v_mfma_f32_16x16x32_bf16 v[192:195], v[252:255], v[80:83], v[192:195]
  ds_read_b128 v[232:235], v13 offset:9216
  s_waitcnt lgkmcnt(5)
  v_mfma_f32_16x16x32_bf16 v[176:179], v[196:199], v[84:87], v[176:179]
  ds_read_b128 v[236:239], v10 offset:13824
  v_mfma_f32_16x16x32_bf16 v[180:183], v[200:203], v[84:87], v[180:183]
  ds_read_b128 v[240:243], v10 offset:14848
  buffer_load_dwordx4 v[132:135], v2, s[28:31], s10 offen offset:1024 sc1
  v_mfma_f32_16x16x32_bf16 v[184:187], v[204:207], v[84:87], v[184:187]
  ds_read_b128 v[244:247], v10 offset:15872
  v_mfma_f32_16x16x32_bf16 v[188:191], v[208:211], v[84:87], v[188:191]
  ds_read_b128 v[248:251], v10 offset:16896
  s_add_u32 m0, s17, 98304
  s_add_u32 s11, s11, 4096
  buffer_load_dwordx4 v2, s[32:35], s11 offen lds
  v_mfma_f32_16x16x32_bf16 v[192:195], v[212:215], v[84:87], v[192:195]
  ds_read_b128 v[252:255], v13 offset:13824
  s_waitcnt vmcnt(19) lgkmcnt(5)
  v_max_u32 v4, v88, v89
  v_max3_u32 v4, v90, v91, v4
  v_max3_u32 v4, v92, v93, v4
  v_max3_u32 v4, v94, v95, v4
  v_max3_u32 v4, v96, v97, v4
  v_max3_u32 v4, v98, v99, v4
  v_max3_u32 v4, v100, v101, v4
  v_max3_u32 v4, v102, v103, v4
  v_cmp_eq_u32 vcc, -1, v4
  s_nop 4
  s_cbranch_vccnz kt_tail_kernel_fx34
kt_tail_kernel_fx34r:
  s_barrier
  v_mfma_f32_16x16x32_bf16 v[176:179], v[216:219], v[88:91], v[176:179]
  ds_read_b128 v[196:199], v10 offset:18432
  v_mfma_f32_16x16x32_bf16 v[180:183], v[220:223], v[88:91], v[180:183]
  ds_read_b128 v[200:203], v10 offset:19456
  buffer_load_dwordx4 v[136:139], v2, s[28:31], s10 offen offset:2048 sc1
  v_mfma_f32_16x16x32_bf16 v[184:187], v[224:227], v[88:91], v[184:187]
  ds_read_b128 v[204:207], v10 offset:20480
  v_mfma_f32_16x16x32_bf16 v[188:191], v[228:231], v[88:91], v[188:191]
  ds_read_b128 v[208:211], v10 offset:21504
  s_add_u32 m0, s17, 102400
  s_add_u32 s11, s11, 4096
  buffer_load_dwordx4 v2, s[32:35], s11 offen lds
  v_mfma_f32_16x16x32_bf16 v[192:195], v[232:235], v[88:91], v[192:195]
  ds_read_b128 v[212:215], v13 offset:18432
  s_waitcnt lgkmcnt(5)
  v_mfma_f32_16x16x32_bf16 v[176:179], v[236:239], v[92:95], v[176:179]
  ds_read_b128 v[216:219], v10 offset:23040
  v_mfma_f32_16x16x32_bf16 v[180:183], v[240:243], v[92:95], v[180:183]
  ds_read_b128 v[220:223], v10 offset:24064
  buffer_load_dwordx4 v[140:143], v2, s[28:31], s10 offen offset:3072 sc1
  s_add_u32 s10, s10, 4096
  v_mfma_f32_16x16x32_bf16 v[184:187], v[244:247], v[92:95], v[184:187]
  ds_read_b128 v[224:227], v10 offset:25088
  v_mfma_f32_16x16x32_bf16 v[188:191], v[248:251], v[92:95], v[188:191]
  ds_read_b128 v[228:231], v10 offset:26112
  s_add_u32 m0, s17, 106496
  s_add_u32 s11, s11, 4096
  buffer_load_dwordx4 v2, s[32:35], s11 offen lds
  v_mfma_f32_16x16x32_bf16 v[192:195], v[252:255], v[92:95], v[192:195]
  ds_read_b128 v[232:235], v13 offset:23040
  s_waitcnt lgkmcnt(5)
  v_mfma_f32_16x16x32_bf16 v[176:179], v[196:199], v[96:99], v[176:179]
  ds_read_b128 v[236:239], v10 offset:27648
  v_mfma_f32_16x16x32_bf16 v[180:183], v[200:203], v[96:99], v[180:183]
  ds_read_b128 v[240:243], v10 offset:28672
  buffer_load_dwordx4 v[48:51], v2, s[28:31], s10 offen offset:0 sc1
  v_mfma_f32_16x16x32_bf16 v[184:187], v[204:207], v[96:99], v[184:187]
  ds_read_b128 v[244:247], v10 offset:29696
  s_add_u32 m0, s17, 110592
  s_add_u32 s11, s11, 4096
  buffer_load_dwordx4 v2, s[32:35], s11 offen lds
  v_mfma_f32_16x16x32_bf16 v[188:191], v[208:211], v[96:99], v[188:191]
  ds_read_b128 v[248:251], v10 offset:30720
  s_add_u32 m0, s17, 114688
  s_add_u32 s11, s11, 4096
  buffer_load_dwordx4 v2, s[32:35], s11 offen lds
  v_mfma_f32_16x16x32_bf16 v[192:195], v[212:215], v[96:99], v[192:195]
  ds_read_b128 v[252:255], v13 offset:27648
  s_waitcnt lgkmcnt(5)
  v_mfma_f32_16x16x32_bf16 v[176:179], v[216:219], v[100:103], v[176:179]
  ds_read_b128 v[196:199], v10 offset:32256
  v_mfma_f32_16x16x32_bf16 v[180:183], v[220:223], v[100:103], v[180:183]
  ds_read_b128 v[200:203], v10 offset:33280
  buffer_load_dwordx4 v[52:55], v2, s[28:31], s10 offen offset:1024 sc1
  v_mfma_f32_16x16x32_bf16 v[184:187], v[224:227], v[100:103], v[184:187]
  ds_read_b128 v[204:207], v10 offset:34304
  v_mfma_f32_16x16x32_bf16 v[188:191], v[228:231], v[100:103], v[188:191]
  ds_read_b128 v[208:211], v10 offset:35328
  s_add_u32 m0, s17, 118784
  s_add_u32 s11, s11, 4096
  buffer_load_dwordx4 v2, s[32:35], s11 offen lds
  v_mfma_f32_16x16x32_bf16 v[192:195], v[232:235], v[100:103], v[192:195]
  ds_read_b128 v[212:215], v13 offset:32256
  s_waitcnt vmcnt(19) lgkmcnt(5)
  v_max_u32 v4, v104, v105
  v_max3_u32 v4, v106, v107, v4
  v_max3_u32 v4, v108, v109, v4
  v_max3_u32 v4, v110, v111, v4
  v_max3_u32 v4, v112, v113, v4
  v_max3_u32 v4, v114, v115, v4
  v_max3_u32 v4, v116, v117, v4
  v_max3_u32 v4, v118, v119, v4
  v_cmp_eq_u32 vcc, -1, v4
  s_nop 4
  s_cbranch_vccnz kt_tail_kernel_fx38
kt_tail_kernel_fx38r:
  s_barrier
  v_mfma_f32_16x16x32_bf16 v[176:179], v[236:239], v[104:107], v[176:179]
  ds_read_b128 v[216:219], v10 offset:36864
  v_mfma_f32_16x16x32_bf16 v[180:183], v[240:243], v[104:107], v[180:183]
  ds_read_b128 v[220:223], v10 offset:37888
  buffer_load_dwordx4 v[56:59], v2, s[28:31], s10 offen offset:2048 sc1
  v_mfma_f32_16x16x32_bf16 v[184:187], v[244:247], v[104:107], v[184:187]
  ds_read_b128 v[224:227], v10 offset:38912
  v_mfma_f32_16x16x32_bf16 v[188:191], v[248:251], v[104:107], v[188:191]
  ds_read_b128 v[228:231], v10 offset:39936
  s_add_u32 m0, s17, 122880
  s_add_u32 s11, s11, 4096
  buffer_load_dwordx4 v2, s[32:35], s11 offen lds
  v_mfma_f32_16x16x32_bf16 v[192:195], v[252:255], v[104:107], v[192:195]
  ds_read_b128 v[232:235], v13 offset:36864
  s_waitcnt lgkmcnt(5)
  v_mfma_f32_16x16x32_bf16 v[176:179], v[196:199], v[108:111], v[176:179]
  ds_read_b128 v[236:239], v10 offset:41472
  v_mfma_f32_16x16x32_bf16 v[180:183], v[200:203], v[108:111], v[180:183]
  ds_read_b128 v[240:243], v10 offset:42496
  buffer_load_dwordx4 v[60:63], v2, s[28:31], s10 offen offset:3072 sc1
  s_add_u32 s10, s10, 4096
  v_mfma_f32_16x16x32_bf16 v[184:187], v[204:207], v[108:111], v[184:187]
  ds_read_b128 v[244:247], v10 offset:43520
  v_mfma_f32_16x16x32_bf16 v[188:191], v[208:211], v[108:111], v[188:191]
  ds_read_b128 v[248:251], v10 offset:44544
  s_add_u32 m0, s17, 126976
  s_add_u32 s11, s11, 4096
  buffer_load_dwordx4 v2, s[32:35], s11 offen lds
  v_mfma_f32_16x16x32_bf16 v[192:195], v[212:215], v[108:111], v[192:195]
  ds_read_b128 v[252:255], v13 offset:41472
  s_waitcnt lgkmcnt(5)
  v_mfma_f32_16x16x32_bf16 v[176:179], v[216:219], v[112:115], v[176:179]
  ds_read_b128 v[196:199], v10 offset:46080
  v_mfma_f32_16x16x32_bf16 v[180:183], v[220:223], v[112:115], v[180:183]
  ds_read_b128 v[200:203], v10 offset:47104
  buffer_load_dwordx4 v[64:67], v2, s[28:31], s10 offen offset:0 sc1
  v_mfma_f32_16x16x32_bf16 v[184:187], v[224:227], v[112:115], v[184:187]
  ds_read_b128 v[204:207], v10 offset:48128
  v_mfma_f32_16x16x32_bf16 v[188:191], v[228:231], v[112:115], v[188:191]
  ds_read_b128 v[208:211], v10 offset:49152
  s_add_u32 m0, s17, 131072
  s_add_u32 s11, s11, 4096
  buffer_load_dwordx4 v2, s[32:35], s11 offen lds
  v_mfma_f32_16x16x32_bf16 v[192:195], v[232:235], v[112:115], v[192:195]
  ds_read_b128 v[212:215], v13 offset:46080
  s_waitcnt lgkmcnt(5)
  v_mfma_f32_16x16x32_bf16 v[176:179], v[236:239], v[116:119], v[176:179]
  ds_read_b128 v[216:219], v10 offset:50688
  v_mfma_f32_16x16x32_bf16 v[180:183], v[240:243], v[116:119], v[180:183]
  ds_read_b128 v[220:223], v10 offset:51712
  buffer_load_dwordx4 v[68:71], v2, s[28:31], s10 offen offset:1024 sc1
  v_mfma_f32_16x16x32_bf16 v[184:187], v[244:247], v[116:119], v[184:187]
  ds_read_b128 v[224:227], v10 offset:52736
  v_mfma_f32_16x16x32_bf16 v[188:191], v[248:251], v[116:119], v[188:191]
  ds_read_b128 v[228:231], v10 offset:53760
  s_add_u32 m0, s17, 135168
  s_add_u32 s11, s11, 4096
  buffer_load_dwordx4 v2, s[32:35], s11 offen lds
  v_mfma_f32_16x16x32_bf16 v[192:195], v[252:255], v[116:119], v[192:195]
  ds_read_b128 v[232:235], v13 offset:50688
  s_waitcnt vmcnt(18) lgkmcnt(5)
  v_max_u32 v4, v120, v121
  v_max3_u32 v4, v122, v123, v4
  v_max3_u32 v4, v124, v125, v4
  v_max3_u32 v4, v126, v127, v4
  v_max3_u32 v4, v128, v129, v4
  v_max3_u32 v4, v130, v131, v4
  v_max3_u32 v4, v132, v133, v4
  v_max3_u32 v4, v134, v135, v4
  v_cmp_eq_u32 vcc, -1, v4
  s_nop 4
  s_cbranch_vccnz kt_tail_kernel_fx42
kt_tail_kernel_fx42r:
  s_barrier
  v_mfma_f32_16x16x32_bf16 v[176:179], v[196:199], v[120:123], v[176:179]
  ds_read_b128 v[236:239], v10 offset:55296
  v_mfma_f32_16x16x32_bf16 v[180:183], v[200:203], v[120:123], v[180:183]
  ds_read_b128 v[240:243], v10 offset:56320
  buffer_load_dwordx4 v[72:75], v2, s[28:31], s10 offen offset:2048 sc1
  v_mfma_f32_16x16x32_bf16 v[184:187], v[204:207], v[120:123], v[184:187]
  ds_read_b128 v[244:247], v10 offset:57344
  v_mfma_f32_16x16x32_bf16 v[188:191], v[208:211], v[120:123], v[188:191]
  ds_read_b128 v[248:251], v10 offset:58368
  s_add_u32 m0, s17, 139264
  s_add_u32 s11, s11, 4096
  buffer_load_dwordx4 v2, s[32:35], s11 offen lds
  v_mfma_f32_16x16x32_bf16 v[192:195], v[212:215], v[120:123], v[192:195]
  ds_read_b128 v[252:255], v13 offset:55296
  s_waitcnt lgkmcnt(5)
  v_mfma_f32_16x16x32_bf16 v[176:179], v[216:219], v[124:127], v[176:179]
  ds_read_b128 v[196:199], v10 offset:59904
  v_mfma_f32_16x16x32_bf16 v[180:183], v[220:223], v[124:127], v[180:183]
  ds_read_b128 v[200:203], v10 offset:60928
  buffer_load_dwordx4 v[76:79], v2, s[28:31], s10 offen offset:3072 sc1
  s_add_u32 s10, s10, 4096
  v_mfma_f32_16x16x32_bf16 v[184:187], v[224:227], v[124:127], v[184:187]
  ds_read_b128 v[204:207], v10 offset:61952
  v_mfma_f32_16x16x32_bf16 v[188:191], v[228:231], v[124:127], v[188:191]
  ds_read_b128 v[208:211], v10 offset:62976
  s_add_u32 m0, s17, 143360
  s_add_u32 s11, s11, 4096
  buffer_load_dwordx4 v2, s[32:35], s11 offen lds
  v_mfma_f32_16x16x32_bf16 v[192:195], v[232:235], v[124:127], v[192:195]
  ds_read_b128 v[212:215], v13 offset:59904
  s_waitcnt lgkmcnt(5)
  v_mfma_f32_16x16x32_bf16 v[176:179], v[236:239], v[128:131], v[176:179]
  ds_read_b128 v[216:219], v11 offset:0
  v_mfma_f32_16x16x32_bf16 v[180:183], v[240:243], v[128:131], v[180:183]
  ds_read_b128 v[220:223], v11 offset:1024
  buffer_load_dwordx4 v[80:83], v2, s[28:31], s10 offen offset:0 sc1
  v_mfma_f32_16x16x32_bf16 v[184:187], v[244:247], v[128:131], v[184:187]
  ds_read_b128 v[224:227], v11 offset:2048
  s_add_u32 m0, s17, 0
  s_add_u32 s11, s11, 4096
  buffer_load_dwordx4 v2, s[32:35], s11 offen lds
  v_mfma_f32_16x16x32_bf16 v[188:191], v[248:251], v[128:131], v[188:191]
  ds_read_b128 v[228:231], v11 offset:3072
  s_add_u32 m0, s17, 4096
  s_add_u32 s11, s11, 4096
  buffer_load_dwordx4 v2, s[32:35], s11 offen lds
  v_mfma_f32_16x16x32_bf16 v[192:195], v[252:255], v[128:131], v[192:195]
  ds_read_b128 v[232:235], v14 offset:0
  s_waitcnt lgkmcnt(5)
  v_mfma_f32_16x16x32_bf16 v[176:179], v[196:199], v[132:135], v[176:179]
  ds_read_b128 v[236:239], v11 offset:4608
  v_mfma_f32_16x16x32_bf16 v[180:183], v[200:203], v[132:135], v[180:183]
  ds_read_b128 v[240:243], v11 offset:5632
  buffer_load_dwordx4 v[84:87], v2, s[28:31], s10 offen offset:1024 sc1
  v_mfma_f32_16x16x32_bf16 v[184:187], v[204:207], v[132:135], v[184:187]
  ds_read_b128 v[244:247], v11 offset:6656
  v_mfma_f32_16x16x32_bf16 v[188:191], v[208:211], v[132:135], v[188:191]
  ds_read_b128 v[248:251], v11 offset:7680
  s_add_u32 m0, s17, 8192
  s_add_u32 s11, s11, 4096
  buffer_load_dwordx4 v2, s[32:35], s11 offen lds
  v_mfma_f32_16x16x32_bf16 v[192:195], v[212:215], v[132:135], v[192:195]
  ds_read_b128 v[252:255], v14 offset:4608
  s_waitcnt vmcnt(18) lgkmcnt(5)
  v_max_u32 v4, v136, v137
  v_max3_u32 v4, v138, v139, v4
  v_max3_u32 v4, v140, v141, v4
  v_max3_u32 v4, v142, v143, v4
  v_max3_u32 v4, v48, v49, v4
  v_max3_u32 v4, v50, v51, v4
  v_max3_u32 v4, v52, v53, v4
  v_max3_u32 v4, v54, v55, v4
  v_cmp_eq_u32 vcc, -1, v4
  s_nop 4
  s_cbranch_vccnz kt_tail_kernel_fx46
kt_tail_kernel_fx46r:
  s_barrier
  v_mfma_f32_16x16x32_bf16 v[176:179], v[216:219], v[136:139], v[176:179]
  ds_read_b128 v[196:199], v11 offset:9216
  v_mfma_f32_16x16x32_bf16 v[180:183], v[220:223], v[136:139], v[180:183]
  ds_read_b128 v[200:203], v11 offset:10240
  buffer_load_dwordx4 v[88:91], v2, s[28:31], s10 offen offset:2048 sc1
  v_mfma_f32_16x16x32_bf16 v[184:187], v[224:227], v[136:139], v[184:187]
  ds_read_b128 v[204:207], v11 offset:11264
  v_mfma_f32_16x16x32_bf16 v[188:191], v[228:231], v[136:139], v[188:191]
  ds_read_b128 v[208:211], v11 offset:12288
  s_add_u32 m0, s17, 12288
  s_add_u32 s11, s11, 4096
  buffer_load_dwordx4 v2, s[32:35], s11 offen lds
  v_mfma_f32_16x16x32_bf16 v[192:195], v[232:235], v[136:139], v[192:195]
  ds_read_b128 v[212:215], v14 offset:9216
  s_waitcnt lgkmcnt(5)
  v_mfma_f32_16x16x32_bf16 v[176:179], v[236:239], v[140:143], v[176:179]
  ds_read_b128 v[216:219], v11 offset:13824
  v_mfma_f32_16x16x32_bf16 v[180:183], v[240:243], v[140:143], v[180:183]
  ds_read_b128 v[220:223], v11 offset:14848
  buffer_load_dwordx4 v[92:95], v2, s[28:31], s10 offen offset:3072 sc1
  s_add_u32 s10, s10, 4096
  v_mfma_f32_16x16x32_bf16 v[184:187], v[244:247], v[140:143], v[184:187]
  ds_read_b128 v[224:227], v11 offset:15872
  v_mfma_f32_16x16x32_bf16 v[188:191], v[248:251], v[140:143], v[188:191]
  ds_read_b128 v[228:231], v11 offset:16896
  s_add_u32 m0, s17, 16384
  s_add_u32 s11, s11, 4096
  buffer_load_dwordx4 v2, s[32:35], s11 offen lds
  v_mfma_f32_16x16x32_bf16 v[192:195], v[252:255], v[140:143], v[192:195]
  ds_read_b128 v[232:235], v14 offset:13824
  s_waitcnt lgkmcnt(5)
  v_mfma_f32_16x16x32_bf16 v[176:179], v[196:199], v[48:51], v[176:179]
  ds_read_b128 v[236:239], v11 offset:18432
  v_mfma_f32_16x16x32_bf16 v[180:183], v[200:203], v[48:51], v[180:183]
  ds_read_b128 v[240:243], v11 offset:19456
  buffer_load_dwordx4 v[96:99], v2, s[28:31], s10 offen offset:0 sc1
  v_mfma_f32_16x16x32_bf16 v[184:187], v[204:207], v[48:51], v[184:187]
  ds_read_b128 v[244:247], v11 offset:20480
  v_mfma_f32_16x16x32_bf16 v[188:191], v[208:211], v[48:51], v[188:191]
  ds_read_b128 v[248:251], v11 offset:21504
  s_add_u32 m0, s17, 20480
  s_add_u32 s11, s11, 4096
  buffer_load_dwordx4 v2, s[32:35], s11 offen lds
  v_mfma_f32_16x16x32_bf16 v[192:195], v[212:215], v[48:51], v[192:195]
  ds_read_b128 v[252:255], v14 offset:18432
  s_waitcnt lgkmcnt(5)
  v_mfma_f32_16x16x32_bf16 v[176:179], v[216:219], v[52:55], v[176:179]
  ds_read_b128 v[196:199], v11 offset:23040
  v_mfma_f32_16x16x32_bf16 v[180:183], v[220:223], v[52:55], v[180:183]
  ds_read_b128 v[200:203], v11 offset:24064
  buffer_load_dwordx4 v[100:103], v2, s[28:31], s10 offen offset:1024 sc1
  v_mfma_f32_16x16x32_bf16 v[184:187], v[224:227], v[52:55], v[184:187]
  ds_read_b128 v[204:207], v11 offset:25088
  v_mfma_f32_16x16x32_bf16 v[188:191], v[228:231], v[52:55], v[188:191]
  ds_read_b128 v[208:211], v11 offset:26112
  s_add_u32 m0, s17, 24576
  s_add_u32 s11, s11, 4096
  buffer_load_dwordx4 v2, s[32:35], s11 offen lds
  v_mfma_f32_16x16x32_bf16 v[192:195], v[232:235], v[52:55], v[192:195]
  ds_read_b128 v[212:215], v14 offset:23040
  s_waitcnt vmcnt(18) lgkmcnt(5)
  v_max_u32 v4, v56, v57
  v_max3_u32 v4, v58, v59, v4
  v_max3_u32 v4, v60, v61, v4
  v_max3_u32 v4, v62, v63, v4
  v_max3_u32 v4, v64, v65, v4
  v_max3_u32 v4, v66, v67, v4
  v_max3_u32 v4, v68, v69, v4
  v_max3_u32 v4, v70, v71, v4
  v_cmp_eq_u32 vcc, -1, v4
  s_nop 4
  s_cbranch_vccnz kt_tail_kernel_fx50
kt_tail_kernel_fx50r:
  s_barrier
  v_mfma_f32_16x16x32_bf16 v[176:179], v[236:239], v[56:59], v[176:179]
  ds_read_b128 v[216:219], v11 offset:27648
  v_mfma_f32_16x16x32_bf16 v[180:183], v[240:243], v[56:59], v[180:183]
  ds_read_b128 v[220:223], v11 offset:28672
  buffer_load_dwordx4 v[104:107], v2, s[28:31], s10 offen offset:2048 sc1
  v_mfma_f32_16x16x32_bf16 v[184:187], v[244:247], v[56:59], v[184:187]
  ds_read_b128 v[224:227], v11 offset:29696
  v_mfma_f32_16x16x32_bf16 v[188:191], v[248:251], v[56:59], v[188:191]
  ds_read_b128 v[228:231], v11 offset:30720
  s_add_u32 m0, s17, 28672
  s_add_u32 s11, s11, 4096
  buffer_load_dwordx4 v2, s[32:35], s11 offen lds
  v_mfma_f32_16x16x32_bf16 v[192:195], v[252:255], v[56:59], v[192:195]
  ds_read_b128 v[232:235], v14 offset:27648
  s_waitcnt lgkmcnt(5)
  v_mfma_f32_16x16x32_bf16 v[176:179], v[196:199], v[60:63], v[176:179]
  ds_read_b128 v[236:239], v11 offset:32256
  v_mfma_f32_16x16x32_bf16 v[180:183], v[200:203], v[60:63], v[180:183]
  ds_read_b128 v[240:243], v11 offset:33280
  buffer_load_dwordx4 v[108:111], v2, s[28:31], s10 offen offset:3072 sc1
  s_add_u32 s10, s10, 4096
  v_mfma_f32_16x16x32_bf16 v[184:187], v[204:207], v[60:63], v[184:187]
  ds_read_b128 v[244:247], v11 offset:34304
  v_mfma_f32_16x16x32_bf16 v[188:191], v[208:211], v[60:63], v[188:191]
  ds_read_b128 v[248:251], v11 offset:35328
  s_add_u32 m0, s17, 32768
  s_add_u32 s11, s11, 4096
  buffer_load_dwordx4 v2, s[32:35], s11 offen lds
  v_mfma_f32_16x16x32_bf16 v[192:195], v[212:215], v[60:63], v[192:195]
  ds_read_b128 v[252:255], v14 offset:32256
  s_waitcnt lgkmcnt(5)
  v_mfma_f32_16x16x32_bf16 v[176:179], v[216:219], v[64:67], v[176:179]
  ds_read_b128 v[196:199], v11 offset:36864
  v_mfma_f32_16x16x32_bf16 v[180:183], v[220:223], v[64:67], v[180:183]
  ds_read_b128 v[200:203], v11 offset:37888
  v_mfma_f32_16x16x32_bf16 v[184:187], v[224:227], v[64:67], v[184:187]
  ds_read_b128 v[204:207], v11 offset:38912
  buffer_load_dwordx4 v[112:115], v2, s[28:31], s10 offen offset:0 sc1
  v_mfma_f32_16x16x32_bf16 v[188:191], v[228:231], v[64:67], v[188:191]
  ds_read_b128 v[208:211], v11 offset:39936
  v_mfma_f32_16x16x32_bf16 v[192:195], v[232:235], v[64:67], v[192:195]
  ds_read_b128 v[212:215], v14 offset:36864
  s_waitcnt lgkmcnt(5)
  v_mfma_f32_16x16x32_bf16 v[176:179], v[236:239], v[68:71], v[176:179]
  ds_read_b128 v[216:219], v11 offset:41472
  v_mfma_f32_16x16x32_bf16 v[180:183], v[240:243], v[68:71], v[180:183]
  ds_read_b128 v[220:223], v11 offset:42496
  v_mfma_f32_16x16x32_bf16 v[184:187], v[244:247], v[68:71], v[184:187]
  ds_read_b128 v[224:227], v11 offset:43520
  buffer_load_dwordx4 v[116:119], v2, s[28:31], s10 offen offset:1024 sc1
  v_mfma_f32_16x16x32_bf16 v[188:191], v[248:251], v[68:71], v[188:191]
  ds_read_b128 v[228:231], v11 offset:44544
  v_mfma_f32_16x16x32_bf16 v[192:195], v[252:255], v[68:71], v[192:195]
  ds_read_b128 v[232:235], v14 offset:41472
  s_waitcnt vmcnt(15) lgkmcnt(5)
  v_max_u32 v4, v72, v73
  v_max3_u32 v4, v74, v75, v4
  v_max3_u32 v4, v76, v77, v4
  v_max3_u32 v4, v78, v79, v4
  v_max3_u32 v4, v80, v81, v4
  v_max3_u32 v4, v82, v83, v4
  v_max3_u32 v4, v84, v85, v4
  v_max3_u32 v4, v86, v87, v4
  v_cmp_eq_u32 vcc, -1, v4
  s_nop 4
  s_cbranch_vccnz kt_tail_kernel_fx54
kt_tail_kernel_fx54r:
  s_barrier
  v_mfma_f32_16x16x32_bf16 v[176:179], v[196:199], v[72:75], v[176:179]
  ds_read_b128 v[236:239], v11 offset:46080
  v_mfma_f32_16x16x32_bf16 v[180:183], v[200:203], v[72:75], v[180:183]
  ds_read_b128 v[240:243], v11 offset:47104
  v_mfma_f32_16x16x32_bf16 v[184:187], v[204:207], v[72:75], v[184:187]
  ds_read_b128 v[244:247], v11 offset:48128
  buffer_load_dwordx4 v[120:123], v2, s[28:31], s10 offen offset:2048 sc1
  v_mfma_f32_16x16x32_bf16 v[188:191], v[208:211], v[72:75], v[188:191]
  ds_read_b128 v[248:251], v11 offset:49152
  v_mfma_f32_16x16x32_bf16 v[192:195], v[212:215], v[72:75], v[192:195]
  ds_read_b128 v[252:255], v14 offset:46080
  s_waitcnt lgkmcnt(5)
  v_mfma_f32_16x16x32_bf16 v[176:179], v[216:219], v[76:79], v[176:179]
  ds_read_b128 v[196:199], v11 offset:50688
  v_mfma_f32_16x16x32_bf16 v[180:183], v[220:223], v[76:79], v[180:183]
  ds_read_b128 v[200:203], v11 offset:51712
  v_mfma_f32_16x16x32_bf16 v[184:187], v[224:227], v[76:79], v[184:187]
  ds_read_b128 v[204:207], v11 offset:52736
  buffer_load_dwordx4 v[124:127], v2, s[28:31], s10 offen offset:3072 sc1
  s_add_u32 s10, s10, 4096
  v_mfma_f32_16x16x32_bf16 v[188:191], v[228:231], v[76:79], v[188:191]
  ds_read_b128 v[208:211], v11 offset:53760
  v_mfma_f32_16x16x32_bf16 v[192:195], v[232:235], v[76:79], v[192:195]
  ds_read_b128 v[212:215], v14 offset:50688
  ds_read_b128 v[28:31], v7 offset:0
  ds_read_b128 v[32:35], v7 offset:64
  ds_read_b128 v[36:39], v7 offset:128
  ds_read_b128 v[40:43], v7 offset:192
  ds_read_b128 v[44:47], v7 offset:256
  s_waitcnt lgkmcnt(10)
  v_mfma_f32_16x16x32_bf16 v[176:179], v[236:239], v[80:83], v[176:179]
  ds_read_b128 v[216:219], v11 offset:55296
  v_mfma_f32_16x16x32_bf16 v[180:183], v[240:243], v[80:83], v[180:183]
  ds_read_b128 v[220:223], v11 offset:56320
  v_mfma_f32_16x16x32_bf16 v[184:187], v[244:247], v[80:83], v[184:187]
  ds_read_b128 v[224:227], v11 offset:57344
  v_mfma_f32_16x16x32_bf16 v[188:191], v[248:251], v[80:83], v[188:191]
  ds_read_b128 v[228:231], v11 offset:58368
  v_mfma_f32_16x16x32_bf16 v[192:195], v[252:255], v[80:83], v[192:195]
  ds_read_b128 v[232:235], v14 offset:55296
  buffer_load_dwordx4 v[128:131], v2, s[28:31], s10 offen offset:0 sc1
  s_waitcnt lgkmcnt(10)
  v_mfma_f32_16x16x32_bf16 v[176:179], v[196:199], v[84:87], v[176:179]
  ds_read_b128 v[236:239], v11 offset:59904
  v_mfma_f32_16x16x32_bf16 v[180:183], v[200:203], v[84:87], v[180:183]
  ds_read_b128 v[240:243], v11 offset:60928
  v_mfma_f32_16x16x32_bf16 v[184:187], v[204:207], v[84:87], v[184:187]
  ds_read_b128 v[244:247], v11 offset:61952
  v_mfma_f32_16x16x32_bf16 v[188:191], v[208:211], v[84:87], v[188:191]
  ds_read_b128 v[248:251], v11 offset:62976
  v_mfma_f32_16x16x32_bf16 v[192:195], v[212:215], v[84:87], v[192:195]
  ds_read_b128 v[252:255], v14 offset:59904
  buffer_load_dwordx4 v[132:135], v2, s[28:31], s10 offen offset:1024 sc1
  s_waitcnt vmcnt(11) lgkmcnt(5)
  v_max_u32 v4, v88, v89
  v_max3_u32 v4, v90, v91, v4
  v_max3_u32 v4, v92, v93, v4
  v_max3_u32 v4, v94, v95, v4
  v_max3_u32 v4, v96, v97, v4
  v_max3_u32 v4, v98, v99, v4
  v_max3_u32 v4, v100, v101, v4
  v_max3_u32 v4, v102, v103, v4
  v_cmp_eq_u32 vcc, -1, v4
  s_nop 4
  s_cbranch_vccnz kt_tail_kernel_fx58
kt_tail_kernel_fx58r:
  s_barrier
  v_mfma_f32_16x16x32_bf16 v[176:179], v[216:219], v[88:91], v[176:179]
  ds_read_b128 v[196:199], v12 offset:0
  v_mfma_f32_16x16x32_bf16 v[180:183], v[220:223], v[88:91], v[180:183]
  ds_read_b128 v[200:203], v12 offset:1024
  v_mfma_f32_16x16x32_bf16 v[184:187], v[224:227], v[88:91], v[184:187]
  ds_read_b128 v[204:207], v12 offset:2048
  v_mfma_f32_16x16x32_bf16 v[188:191], v[228:231], v[88:91], v[188:191]
  ds_read_b128 v[208:211], v12 offset:3072
  v_mfma_f32_16x16x32_bf16 v[192:195], v[232:235], v[88:91], v[192:195]
  ds_read_b128 v[212:215], v15 offset:0
  buffer_load_dwordx4 v[136:139], v2, s[28:31], s10 offen offset:2048 sc1
  s_waitcnt lgkmcnt(5)
  v_mfma_f32_16x16x32_bf16 v[176:179], v[236:239], v[92:95], v[176:179]
  ds_read_b128 v[216:219], v12 offset:4608
  v_mfma_f32_16x16x32_bf16 v[180:183], v[240:243], v[92:95], v[180:183]
  ds_read_b128 v[220:223], v12 offset:5632
  v_mfma_f32_16x16x32_bf16 v[184:187], v[244:247], v[92:95], v[184:187]
  ds_read_b128 v[224:227], v12 offset:6656
  v_mfma_f32_16x16x32_bf16 v[188:191], v[248:251], v[92:95], v[188:191]
  ds_read_b128 v[228:231], v12 offset:7680
  v_mfma_f32_16x16x32_bf16 v[192:195], v[252:255], v[92:95], v[192:195]
  ds_read_b128 v[232:235], v15 offset:4608
  buffer_load_dwordx4 v[140:143], v2, s[28:31], s10 offen offset:3072 sc1
  s_add_u32 s10, s10, 4096
  s_waitcnt lgkmcnt(5)
  v_mfma_f32_16x16x32_bf16 v[176:179], v[196:199], v[96:99], v[176:179]
  ds_read_b128 v[236:239], v12 offset:9216
  v_mfma_f32_16x16x32_bf16 v[180:183], v[200:203], v[96:99], v[180:183]
  ds_read_b128 v[240:243], v12 offset:10240
  v_mfma_f32_16x16x32_bf16 v[184:187], v[204:207], v[96:99], v[184:187]
  ds_read_b128 v[244:247], v12 offset:11264
  v_mfma_f32_16x16x32_bf16 v[188:191], v[208:211], v[96:99], v[188:191]
  ds_read_b128 v[248:251], v12 offset:12288
  v_mfma_f32_16x16x32_bf16 v[192:195], v[212:215], v[96:99], v[192:195]
  ds_read_b128 v[252:255], v15 offset:9216
  s_waitcnt lgkmcnt(5)
  v_mfma_f32_16x16x32_bf16 v[176:179], v[216:219], v[100:103], v[176:179]
  ds_read_b128 v[196:199], v12 offset:13824
  v_mfma_f32_16x16x32_bf16 v[180:183], v[220:223], v[100:103], v[180:183]
  ds_read_b128 v[200:203], v12 offset:14848
  v_mfma_f32_16x16x32_bf16 v[184:187], v[224:227], v[100:103], v[184:187]
  ds_read_b128 v[204:207], v12 offset:15872
  v_mfma_f32_16x16x32_bf16 v[188:191], v[228:231], v[100:103], v[188:191]
  ds_read_b128 v[208:211], v12 offset:16896
  v_mfma_f32_16x16x32_bf16 v[192:195], v[232:235], v[100:103], v[192:195]
  ds_read_b128 v[212:215], v15 offset:13824
  s_waitcnt vmcnt(6) lgkmcnt(5)
  v_max_u32 v4, v104, v105
  v_max3_u32 v4, v106, v107, v4
  v_max3_u32 v4, v108, v109, v4
  v_max3_u32 v4, v110, v111, v4
  v_max3_u32 v4, v112, v113, v4
  v_max3_u32 v4, v114, v115, v4
  v_max3_u32 v4, v116, v117, v4
  v_max3_u32 v4, v118, v119, v4
  v_cmp_eq_u32 vcc, -1, v4
  s_nop 4
  s_cbranch_vccnz kt_tail_kernel_fx62
kt_tail_kernel_fx62r:
  s_barrier
  v_mfma_f32_16x16x32_bf16 v[176:179], v[236:239], v[104:107], v[176:179]
  ds_read_b128 v[216:219], v10 offset:0
  v_mfma_f32_16x16x32_bf16 v[180:183], v[240:243], v[104:107], v[180:183]
  ds_read_b128 v[220:223], v10 offset:1024
  v_mfma_f32_16x16x32_bf16 v[184:187], v[244:247], v[104:107], v[184:187]
  ds_read_b128 v[224:227], v10 offset:2048
  v_mfma_f32_16x16x32_bf16 v[188:191], v[248:251], v[104:107], v[188:191]
  ds_read_b128 v[228:231], v10 offset:3072
  v_mfma_f32_16x16x32_bf16 v[192:195], v[252:255], v[104:107], v[192:195]
  ds_read_b128 v[232:235], v13 offset:0
  s_waitcnt lgkmcnt(5)
  v_mfma_f32_16x16x32_bf16 v[176:179], v[196:199], v[108:111], v[176:179]
  ds_read_b128 v[236:239], v10 offset:4608
  v_mfma_f32_16x16x32_bf16 v[180:183], v[200:203], v[108:111], v[180:183]
  ds_read_b128 v[240:243], v10 offset:5632
  v_mfma_f32_16x16x32_bf16 v[184:187], v[204:207], v[108:111], v[184:187]
  ds_read_b128 v[244:247], v10 offset:6656
  v_mfma_f32_16x16x32_bf16 v[188:191], v[208:211], v[108:111], v[188:191]
  ds_read_b128 v[248:251], v10 offset:7680
  v_mfma_f32_16x16x32_bf16 v[192:195], v[212:215], v[108:111], v[192:195]
  ds_read_b128 v[252:255], v13 offset:4608
  s_waitcnt lgkmcnt(5)
  v_mfma_f32_16x16x32_bf16 v[176:179], v[216:219], v[112:115], v[176:179]
  ds_read_b128 v[196:199], v10 offset:9216
  v_mfma_f32_16x16x32_bf16 v[180:183], v[220:223], v[112:115], v[180:183]
  ds_read_b128 v[200:203], v10 offset:10240
  v_mfma_f32_16x16x32_bf16 v[184:187], v[224:227], v[112:115], v[184:187]
  ds_read_b128 v[204:207], v10 offset:11264
  v_mfma_f32_16x16x32_bf16 v[188:191], v[228:231], v[112:115], v[188:191]
  ds_read_b128 v[208:211], v10 offset:12288
  v_mfma_f32_16x16x32_bf16 v[192:195], v[232:235], v[112:115], v[192:195]
  ds_read_b128 v[212:215], v13 offset:9216
  s_waitcnt lgkmcnt(5)
  v_mfma_f32_16x16x32_bf16 v[176:179], v[236:239], v[116:119], v[176:179]
  ds_read_b128 v[216:219], v10 offset:13824
  v_mfma_f32_16x16x32_bf16 v[180:183], v[240:243], v[116:119], v[180:183]
  ds_read_b128 v[220:223], v10 offset:14848
  v_mfma_f32_16x16x32_bf16 v[184:187], v[244:247], v[116:119], v[184:187]
  ds_read_b128 v[224:227], v10 offset:15872
  v_mfma_f32_16x16x32_bf16 v[188:191], v[248:251], v[116:119], v[188:191]
  ds_read_b128 v[228:231], v10 offset:16896
  v_mfma_f32_16x16x32_bf16 v[192:195], v[252:255], v[116:119], v[192:195]
  ds_read_b128 v[232:235], v13 offset:13824
  s_waitcnt vmcnt(3) lgkmcnt(5)
  v_max_u32 v4, v120, v121
  v_max3_u32 v4, v122, v123, v4
  v_max3_u32 v4, v124, v125, v4
  v_max3_u32 v4, v126, v127, v4
  v_max3_u32 v4, v128, v129, v4
  v_max3_u32 v4, v130, v131, v4
  v_cmp_eq_u32 vcc, -1, v4
  s_nop 4
  s_cbranch_vccnz kt_tail_kernel_fx66
kt_tail_kernel_fx66r:
  s_barrier
  v_mfma_f32_16x16x32_bf16 v[176:179], v[196:199], v[120:123], v[176:179]
  ds_read_b128 v[236:239], v10 offset:18432
  v_mfma_f32_16x16x32_bf16 v[180:183], v[200:203], v[120:123], v[180:183]
  ds_read_b128 v[240:243], v10 offset:19456
  v_mfma_f32_16x16x32_bf16 v[184:187], v[204:207], v[120:123], v[184:187]
  ds_read_b128 v[244:247], v10 offset:20480
  v_mfma_f32_16x16x32_bf16 v[188:191], v[208:211], v[120:123], v[188:191]
  ds_read_b128 v[248:251], v10 offset:21504
  v_mfma_f32_16x16x32_bf16 v[192:195], v[212:215], v[120:123], v[192:195]
  ds_read_b128 v[252:255], v13 offset:18432
  s_waitcnt lgkmcnt(5)
  v_mfma_f32_16x16x32_bf16 v[176:179], v[216:219], v[124:127], v[176:179]
  ds_read_b128 v[196:199], v10 offset:23040
  v_mfma_f32_16x16x32_bf16 v[180:183], v[220:223], v[124:127], v[180:183]
  ds_read_b128 v[200:203], v10 offset:24064
  v_mfma_f32_16x16x32_bf16 v[184:187], v[224:227], v[124:127], v[184:187]
  ds_read_b128 v[204:207], v10 offset:25088
  v_mfma_f32_16x16x32_bf16 v[188:191], v[228:231], v[124:127], v[188:191]
  ds_read_b128 v[208:211], v10 offset:26112
  v_mfma_f32_16x16x32_bf16 v[192:195], v[232:235], v[124:127], v[192:195]
  ds_read_b128 v[212:215], v13 offset:23040
  s_waitcnt lgkmcnt(5)
  v_mfma_f32_16x16x32_bf16 v[176:179], v[236:239], v[128:131], v[176:179]
  ds_read_b128 v[216:219], v10 offset:27648
  v_mfma_f32_16x16x32_bf16 v[180:183], v[240:243], v[128:131], v[180:183]
  ds_read_b128 v[220:223], v10 offset:28672
  v_mfma_f32_16x16x32_bf16 v[184:187], v[244:247], v[128:131], v[184:187]
  ds_read_b128 v[224:227], v10 offset:29696
  v_mfma_f32_16x16x32_bf16 v[188:191], v[248:251], v[128:131], v[188:191]
  ds_read_b128 v[228:231], v10 offset:30720
  v_mfma_f32_16x16x32_bf16 v[192:195], v[252:255], v[128:131], v[192:195]
  ds_read_b128 v[232:235], v13 offset:27648
  s_waitcnt vmcnt(0) lgkmcnt(5)
  v_max_u32 v4, v132, v133
  v_max3_u32 v4, v134, v135, v4
  v_max3_u32 v4, v136, v137, v4
  v_max3_u32 v4, v138, v139, v4
  v_max3_u32 v4, v140, v141, v4
  v_max3_u32 v4, v142, v143, v4
  v_cmp_eq_u32 vcc, -1, v4
  s_nop 4
  s_cbranch_vccnz kt_tail_kernel_fx69
kt_tail_kernel_fx69r:
  s_barrier
  v_mfma_f32_16x16x32_bf16 v[176:179], v[196:199], v[132:135], v[176:179]
  ds_read_b128 v[236:239], v10 offset:32256
  v_mfma_f32_16x16x32_bf16 v[180:183], v[200:203], v[132:135], v[180:183]
  ds_read_b128 v[240:243], v10 offset:33280
  v_mfma_f32_16x16x32_bf16 v[184:187], v[204:207], v[132:135], v[184:187]
  ds_read_b128 v[244:247], v10 offset:34304
  v_mfma_f32_16x16x32_bf16 v[188:191], v[208:211], v[132:135], v[188:191]
  ds_read_b128 v[248:251], v10 offset:35328
  v_mfma_f32_16x16x32_bf16 v[192:195], v[212:215], v[132:135], v[192:195]
  ds_read_b128 v[252:255], v13 offset:32256
  s_waitcnt lgkmcnt(5)
  v_mfma_f32_16x16x32_bf16 v[176:179], v[216:219], v[136:139], v[176:179]
  v_mfma_f32_16x16x32_bf16 v[180:183], v[220:223], v[136:139], v[180:183]
  v_mfma_f32_16x16x32_bf16 v[184:187], v[224:227], v[136:139], v[184:187]
  v_mfma_f32_16x16x32_bf16 v[188:191], v[228:231], v[136:139], v[188:191]
  v_mfma_f32_16x16x32_bf16 v[192:195], v[232:235], v[136:139], v[192:195]
  s_waitcnt lgkmcnt(0)
  v_mfma_f32_16x16x32_bf16 v[176:179], v[236:239], v[140:143], v[176:179]
  v_mfma_f32_16x16x32_bf16 v[180:183], v[240:243], v[140:143], v[180:183]
  v_mfma_f32_16x16x32_bf16 v[184:187], v[244:247], v[140:143], v[184:187]
  v_mfma_f32_16x16x32_bf16 v[188:191], v[248:251], v[140:143], v[188:191]
  v_mfma_f32_16x16x32_bf16 v[192:195], v[252:255], v[140:143], v[192:195]
  s_nop 3
  v_pk_fma_f32 v[144:145], v[176:177], v[28:29], v[144:145]
  v_pk_fma_f32 v[146:147], v[178:179], v[30:31], v[146:147]
  v_pk_fma_f32 v[148:149], v[180:181], v[32:33], v[148:149]
  v_pk_fma_f32 v[150:151], v[182:183], v[34:35], v[150:151]
  v_pk_fma_f32 v[152:153], v[184:185], v[36:37], v[152:153]
  v_pk_fma_f32 v[154:155], v[186:187], v[38:39], v[154:155]
  v_pk_fma_f32 v[156:157], v[188:189], v[40:41], v[156:157]
  v_pk_fma_f32 v[158:159], v[190:191], v[42:43], v[158:159]
  v_pk_fma_f32 v[160:161], v[192:193], v[44:45], v[160:161]
  v_pk_fma_f32 v[162:163], v[194:195], v[46:47], v[162:163]
  v_cvt_pk_bf16_f32 v164, v144, v145
  v_cvt_pk_bf16_f32 v165, v146, v147
  v_cvt_pk_bf16_f32 v166, v148, v149
  v_cvt_pk_bf16_f32 v167, v150, v151
  v_cvt_pk_bf16_f32 v168, v152, v153
  v_cvt_pk_bf16_f32 v169, v154, v155
  v_cvt_pk_bf16_f32 v170, v156, v157
  v_cvt_pk_bf16_f32 v171, v158, v159
  v_cvt_pk_bf16_f32 v172, v160, v161
  v_cvt_pk_bf16_f32 v173, v162, v163
  v_permlane16_swap_b32 v164, v166
  v_permlane16_swap_b32 v165, v167
  v_permlane16_swap_b32 v168, v170
  v_permlane16_swap_b32 v169, v171
  buffer_store_dwordx4 v[164:167], v26, s[24:27], s22 offen
  buffer_store_dwordx4 v[168:171], v26, s[24:27], s22 offen offset:64
  s_mov_b32 exec_hi, 0
  buffer_store_dwordx2 v[172:173], v27, s[24:27], s22 offen offset:128
  s_endpgm
kt_tail_kernel_fx0:
  s_sleep 2
  s_sub_u32 s9, s9, 1
  s_cmp_eq_u32 s9, 0
  s_cbranch_scc1 kt_tail_kernel_fx0r
  s_add_u32 s19, s18, 0
  buffer_load_dwordx4 v[48:51], v2, s[28:31], s19 offen offset:0 sc1
  s_waitcnt vmcnt(0)
  v_max_u32 v4, v48, v49
  v_max3_u32 v4, v50, v51, v4
  v_cmp_eq_u32 vcc, -1, v4
  s_nop 4
  s_cbranch_vccnz kt_tail_kernel_fx0
  s_branch kt_tail_kernel_fx0r
kt_tail_kernel_fx1:
  s_sleep 2
  s_sub_u32 s9, s9, 1
  s_cmp_eq_u32 s9, 0
  s_cbranch_scc1 kt_tail_kernel_fx1r
  s_add_u32 s19, s18, 1024
  buffer_load_dwordx4 v[52:55], v2, s[28:31], s19 offen offset:0 sc1
  buffer_load_dwordx4 v[56:59], v2, s[28:31], s19 offen offset:1024 sc1
  s_waitcnt vmcnt(0)
  v_max_u32 v4, v52, v53
  v_max3_u32 v4, v54, v55, v4
  v_max3_u32 v4, v56, v57, v4
  v_max3_u32 v4, v58, v59, v4
  v_cmp_eq_u32 vcc, -1, v4
  s_nop 4
  s_cbranch_vccnz kt_tail_kernel_fx1
  s_branch kt_tail_kernel_fx1r
kt_tail_kernel_fx3:
  s_sleep 2
  s_sub_u32 s9, s9, 1
  s_cmp_eq_u32 s9, 0
  s_cbranch_scc1 kt_tail_kernel_fx3r
  s_add_u32 s19, s18, 3072
  buffer_load_dwordx4 v[60:63], v2, s[28:31], s19 offen offset:0 sc1
  buffer_load_dwordx4 v[64:67], v2, s[28:31], s19 offen offset:1024 sc1
  buffer_load_dwordx4 v[68:71], v2, s[28:31], s19 offen offset:2048 sc1
  s_waitcnt vmcnt(0)
  v_max_u32 v4, v60, v61
  v_max3_u32 v4, v62, v63, v4
  v_max3_u32 v4, v64, v65, v4
  v_max3_u32 v4, v66, v67, v4
  v_max3_u32 v4, v68, v69, v4
  v_max3_u32 v4, v70, v71, v4
  v_cmp_eq_u32 vcc, -1, v4
  s_nop 4
  s_cbranch_vccnz kt_tail_kernel_fx3
  s_branch kt_tail_kernel_fx3r
kt_tail_kernel_fx6:
  s_sleep 2
  s_sub_u32 s9, s9, 1
  s_cmp_eq_u32 s9, 0
  s_cbranch_scc1 kt_tail_kernel_fx6r
  s_add_u32 s19, s18, 6144
  buffer_load_dwordx4 v[72:75], v2, s[28:31], s19 offen offset:0 sc1
  buffer_load_dwordx4 v[76:79], v2, s[28:31], s19 offen offset:1024 sc1
  buffer_load_dwordx4 v[80:83], v2, s[28:31], s19 offen offset:2048 sc1
  buffer_load_dwordx4 v[84:87], v2, s[28:31], s19 offen offset:3072 sc1
  s_waitcnt vmcnt(0)
  v_max_u32 v4, v72, v73
  v_max3_u32 v4, v74, v75, v4
  v_max3_u32 v4, v76, v77, v4
  v_max3_u32 v4, v78, v79, v4
  v_max3_u32 v4, v80, v81, v4
  v_max3_u32 v4, v82, v83, v4
  v_max3_u32 v4, v84, v85, v4
  v_max3_u32 v4, v86, v87, v4
  v_cmp_eq_u32 vcc, -1, v4
  s_nop 4
  s_cbranch_vccnz kt_tail_kernel_fx6
  s_branch kt_tail_kernel_fx6r
kt_tail_kernel_fx10:
  s_sleep 2
  s_sub_u32 s9, s9, 1
  s_cmp_eq_u32 s9, 0
  s_cbranch_scc1 kt_tail_kernel_fx10r
  s_add_u32 s19, s18, 10240
  buffer_load_dwordx4 v[88:91], v2, s[28:31], s19 offen offset:0 sc1
  buffer_load_dwordx4 v[92:95], v2, s[28:31], s19 offen offset:1024 sc1
  buffer_load_dwordx4 v[96:99], v2, s[28:31], s19 offen offset:2048 sc1
  buffer_load_dwordx4 v[100:103], v2, s[28:31], s19 offen offset:3072 sc1
  s_waitcnt vmcnt(0)
  v_max_u32 v4, v88, v89
  v_max3_u32 v4, v90, v91, v4
  v_max3_u32 v4, v92, v93, v4
  v_max3_u32 v4, v94, v95, v4
  v_max3_u32 v4, v96, v97, v4
  v_max3_u32 v4, v98, v99, v4
  v_max3_u32 v4, v100, v101, v4
  v_max3_u32 v4, v102, v103, v4
  v_cmp_eq_u32 vcc, -1, v4
  s_nop 4
  s_cbranch_vccnz kt_tail_kernel_fx10
  s_branch kt_tail_kernel_fx10r
kt_tail_kernel_fx14:
  s_sleep 2
  s_sub_u32 s9, s9, 1
  s_cmp_eq_u32 s9, 0
  s_cbranch_scc1 kt_tail_kernel_fx14r
  s_add_u32 s19, s18, 14336
  buffer_load_dwordx4 v[104:107], v2, s[28:31], s19 offen offset:0 sc1
  buffer_load_dwordx4 v[108:111], v2, s[28:31], s19 offen offset:1024 sc1
  buffer_load_dwordx4 v[112:115], v2, s[28:31], s19 offen offset:2048 sc1
  buffer_load_dwordx4 v[116:119], v2, s[28:31], s19 offen offset:3072 sc1
  s_waitcnt vmcnt(0)
  v_max_u32 v4, v104, v105
  v_max3_u32 v4, v106, v107, v4
  v_max3_u32 v4, v108, v109, v4
  v_max3_u32 v4, v110, v111, v4
  v_max3_u32 v4, v112, v113, v4
  v_max3_u32 v4, v114, v115, v4
  v_max3_u32 v4, v116, v117, v4
  v_max3_u32 v4, v118, v119, v4
  v_cmp_eq_u32 vcc, -1, v4
  s_nop 4
  s_cbranch_vccnz kt_tail_kernel_fx14
  s_branch kt_tail_kernel_fx14r
kt_tail_kernel_fx18:
  s_sleep 2
  s_sub_u32 s9, s9, 1
  s_cmp_eq_u32 s9, 0
  s_cbranch_scc1 kt_tail_kernel_fx18r
  s_add_u32 s19, s18, 18432
  buffer_load_dwordx4 v[120:123], v2, s[28:31], s19 offen offset:0 sc1
  buffer_load_dwordx4 v[124:127], v2, s[28:31], s19 offen offset:1024 sc1
  buffer_load_dwordx4 v[128:131], v2, s[28:31], s19 offen offset:2048 sc1
  buffer_load_dwordx4 v[132:135], v2, s[28:31], s19 offen offset:3072 sc1
  s_waitcnt vmcnt(0)
  v_max_u32 v4, v120, v121
  v_max3_u32 v4, v122, v123, v4
  v_max3_u32 v4, v124, v125, v4
  v_max3_u32 v4, v126, v127, v4
  v_max3_u32 v4, v128, v129, v4
  v_max3_u32 v4, v130, v131, v4
  v_max3_u32 v4, v132, v133, v4
  v_max3_u32 v4, v134, v135, v4
  v_cmp_eq_u32 vcc, -1, v4
  s_nop 4
  s_cbranch_vccnz kt_tail_kernel_fx18
  s_branch kt_tail_kernel_fx18r
kt_tail_kernel_fx22:
  s_sleep 2
  s_sub_u32 s9, s9, 1
  s_cmp_eq_u32 s9, 0
  s_cbranch_scc1 kt_tail_kernel_fx22r
  s_add_u32 s19, s18, 22528
  buffer_load_dwordx4 v[136:139], v2, s[28:31], s19 offen offset:0 sc1
  buffer_load_dwordx4 v[140:143], v2, s[28:31], s19 offen offset:1024 sc1
  buffer_load_dwordx4 v[48:51], v2, s[28:31], s19 offen offset:2048 sc1
  buffer_load_dwordx4 v[52:55], v2, s[28:31], s19 offen offset:3072 sc1
  s_waitcnt vmcnt(0)
  v_max_u32 v4, v136, v137
  v_max3_u32 v4, v138, v139, v4
  v_max3_u32 v4, v140, v141, v4
  v_max3_u32 v4, v142, v143, v4
  v_max3_u32 v4, v48, v49, v4
  v_max3_u32 v4, v50, v51, v4
  v_max3_u32 v4, v52, v53, v4
  v_max3_u32 v4, v54, v55, v4
  v_cmp_eq_u32 vcc, -1, v4
  s_nop 4
  s_cbranch_vccnz kt_tail_kernel_fx22
  s_branch kt_tail_kernel_fx22r
kt_tail_kernel_fx26:
  s_sleep 2
  s_sub_u32 s9, s9, 1
  s_cmp_eq_u32 s9, 0
  s_cbranch_scc1 kt_tail_kernel_fx26r
  s_add_u32 s19, s18, 26624
  buffer_load_dwordx4 v[56:59], v2, s[28:31], s19 offen offset:0 sc1
  buffer_load_dwordx4 v[60:63], v2, s[28:31], s19 offen offset:1024 sc1
  buffer_load_dwordx4 v[64:67], v2, s[28:31], s19 offen offset:2048 sc1
  buffer_load_dwordx4 v[68:71], v2, s[28:31], s19 offen offset:3072 sc1
  s_waitcnt vmcnt(0)
  v_max_u32 v4, v56, v57
  v_max3_u32 v4, v58, v59, v4
  v_max3_u32 v4, v60, v61, v4
  v_max3_u32 v4, v62, v63, v4
  v_max3_u32 v4, v64, v65, v4
  v_max3_u32 v4, v66, v67, v4
  v_max3_u32 v4, v68, v69, v4
  v_max3_u32 v4, v70, v71, v4
  v_cmp_eq_u32 vcc, -1, v4
  s_nop 4
  s_cbranch_vccnz kt_tail_kernel_fx26
  s_branch kt_tail_kernel_fx26r
kt_tail_kernel_fx30:
  s_sleep 2
  s_sub_u32 s9, s9, 1
  s_cmp_eq_u32 s9, 0
  s_cbranch_scc1 kt_tail_kernel_fx30r
  s_add_u32 s19, s18, 30720
  buffer_load_dwordx4 v[72:75], v2, s[28:31], s19 offen offset:0 sc1
  buffer_load_dwordx4 v[76:79], v2, s[28:31], s19 offen offset:1024 sc1
  buffer_load_dwordx4 v[80:83], v2, s[28:31], s19 offen offset:2048 sc1
  buffer_load_dwordx4 v[84:87], v2, s[28:31], s19 offen offset:3072 sc1
  s_waitcnt vmcnt(0)
  v_max_u32 v4, v72, v73
  v_max3_u32 v4, v74, v75, v4
  v_max3_u32 v4, v76, v77, v4
  v_max3_u32 v4, v78, v79, v4
  v_max3_u32 v4, v80, v81, v4
  v_max3_u32 v4, v82, v83, v4
  v_max3_u32 v4, v84, v85, v4
  v_max3_u32 v4, v86, v87, v4
  v_cmp_eq_u32 vcc, -1, v4
  s_nop 4
  s_cbranch_vccnz kt_tail_kernel_fx30
  s_branch kt_tail_kernel_fx30r
kt_tail_kernel_fx34:
  s_sleep 2
  s_sub_u32 s9, s9, 1
  s_cmp_eq_u32 s9, 0
  s_cbranch_scc1 kt_tail_kernel_fx34r
  s_add_u32 s19, s18, 34816
  buffer_load_dwordx4 v[88:91], v2, s[28:31], s19 offen offset:0 sc1
  buffer_load_dwordx4 v[92:95], v2, s[28:31], s19 offen offset:1024 sc1
  buffer_load_dwordx4 v[96:99], v2, s[28:31], s19 offen offset:2048 sc1
  buffer_load_dwordx4 v[100:103], v2, s[28:31], s19 offen offset:3072 sc1
  s_waitcnt vmcnt(0)
  v_max_u32 v4, v88, v89
  v_max3_u32 v4, v90, v91, v4
  v_max3_u32 v4, v92, v93, v4
  v_max3_u32 v4, v94, v95, v4
  v_max3_u32 v4, v96, v97, v4
  v_max3_u32 v4, v98, v99, v4
  v_max3_u32 v4, v100, v101, v4
  v_max3_u32 v4, v102, v103, v4
  v_cmp_eq_u32 vcc, -1, v4
  s_nop 4
  s_cbranch_vccnz kt_tail_kernel_fx34
  s_branch kt_tail_kernel_fx34r
kt_tail_kernel_fx38:
  s_sleep 2
  s_sub_u32 s9, s9, 1
  s_cmp_eq_u32 s9, 0
  s_cbranch_scc1 kt_tail_kernel_fx38r
  s_add_u32 s19, s18, 38912
  buffer_load_dwordx4 v[104:107], v2, s[28:31], s19 offen offset:0 sc1
  buffer_load_dwordx4 v[108:111], v2, s[28:31], s19 offen offset:1024 sc1
  buffer_load_dwordx4 v[112:115], v2, s[28:31], s19 offen offset:2048 sc1
  buffer_load_dwordx4 v[116:119], v2, s[28:31], s19 offen offset:3072 sc1
  s_waitcnt vmcnt(0)
  v_max_u32 v4, v104, v105
  v_max3_u32 v4, v106, v107, v4
  v_max3_u32 v4, v108, v109, v4
  v_max3_u32 v4, v110, v111, v4
  v_max3_u32 v4, v112, v113, v4
  v_max3_u32 v4, v114, v115, v4
  v_max3_u32 v4, v116, v117, v4
  v_max3_u32 v4, v118, v119, v4
  v_cmp_eq_u32 vcc, -1, v4
  s_nop 4
  s_cbranch_vccnz kt_tail_kernel_fx38
  s_branch kt_tail_kernel_fx38r
kt_tail_kernel_fx42:
  s_sleep 2
  s_sub_u32 s9, s9, 1
  s_cmp_eq_u32 s9, 0
  s_cbranch_scc1 kt_tail_kernel_fx42r
  s_add_u32 s19, s18, 43008
  buffer_load_dwordx4 v[120:123], v2, s[28:31], s19 offen offset:0 sc1
  buffer_load_dwordx4 v[124:127], v2, s[28:31], s19 offen offset:1024 sc1
  buffer_load_dwordx4 v[128:131], v2, s[28:31], s19 offen offset:2048 sc1
  buffer_load_dwordx4 v[132:135], v2, s[28:31], s19 offen offset:3072 sc1
  s_waitcnt vmcnt(0)
  v_max_u32 v4, v120, v121
  v_max3_u32 v4, v122, v123, v4
  v_max3_u32 v4, v124, v125, v4
  v_max3_u32 v4, v126, v127, v4
  v_max3_u32 v4, v128, v129, v4
  v_max3_u32 v4, v130, v131, v4
  v_max3_u32 v4, v132, v133, v4
  v_max3_u32 v4, v134, v135, v4
  v_cmp_eq_u32 vcc, -1, v4
  s_nop 4
  s_cbranch_vccnz kt_tail_kernel_fx42
  s_branch kt_tail_kernel_fx42r
kt_tail_kernel_fx46:
  s_sleep 2
  s_sub_u32 s9, s9, 1
  s_cmp_eq_u32 s9, 0
  s_cbranch_scc1 kt_tail_kernel_fx46r
  s_add_u32 s19, s18, 47104
  buffer_load_dwordx4 v[136:139], v2, s[28:31], s19 offen offset:0 sc1
  buffer_load_dwordx4 v[140:143], v2, s[28:31], s19 offen offset:1024 sc1
  buffer_load_dwordx4 v[48:51], v2, s[28:31], s19 offen offset:2048 sc1
  buffer_load_dwordx4 v[52:55], v2, s[28:31], s19 offen offset:3072 sc1
  s_waitcnt vmcnt(0)
  v_max_u32 v4, v136, v137
  v_max3_u32 v4, v138, v139, v4
  v_max3_u32 v4, v140, v141, v4
  v_max3_u32 v4, v142, v143, v4
  v_max3_u32 v4, v48, v49, v4
  v_max3_u32 v4, v50, v51, v4
  v_max3_u32 v4, v52, v53, v4
  v_max3_u32 v4, v54, v55, v4
  v_cmp_eq_u32 vcc, -1, v4
  s_nop 4
  s_cbranch_vccnz kt_tail_kernel_fx46
  s_branch kt_tail_kernel_fx46r
kt_tail_kernel_fx50:
  s_sleep 2
  s_sub_u32 s9, s9, 1
  s_cmp_eq_u32 s9, 0
  s_cbranch_scc1 kt_tail_kernel_fx50r
  s_add_u32 s19, s18, 51200
  buffer_load_dwordx4 v[56:59], v2, s[28:31], s19 offen offset:0 sc1
  buffer_load_dwordx4 v[60:63], v2, s[28:31], s19 offen offset:1024 sc1
  buffer_load_dwordx4 v[64:67], v2, s[28:31], s19 offen offset:2048 sc1
  buffer_load_dwordx4 v[68:71], v2, s[28:31], s19 offen offset:3072 sc1
  s_waitcnt vmcnt(0)
  v_max_u32 v4, v56, v57
  v_max3_u32 v4, v58, v59, v4
  v_max3_u32 v4, v60, v61, v4
  v_max3_u32 v4, v62, v63, v4
  v_max3_u32 v4, v64, v65, v4
  v_max3_u32 v4, v66, v67, v4
  v_max3_u32 v4, v68, v69, v4
  v_max3_u32 v4, v70, v71, v4
  v_cmp_eq_u32 vcc, -1, v4
  s_nop 4
  s_cbranch_vccnz kt_tail_kernel_fx50
  s_branch kt_tail_kernel_fx50r
kt_tail_kernel_fx54:
  s_sleep 2
  s_sub_u32 s9, s9, 1
  s_cmp_eq_u32 s9, 0
  s_cbranch_scc1 kt_tail_kernel_fx54r
  s_add_u32 s19, s18, 55296
  buffer_load_dwordx4 v[72:75], v2, s[28:31], s19 offen offset:0 sc1
  buffer_load_dwordx4 v[76:79], v2, s[28:31], s19 offen offset:1024 sc1
  buffer_load_dwordx4 v[80:83], v2, s[28:31], s19 offen offset:2048 sc1
  buffer_load_dwordx4 v[84:87], v2, s[28:31], s19 offen offset:3072 sc1
  s_waitcnt vmcnt(0)
  v_max_u32 v4, v72, v73
  v_max3_u32 v4, v74, v75, v4
  v_max3_u32 v4, v76, v77, v4
  v_max3_u32 v4, v78, v79, v4
  v_max3_u32 v4, v80, v81, v4
  v_max3_u32 v4, v82, v83, v4
  v_max3_u32 v4, v84, v85, v4
  v_max3_u32 v4, v86, v87, v4
  v_cmp_eq_u32 vcc, -1, v4
  s_nop 4
  s_cbranch_vccnz kt_tail_kernel_fx54
  s_branch kt_tail_kernel_fx54r
kt_tail_kernel_fx58:
  s_sleep 2
  s_sub_u32 s9, s9, 1
  s_cmp_eq_u32 s9, 0
  s_cbranch_scc1 kt_tail_kernel_fx58r
  s_add_u32 s19, s18, 59392
  buffer_load_dwordx4 v[88:91], v2, s[28:31], s19 offen offset:0 sc1
  buffer_load_dwordx4 v[92:95], v2, s[28:31], s19 offen offset:1024 sc1
  buffer_load_dwordx4 v[96:99], v2, s[28:31], s19 offen offset:2048 sc1
  buffer_load_dwordx4 v[100:103], v2, s[28:31], s19 offen offset:3072 sc1
  s_waitcnt vmcnt(0)
  v_max_u32 v4, v88, v89
  v_max3_u32 v4, v90, v91, v4
  v_max3_u32 v4, v92, v93, v4
  v_max3_u32 v4, v94, v95, v4
  v_max3_u32 v4, v96, v97, v4
  v_max3_u32 v4, v98, v99, v4
  v_max3_u32 v4, v100, v101, v4
  v_max3_u32 v4, v102, v103, v4
  v_cmp_eq_u32 vcc, -1, v4
  s_nop 4
  s_cbranch_vccnz kt_tail_kernel_fx58
  s_branch kt_tail_kernel_fx58r
kt_tail_kernel_fx62:
  s_sleep 2
  s_sub_u32 s9, s9, 1
  s_cmp_eq_u32 s9, 0
  s_cbranch_scc1 kt_tail_kernel_fx62r
  s_add_u32 s19, s18, 63488
  buffer_load_dwordx4 v[104:107], v2, s[28:31], s19 offen offset:0 sc1
  buffer_load_dwordx4 v[108:111], v2, s[28:31], s19 offen offset:1024 sc1
  buffer_load_dwordx4 v[112:115], v2, s[28:31], s19 offen offset:2048 sc1
  buffer_load_dwordx4 v[116:119], v2, s[28:31], s19 offen offset:3072 sc1
  s_waitcnt vmcnt(0)
  v_max_u32 v4, v104, v105
  v_max3_u32 v4, v106, v107, v4
  v_max3_u32 v4, v108, v109, v4
  v_max3_u32 v4, v110, v111, v4
  v_max3_u32 v4, v112, v113, v4
  v_max3_u32 v4, v114, v115, v4
  v_max3_u32 v4, v116, v117, v4
  v_max3_u32 v4, v118, v119, v4
  v_cmp_eq_u32 vcc, -1, v4
  s_nop 4
  s_cbranch_vccnz kt_tail_kernel_fx62
  s_branch kt_tail_kernel_fx62r
kt_tail_kernel_fx66:
  s_sleep 2
  s_sub_u32 s9, s9, 1
  s_cmp_eq_u32 s9, 0
  s_cbranch_scc1 kt_tail_kernel_fx66r
  s_add_u32 s19, s18, 67584
  buffer_load_dwordx4 v[120:123], v2, s[28:31], s19 offen offset:0 sc1
  buffer_load_dwordx4 v[124:127], v2, s[28:31], s19 offen offset:1024 sc1
  buffer_load_dwordx4 v[128:131], v2, s[28:31], s19 offen offset:2048 sc1
  s_waitcnt vmcnt(0)
  v_max_u32 v4, v120, v121
  v_max3_u32 v4, v122, v123, v4
  v_max3_u32 v4, v124, v125, v4
  v_max3_u32 v4, v126, v127, v4
  v_max3_u32 v4, v128, v129, v4
  v_max3_u32 v4, v130, v131, v4
  v_cmp_eq_u32 vcc, -1, v4
  s_nop 4
  s_cbranch_vccnz kt_tail_kernel_fx66
  s_branch kt_tail_kernel_fx66r
kt_tail_kernel_fx69:
  s_sleep 2
  s_sub_u32 s9, s9, 1
  s_cmp_eq_u32 s9, 0
  s_cbranch_scc1 kt_tail_kernel_fx69r
  s_add_u32 s19, s18, 70656
  buffer_load_dwordx4 v[132:135], v2, s[28:31], s19 offen offset:0 sc1
  buffer_load_dwordx4 v[136:139], v2, s[28:31], s19 offen offset:1024 sc1
  buffer_load_dwordx4 v[140:143], v2, s[28:31], s19 offen offset:2048 sc1
  s_waitcnt vmcnt(0)
  v_max_u32 v4, v132, v133
  v_max3_u32 v4, v134, v135, v4
  v_max3_u32 v4, v136, v137, v4
  v_max3_u32 v4, v138, v139, v4
  v_max3_u32 v4, v140, v141, v4
  v_max3_u32 v4, v142, v143, v4
  v_cmp_eq_u32 vcc, -1, v4
  s_nop 4
  s_cbranch_vccnz kt_tail_kernel_fx69
  s_branch kt_tail_kernel_fx69r
kt_tail_kernel_end:
  s_endpgm
code_end:
    s_endpgm
.fill 1024, 4, 0xbf810000
.section .rodata,"a"
.p2align 6
.amdhsa_kernel k1_prep_kernel
  .amdhsa_next_free_vgpr 80
  .amdhsa_next_free_sgpr 100
  .amdhsa_accum_offset 80
  .amdhsa_group_segment_fixed_size 0
  .amdhsa_kernarg_size 120
  .amdhsa_user_sgpr_count 2
  .amdhsa_user_sgpr_kernarg_segment_ptr 1
  .amdhsa_system_sgpr_workgroup_id_x 1
  .amdhsa_float_denorm_mode_32 3
.end_amdhsa_kernel
.section .rodata,"a"
.p2align 6
.amdhsa_kernel kf_front_kernel
  .amdhsa_next_free_vgpr 168
  .amdhsa_next_free_sgpr 100
  .amdhsa_accum_offset 168
  .amdhsa_group_segment_fixed_size 0
  .amdhsa_kernarg_size 120
  .amdhsa_user_sgpr_count 2
  .amdhsa_user_sgpr_kernarg_segment_ptr 1
  .amdhsa_system_sgpr_workgroup_id_x 1
  .amdhsa_float_denorm_mode_32 3
.end_amdhsa_kernel
.section .rodata,"a"
.p2align 6
.amdhsa_kernel kt_tail_kernel
  .amdhsa_next_free_vgpr 512
  .amdhsa_next_free_sgpr 100
  .amdhsa_accum_offset 256
  .amdhsa_group_segment_fixed_size 0
  .amdhsa_kernarg_size 120
  .amdhsa_user_sgpr_count 2
  .amdhsa_user_sgpr_kernarg_segment_ptr 1
  .amdhsa_system_sgpr_workgroup_id_x 1
  .amdhsa_float_denorm_mode_32 3
.end_amdhsa_kernel
```
